```python
import torch

def _softmax(x, axis=-1):
    return torch.softmax(x, dim=axis)

def _gelu(x):
    return torch.nn.functional.gelu(x, approximate='tanh')

def _silu(x):
    return torch.nn.functional.silu(x)

def _sigmoid(x):
    return torch.sigmoid(x)

def _layernorm(x, axis=-1, eps=1e-05):
    m = x.mean(dim=axis, keepdim=True)
    v = x.var(dim=axis, keepdim=True, unbiased=False)
    return (x - m) / torch.sqrt(v + eps)

def _scatter_add(tgt, idx, src, axis=0):
    return tgt.clone().index_add_(axis, idx, src)

def _segment_sum(src, seg, n):
    out = torch.zeros((n,) + src.shape[1:], dtype=src.dtype)
    return out.index_add_(0, seg, src)

def _pad(x, pw):
    flat = tuple((v for pair in reversed(pw) for v in pair))
    return torch.nn.functional.pad(x, flat)
kernel_name = 'adaLN_cond__memory_aug_recurrent_mem_tr__mixer_channel_mlp__prompt'

def setup_inputs():

    _w = lambda a: (lambda t: t.to(torch.bfloat16) if t.is_floating_point() else t)(torch.as_tensor(a))

    def _A_setup():
        B, S, Dm = (1, 2048, 640)
        H, Dh = (32, 128)
        M, seg = (8, 32)
        seg = min(seg, S)
        S = S // seg * seg
        return {'x': _w((lambda *s: torch.randn(*s, dtype=torch.bfloat16) * 0.05)(B, S, Dm)), 'mem0': _w((lambda *s: torch.randn(*s, dtype=torch.bfloat16) * 0.4)(B, M, Dm)), 'Wq': _w((lambda *s: torch.randn(*s, dtype=torch.bfloat16) * 1.6)(Dm, H, Dh) * Dm ** (-0.5)), 'Wk': _w((lambda *s: torch.randn(*s, dtype=torch.bfloat16) * 1.6)(Dm, H, Dh) * Dm ** (-0.5)), 'Wv': _w((lambda *s: torch.randn(*s, dtype=torch.bfloat16) * 0.4)(Dm, H, Dh) * Dm ** (-0.5)), 'Wo': _w((lambda *s: torch.randn(*s, dtype=torch.bfloat16) * 0.4)(H, Dh, Dm) * (H * Dh) ** (-0.5)), 'seg_len': seg}
    _A_in = _A_setup()

    def _B_setup():
        B, S, D, F = (1, 2048, 640, 1728)
        return {'x': _w((lambda *s: torch.randn(*s, dtype=torch.bfloat16) * 0.05)(B, S, D)), 'w1': _w((lambda *s: torch.randn(*s, dtype=torch.bfloat16) * 1.6)(D, F) * D ** (-0.5)), 'b1': _w((lambda *s: torch.randn(*s, dtype=torch.bfloat16) * 0.8)(F)), 'w2': _w((lambda *s: torch.randn(*s, dtype=torch.bfloat16) * 0.1)(F, D) * F ** (-0.5)), 'b2': _w((lambda *s: torch.randn(*s, dtype=torch.bfloat16) * 0.1)(D))}
    _B_in = _B_setup()
    return {'A_x': _A_in['x'], 'A_mem0': _A_in['mem0'], 'A_Wq': _A_in['Wq'], 'A_Wk': _A_in['Wk'], 'A_Wv': _A_in['Wv'], 'A_Wo': _A_in['Wo'], 'A_seg_len': _A_in['seg_len'], 'B_x': _B_in['x'], 'B_w1': _B_in['w1'], 'B_b1': _B_in['b1'], 'B_w2': _B_in['w2'], 'B_b2': _B_in['b2'], 'c': _w((lambda *s: torch.randn(*s, dtype=torch.bfloat16) * 0.1)(1, 640) * 8.0), 'w_mod': _w((lambda *s: torch.randn(*s, dtype=torch.bfloat16) * 0.1)(640, 6 * 640) * 640 ** (-0.5) * 8.0)}

def reference(A_x, A_mem0, A_Wq, A_Wk, A_Wv, A_Wo, A_seg_len, B_x, B_w1, B_b1, B_w2, B_b2, c, w_mod):

    def _A_ref(x, mem0, Wq, Wk, Wv, Wo, seg_len):
        B, S, Dm = x.shape
        H, Dh = (Wq.shape[1], Wq.shape[2])
        M = mem0.shape[1]
        scale = Dh ** (-0.5)
        n_seg = S // seg_len
        L = M + seg_len
        idx = torch.arange(L)
        mask = (idx[:, None] < M) | (idx[:, None] >= idx[None, :])
        mem = mem0
        outs = []
        for s in range(n_seg):
            xs = x[:, s * seg_len:(s + 1) * seg_len, :].clone()
            h = torch.concatenate([mem, xs], axis=1)
            q = torch.einsum('btd,dhe->bhte', h, Wq)
            k = torch.einsum('btd,dhe->bhte', h, Wk)
            v = torch.einsum('btd,dhe->bhte', h, Wv)
            scores = torch.einsum('bhqe,bhke->bhqk', q, k) * scale
            scores = torch.where(mask[None, None], scores, -1000000000.0)
            p = _softmax(scores, axis=-1)
            o = torch.einsum('bhqk,bhke->bhqe', p, v)
            o = torch.einsum('bhte,hed->btd', o, Wo)
            mem = o[:, :M, :].clone()
            outs.append(o[:, M:, :])
        return torch.concatenate(outs, axis=1)

    def _B_ref(x, w1, b1, w2, b2):
        y = _layernorm(x, axis=-1)
        h = _gelu(torch.einsum('bsd,df->bsf', y, w1) + b1)
        return torch.einsum('bsf,fd->bsd', h, w2) + b2
    x = A_x
    mod = (_silu(c) @ w_mod).reshape(c.shape[0], 6, 1, -1)
    sa, ca, ga, sb, cb, gb = (mod[:, 0].clone(), mod[:, 1].clone(), mod[:, 2].clone(), mod[:, 3].clone(), mod[:, 4].clone(), mod[:, 5].clone())
    h = _layernorm(x, axis=-1) * (1 + ca) + sa
    x = x + ga * _A_ref(h, A_mem0, A_Wq, A_Wk, A_Wv, A_Wo, A_seg_len)
    h = _layernorm(x, axis=-1) * (1 + cb) + sb
    x = x + gb * _B_ref(h, B_w1, B_b1, B_w2, B_b2)
    return x
```

```asm
; @launch grid=(256,1,1) block=(256,1,1) lds=163840
.amdgcn_target "amdgcn-amd-amdhsa--gfx950"
.text
.globl adaLN_cond__memory_aug_recurrent_mem_tr__mixer_channel_mlp__prompt_kernel
.p2align 8
.type adaLN_cond__memory_aug_recurrent_mem_tr__mixer_channel_mlp__prompt_kernel,@function
adaLN_cond__memory_aug_recurrent_mem_tr__mixer_channel_mlp__prompt_kernel:
    s_cmp_ge_u32 s2, 256
    s_cbranch_scc1 L_end
    s_load_dwordx4 s[72:75], s[0:1], 120
    s_load_dwordx4 s[36:39], s[0:1], 16
    s_load_dwordx2 s[40:41], s[0:1], 32
    s_load_dwordx2 s[42:43], s[0:1], 0
    s_load_dwordx2 s[44:45], s[0:1], 104
    s_getreg_b32 s3, hwreg(HW_REG_XCC_ID, 0, 3)
    v_lshrrev_b32 v1, 6, v0
    v_and_b32 v6, 63, v0
    v_readfirstlane_b32 s13, v1
    s_lshr_b32 s25, s2, 3
    s_mov_b32 s11, 0x20000
    s_cmp_lg_u32 s13, 1
    s_cbranch_scc1 L_nopf
    s_getpc_b64 s[8:9]
L_pc:
    s_mov_b32 s10, L_code_end-L_pc
    s_lshl_b32 s24, s25, 12
    v_and_b32 v5, 31, v0
    v_lshlrev_b32 v5, 7, v5
    v_add_u32 v5, s24, v5
    buffer_load_dword a255, v5, s[8:11], 0 offen
L_nopf:
    s_lshl_b32 s3, s3, 2
    s_lshr_b32 s3, 1983009808, s3
    s_and_b32 s3, s3, 7
    v_mov_b32 v3, 0
    s_mov_b32 s6, 268435456
    s_mov_b32 s7, 0x20000
    s_mov_b32 s15, 300000
    s_lshl_b32 s24, s3, 5
    s_mov_b32 s26, 1
    s_waitcnt lgkmcnt(0)
    s_mov_b32 s4, s74
    s_mov_b32 s5, s75
    s_mov_b32 s74, 256
    s_mov_b32 s75, 0x20000
    s_cmp_lg_u32 s13, 0
    s_cbranch_scc1 L_not0
    s_atomic_add s26, s[72:73], s24 glc
    s_waitcnt lgkmcnt(0)
    v_mov_b32 v2, s26
    ds_write_b32 v3, v2
    s_waitcnt lgkmcnt(0)
    s_branch L_tick
L_not0:
L_tick:
    s_barrier
    v_and_b32 v0, 63, v0
    ds_read_b32 v4, v3
    s_waitcnt lgkmcnt(0)
    v_readfirstlane_b32 s12, v4
    s_barrier
    s_cmp_lt_u32 s12, 32
    s_cbranch_scc1 L_placed
    v_mbcnt_lo_u32_b32 v5, -1, 0
    v_and_b32 v5, 7, v5
    v_lshlrev_b32 v5, 5, v5
Lcen1:
    buffer_load_dword v4, v5, s[72:75], 0 offen sc1
    s_waitcnt vmcnt(0)
    v_mov_b32 v6, v4
    s_nop 1
    v_add_u32_dpp v6, v6, v6 row_ror:1 row_mask:0xf bank_mask:0xf
    s_nop 1
    v_add_u32_dpp v6, v6, v6 row_ror:2 row_mask:0xf bank_mask:0xf
    s_nop 1
    v_add_u32_dpp v6, v6, v6 row_ror:4 row_mask:0xf bank_mask:0xf
    s_nop 0
    v_readfirstlane_b32 s24, v6
    s_nop 3
    s_cmp_ge_u32 s24, 256
    s_cbranch_scc1 Lcen1d
    s_sub_u32 s15, s15, 1
    s_cbranch_scc0 Lcen1
    s_mov_b32 s15, 0
Lcen1d:
    s_cmp_lg_u32 s13, 0
    s_cbranch_scc1 L_ov1
    v_mov_b32 v2, 1
    s_mov_b64 exec, 1
    buffer_atomic_add v2, off, s[72:75], 0 offset:44 sc0
    s_waitcnt vmcnt(0)
    ds_write_b32 v3, v2
    s_waitcnt lgkmcnt(0)
    s_mov_b64 exec, -1
L_ov1:
    s_barrier
    ds_read_b32 v2, v3
    s_waitcnt lgkmcnt(0)
    v_readfirstlane_b32 s25, v2
    s_barrier
    v_readlane_b32 s26, v4, 0
    s_nop 3
    s_min_u32 s26, s26, 32
    s_add_u32 s12, s26, s25
    s_mov_b32 s3, 0
    s_cmp_lt_u32 s12, 32
    s_cbranch_scc1 L_placed
    s_sub_u32 s25, s12, 32
    v_readlane_b32 s26, v4, 1
    s_nop 3
    s_min_u32 s26, s26, 32
    s_add_u32 s12, s26, s25
    s_mov_b32 s3, 1
    s_cmp_lt_u32 s12, 32
    s_cbranch_scc1 L_placed
    s_sub_u32 s25, s12, 32
    v_readlane_b32 s26, v4, 2
    s_nop 3
    s_min_u32 s26, s26, 32
    s_add_u32 s12, s26, s25
    s_mov_b32 s3, 2
    s_cmp_lt_u32 s12, 32
    s_cbranch_scc1 L_placed
    s_sub_u32 s25, s12, 32
    v_readlane_b32 s26, v4, 3
    s_nop 3
    s_min_u32 s26, s26, 32
    s_add_u32 s12, s26, s25
    s_mov_b32 s3, 3
    s_cmp_lt_u32 s12, 32
    s_cbranch_scc1 L_placed
    s_sub_u32 s25, s12, 32
    v_readlane_b32 s26, v4, 4
    s_nop 3
    s_min_u32 s26, s26, 32
    s_add_u32 s12, s26, s25
    s_mov_b32 s3, 4
    s_cmp_lt_u32 s12, 32
    s_cbranch_scc1 L_placed
    s_sub_u32 s25, s12, 32
    v_readlane_b32 s26, v4, 5
    s_nop 3
    s_min_u32 s26, s26, 32
    s_add_u32 s12, s26, s25
    s_mov_b32 s3, 5
    s_cmp_lt_u32 s12, 32
    s_cbranch_scc1 L_placed
    s_sub_u32 s25, s12, 32
    v_readlane_b32 s26, v4, 6
    s_nop 3
    s_min_u32 s26, s26, 32
    s_add_u32 s12, s26, s25
    s_mov_b32 s3, 6
    s_cmp_lt_u32 s12, 32
    s_cbranch_scc1 L_placed
    s_sub_u32 s25, s12, 32
    v_readlane_b32 s26, v4, 7
    s_nop 3
    s_min_u32 s26, s26, 32
    s_add_u32 s12, s26, s25
    s_mov_b32 s3, 7
    s_cmp_lt_u32 s12, 32
    s_cbranch_scc1 L_placed
    s_sub_u32 s25, s12, 32
    s_endpgm
L_placed:
    s_cmp_lt_u32 s3, 2
    s_cbranch_scc1 L_chain
    s_cmp_lt_u32 s3, 4
    s_cbranch_scc1 L_proj
    s_branch L_post
L_end:
    s_endpgm
L_proj:
    s_add_u32 s12, s12, 24
    s_and_b32 s12, s12, 31
    s_cmp_lt_u32 s12, 24
    s_cbranch_scc1 Lgo2
    s_sub_u32 s16, s12, 24
    s_lshl_b32 s16, s16, 1
    s_add_u32 s16, s16, s3
    s_sub_u32 s16, s16, 1
    s_cmp_gt_u32 s16, 14
    s_cbranch_scc1 Lsv5
    s_lshl_b32 s17, s13, 6
    v_add_u32 v2, s17, v0
    v_lshlrev_b32 v1, 4, v2
    s_cmp_le_u32 s16, 2
    s_cselect_b32 s19, 48, 56
    s_sub_u32 s20, s16, 1
    s_lshl_b32 s20, s20, 15
    s_sub_u32 s16, s16, 3
    s_cmp_le_u32 s16, 1
    s_cbranch_scc1 Lsv3
    s_sub_u32 s17, s16, 2
    s_and_b32 s18, s17, 1
    s_lshl_b32 s18, s18, 19
    s_lshr_b32 s17, s17, 1
    s_lshl_b32 s17, s17, 15
    s_add_u32 s17, s17, s18
    s_add_u32 s17, s17, 1048576
    s_cmp_eq_u32 s19, 48
    s_cselect_b32 s17, s20, s17
    v_mov_b64 v[4:5], 0
    v_mov_b64 v[6:7], 0
    buffer_store_dwordx4 v[4:7], v1, s[4:7], s17 offen sc1
    s_add_u32 s17, s17, 4096
    buffer_store_dwordx4 v[4:7], v1, s[4:7], s17 offen sc1
    s_add_u32 s17, s17, 4096
    buffer_store_dwordx4 v[4:7], v1, s[4:7], s17 offen sc1
    s_add_u32 s17, s17, 4096
    buffer_store_dwordx4 v[4:7], v1, s[4:7], s17 offen sc1
    s_add_u32 s17, s17, 4096
    buffer_store_dwordx4 v[4:7], v1, s[4:7], s17 offen sc1
    s_add_u32 s17, s17, 4096
    buffer_store_dwordx4 v[4:7], v1, s[4:7], s17 offen sc1
    s_add_u32 s17, s17, 4096
    buffer_store_dwordx4 v[4:7], v1, s[4:7], s17 offen sc1
    s_add_u32 s17, s17, 4096
    buffer_store_dwordx4 v[4:7], v1, s[4:7], s17 offen sc1
    s_add_u32 s17, s17, 4096
    s_branch Lsv4
Lsv3:
    s_load_dwordx2 s[8:9], s[0:1], 8
    s_waitcnt lgkmcnt(0)
    s_mov_b32 s10, 10240
    s_mov_b32 s11, 0x20000
    s_mul_i32 s18, s16, 640
    v_bfe_u32 v3, v2, 1, 3
    v_mul_u32_u24 v3, 1280, v3
    v_lshrrev_b32 v4, 4, v2
    v_lshl_add_u32 v3, v4, 5, v3
    v_and_b32 v4, 1, v2
    v_lshl_add_u32 v3, v4, 4, v3
    v_add_u32 v3, s18, v3
    buffer_load_dwordx4 v[8:11], v3, s[8:11], 0 offen
    buffer_load_dwordx4 v[12:15], v3, s[8:11], 0 offen offset:512
    v_mov_b64 v[4:5], -1
    v_mov_b64 v[6:7], -1
    s_lshl_b32 s16, s16, 17
    s_add_u32 s17, s16, 147456
    buffer_store_dwordx4 v[4:7], v1, s[4:7], s17 offen sc1
    s_add_u32 s17, s16, 151552
    buffer_store_dwordx4 v[4:7], v1, s[4:7], s17 offen sc1
    s_add_u32 s17, s16, 163840
    buffer_store_dwordx4 v[4:7], v1, s[4:7], s17 offen sc1
    s_add_u32 s17, s16, 167936
    buffer_store_dwordx4 v[4:7], v1, s[4:7], s17 offen sc1
    s_add_u32 s17, s16, 180224
    buffer_store_dwordx4 v[4:7], v1, s[4:7], s17 offen sc1
    s_add_u32 s17, s16, 184320
    buffer_store_dwordx4 v[4:7], v1, s[4:7], s17 offen sc1
    s_add_u32 s17, s16, 131072
    s_waitcnt vmcnt(7)
    buffer_store_dwordx4 v[8:11], v1, s[4:7], s17 offen sc1
    s_add_u32 s17, s16, 135168
    s_waitcnt vmcnt(7)
    buffer_store_dwordx4 v[12:15], v1, s[4:7], s17 offen sc1
    s_add_u32 s17, s16, 2113536
    buffer_store_dwordx4 v[4:7], v1, s[4:7], s17 offen sc1
    s_add_u32 s17, s16, 2117632
    buffer_store_dwordx4 v[4:7], v1, s[4:7], s17 offen sc1
    s_add_u32 s17, s16, 2129920
    buffer_store_dwordx4 v[4:7], v1, s[4:7], s17 offen sc1
    s_add_u32 s17, s16, 2134016
    buffer_store_dwordx4 v[4:7], v1, s[4:7], s17 offen sc1
    s_add_u32 s17, s16, 2146304
    buffer_store_dwordx4 v[4:7], v1, s[4:7], s17 offen sc1
    s_add_u32 s17, s16, 2150400
    buffer_store_dwordx4 v[4:7], v1, s[4:7], s17 offen sc1
    s_add_u32 s17, s16, 2097152
    buffer_store_dwordx4 v[8:11], v1, s[4:7], s17 offen sc1
    s_add_u32 s17, s16, 2101248
    buffer_store_dwordx4 v[12:15], v1, s[4:7], s17 offen sc1
    s_add_u32 s17, s16, 2121728
    buffer_store_dwordx4 v[4:7], v1, s[4:7], s17 offen sc1
    s_add_u32 s17, s16, 2125824
    buffer_store_dwordx4 v[4:7], v1, s[4:7], s17 offen sc1
    s_add_u32 s17, s16, 2138112
    buffer_store_dwordx4 v[4:7], v1, s[4:7], s17 offen sc1
    s_add_u32 s17, s16, 2142208
    buffer_store_dwordx4 v[4:7], v1, s[4:7], s17 offen sc1
    s_add_u32 s17, s16, 2154496
    buffer_store_dwordx4 v[4:7], v1, s[4:7], s17 offen sc1
    s_add_u32 s17, s16, 2158592
    buffer_store_dwordx4 v[4:7], v1, s[4:7], s17 offen sc1
    s_add_u32 s17, s16, 2105344
    buffer_store_dwordx4 v[8:11], v1, s[4:7], s17 offen sc1
    s_add_u32 s17, s16, 2109440
    buffer_store_dwordx4 v[12:15], v1, s[4:7], s17 offen sc1
Lsv4:
    s_waitcnt vmcnt(0)
    s_barrier
    s_cmp_lg_u32 s13, 0
    s_cbranch_scc1 Lsv5
    v_mov_b32 v2, 1
    s_mov_b64 exec, 1
    buffer_atomic_add v2, off, s[72:75], s19
    s_mov_b64 exec, -1
Lsv5:
    s_and_b32 s16, s12, 1
    s_cselect_b64 s[8:9], s[40:41], s[38:39]
    s_mov_b32 s10, 5242880
    s_mov_b32 s11, 0x20000
    s_and_b32 s16, s12, 6
    s_lshl_b32 s16, s16, 9
    s_and_b32 s17, s3, 1
    s_lshl_b32 s17, s17, 12
    s_add_u32 s16, s16, s17
    s_and_b32 s17, s13, 1
    s_lshl_b32 s17, s17, 7
    s_add_u32 s16, s16, s17
    s_lshr_b32 s17, s13, 1
    s_mul_i32 s17, s17, 2621440
    s_add_u32 s16, s16, s17
    v_lshlrev_b32 v1, 13, v0
    s_add_u32 s17, s16, 1048832
    buffer_load_dword v2, v1, s[8:11], s17 offen
    s_add_u32 s17, s16, 1573120
    buffer_load_dword v2, v1, s[8:11], s17 offen
    s_add_u32 s17, s16, 2097408
    buffer_load_dword v2, v1, s[8:11], s17 offen
    s_endpgm
Lgo2:
    s_load_dwordx4 s[36:39], s[0:1], 16
    s_load_dwordx2 s[40:41], s[0:1], 32
    s_sub_u32 s24, s3, 2
    s_and_b32 s25, s13, 1
    s_waitcnt lgkmcnt(0)
    s_mov_b32 s10, 5242880
    s_mov_b32 s11, 0x20000
    s_cmp_ge_u32 s12, 16
    s_cbranch_scc1 Lisq6
    s_lshl_b32 s24, s24, 4
    s_add_u32 s24, s24, s12
    s_lshr_b32 s28, s13, 1
    s_cmp_eq_u32 s28, 0
    s_cselect_b64 s[8:9], s[38:39], s[40:41]
    s_cselect_b32 s17, 10, 12
    s_lshl_b32 s17, s25, s17
    s_lshl_b32 s16, s28, 14
    s_add_u32 s17, s17, s16
    s_lshl_b32 s16, s24, 15
    s_add_u32 s17, s17, s16
    s_add_u32 s17, s17, 8396800
    s_lshl_b32 s16, s24, 8
    s_lshl_b32 s25, s25, 7
    s_add_u32 s16, s16, s25
    s_lshl_b32 s21, s24, 7
    s_lshl_b32 s24, s13, 4
    s_add_u32 s21, s21, s24
    s_branch Lprm7
Lisq6:
    s_mov_b32 s28, 2
    s_mov_b64 s[8:9], s[36:37]
    s_lshl_b32 s24, s24, 3
    s_add_u32 s24, s24, s12
    s_sub_u32 s24, s24, 16
    s_lshl_b32 s24, s24, 1
    s_lshr_b32 s23, s13, 1
    s_add_u32 s24, s24, s23
    s_lshl_b32 s21, s24, 7
    s_lshl_b32 s16, s25, 4
    s_add_u32 s21, s21, s16
    s_add_u32 s21, s21, 64
    s_lshl_b32 s17, s24, 15
    s_lshl_b32 s16, s25, 11
    s_add_u32 s17, s17, s16
    s_add_u32 s17, s17, 8388608
    s_lshl_b32 s16, s24, 8
    s_lshl_b32 s25, s25, 7
    s_add_u32 s16, s16, s25
Lprm7:
    s_add_u32 s21, s21, 0
    s_mov_b32 s19, 4194304
    s_mov_b32 s20, 40960
    s_mov_b32 s23, 64
    s_mul_i32 s24, s13, 10240
    s_add_u32 s19, s19, s24
    s_mov_b32 s27, 1040356334
    s_mov_b32 s30, 0xcccccccc
    s_mov_b32 s31, 0xcccccccc
    s_mov_b32 s32, 0x33333333
    s_mov_b32 s33, 0x33333333
    v_lshlrev_b32 v1, 4, v0
    v_lshrrev_b32 v4, 3, v0
    v_and_b32 v5, 7, v0
    v_lshlrev_b32 v4, 13, v4
    v_lshl_add_u32 v4, v5, 4, v4
    v_lshrrev_b32 v5, 4, v0
    v_bfe_u32 v6, v0, 2, 2
    v_lshl_add_u32 v5, v5, 3, v6
    v_lshlrev_b32 v5, 7, v5
    v_and_b32 v6, 3, v0
    v_lshl_add_u32 v5, v6, 3, v5
    s_mul_i32 s42, s13, 20480
    s_add_u32 s42, s42, 81920
    v_add_u32 v3, s42, v5
    v_lshlrev_b32 v12, 7, v0
    v_and_b32 v12, 0xf80, v12
    s_add_u32 m0, s42, 0
    s_add_u32 s24, s16, 0
    buffer_load_dwordx4 v4, s[8:11], s24 offen offset:0 lds
    s_add_u32 s24, s16, 64512
    buffer_load_dwordx4 v4, s[8:11], s24 offen offset:1024 lds
    s_add_u32 s24, s16, 129024
    buffer_load_dwordx4 v4, s[8:11], s24 offen offset:2048 lds
    s_add_u32 s24, s16, 193536
    buffer_load_dwordx4 v4, s[8:11], s24 offen offset:3072 lds
    s_add_u32 m0, s42, 4096
    s_add_u32 s24, s16, 262144
    buffer_load_dwordx4 v4, s[8:11], s24 offen offset:0 lds
    s_add_u32 s24, s16, 326656
    buffer_load_dwordx4 v4, s[8:11], s24 offen offset:1024 lds
    s_add_u32 s24, s16, 391168
    buffer_load_dwordx4 v4, s[8:11], s24 offen offset:2048 lds
    s_add_u32 s24, s16, 455680
    buffer_load_dwordx4 v4, s[8:11], s24 offen offset:3072 lds
    s_add_u32 m0, s42, 8192
    s_add_u32 s24, s16, 2621440
    buffer_load_dwordx4 v4, s[8:11], s24 offen offset:0 lds
    s_add_u32 s24, s16, 2685952
    buffer_load_dwordx4 v4, s[8:11], s24 offen offset:1024 lds
    s_add_u32 s24, s16, 2750464
    buffer_load_dwordx4 v4, s[8:11], s24 offen offset:2048 lds
    s_add_u32 s24, s16, 2814976
    buffer_load_dwordx4 v4, s[8:11], s24 offen offset:3072 lds
    s_add_u32 m0, s42, 12288
    s_add_u32 s24, s16, 2883584
    buffer_load_dwordx4 v4, s[8:11], s24 offen offset:0 lds
    s_add_u32 s24, s16, 2948096
    buffer_load_dwordx4 v4, s[8:11], s24 offen offset:1024 lds
    s_add_u32 s24, s16, 3012608
    buffer_load_dwordx4 v4, s[8:11], s24 offen offset:2048 lds
    s_add_u32 s24, s16, 3077120
    buffer_load_dwordx4 v4, s[8:11], s24 offen offset:3072 lds
    s_add_u32 m0, s42, 16384
    s_add_u32 s24, s16, 524288
    buffer_load_dwordx4 v4, s[8:11], s24 offen offset:0 lds
    s_add_u32 s24, s16, 588800
    buffer_load_dwordx4 v4, s[8:11], s24 offen offset:1024 lds
    s_add_u32 s24, s16, 653312
    buffer_load_dwordx4 v4, s[8:11], s24 offen offset:2048 lds
    s_add_u32 s24, s16, 717824
    buffer_load_dwordx4 v4, s[8:11], s24 offen offset:3072 lds
    s_waitcnt vmcnt(16)
    ds_read_b64_tr_b16 a[0:1], v3 offset:0
    ds_read_b64_tr_b16 a[2:3], v3 offset:512
    ds_read_b64_tr_b16 a[4:5], v3 offset:32
    ds_read_b64_tr_b16 a[6:7], v3 offset:544
    ds_read_b64_tr_b16 a[8:9], v3 offset:64
    ds_read_b64_tr_b16 a[10:11], v3 offset:576
    ds_read_b64_tr_b16 a[12:13], v3 offset:96
    ds_read_b64_tr_b16 a[14:15], v3 offset:608
    s_waitcnt lgkmcnt(0)
    s_add_u32 m0, s42, 0
    s_add_u32 s24, s16, 786432
    buffer_load_dwordx4 v4, s[8:11], s24 offen offset:0 lds
    s_add_u32 s24, s16, 850944
    buffer_load_dwordx4 v4, s[8:11], s24 offen offset:1024 lds
    s_add_u32 s24, s16, 915456
    buffer_load_dwordx4 v4, s[8:11], s24 offen offset:2048 lds
    s_add_u32 s24, s16, 979968
    buffer_load_dwordx4 v4, s[8:11], s24 offen offset:3072 lds
    s_waitcnt vmcnt(16)
    ds_read_b64_tr_b16 a[16:17], v3 offset:4096
    ds_read_b64_tr_b16 a[18:19], v3 offset:4608
    ds_read_b64_tr_b16 a[20:21], v3 offset:4128
    ds_read_b64_tr_b16 a[22:23], v3 offset:4640
    ds_read_b64_tr_b16 a[24:25], v3 offset:4160
    ds_read_b64_tr_b16 a[26:27], v3 offset:4672
    ds_read_b64_tr_b16 a[28:29], v3 offset:4192
    ds_read_b64_tr_b16 a[30:31], v3 offset:4704
    s_waitcnt lgkmcnt(0)
    s_add_u32 m0, s42, 4096
    s_add_u32 s24, s16, 3145728
    buffer_load_dwordx4 v4, s[8:11], s24 offen offset:0 lds
    s_add_u32 s24, s16, 3210240
    buffer_load_dwordx4 v4, s[8:11], s24 offen offset:1024 lds
    s_add_u32 s24, s16, 3274752
    buffer_load_dwordx4 v4, s[8:11], s24 offen offset:2048 lds
    s_add_u32 s24, s16, 3339264
    buffer_load_dwordx4 v4, s[8:11], s24 offen offset:3072 lds
    s_waitcnt vmcnt(16)
    ds_read_b64_tr_b16 a[160:161], v3 offset:8192
    ds_read_b64_tr_b16 a[162:163], v3 offset:8704
    ds_read_b64_tr_b16 a[164:165], v3 offset:8224
    ds_read_b64_tr_b16 a[166:167], v3 offset:8736
    ds_read_b64_tr_b16 a[168:169], v3 offset:8256
    ds_read_b64_tr_b16 a[170:171], v3 offset:8768
    ds_read_b64_tr_b16 a[172:173], v3 offset:8288
    ds_read_b64_tr_b16 a[174:175], v3 offset:8800
    s_waitcnt lgkmcnt(0)
    s_add_u32 m0, s42, 8192
    s_add_u32 s24, s16, 3407872
    buffer_load_dwordx4 v4, s[8:11], s24 offen offset:0 lds
    s_add_u32 s24, s16, 3472384
    buffer_load_dwordx4 v4, s[8:11], s24 offen offset:1024 lds
    s_add_u32 s24, s16, 3536896
    buffer_load_dwordx4 v4, s[8:11], s24 offen offset:2048 lds
    s_add_u32 s24, s16, 3601408
    buffer_load_dwordx4 v4, s[8:11], s24 offen offset:3072 lds
    s_waitcnt vmcnt(16)
    ds_read_b64_tr_b16 a[176:177], v3 offset:12288
    ds_read_b64_tr_b16 a[178:179], v3 offset:12800
    ds_read_b64_tr_b16 a[180:181], v3 offset:12320
    ds_read_b64_tr_b16 a[182:183], v3 offset:12832
    ds_read_b64_tr_b16 a[184:185], v3 offset:12352
    ds_read_b64_tr_b16 a[186:187], v3 offset:12864
    ds_read_b64_tr_b16 a[188:189], v3 offset:12384
    ds_read_b64_tr_b16 a[190:191], v3 offset:12896
    s_waitcnt lgkmcnt(0)
    s_add_u32 m0, s42, 12288
    s_add_u32 s24, s16, 1048576
    buffer_load_dwordx4 v4, s[8:11], s24 offen offset:0 lds
    s_add_u32 s24, s16, 1113088
    buffer_load_dwordx4 v4, s[8:11], s24 offen offset:1024 lds
    s_add_u32 s24, s16, 1177600
    buffer_load_dwordx4 v4, s[8:11], s24 offen offset:2048 lds
    s_add_u32 s24, s16, 1242112
    buffer_load_dwordx4 v4, s[8:11], s24 offen offset:3072 lds
    s_waitcnt vmcnt(16)
    ds_read_b64_tr_b16 a[32:33], v3 offset:16384
    ds_read_b64_tr_b16 a[34:35], v3 offset:16896
    ds_read_b64_tr_b16 a[36:37], v3 offset:16416
    ds_read_b64_tr_b16 a[38:39], v3 offset:16928
    ds_read_b64_tr_b16 a[40:41], v3 offset:16448
    ds_read_b64_tr_b16 a[42:43], v3 offset:16960
    ds_read_b64_tr_b16 a[44:45], v3 offset:16480
    ds_read_b64_tr_b16 a[46:47], v3 offset:16992
    s_waitcnt lgkmcnt(0)
    s_add_u32 m0, s42, 16384
    s_add_u32 s24, s16, 1310720
    buffer_load_dwordx4 v4, s[8:11], s24 offen offset:0 lds
    s_add_u32 s24, s16, 1375232
    buffer_load_dwordx4 v4, s[8:11], s24 offen offset:1024 lds
    s_add_u32 s24, s16, 1439744
    buffer_load_dwordx4 v4, s[8:11], s24 offen offset:2048 lds
    s_add_u32 s24, s16, 1504256
    buffer_load_dwordx4 v4, s[8:11], s24 offen offset:3072 lds
    s_waitcnt vmcnt(16)
    ds_read_b64_tr_b16 a[48:49], v3 offset:0
    ds_read_b64_tr_b16 a[50:51], v3 offset:512
    ds_read_b64_tr_b16 a[52:53], v3 offset:32
    ds_read_b64_tr_b16 a[54:55], v3 offset:544
    ds_read_b64_tr_b16 a[56:57], v3 offset:64
    ds_read_b64_tr_b16 a[58:59], v3 offset:576
    ds_read_b64_tr_b16 a[60:61], v3 offset:96
    ds_read_b64_tr_b16 a[62:63], v3 offset:608
    s_waitcnt lgkmcnt(0)
    s_add_u32 m0, s42, 0
    s_add_u32 s24, s16, 3670016
    buffer_load_dwordx4 v4, s[8:11], s24 offen offset:0 lds
    s_add_u32 s24, s16, 3734528
    buffer_load_dwordx4 v4, s[8:11], s24 offen offset:1024 lds
    s_add_u32 s24, s16, 3799040
    buffer_load_dwordx4 v4, s[8:11], s24 offen offset:2048 lds
    s_add_u32 s24, s16, 3863552
    buffer_load_dwordx4 v4, s[8:11], s24 offen offset:3072 lds
    s_waitcnt vmcnt(16)
    ds_read_b64_tr_b16 a[192:193], v3 offset:4096
    ds_read_b64_tr_b16 a[194:195], v3 offset:4608
    ds_read_b64_tr_b16 a[196:197], v3 offset:4128
    ds_read_b64_tr_b16 a[198:199], v3 offset:4640
    ds_read_b64_tr_b16 a[200:201], v3 offset:4160
    ds_read_b64_tr_b16 a[202:203], v3 offset:4672
    ds_read_b64_tr_b16 a[204:205], v3 offset:4192
    ds_read_b64_tr_b16 a[206:207], v3 offset:4704
    s_waitcnt lgkmcnt(0)
    s_add_u32 m0, s42, 4096
    s_add_u32 s24, s16, 3932160
    buffer_load_dwordx4 v4, s[8:11], s24 offen offset:0 lds
    s_add_u32 s24, s16, 3996672
    buffer_load_dwordx4 v4, s[8:11], s24 offen offset:1024 lds
    s_add_u32 s24, s16, 4061184
    buffer_load_dwordx4 v4, s[8:11], s24 offen offset:2048 lds
    s_add_u32 s24, s16, 4125696
    buffer_load_dwordx4 v4, s[8:11], s24 offen offset:3072 lds
    s_waitcnt vmcnt(16)
    ds_read_b64_tr_b16 a[208:209], v3 offset:8192
    ds_read_b64_tr_b16 a[210:211], v3 offset:8704
    ds_read_b64_tr_b16 a[212:213], v3 offset:8224
    ds_read_b64_tr_b16 a[214:215], v3 offset:8736
    ds_read_b64_tr_b16 a[216:217], v3 offset:8256
    ds_read_b64_tr_b16 a[218:219], v3 offset:8768
    ds_read_b64_tr_b16 a[220:221], v3 offset:8288
    ds_read_b64_tr_b16 a[222:223], v3 offset:8800
    s_waitcnt lgkmcnt(0)
    s_add_u32 m0, s42, 8192
    s_add_u32 s24, s16, 1572864
    buffer_load_dwordx4 v4, s[8:11], s24 offen offset:0 lds
    s_add_u32 s24, s16, 1637376
    buffer_load_dwordx4 v4, s[8:11], s24 offen offset:1024 lds
    s_add_u32 s24, s16, 1701888
    buffer_load_dwordx4 v4, s[8:11], s24 offen offset:2048 lds
    s_add_u32 s24, s16, 1766400
    buffer_load_dwordx4 v4, s[8:11], s24 offen offset:3072 lds
    s_waitcnt vmcnt(16)
    ds_read_b64_tr_b16 a[64:65], v3 offset:12288
    ds_read_b64_tr_b16 a[66:67], v3 offset:12800
    ds_read_b64_tr_b16 a[68:69], v3 offset:12320
    ds_read_b64_tr_b16 a[70:71], v3 offset:12832
    ds_read_b64_tr_b16 a[72:73], v3 offset:12352
    ds_read_b64_tr_b16 a[74:75], v3 offset:12864
    ds_read_b64_tr_b16 a[76:77], v3 offset:12384
    ds_read_b64_tr_b16 a[78:79], v3 offset:12896
    s_waitcnt lgkmcnt(0)
    s_add_u32 m0, s42, 12288
    s_add_u32 s24, s16, 1835008
    buffer_load_dwordx4 v4, s[8:11], s24 offen offset:0 lds
    s_add_u32 s24, s16, 1899520
    buffer_load_dwordx4 v4, s[8:11], s24 offen offset:1024 lds
    s_add_u32 s24, s16, 1964032
    buffer_load_dwordx4 v4, s[8:11], s24 offen offset:2048 lds
    s_add_u32 s24, s16, 2028544
    buffer_load_dwordx4 v4, s[8:11], s24 offen offset:3072 lds
    buffer_load_dword v8, off, s[72:75], 0 offset:48 sc1
    s_waitcnt vmcnt(17)
    ds_read_b64_tr_b16 a[80:81], v3 offset:16384
    ds_read_b64_tr_b16 a[82:83], v3 offset:16896
    ds_read_b64_tr_b16 a[84:85], v3 offset:16416
    ds_read_b64_tr_b16 a[86:87], v3 offset:16928
    ds_read_b64_tr_b16 a[88:89], v3 offset:16448
    ds_read_b64_tr_b16 a[90:91], v3 offset:16960
    ds_read_b64_tr_b16 a[92:93], v3 offset:16480
    ds_read_b64_tr_b16 a[94:95], v3 offset:16992
    s_waitcnt lgkmcnt(0)
    s_add_u32 m0, s42, 16384
    s_add_u32 s24, s16, 4194304
    buffer_load_dwordx4 v4, s[8:11], s24 offen offset:0 lds
    s_add_u32 s24, s16, 4258816
    buffer_load_dwordx4 v4, s[8:11], s24 offen offset:1024 lds
    s_add_u32 s24, s16, 4323328
    buffer_load_dwordx4 v4, s[8:11], s24 offen offset:2048 lds
    s_add_u32 s24, s16, 4387840
    buffer_load_dwordx4 v4, s[8:11], s24 offen offset:3072 lds
    s_waitcnt vmcnt(17)
    ds_read_b64_tr_b16 a[224:225], v3 offset:0
    ds_read_b64_tr_b16 a[226:227], v3 offset:512
    ds_read_b64_tr_b16 a[228:229], v3 offset:32
    ds_read_b64_tr_b16 a[230:231], v3 offset:544
    ds_read_b64_tr_b16 a[232:233], v3 offset:64
    ds_read_b64_tr_b16 a[234:235], v3 offset:576
    ds_read_b64_tr_b16 a[236:237], v3 offset:96
    ds_read_b64_tr_b16 a[238:239], v3 offset:608
    s_waitcnt lgkmcnt(0)
    s_add_u32 m0, s42, 0
    s_add_u32 s24, s16, 4456448
    buffer_load_dwordx4 v4, s[8:11], s24 offen offset:0 lds
    s_add_u32 s24, s16, 4520960
    buffer_load_dwordx4 v4, s[8:11], s24 offen offset:1024 lds
    s_add_u32 s24, s16, 4585472
    buffer_load_dwordx4 v4, s[8:11], s24 offen offset:2048 lds
    s_add_u32 s24, s16, 4649984
    buffer_load_dwordx4 v4, s[8:11], s24 offen offset:3072 lds
    s_waitcnt vmcnt(17)
    ds_read_b64_tr_b16 a[240:241], v3 offset:4096
    ds_read_b64_tr_b16 a[242:243], v3 offset:4608
    ds_read_b64_tr_b16 a[244:245], v3 offset:4128
    ds_read_b64_tr_b16 a[246:247], v3 offset:4640
    ds_read_b64_tr_b16 a[248:249], v3 offset:4160
    ds_read_b64_tr_b16 a[250:251], v3 offset:4672
    ds_read_b64_tr_b16 a[252:253], v3 offset:4192
    ds_read_b64_tr_b16 a[254:255], v3 offset:4704
    s_waitcnt lgkmcnt(0)
    s_add_u32 m0, s42, 4096
    s_add_u32 s24, s16, 2097152
    buffer_load_dwordx4 v4, s[8:11], s24 offen offset:0 lds
    s_add_u32 s24, s16, 2161664
    buffer_load_dwordx4 v4, s[8:11], s24 offen offset:1024 lds
    s_add_u32 s24, s16, 2226176
    buffer_load_dwordx4 v4, s[8:11], s24 offen offset:2048 lds
    s_add_u32 s24, s16, 2290688
    buffer_load_dwordx4 v4, s[8:11], s24 offen offset:3072 lds
    s_waitcnt vmcnt(17)
    ds_read_b64_tr_b16 a[96:97], v3 offset:8192
    ds_read_b64_tr_b16 a[98:99], v3 offset:8704
    ds_read_b64_tr_b16 a[100:101], v3 offset:8224
    ds_read_b64_tr_b16 a[102:103], v3 offset:8736
    ds_read_b64_tr_b16 a[104:105], v3 offset:8256
    ds_read_b64_tr_b16 a[106:107], v3 offset:8768
    ds_read_b64_tr_b16 a[108:109], v3 offset:8288
    ds_read_b64_tr_b16 a[110:111], v3 offset:8800
    s_waitcnt lgkmcnt(0)
    s_add_u32 m0, s42, 8192
    s_add_u32 s24, s16, 2359296
    buffer_load_dwordx4 v4, s[8:11], s24 offen offset:0 lds
    s_add_u32 s24, s16, 2423808
    buffer_load_dwordx4 v4, s[8:11], s24 offen offset:1024 lds
    s_add_u32 s24, s16, 2488320
    buffer_load_dwordx4 v4, s[8:11], s24 offen offset:2048 lds
    s_add_u32 s24, s16, 2552832
    buffer_load_dwordx4 v4, s[8:11], s24 offen offset:3072 lds
    s_waitcnt vmcnt(17)
    ds_read_b64_tr_b16 a[112:113], v3 offset:12288
    ds_read_b64_tr_b16 a[114:115], v3 offset:12800
    ds_read_b64_tr_b16 a[116:117], v3 offset:12320
    ds_read_b64_tr_b16 a[118:119], v3 offset:12832
    ds_read_b64_tr_b16 a[120:121], v3 offset:12352
    ds_read_b64_tr_b16 a[122:123], v3 offset:12864
    ds_read_b64_tr_b16 a[124:125], v3 offset:12384
    ds_read_b64_tr_b16 a[126:127], v3 offset:12896
    s_waitcnt lgkmcnt(0)
    s_add_u32 m0, s42, 12288
    s_add_u32 s24, s16, 4718592
    buffer_load_dwordx4 v4, s[8:11], s24 offen offset:0 lds
    s_add_u32 s24, s16, 4783104
    buffer_load_dwordx4 v4, s[8:11], s24 offen offset:1024 lds
    s_add_u32 s24, s16, 4847616
    buffer_load_dwordx4 v4, s[8:11], s24 offen offset:2048 lds
    s_add_u32 s24, s16, 4912128
    buffer_load_dwordx4 v4, s[8:11], s24 offen offset:3072 lds
    s_waitcnt vmcnt(16)
    ds_read_b64_tr_b16 v[192:193], v3 offset:16384
    ds_read_b64_tr_b16 v[194:195], v3 offset:16896
    ds_read_b64_tr_b16 v[196:197], v3 offset:16416
    ds_read_b64_tr_b16 v[198:199], v3 offset:16928
    ds_read_b64_tr_b16 v[200:201], v3 offset:16448
    ds_read_b64_tr_b16 v[202:203], v3 offset:16960
    ds_read_b64_tr_b16 v[204:205], v3 offset:16480
    ds_read_b64_tr_b16 v[206:207], v3 offset:16992
    s_waitcnt lgkmcnt(0)
    s_add_u32 m0, s42, 16384
    s_add_u32 s24, s16, 4980736
    buffer_load_dwordx4 v4, s[8:11], s24 offen offset:0 lds
    s_add_u32 s24, s16, 5045248
    buffer_load_dwordx4 v4, s[8:11], s24 offen offset:1024 lds
    s_add_u32 s24, s16, 5109760
    buffer_load_dwordx4 v4, s[8:11], s24 offen offset:2048 lds
    s_add_u32 s24, s16, 5174272
    buffer_load_dwordx4 v4, s[8:11], s24 offen offset:3072 lds
    s_waitcnt vmcnt(16)
    ds_read_b64_tr_b16 v[208:209], v3 offset:0
    ds_read_b64_tr_b16 v[210:211], v3 offset:512
    ds_read_b64_tr_b16 v[212:213], v3 offset:32
    ds_read_b64_tr_b16 v[214:215], v3 offset:544
    ds_read_b64_tr_b16 v[216:217], v3 offset:64
    ds_read_b64_tr_b16 v[218:219], v3 offset:576
    ds_read_b64_tr_b16 v[220:221], v3 offset:96
    ds_read_b64_tr_b16 v[222:223], v3 offset:608
    s_waitcnt vmcnt(12)
    ds_read_b64_tr_b16 a[128:129], v3 offset:4096
    ds_read_b64_tr_b16 a[130:131], v3 offset:4608
    ds_read_b64_tr_b16 a[132:133], v3 offset:4128
    ds_read_b64_tr_b16 a[134:135], v3 offset:4640
    ds_read_b64_tr_b16 a[136:137], v3 offset:4160
    ds_read_b64_tr_b16 a[138:139], v3 offset:4672
    ds_read_b64_tr_b16 a[140:141], v3 offset:4192
    ds_read_b64_tr_b16 a[142:143], v3 offset:4704
    s_waitcnt vmcnt(8)
    ds_read_b64_tr_b16 a[144:145], v3 offset:8192
    ds_read_b64_tr_b16 a[146:147], v3 offset:8704
    ds_read_b64_tr_b16 a[148:149], v3 offset:8224
    ds_read_b64_tr_b16 a[150:151], v3 offset:8736
    ds_read_b64_tr_b16 a[152:153], v3 offset:8256
    ds_read_b64_tr_b16 a[154:155], v3 offset:8768
    ds_read_b64_tr_b16 a[156:157], v3 offset:8288
    ds_read_b64_tr_b16 a[158:159], v3 offset:8800
    buffer_load_dword v10, off, s[72:75], 0 offset:52 sc1
    s_lshl_b32 s43, s13, 12
    s_add_u32 s43, s43, 32768
    buffer_load_dword v11, v12, s[4:7], s43 offen sc1
    s_waitcnt vmcnt(6)
    ds_read_b64_tr_b16 v[224:225], v3 offset:12288
    ds_read_b64_tr_b16 v[226:227], v3 offset:12800
    ds_read_b64_tr_b16 v[228:229], v3 offset:12320
    ds_read_b64_tr_b16 v[230:231], v3 offset:12832
    ds_read_b64_tr_b16 v[232:233], v3 offset:12352
    ds_read_b64_tr_b16 v[234:235], v3 offset:12864
    ds_read_b64_tr_b16 v[236:237], v3 offset:12384
    ds_read_b64_tr_b16 v[238:239], v3 offset:12896
    s_waitcnt vmcnt(2)
    ds_read_b64_tr_b16 v[240:241], v3 offset:16384
    ds_read_b64_tr_b16 v[242:243], v3 offset:16896
    ds_read_b64_tr_b16 v[244:245], v3 offset:16416
    ds_read_b64_tr_b16 v[246:247], v3 offset:16928
    ds_read_b64_tr_b16 v[248:249], v3 offset:16448
    ds_read_b64_tr_b16 v[250:251], v3 offset:16960
    ds_read_b64_tr_b16 v[252:253], v3 offset:16480
    ds_read_b64_tr_b16 v[254:255], v3 offset:16992
    s_waitcnt lgkmcnt(0)
    v_lshrrev_b32 v8, 1, v8
    s_waitcnt vmcnt(1)
    v_lshrrev_b32 v4, 19, v10
    s_waitcnt vmcnt(0)
    v_min3_u32 v4, v4, v11, v8
    v_cmp_eq_u32 vcc, 0, v4
    s_cbranch_vccz Lok8
    v_mov_b32 v5, 0
    s_mov_b32 exec_lo, 0x1
    s_mov_b32 exec_hi, 0x0
Lwf9:
    buffer_load_dword v4, v5, s[72:75], 0 offen offset:48 sc1
    s_waitcnt vmcnt(0)
    v_cmp_gt_u32 vcc, 2, v4
    s_cbranch_vccz Lwf9d
    s_sub_u32 s15, s15, 1
    s_cbranch_scc0 Lwf9
    s_mov_b32 s15, 0
Lwf9d:
    s_mov_b64 exec, -1
    v_mov_b32 v11, 0
    s_mov_b32 exec_lo, 0x1
    s_mov_b32 exec_hi, 0x0
Lwf10:
    buffer_load_dword v10, v11, s[72:75], 0 offen offset:52 sc1
    s_waitcnt vmcnt(0)
    v_cmp_gt_u32 vcc, 524288, v10
    s_cbranch_vccz Lwf10d
    s_sub_u32 s15, s15, 1
    s_cbranch_scc0 Lwf10
    s_mov_b32 s15, 0
Lwf10d:
    s_mov_b64 exec, -1
Lwf11:
    buffer_load_dword v4, v12, s[4:7], s43 offen offset:0 sc1
    s_waitcnt vmcnt(0)
    v_cmp_gt_u32 vcc, 1, v4
    s_cbranch_vccz Lwf11d
    s_sub_u32 s15, s15, 1
    s_cbranch_scc0 Lwf11
    s_mov_b32 s15, 0
Lwf11d:
Lok8:
    s_barrier
    s_mul_i32 s26, s13, 10240
    s_add_u32 m0, s26, 0
    s_add_u32 s25, s19, 0
    buffer_load_dwordx4 v1, s[4:7], s25 offen offset:0 sc1 lds
    buffer_load_dwordx4 v1, s[4:7], s25 offen offset:1024 sc1 lds
    buffer_load_dwordx4 v1, s[4:7], s25 offen offset:2048 sc1 lds
    buffer_load_dwordx4 v1, s[4:7], s25 offen offset:3072 sc1 lds
    s_add_u32 m0, s26, 4096
    s_add_u32 s25, s19, 4096
    buffer_load_dwordx4 v1, s[4:7], s25 offen offset:0 sc1 lds
    buffer_load_dwordx4 v1, s[4:7], s25 offen offset:1024 sc1 lds
    buffer_load_dwordx4 v1, s[4:7], s25 offen offset:2048 sc1 lds
    buffer_load_dwordx4 v1, s[4:7], s25 offen offset:3072 sc1 lds
    s_add_u32 m0, s26, 8192
    s_add_u32 s25, s19, 8192
    buffer_load_dwordx4 v1, s[4:7], s25 offen offset:0 sc1 lds
    buffer_load_dwordx4 v1, s[4:7], s25 offen offset:1024 sc1 lds
    s_add_u32 s26, s26, 40960
    s_add_u32 s19, s19, 40960
    s_add_u32 m0, s26, 0
    s_add_u32 s25, s19, 0
    buffer_load_dwordx4 v1, s[4:7], s25 offen offset:0 sc1 lds
    buffer_load_dwordx4 v1, s[4:7], s25 offen offset:1024 sc1 lds
    buffer_load_dwordx4 v1, s[4:7], s25 offen offset:2048 sc1 lds
    buffer_load_dwordx4 v1, s[4:7], s25 offen offset:3072 sc1 lds
    s_add_u32 m0, s26, 4096
    s_add_u32 s25, s19, 4096
    buffer_load_dwordx4 v1, s[4:7], s25 offen offset:0 sc1 lds
    buffer_load_dwordx4 v1, s[4:7], s25 offen offset:1024 sc1 lds
    buffer_load_dwordx4 v1, s[4:7], s25 offen offset:2048 sc1 lds
    buffer_load_dwordx4 v1, s[4:7], s25 offen offset:3072 sc1 lds
    s_add_u32 m0, s26, 8192
    s_add_u32 s25, s19, 8192
    buffer_load_dwordx4 v1, s[4:7], s25 offen offset:0 sc1 lds
    buffer_load_dwordx4 v1, s[4:7], s25 offen offset:1024 sc1 lds
    v_readfirstlane_b32 s24, v10
    s_mul_i32 s20, s13, 10240
    v_mov_b32 v2, v1
    s_mov_b32 s22, 0
    s_nop 0
    s_and_b32 s24, s24, 0x60
    s_cselect_b32 s24, 0x2000, 0
    s_xor_b32 s17, s17, s24
    s_mov_b32 s35, 40960
    v_add_u32 v6, s35, v1
    s_lshl_b32 s34, s13, 12
    s_add_u32 s34, s34, 7340032
    s_waitcnt vmcnt(10)
    s_barrier
    ds_read_b128 v[8:11], v2 offset:0
    ds_read_b128 v[12:15], v2 offset:1024
    ds_read_b128 v[16:19], v2 offset:2048
    s_waitcnt lgkmcnt(0)
    s_cmp_eq_u32 s28, 1
    s_cbranch_scc1 Lpj13
    s_cmp_eq_u32 s28, 2
    s_cbranch_scc1 Lpj14
Lpj12:
    s_waitcnt lgkmcnt(2)
    v_mfma_f32_16x16x32_bf16 v[24:27], a[0:3], v[8:11], 0
    ds_read_b128 v[20:23], v2 offset:3072
    v_mfma_f32_16x16x32_bf16 v[28:31], a[4:7], v[8:11], 0
    v_mfma_f32_16x16x32_bf16 v[32:35], a[8:11], v[8:11], 0
    v_mfma_f32_16x16x32_bf16 v[36:39], a[12:15], v[8:11], 0
    s_waitcnt lgkmcnt(2)
    v_mul_f32 v40, s27, v40
    v_mul_f32 v41, s27, v41
    v_mfma_f32_16x16x32_bf16 v[24:27], a[16:19], v[12:15], v[24:27]
    ds_read_b128 v[8:11], v2 offset:4096
    v_mfma_f32_16x16x32_bf16 v[28:31], a[20:23], v[12:15], v[28:31]
    v_mul_f32 v42, s27, v42
    v_mul_f32 v43, s27, v43
    v_mfma_f32_16x16x32_bf16 v[32:35], a[24:27], v[12:15], v[32:35]
    v_mul_f32 v44, s27, v44
    v_mul_f32 v45, s27, v45
    v_mfma_f32_16x16x32_bf16 v[36:39], a[28:31], v[12:15], v[36:39]
    s_waitcnt lgkmcnt(2)
    v_mul_f32 v46, s27, v46
    v_mul_f32 v47, s27, v47
    v_mfma_f32_16x16x32_bf16 v[24:27], a[32:35], v[16:19], v[24:27]
    ds_read_b128 v[12:15], v2 offset:5120
    v_mfma_f32_16x16x32_bf16 v[28:31], a[36:39], v[16:19], v[28:31]
    v_mul_f32 v48, s27, v48
    v_mul_f32 v49, s27, v49
    v_mfma_f32_16x16x32_bf16 v[32:35], a[40:43], v[16:19], v[32:35]
    v_mul_f32 v50, s27, v50
    v_mul_f32 v51, s27, v51
    v_mfma_f32_16x16x32_bf16 v[36:39], a[44:47], v[16:19], v[36:39]
    s_waitcnt lgkmcnt(2)
    v_mul_f32 v52, s27, v52
    v_mul_f32 v53, s27, v53
    v_mfma_f32_16x16x32_bf16 v[24:27], a[48:51], v[20:23], v[24:27]
    ds_read_b128 v[16:19], v2 offset:6144
    v_mfma_f32_16x16x32_bf16 v[28:31], a[52:55], v[20:23], v[28:31]
    v_mul_f32 v54, s27, v54
    v_mul_f32 v55, s27, v55
    v_mfma_f32_16x16x32_bf16 v[32:35], a[56:59], v[20:23], v[32:35]
    v_cvt_pk_bf16_f32 v72, v40, v41
    v_cvt_pk_bf16_f32 v73, v42, v43
    v_mfma_f32_16x16x32_bf16 v[36:39], a[60:63], v[20:23], v[36:39]
    s_waitcnt lgkmcnt(2)
    v_cvt_pk_bf16_f32 v74, v48, v49
    v_cvt_pk_bf16_f32 v75, v50, v51
    v_mfma_f32_16x16x32_bf16 v[24:27], a[64:67], v[8:11], v[24:27]
    ds_read_b128 v[20:23], v2 offset:7168
    v_mfma_f32_16x16x32_bf16 v[28:31], a[68:71], v[8:11], v[28:31]
    v_cvt_pk_bf16_f32 v76, v44, v45
    v_cvt_pk_bf16_f32 v77, v46, v47
    v_mfma_f32_16x16x32_bf16 v[32:35], a[72:75], v[8:11], v[32:35]
    v_cvt_pk_bf16_f32 v78, v52, v53
    v_cvt_pk_bf16_f32 v79, v54, v55
    v_mfma_f32_16x16x32_bf16 v[36:39], a[76:79], v[8:11], v[36:39]
    s_waitcnt lgkmcnt(2)
    s_mov_b64 vcc, s[32:33]
    v_cndmask_b32_dpp v64, v76, v72, vcc quad_perm:[2,3,0,1] row_mask:0xf bank_mask:0xf
    v_cndmask_b32_dpp v65, v77, v73, vcc quad_perm:[2,3,0,1] row_mask:0xf bank_mask:0xf
    v_mfma_f32_16x16x32_bf16 v[24:27], a[80:83], v[12:15], v[24:27]
    ds_read_b128 v[8:11], v2 offset:8192
    v_mfma_f32_16x16x32_bf16 v[28:31], a[84:87], v[12:15], v[28:31]
    v_cndmask_b32_dpp v66, v78, v74, vcc quad_perm:[2,3,0,1] row_mask:0xf bank_mask:0xf
    v_cndmask_b32_dpp v67, v79, v75, vcc quad_perm:[2,3,0,1] row_mask:0xf bank_mask:0xf
    v_mfma_f32_16x16x32_bf16 v[32:35], a[88:91], v[12:15], v[32:35]
    buffer_store_dwordx4 v[64:67], v1, s[4:7], s34 offen offset:0 sc1
    s_mov_b64 vcc, s[30:31]
    v_cndmask_b32_dpp v68, v72, v76, vcc quad_perm:[2,3,0,1] row_mask:0xf bank_mask:0xf
    v_mfma_f32_16x16x32_bf16 v[36:39], a[92:95], v[12:15], v[36:39]
    s_waitcnt lgkmcnt(2)
    v_cndmask_b32_dpp v69, v73, v77, vcc quad_perm:[2,3,0,1] row_mask:0xf bank_mask:0xf
    v_cndmask_b32_dpp v70, v74, v78, vcc quad_perm:[2,3,0,1] row_mask:0xf bank_mask:0xf
    v_mfma_f32_16x16x32_bf16 v[24:27], a[96:99], v[16:19], v[24:27]
    ds_read_b128 v[12:15], v2 offset:9216
    v_mfma_f32_16x16x32_bf16 v[28:31], a[100:103], v[16:19], v[28:31]
    v_cndmask_b32_dpp v71, v75, v79, vcc quad_perm:[2,3,0,1] row_mask:0xf bank_mask:0xf
    buffer_store_dwordx4 v[68:71], v1, s[4:7], s34 offen offset:2048 sc1
    v_mfma_f32_16x16x32_bf16 v[32:35], a[104:107], v[16:19], v[32:35]
    v_mfma_f32_16x16x32_bf16 v[36:39], a[108:111], v[16:19], v[36:39]
    s_waitcnt lgkmcnt(2)
    v_mfma_f32_16x16x32_bf16 v[24:27], a[112:115], v[20:23], v[24:27]
    ds_read_b128 v[16:19], v2 offset:10240
    v_mfma_f32_16x16x32_bf16 v[28:31], a[116:119], v[20:23], v[28:31]
    v_mfma_f32_16x16x32_bf16 v[32:35], a[120:123], v[20:23], v[32:35]
    v_mfma_f32_16x16x32_bf16 v[36:39], a[124:127], v[20:23], v[36:39]
    s_waitcnt lgkmcnt(2)
    v_mfma_f32_16x16x32_bf16 v[24:27], a[128:131], v[8:11], v[24:27]
    ds_read_b128 v[20:23], v2 offset:11264
    v_mfma_f32_16x16x32_bf16 v[28:31], a[132:135], v[8:11], v[28:31]
    v_mfma_f32_16x16x32_bf16 v[32:35], a[136:139], v[8:11], v[32:35]
    v_mfma_f32_16x16x32_bf16 v[36:39], a[140:143], v[8:11], v[36:39]
    s_waitcnt lgkmcnt(2)
    v_mfma_f32_16x16x32_bf16 v[24:27], a[144:147], v[12:15], v[24:27]
    ds_read_b128 v[8:11], v2 offset:12288
    v_mfma_f32_16x16x32_bf16 v[28:31], a[148:151], v[12:15], v[28:31]
    v_mfma_f32_16x16x32_bf16 v[32:35], a[152:155], v[12:15], v[32:35]
    v_mfma_f32_16x16x32_bf16 v[36:39], a[156:159], v[12:15], v[36:39]
    s_waitcnt lgkmcnt(2)
    v_mfma_f32_16x16x32_bf16 v[24:27], a[160:163], v[16:19], v[24:27]
    ds_read_b128 v[12:15], v2 offset:13312
    v_mfma_f32_16x16x32_bf16 v[28:31], a[164:167], v[16:19], v[28:31]
    v_mfma_f32_16x16x32_bf16 v[32:35], a[168:171], v[16:19], v[32:35]
    v_mfma_f32_16x16x32_bf16 v[36:39], a[172:175], v[16:19], v[36:39]
    s_waitcnt lgkmcnt(2)
    v_mfma_f32_16x16x32_bf16 v[24:27], a[176:179], v[20:23], v[24:27]
    ds_read_b128 v[16:19], v2 offset:14336
    v_mfma_f32_16x16x32_bf16 v[28:31], a[180:183], v[20:23], v[28:31]
    v_mfma_f32_16x16x32_bf16 v[32:35], a[184:187], v[20:23], v[32:35]
    v_mfma_f32_16x16x32_bf16 v[36:39], a[188:191], v[20:23], v[36:39]
    s_waitcnt lgkmcnt(2)
    v_mfma_f32_16x16x32_bf16 v[24:27], a[192:195], v[8:11], v[24:27]
    ds_read_b128 v[20:23], v2 offset:15360
    v_mfma_f32_16x16x32_bf16 v[28:31], a[196:199], v[8:11], v[28:31]
    v_mfma_f32_16x16x32_bf16 v[32:35], a[200:203], v[8:11], v[32:35]
    v_mfma_f32_16x16x32_bf16 v[36:39], a[204:207], v[8:11], v[36:39]
    s_waitcnt lgkmcnt(2)
    v_mfma_f32_16x16x32_bf16 v[24:27], a[208:211], v[12:15], v[24:27]
    ds_read_b128 v[8:11], v2 offset:16384
    v_mfma_f32_16x16x32_bf16 v[28:31], a[212:215], v[12:15], v[28:31]
    v_mfma_f32_16x16x32_bf16 v[32:35], a[216:219], v[12:15], v[32:35]
    v_mfma_f32_16x16x32_bf16 v[36:39], a[220:223], v[12:15], v[36:39]
    s_waitcnt lgkmcnt(2)
    v_mfma_f32_16x16x32_bf16 v[24:27], a[224:227], v[16:19], v[24:27]
    ds_read_b128 v[12:15], v2 offset:17408
    v_mfma_f32_16x16x32_bf16 v[28:31], a[228:231], v[16:19], v[28:31]
    v_mfma_f32_16x16x32_bf16 v[32:35], a[232:235], v[16:19], v[32:35]
    v_mfma_f32_16x16x32_bf16 v[36:39], a[236:239], v[16:19], v[36:39]
    s_waitcnt lgkmcnt(2)
    v_mfma_f32_16x16x32_bf16 v[24:27], a[240:243], v[20:23], v[24:27]
    ds_read_b128 v[16:19], v2 offset:18432
    v_mfma_f32_16x16x32_bf16 v[28:31], a[244:247], v[20:23], v[28:31]
    v_mfma_f32_16x16x32_bf16 v[32:35], a[248:251], v[20:23], v[32:35]
    v_mfma_f32_16x16x32_bf16 v[36:39], a[252:255], v[20:23], v[36:39]
    s_waitcnt lgkmcnt(2)
    v_mfma_f32_16x16x32_bf16 v[24:27], v[192:195], v[8:11], v[24:27]
    ds_read_b128 v[20:23], v2 offset:19456
    v_mfma_f32_16x16x32_bf16 v[28:31], v[196:199], v[8:11], v[28:31]
    v_mfma_f32_16x16x32_bf16 v[32:35], v[200:203], v[8:11], v[32:35]
    s_lshr_b32 s29, s17, 8
    s_and_b32 s29, s29, 0x2000
    s_xor_b32 s29, s17, s29
    s_add_u32 s17, s17, 1048576
    v_mfma_f32_16x16x32_bf16 v[36:39], v[204:207], v[8:11], v[36:39]
    s_waitcnt lgkmcnt(2)
    v_mfma_f32_16x16x32_bf16 v[24:27], v[208:211], v[12:15], v[24:27]
    ds_read_b128 v[8:11], v2 offset:20480
    v_mfma_f32_16x16x32_bf16 v[28:31], v[212:215], v[12:15], v[28:31]
    v_mfma_f32_16x16x32_bf16 v[32:35], v[216:219], v[12:15], v[32:35]
    v_mfma_f32_16x16x32_bf16 v[36:39], v[220:223], v[12:15], v[36:39]
    s_waitcnt lgkmcnt(2)
    v_mfma_f32_16x16x32_bf16 v[24:27], v[224:227], v[16:19], v[24:27]
    ds_read_b128 v[12:15], v2 offset:21504
    v_mfma_f32_16x16x32_bf16 v[28:31], v[228:231], v[16:19], v[28:31]
    v_mfma_f32_16x16x32_bf16 v[32:35], v[232:235], v[16:19], v[32:35]
    v_mfma_f32_16x16x32_bf16 v[36:39], v[236:239], v[16:19], v[36:39]
    s_waitcnt lgkmcnt(2)
    v_mfma_f32_16x16x32_bf16 v[24:27], v[240:243], v[20:23], v[24:27]
    ds_read_b128 v[16:19], v2 offset:22528
    v_mfma_f32_16x16x32_bf16 v[28:31], v[244:247], v[20:23], v[28:31]
    v_mfma_f32_16x16x32_bf16 v[32:35], v[248:251], v[20:23], v[32:35]
    s_waitcnt vmcnt(0)
    v_mov_b32 v4, s22
    v_mov_b32 v5, 0
    s_mov_b64 exec, 1
    buffer_store_dword v4, v5, s[4:7], s21 offen offset:0 sc1
    s_mov_b64 exec, -1
    v_mfma_f32_16x16x32_bf16 v[36:39], v[252:255], v[20:23], v[36:39]
    s_waitcnt lgkmcnt(2)
    v_mfma_f32_16x16x32_bf16 v[40:43], a[0:3], v[8:11], 0
    ds_read_b128 v[20:23], v2 offset:23552
    v_mfma_f32_16x16x32_bf16 v[44:47], a[4:7], v[8:11], 0
    v_mfma_f32_16x16x32_bf16 v[48:51], a[8:11], v[8:11], 0
    v_mfma_f32_16x16x32_bf16 v[52:55], a[12:15], v[8:11], 0
    s_waitcnt lgkmcnt(2)
    v_mul_f32 v24, s27, v24
    v_mul_f32 v25, s27, v25
    v_mfma_f32_16x16x32_bf16 v[40:43], a[16:19], v[12:15], v[40:43]
    ds_read_b128 v[8:11], v2 offset:24576
    v_mfma_f32_16x16x32_bf16 v[44:47], a[20:23], v[12:15], v[44:47]
    v_mul_f32 v26, s27, v26
    v_mul_f32 v27, s27, v27
    v_mfma_f32_16x16x32_bf16 v[48:51], a[24:27], v[12:15], v[48:51]
    v_mul_f32 v28, s27, v28
    v_mul_f32 v29, s27, v29
    v_mfma_f32_16x16x32_bf16 v[52:55], a[28:31], v[12:15], v[52:55]
    s_waitcnt lgkmcnt(2)
    v_mul_f32 v30, s27, v30
    v_mul_f32 v31, s27, v31
    v_mfma_f32_16x16x32_bf16 v[40:43], a[32:35], v[16:19], v[40:43]
    ds_read_b128 v[12:15], v2 offset:25600
    v_mfma_f32_16x16x32_bf16 v[44:47], a[36:39], v[16:19], v[44:47]
    v_mul_f32 v32, s27, v32
    v_mul_f32 v33, s27, v33
    v_mfma_f32_16x16x32_bf16 v[48:51], a[40:43], v[16:19], v[48:51]
    v_mul_f32 v34, s27, v34
    v_mul_f32 v35, s27, v35
    v_mfma_f32_16x16x32_bf16 v[52:55], a[44:47], v[16:19], v[52:55]
    s_waitcnt lgkmcnt(2)
    v_mul_f32 v36, s27, v36
    v_mul_f32 v37, s27, v37
    v_mfma_f32_16x16x32_bf16 v[40:43], a[48:51], v[20:23], v[40:43]
    ds_read_b128 v[16:19], v2 offset:26624
    v_mfma_f32_16x16x32_bf16 v[44:47], a[52:55], v[20:23], v[44:47]
    v_mul_f32 v38, s27, v38
    v_mul_f32 v39, s27, v39
    v_mfma_f32_16x16x32_bf16 v[48:51], a[56:59], v[20:23], v[48:51]
    v_cvt_pk_bf16_f32 v72, v24, v25
    v_cvt_pk_bf16_f32 v73, v26, v27
    v_mfma_f32_16x16x32_bf16 v[52:55], a[60:63], v[20:23], v[52:55]
    s_waitcnt lgkmcnt(2)
    v_cvt_pk_bf16_f32 v74, v32, v33
    v_cvt_pk_bf16_f32 v75, v34, v35
    v_mfma_f32_16x16x32_bf16 v[40:43], a[64:67], v[8:11], v[40:43]
    ds_read_b128 v[20:23], v2 offset:27648
    v_mfma_f32_16x16x32_bf16 v[44:47], a[68:71], v[8:11], v[44:47]
    v_cvt_pk_bf16_f32 v76, v28, v29
    v_cvt_pk_bf16_f32 v77, v30, v31
    v_mfma_f32_16x16x32_bf16 v[48:51], a[72:75], v[8:11], v[48:51]
    v_cvt_pk_bf16_f32 v78, v36, v37
    v_cvt_pk_bf16_f32 v79, v38, v39
    v_mfma_f32_16x16x32_bf16 v[52:55], a[76:79], v[8:11], v[52:55]
    s_waitcnt lgkmcnt(2)
    s_mov_b64 vcc, s[32:33]
    v_cndmask_b32_dpp v56, v76, v72, vcc quad_perm:[2,3,0,1] row_mask:0xf bank_mask:0xf
    v_cndmask_b32_dpp v57, v77, v73, vcc quad_perm:[2,3,0,1] row_mask:0xf bank_mask:0xf
    v_mfma_f32_16x16x32_bf16 v[40:43], a[80:83], v[12:15], v[40:43]
    ds_read_b128 v[8:11], v2 offset:28672
    v_mfma_f32_16x16x32_bf16 v[44:47], a[84:87], v[12:15], v[44:47]
    v_cndmask_b32_dpp v58, v78, v74, vcc quad_perm:[2,3,0,1] row_mask:0xf bank_mask:0xf
    v_cndmask_b32_dpp v59, v79, v75, vcc quad_perm:[2,3,0,1] row_mask:0xf bank_mask:0xf
    v_mfma_f32_16x16x32_bf16 v[48:51], a[88:91], v[12:15], v[48:51]
    buffer_store_dwordx4 v[56:59], v1, s[4:7], s29 offen offset:0 sc1
    s_mov_b64 vcc, s[30:31]
    v_cndmask_b32_dpp v60, v72, v76, vcc quad_perm:[2,3,0,1] row_mask:0xf bank_mask:0xf
    v_mfma_f32_16x16x32_bf16 v[52:55], a[92:95], v[12:15], v[52:55]
    s_waitcnt lgkmcnt(2)
    v_cndmask_b32_dpp v61, v73, v77, vcc quad_perm:[2,3,0,1] row_mask:0xf bank_mask:0xf
    v_cndmask_b32_dpp v62, v74, v78, vcc quad_perm:[2,3,0,1] row_mask:0xf bank_mask:0xf
    v_mfma_f32_16x16x32_bf16 v[40:43], a[96:99], v[16:19], v[40:43]
    ds_read_b128 v[12:15], v2 offset:29696
    v_mfma_f32_16x16x32_bf16 v[44:47], a[100:103], v[16:19], v[44:47]
    v_cndmask_b32_dpp v63, v75, v79, vcc quad_perm:[2,3,0,1] row_mask:0xf bank_mask:0xf
    buffer_store_dwordx4 v[60:63], v1, s[4:7], s29 offen offset:2048 sc1
    v_mfma_f32_16x16x32_bf16 v[48:51], a[104:107], v[16:19], v[48:51]
    s_barrier
    s_add_u32 s26, s26, 40960
    s_cmp_ge_u32 s26, 122880
    s_cselect_b32 s26, s20, s26
    s_add_u32 s19, s19, 40960
    v_mfma_f32_16x16x32_bf16 v[52:55], a[108:111], v[16:19], v[52:55]
    s_waitcnt lgkmcnt(2)
    v_mfma_f32_16x16x32_bf16 v[40:43], a[112:115], v[20:23], v[40:43]
    ds_read_b128 v[16:19], v2 offset:30720
    v_mfma_f32_16x16x32_bf16 v[44:47], a[116:119], v[20:23], v[44:47]
    v_mfma_f32_16x16x32_bf16 v[48:51], a[120:123], v[20:23], v[48:51]
    s_add_u32 m0, s26, 0
    s_add_u32 s25, s19, 0
    buffer_load_dwordx4 v1, s[4:7], s25 offen offset:0 sc1 lds
    v_mfma_f32_16x16x32_bf16 v[52:55], a[124:127], v[20:23], v[52:55]
    s_waitcnt lgkmcnt(2)
    v_mfma_f32_16x16x32_bf16 v[40:43], a[128:131], v[8:11], v[40:43]
    ds_read_b128 v[20:23], v2 offset:31744
    v_mfma_f32_16x16x32_bf16 v[44:47], a[132:135], v[8:11], v[44:47]
    v_mfma_f32_16x16x32_bf16 v[48:51], a[136:139], v[8:11], v[48:51]
    buffer_load_dwordx4 v1, s[4:7], s25 offen offset:1024 sc1 lds
    v_mfma_f32_16x16x32_bf16 v[52:55], a[140:143], v[8:11], v[52:55]
    s_waitcnt lgkmcnt(2)
    v_mfma_f32_16x16x32_bf16 v[40:43], a[144:147], v[12:15], v[40:43]
    ds_read_b128 v[8:11], v2 offset:32768
    v_mfma_f32_16x16x32_bf16 v[44:47], a[148:151], v[12:15], v[44:47]
    v_mfma_f32_16x16x32_bf16 v[48:51], a[152:155], v[12:15], v[48:51]
    buffer_load_dwordx4 v1, s[4:7], s25 offen offset:2048 sc1 lds
    v_mfma_f32_16x16x32_bf16 v[52:55], a[156:159], v[12:15], v[52:55]
    s_waitcnt lgkmcnt(2)
    v_mfma_f32_16x16x32_bf16 v[40:43], a[160:163], v[16:19], v[40:43]
    ds_read_b128 v[12:15], v2 offset:33792
    v_mfma_f32_16x16x32_bf16 v[44:47], a[164:167], v[16:19], v[44:47]
    v_mfma_f32_16x16x32_bf16 v[48:51], a[168:171], v[16:19], v[48:51]
    buffer_load_dwordx4 v1, s[4:7], s25 offen offset:3072 sc1 lds
    v_mfma_f32_16x16x32_bf16 v[52:55], a[172:175], v[16:19], v[52:55]
    s_waitcnt lgkmcnt(2)
    v_mfma_f32_16x16x32_bf16 v[40:43], a[176:179], v[20:23], v[40:43]
    ds_read_b128 v[16:19], v2 offset:34816
    v_mfma_f32_16x16x32_bf16 v[44:47], a[180:183], v[20:23], v[44:47]
    v_mfma_f32_16x16x32_bf16 v[48:51], a[184:187], v[20:23], v[48:51]
    s_add_u32 m0, s26, 4096
    s_add_u32 s25, s19, 4096
    buffer_load_dwordx4 v1, s[4:7], s25 offen offset:0 sc1 lds
    v_mfma_f32_16x16x32_bf16 v[52:55], a[188:191], v[20:23], v[52:55]
    s_waitcnt lgkmcnt(2)
    v_mfma_f32_16x16x32_bf16 v[40:43], a[192:195], v[8:11], v[40:43]
    ds_read_b128 v[20:23], v2 offset:35840
    v_mfma_f32_16x16x32_bf16 v[44:47], a[196:199], v[8:11], v[44:47]
    v_mfma_f32_16x16x32_bf16 v[48:51], a[200:203], v[8:11], v[48:51]
    buffer_load_dwordx4 v1, s[4:7], s25 offen offset:1024 sc1 lds
    v_mfma_f32_16x16x32_bf16 v[52:55], a[204:207], v[8:11], v[52:55]
    s_waitcnt lgkmcnt(2)
    v_mfma_f32_16x16x32_bf16 v[40:43], a[208:211], v[12:15], v[40:43]
    ds_read_b128 v[8:11], v2 offset:36864
    v_mfma_f32_16x16x32_bf16 v[44:47], a[212:215], v[12:15], v[44:47]
    v_mfma_f32_16x16x32_bf16 v[48:51], a[216:219], v[12:15], v[48:51]
    buffer_load_dwordx4 v1, s[4:7], s25 offen offset:2048 sc1 lds
    v_mfma_f32_16x16x32_bf16 v[52:55], a[220:223], v[12:15], v[52:55]
    s_waitcnt lgkmcnt(2)
    v_mfma_f32_16x16x32_bf16 v[40:43], a[224:227], v[16:19], v[40:43]
    ds_read_b128 v[12:15], v2 offset:37888
    v_mfma_f32_16x16x32_bf16 v[44:47], a[228:231], v[16:19], v[44:47]
    v_mfma_f32_16x16x32_bf16 v[48:51], a[232:235], v[16:19], v[48:51]
    buffer_load_dwordx4 v1, s[4:7], s25 offen offset:3072 sc1 lds
    v_mfma_f32_16x16x32_bf16 v[52:55], a[236:239], v[16:19], v[52:55]
    s_waitcnt lgkmcnt(2)
    v_mfma_f32_16x16x32_bf16 v[40:43], a[240:243], v[20:23], v[40:43]
    ds_read_b128 v[16:19], v2 offset:38912
    v_mfma_f32_16x16x32_bf16 v[44:47], a[244:247], v[20:23], v[44:47]
    v_mfma_f32_16x16x32_bf16 v[48:51], a[248:251], v[20:23], v[48:51]
    s_add_u32 m0, s26, 8192
    s_add_u32 s25, s19, 8192
    buffer_load_dwordx4 v1, s[4:7], s25 offen offset:0 sc1 lds
    v_mfma_f32_16x16x32_bf16 v[52:55], a[252:255], v[20:23], v[52:55]
    s_waitcnt lgkmcnt(2)
    v_mfma_f32_16x16x32_bf16 v[40:43], v[192:195], v[8:11], v[40:43]
    ds_read_b128 v[20:23], v2 offset:39936
    v_mfma_f32_16x16x32_bf16 v[44:47], v[196:199], v[8:11], v[44:47]
    v_mfma_f32_16x16x32_bf16 v[48:51], v[200:203], v[8:11], v[48:51]
    buffer_load_dwordx4 v1, s[4:7], s25 offen offset:1024 sc1 lds
    v_mfma_f32_16x16x32_bf16 v[52:55], v[204:207], v[8:11], v[52:55]
    s_waitcnt lgkmcnt(2)
    v_mfma_f32_16x16x32_bf16 v[40:43], v[208:211], v[12:15], v[40:43]
    ds_read_b128 v[8:11], v6 offset:0
    v_mfma_f32_16x16x32_bf16 v[44:47], v[212:215], v[12:15], v[44:47]
    v_mfma_f32_16x16x32_bf16 v[48:51], v[216:219], v[12:15], v[48:51]
    v_mfma_f32_16x16x32_bf16 v[52:55], v[220:223], v[12:15], v[52:55]
    s_waitcnt lgkmcnt(2)
    v_mfma_f32_16x16x32_bf16 v[40:43], v[224:227], v[16:19], v[40:43]
    ds_read_b128 v[12:15], v6 offset:1024
    v_mfma_f32_16x16x32_bf16 v[44:47], v[228:231], v[16:19], v[44:47]
    v_mfma_f32_16x16x32_bf16 v[48:51], v[232:235], v[16:19], v[48:51]
    s_add_u32 s34, s29, 4096
    s_add_u32 s22, s22, 1
    s_add_u32 s35, s35, 40960
    s_cmp_ge_u32 s35, 122880
    s_cselect_b32 s35, 0, s35
    v_mfma_f32_16x16x32_bf16 v[52:55], v[236:239], v[16:19], v[52:55]
    s_waitcnt lgkmcnt(2)
    v_mfma_f32_16x16x32_bf16 v[40:43], v[240:243], v[20:23], v[40:43]
    ds_read_b128 v[16:19], v6 offset:2048
    v_mfma_f32_16x16x32_bf16 v[44:47], v[244:247], v[20:23], v[44:47]
    v_mov_b32 v2, v6
    v_add_u32 v6, s35, v1
    v_mfma_f32_16x16x32_bf16 v[48:51], v[248:251], v[20:23], v[48:51]
    s_cmp_lt_u32 s22, 64
    v_mfma_f32_16x16x32_bf16 v[52:55], v[252:255], v[20:23], v[52:55]
    s_cbranch_scc1 Lpj12
    v_mul_f32 v40, s27, v40
    v_mul_f32 v41, s27, v41
    v_mul_f32 v42, s27, v42
    v_mul_f32 v43, s27, v43
    v_mul_f32 v44, s27, v44
    v_mul_f32 v45, s27, v45
    v_mul_f32 v46, s27, v46
    v_mul_f32 v47, s27, v47
    v_mul_f32 v48, s27, v48
    v_mul_f32 v49, s27, v49
    v_mul_f32 v50, s27, v50
    v_mul_f32 v51, s27, v51
    v_mul_f32 v52, s27, v52
    v_mul_f32 v53, s27, v53
    v_mul_f32 v54, s27, v54
    v_mul_f32 v55, s27, v55
    v_cvt_pk_bf16_f32 v72, v40, v41
    v_cvt_pk_bf16_f32 v73, v42, v43
    v_cvt_pk_bf16_f32 v74, v48, v49
    v_cvt_pk_bf16_f32 v75, v50, v51
    v_cvt_pk_bf16_f32 v76, v44, v45
    v_cvt_pk_bf16_f32 v77, v46, v47
    v_cvt_pk_bf16_f32 v78, v52, v53
    v_cvt_pk_bf16_f32 v79, v54, v55
    s_mov_b64 vcc, s[32:33]
    v_cndmask_b32_dpp v64, v76, v72, vcc quad_perm:[2,3,0,1] row_mask:0xf bank_mask:0xf
    v_cndmask_b32_dpp v65, v77, v73, vcc quad_perm:[2,3,0,1] row_mask:0xf bank_mask:0xf
    v_cndmask_b32_dpp v66, v78, v74, vcc quad_perm:[2,3,0,1] row_mask:0xf bank_mask:0xf
    v_cndmask_b32_dpp v67, v79, v75, vcc quad_perm:[2,3,0,1] row_mask:0xf bank_mask:0xf
    buffer_store_dwordx4 v[64:67], v1, s[4:7], s34 offen offset:0 sc1
    s_mov_b64 vcc, s[30:31]
    v_cndmask_b32_dpp v68, v72, v76, vcc quad_perm:[2,3,0,1] row_mask:0xf bank_mask:0xf
    v_cndmask_b32_dpp v69, v73, v77, vcc quad_perm:[2,3,0,1] row_mask:0xf bank_mask:0xf
    v_cndmask_b32_dpp v70, v74, v78, vcc quad_perm:[2,3,0,1] row_mask:0xf bank_mask:0xf
    v_cndmask_b32_dpp v71, v75, v79, vcc quad_perm:[2,3,0,1] row_mask:0xf bank_mask:0xf
    buffer_store_dwordx4 v[68:71], v1, s[4:7], s34 offen offset:2048 sc1
    s_branch Lpje15
Lpj13:
    s_waitcnt lgkmcnt(2)
    v_mfma_f32_16x16x32_bf16 v[24:27], v[8:11], a[0:3], 0
    ds_read_b128 v[20:23], v2 offset:3072
    v_mfma_f32_16x16x32_bf16 v[28:31], v[8:11], a[4:7], 0
    v_mfma_f32_16x16x32_bf16 v[32:35], v[8:11], a[8:11], 0
    v_mfma_f32_16x16x32_bf16 v[36:39], v[8:11], a[12:15], 0
    s_waitcnt lgkmcnt(2)
    v_cvt_pk_bf16_f32 v58, v40, v41
    v_cvt_pk_bf16_f32 v59, v42, v43
    v_mfma_f32_16x16x32_bf16 v[24:27], v[12:15], a[16:19], v[24:27]
    ds_read_b128 v[8:11], v2 offset:4096
    v_mfma_f32_16x16x32_bf16 v[28:31], v[12:15], a[20:23], v[28:31]
    buffer_store_dwordx4 v[56:59], v1, s[4:7], s34 offen offset:0 sc1
    v_cvt_pk_bf16_f32 v62, v44, v45
    v_mfma_f32_16x16x32_bf16 v[32:35], v[12:15], a[24:27], v[32:35]
    v_cvt_pk_bf16_f32 v63, v46, v47
    buffer_store_dwordx4 v[60:63], v1, s[4:7], s34 offen offset:1024 sc1
    v_mfma_f32_16x16x32_bf16 v[36:39], v[12:15], a[28:31], v[36:39]
    s_waitcnt lgkmcnt(2)
    v_cvt_pk_bf16_f32 v66, v48, v49
    v_cvt_pk_bf16_f32 v67, v50, v51
    v_mfma_f32_16x16x32_bf16 v[24:27], v[16:19], a[32:35], v[24:27]
    ds_read_b128 v[12:15], v2 offset:5120
    v_mfma_f32_16x16x32_bf16 v[28:31], v[16:19], a[36:39], v[28:31]
    buffer_store_dwordx4 v[64:67], v1, s[4:7], s34 offen offset:2048 sc1
    v_cvt_pk_bf16_f32 v70, v52, v53
    v_mfma_f32_16x16x32_bf16 v[32:35], v[16:19], a[40:43], v[32:35]
    v_cvt_pk_bf16_f32 v71, v54, v55
    buffer_store_dwordx4 v[68:71], v1, s[4:7], s34 offen offset:3072 sc1
    v_mfma_f32_16x16x32_bf16 v[36:39], v[16:19], a[44:47], v[36:39]
    s_waitcnt lgkmcnt(2)
    v_mfma_f32_16x16x32_bf16 v[24:27], v[20:23], a[48:51], v[24:27]
    ds_read_b128 v[16:19], v2 offset:6144
    v_mfma_f32_16x16x32_bf16 v[28:31], v[20:23], a[52:55], v[28:31]
    v_mfma_f32_16x16x32_bf16 v[32:35], v[20:23], a[56:59], v[32:35]
    v_mfma_f32_16x16x32_bf16 v[36:39], v[20:23], a[60:63], v[36:39]
    s_waitcnt lgkmcnt(2)
    v_mfma_f32_16x16x32_bf16 v[24:27], v[8:11], a[64:67], v[24:27]
    ds_read_b128 v[20:23], v2 offset:7168
    v_mfma_f32_16x16x32_bf16 v[28:31], v[8:11], a[68:71], v[28:31]
    v_mfma_f32_16x16x32_bf16 v[32:35], v[8:11], a[72:75], v[32:35]
    v_mfma_f32_16x16x32_bf16 v[36:39], v[8:11], a[76:79], v[36:39]
    s_waitcnt lgkmcnt(2)
    v_mfma_f32_16x16x32_bf16 v[24:27], v[12:15], a[80:83], v[24:27]
    ds_read_b128 v[8:11], v2 offset:8192
    v_mfma_f32_16x16x32_bf16 v[28:31], v[12:15], a[84:87], v[28:31]
    v_mfma_f32_16x16x32_bf16 v[32:35], v[12:15], a[88:91], v[32:35]
    v_mfma_f32_16x16x32_bf16 v[36:39], v[12:15], a[92:95], v[36:39]
    s_waitcnt lgkmcnt(2)
    v_mfma_f32_16x16x32_bf16 v[24:27], v[16:19], a[96:99], v[24:27]
    ds_read_b128 v[12:15], v2 offset:9216
    v_mfma_f32_16x16x32_bf16 v[28:31], v[16:19], a[100:103], v[28:31]
    v_mfma_f32_16x16x32_bf16 v[32:35], v[16:19], a[104:107], v[32:35]
    v_mfma_f32_16x16x32_bf16 v[36:39], v[16:19], a[108:111], v[36:39]
    s_waitcnt lgkmcnt(2)
    v_mfma_f32_16x16x32_bf16 v[24:27], v[20:23], a[112:115], v[24:27]
    ds_read_b128 v[16:19], v2 offset:10240
    v_mfma_f32_16x16x32_bf16 v[28:31], v[20:23], a[116:119], v[28:31]
    v_mfma_f32_16x16x32_bf16 v[32:35], v[20:23], a[120:123], v[32:35]
    v_mfma_f32_16x16x32_bf16 v[36:39], v[20:23], a[124:127], v[36:39]
    s_waitcnt lgkmcnt(2)
    v_mfma_f32_16x16x32_bf16 v[24:27], v[8:11], a[128:131], v[24:27]
    ds_read_b128 v[20:23], v2 offset:11264
    v_mfma_f32_16x16x32_bf16 v[28:31], v[8:11], a[132:135], v[28:31]
    v_mfma_f32_16x16x32_bf16 v[32:35], v[8:11], a[136:139], v[32:35]
    v_mfma_f32_16x16x32_bf16 v[36:39], v[8:11], a[140:143], v[36:39]
    s_waitcnt lgkmcnt(2)
    v_mfma_f32_16x16x32_bf16 v[24:27], v[12:15], a[144:147], v[24:27]
    ds_read_b128 v[8:11], v2 offset:12288
    v_mfma_f32_16x16x32_bf16 v[28:31], v[12:15], a[148:151], v[28:31]
    v_mfma_f32_16x16x32_bf16 v[32:35], v[12:15], a[152:155], v[32:35]
    v_mfma_f32_16x16x32_bf16 v[36:39], v[12:15], a[156:159], v[36:39]
    s_waitcnt lgkmcnt(2)
    v_mfma_f32_16x16x32_bf16 v[24:27], v[16:19], a[160:163], v[24:27]
    ds_read_b128 v[12:15], v2 offset:13312
    v_mfma_f32_16x16x32_bf16 v[28:31], v[16:19], a[164:167], v[28:31]
    v_mfma_f32_16x16x32_bf16 v[32:35], v[16:19], a[168:171], v[32:35]
    v_mfma_f32_16x16x32_bf16 v[36:39], v[16:19], a[172:175], v[36:39]
    s_waitcnt lgkmcnt(2)
    v_mfma_f32_16x16x32_bf16 v[24:27], v[20:23], a[176:179], v[24:27]
    ds_read_b128 v[16:19], v2 offset:14336
    v_mfma_f32_16x16x32_bf16 v[28:31], v[20:23], a[180:183], v[28:31]
    v_mfma_f32_16x16x32_bf16 v[32:35], v[20:23], a[184:187], v[32:35]
    v_mfma_f32_16x16x32_bf16 v[36:39], v[20:23], a[188:191], v[36:39]
    s_waitcnt lgkmcnt(2)
    v_mfma_f32_16x16x32_bf16 v[24:27], v[8:11], a[192:195], v[24:27]
    ds_read_b128 v[20:23], v2 offset:15360
    v_mfma_f32_16x16x32_bf16 v[28:31], v[8:11], a[196:199], v[28:31]
    v_mfma_f32_16x16x32_bf16 v[32:35], v[8:11], a[200:203], v[32:35]
    v_mfma_f32_16x16x32_bf16 v[36:39], v[8:11], a[204:207], v[36:39]
    s_waitcnt lgkmcnt(2)
    v_mfma_f32_16x16x32_bf16 v[24:27], v[12:15], a[208:211], v[24:27]
    ds_read_b128 v[8:11], v2 offset:16384
    v_mfma_f32_16x16x32_bf16 v[28:31], v[12:15], a[212:215], v[28:31]
    v_mfma_f32_16x16x32_bf16 v[32:35], v[12:15], a[216:219], v[32:35]
    v_mfma_f32_16x16x32_bf16 v[36:39], v[12:15], a[220:223], v[36:39]
    s_waitcnt lgkmcnt(2)
    v_mfma_f32_16x16x32_bf16 v[24:27], v[16:19], a[224:227], v[24:27]
    ds_read_b128 v[12:15], v2 offset:17408
    v_mfma_f32_16x16x32_bf16 v[28:31], v[16:19], a[228:231], v[28:31]
    v_mfma_f32_16x16x32_bf16 v[32:35], v[16:19], a[232:235], v[32:35]
    v_mfma_f32_16x16x32_bf16 v[36:39], v[16:19], a[236:239], v[36:39]
    s_waitcnt lgkmcnt(2)
    v_mfma_f32_16x16x32_bf16 v[24:27], v[20:23], a[240:243], v[24:27]
    ds_read_b128 v[16:19], v2 offset:18432
    v_mfma_f32_16x16x32_bf16 v[28:31], v[20:23], a[244:247], v[28:31]
    v_mfma_f32_16x16x32_bf16 v[32:35], v[20:23], a[248:251], v[32:35]
    v_mfma_f32_16x16x32_bf16 v[36:39], v[20:23], a[252:255], v[36:39]
    s_waitcnt lgkmcnt(2)
    v_mfma_f32_16x16x32_bf16 v[24:27], v[8:11], v[192:195], v[24:27]
    ds_read_b128 v[20:23], v2 offset:19456
    v_mfma_f32_16x16x32_bf16 v[28:31], v[8:11], v[196:199], v[28:31]
    v_mfma_f32_16x16x32_bf16 v[32:35], v[8:11], v[200:203], v[32:35]
    s_lshr_b32 s29, s17, 8
    s_and_b32 s29, s29, 0x2000
    s_xor_b32 s29, s17, s29
    s_add_u32 s17, s17, 1048576
    v_mfma_f32_16x16x32_bf16 v[36:39], v[8:11], v[204:207], v[36:39]
    s_waitcnt lgkmcnt(2)
    v_mfma_f32_16x16x32_bf16 v[24:27], v[12:15], v[208:211], v[24:27]
    ds_read_b128 v[8:11], v2 offset:20480
    v_mfma_f32_16x16x32_bf16 v[28:31], v[12:15], v[212:215], v[28:31]
    v_mfma_f32_16x16x32_bf16 v[32:35], v[12:15], v[216:219], v[32:35]
    v_mfma_f32_16x16x32_bf16 v[36:39], v[12:15], v[220:223], v[36:39]
    s_waitcnt lgkmcnt(2)
    v_mfma_f32_16x16x32_bf16 v[24:27], v[16:19], v[224:227], v[24:27]
    ds_read_b128 v[12:15], v2 offset:21504
    v_mfma_f32_16x16x32_bf16 v[28:31], v[16:19], v[228:231], v[28:31]
    v_mfma_f32_16x16x32_bf16 v[32:35], v[16:19], v[232:235], v[32:35]
    v_mfma_f32_16x16x32_bf16 v[36:39], v[16:19], v[236:239], v[36:39]
    s_waitcnt lgkmcnt(2)
    v_mfma_f32_16x16x32_bf16 v[24:27], v[20:23], v[240:243], v[24:27]
    ds_read_b128 v[16:19], v2 offset:22528
    v_mfma_f32_16x16x32_bf16 v[28:31], v[20:23], v[244:247], v[28:31]
    v_mfma_f32_16x16x32_bf16 v[32:35], v[20:23], v[248:251], v[32:35]
    s_waitcnt vmcnt(0)
    v_mov_b32 v4, s22
    v_mov_b32 v5, 0
    s_mov_b64 exec, 1
    buffer_store_dword v4, v5, s[4:7], s21 offen offset:0 sc1
    s_mov_b64 exec, -1
    v_mfma_f32_16x16x32_bf16 v[36:39], v[20:23], v[252:255], v[36:39]
    s_waitcnt lgkmcnt(2)
    v_mfma_f32_16x16x32_bf16 v[40:43], v[8:11], a[0:3], 0
    ds_read_b128 v[20:23], v2 offset:23552
    v_mfma_f32_16x16x32_bf16 v[44:47], v[8:11], a[4:7], 0
    v_mfma_f32_16x16x32_bf16 v[48:51], v[8:11], a[8:11], 0
    v_mfma_f32_16x16x32_bf16 v[52:55], v[8:11], a[12:15], 0
    s_waitcnt lgkmcnt(2)
    v_cvt_pk_bf16_f32 v56, v24, v25
    v_cvt_pk_bf16_f32 v57, v26, v27
    v_mfma_f32_16x16x32_bf16 v[40:43], v[12:15], a[16:19], v[40:43]
    ds_read_b128 v[8:11], v2 offset:24576
    v_mfma_f32_16x16x32_bf16 v[44:47], v[12:15], a[20:23], v[44:47]
    v_cvt_pk_bf16_f32 v60, v28, v29
    v_cvt_pk_bf16_f32 v61, v30, v31
    v_mfma_f32_16x16x32_bf16 v[48:51], v[12:15], a[24:27], v[48:51]
    v_cvt_pk_bf16_f32 v64, v32, v33
    v_cvt_pk_bf16_f32 v65, v34, v35
    v_mfma_f32_16x16x32_bf16 v[52:55], v[12:15], a[28:31], v[52:55]
    s_waitcnt lgkmcnt(2)
    v_cvt_pk_bf16_f32 v68, v36, v37
    v_cvt_pk_bf16_f32 v69, v38, v39
    v_mfma_f32_16x16x32_bf16 v[40:43], v[16:19], a[32:35], v[40:43]
    ds_read_b128 v[12:15], v2 offset:25600
    v_mfma_f32_16x16x32_bf16 v[44:47], v[16:19], a[36:39], v[44:47]
    v_mfma_f32_16x16x32_bf16 v[48:51], v[16:19], a[40:43], v[48:51]
    v_mfma_f32_16x16x32_bf16 v[52:55], v[16:19], a[44:47], v[52:55]
    s_waitcnt lgkmcnt(2)
    v_mfma_f32_16x16x32_bf16 v[40:43], v[20:23], a[48:51], v[40:43]
    ds_read_b128 v[16:19], v2 offset:26624
    v_mfma_f32_16x16x32_bf16 v[44:47], v[20:23], a[52:55], v[44:47]
    v_mfma_f32_16x16x32_bf16 v[48:51], v[20:23], a[56:59], v[48:51]
    v_mfma_f32_16x16x32_bf16 v[52:55], v[20:23], a[60:63], v[52:55]
    s_waitcnt lgkmcnt(2)
    v_mfma_f32_16x16x32_bf16 v[40:43], v[8:11], a[64:67], v[40:43]
    ds_read_b128 v[20:23], v2 offset:27648
    v_mfma_f32_16x16x32_bf16 v[44:47], v[8:11], a[68:71], v[44:47]
    v_mfma_f32_16x16x32_bf16 v[48:51], v[8:11], a[72:75], v[48:51]
    v_mfma_f32_16x16x32_bf16 v[52:55], v[8:11], a[76:79], v[52:55]
    s_waitcnt lgkmcnt(2)
    v_mfma_f32_16x16x32_bf16 v[40:43], v[12:15], a[80:83], v[40:43]
    ds_read_b128 v[8:11], v2 offset:28672
    v_mfma_f32_16x16x32_bf16 v[44:47], v[12:15], a[84:87], v[44:47]
    v_mfma_f32_16x16x32_bf16 v[48:51], v[12:15], a[88:91], v[48:51]
    v_mfma_f32_16x16x32_bf16 v[52:55], v[12:15], a[92:95], v[52:55]
    s_waitcnt lgkmcnt(2)
    v_mfma_f32_16x16x32_bf16 v[40:43], v[16:19], a[96:99], v[40:43]
    ds_read_b128 v[12:15], v2 offset:29696
    v_mfma_f32_16x16x32_bf16 v[44:47], v[16:19], a[100:103], v[44:47]
    v_mfma_f32_16x16x32_bf16 v[48:51], v[16:19], a[104:107], v[48:51]
    s_barrier
    s_add_u32 s26, s26, 40960
    s_cmp_ge_u32 s26, 122880
    s_cselect_b32 s26, s20, s26
    s_add_u32 s19, s19, 40960
    v_mfma_f32_16x16x32_bf16 v[52:55], v[16:19], a[108:111], v[52:55]
    s_waitcnt lgkmcnt(2)
    v_mfma_f32_16x16x32_bf16 v[40:43], v[20:23], a[112:115], v[40:43]
    ds_read_b128 v[16:19], v2 offset:30720
    v_mfma_f32_16x16x32_bf16 v[44:47], v[20:23], a[116:119], v[44:47]
    v_mfma_f32_16x16x32_bf16 v[48:51], v[20:23], a[120:123], v[48:51]
    s_add_u32 m0, s26, 0
    s_add_u32 s25, s19, 0
    buffer_load_dwordx4 v1, s[4:7], s25 offen offset:0 sc1 lds
    v_mfma_f32_16x16x32_bf16 v[52:55], v[20:23], a[124:127], v[52:55]
    s_waitcnt lgkmcnt(2)
    v_mfma_f32_16x16x32_bf16 v[40:43], v[8:11], a[128:131], v[40:43]
    ds_read_b128 v[20:23], v2 offset:31744
    v_mfma_f32_16x16x32_bf16 v[44:47], v[8:11], a[132:135], v[44:47]
    v_mfma_f32_16x16x32_bf16 v[48:51], v[8:11], a[136:139], v[48:51]
    buffer_load_dwordx4 v1, s[4:7], s25 offen offset:1024 sc1 lds
    v_mfma_f32_16x16x32_bf16 v[52:55], v[8:11], a[140:143], v[52:55]
    s_waitcnt lgkmcnt(2)
    v_mfma_f32_16x16x32_bf16 v[40:43], v[12:15], a[144:147], v[40:43]
    ds_read_b128 v[8:11], v2 offset:32768
    v_mfma_f32_16x16x32_bf16 v[44:47], v[12:15], a[148:151], v[44:47]
    v_mfma_f32_16x16x32_bf16 v[48:51], v[12:15], a[152:155], v[48:51]
    buffer_load_dwordx4 v1, s[4:7], s25 offen offset:2048 sc1 lds
    v_mfma_f32_16x16x32_bf16 v[52:55], v[12:15], a[156:159], v[52:55]
    s_waitcnt lgkmcnt(2)
    v_mfma_f32_16x16x32_bf16 v[40:43], v[16:19], a[160:163], v[40:43]
    ds_read_b128 v[12:15], v2 offset:33792
    v_mfma_f32_16x16x32_bf16 v[44:47], v[16:19], a[164:167], v[44:47]
    v_mfma_f32_16x16x32_bf16 v[48:51], v[16:19], a[168:171], v[48:51]
    buffer_load_dwordx4 v1, s[4:7], s25 offen offset:3072 sc1 lds
    v_mfma_f32_16x16x32_bf16 v[52:55], v[16:19], a[172:175], v[52:55]
    s_waitcnt lgkmcnt(2)
    v_mfma_f32_16x16x32_bf16 v[40:43], v[20:23], a[176:179], v[40:43]
    ds_read_b128 v[16:19], v2 offset:34816
    v_mfma_f32_16x16x32_bf16 v[44:47], v[20:23], a[180:183], v[44:47]
    v_mfma_f32_16x16x32_bf16 v[48:51], v[20:23], a[184:187], v[48:51]
    s_add_u32 m0, s26, 4096
    s_add_u32 s25, s19, 4096
    buffer_load_dwordx4 v1, s[4:7], s25 offen offset:0 sc1 lds
    v_mfma_f32_16x16x32_bf16 v[52:55], v[20:23], a[188:191], v[52:55]
    s_waitcnt lgkmcnt(2)
    v_mfma_f32_16x16x32_bf16 v[40:43], v[8:11], a[192:195], v[40:43]
    ds_read_b128 v[20:23], v2 offset:35840
    v_mfma_f32_16x16x32_bf16 v[44:47], v[8:11], a[196:199], v[44:47]
    v_mfma_f32_16x16x32_bf16 v[48:51], v[8:11], a[200:203], v[48:51]
    buffer_load_dwordx4 v1, s[4:7], s25 offen offset:1024 sc1 lds
    v_mfma_f32_16x16x32_bf16 v[52:55], v[8:11], a[204:207], v[52:55]
    s_waitcnt lgkmcnt(2)
    v_mfma_f32_16x16x32_bf16 v[40:43], v[12:15], a[208:211], v[40:43]
    ds_read_b128 v[8:11], v2 offset:36864
    v_mfma_f32_16x16x32_bf16 v[44:47], v[12:15], a[212:215], v[44:47]
    v_mfma_f32_16x16x32_bf16 v[48:51], v[12:15], a[216:219], v[48:51]
    buffer_load_dwordx4 v1, s[4:7], s25 offen offset:2048 sc1 lds
    v_mfma_f32_16x16x32_bf16 v[52:55], v[12:15], a[220:223], v[52:55]
    s_waitcnt lgkmcnt(2)
    v_mfma_f32_16x16x32_bf16 v[40:43], v[16:19], a[224:227], v[40:43]
    ds_read_b128 v[12:15], v2 offset:37888
    v_mfma_f32_16x16x32_bf16 v[44:47], v[16:19], a[228:231], v[44:47]
    v_mfma_f32_16x16x32_bf16 v[48:51], v[16:19], a[232:235], v[48:51]
    buffer_load_dwordx4 v1, s[4:7], s25 offen offset:3072 sc1 lds
    v_mfma_f32_16x16x32_bf16 v[52:55], v[16:19], a[236:239], v[52:55]
    s_waitcnt lgkmcnt(2)
    v_mfma_f32_16x16x32_bf16 v[40:43], v[20:23], a[240:243], v[40:43]
    ds_read_b128 v[16:19], v2 offset:38912
    v_mfma_f32_16x16x32_bf16 v[44:47], v[20:23], a[244:247], v[44:47]
    v_mfma_f32_16x16x32_bf16 v[48:51], v[20:23], a[248:251], v[48:51]
    s_add_u32 m0, s26, 8192
    s_add_u32 s25, s19, 8192
    buffer_load_dwordx4 v1, s[4:7], s25 offen offset:0 sc1 lds
    v_mfma_f32_16x16x32_bf16 v[52:55], v[20:23], a[252:255], v[52:55]
    s_waitcnt lgkmcnt(2)
    v_mfma_f32_16x16x32_bf16 v[40:43], v[8:11], v[192:195], v[40:43]
    ds_read_b128 v[20:23], v2 offset:39936
    v_mfma_f32_16x16x32_bf16 v[44:47], v[8:11], v[196:199], v[44:47]
    v_mfma_f32_16x16x32_bf16 v[48:51], v[8:11], v[200:203], v[48:51]
    buffer_load_dwordx4 v1, s[4:7], s25 offen offset:1024 sc1 lds
    v_mfma_f32_16x16x32_bf16 v[52:55], v[8:11], v[204:207], v[52:55]
    s_waitcnt lgkmcnt(2)
    v_mfma_f32_16x16x32_bf16 v[40:43], v[12:15], v[208:211], v[40:43]
    ds_read_b128 v[8:11], v6 offset:0
    v_mfma_f32_16x16x32_bf16 v[44:47], v[12:15], v[212:215], v[44:47]
    v_mfma_f32_16x16x32_bf16 v[48:51], v[12:15], v[216:219], v[48:51]
    v_mfma_f32_16x16x32_bf16 v[52:55], v[12:15], v[220:223], v[52:55]
    s_waitcnt lgkmcnt(2)
    v_mfma_f32_16x16x32_bf16 v[40:43], v[16:19], v[224:227], v[40:43]
    ds_read_b128 v[12:15], v6 offset:1024
    v_mfma_f32_16x16x32_bf16 v[44:47], v[16:19], v[228:231], v[44:47]
    v_mfma_f32_16x16x32_bf16 v[48:51], v[16:19], v[232:235], v[48:51]
    s_add_u32 s34, s29, 0
    s_add_u32 s22, s22, 1
    s_add_u32 s35, s35, 40960
    s_cmp_ge_u32 s35, 122880
    s_cselect_b32 s35, 0, s35
    v_mfma_f32_16x16x32_bf16 v[52:55], v[16:19], v[236:239], v[52:55]
    s_waitcnt lgkmcnt(2)
    v_mfma_f32_16x16x32_bf16 v[40:43], v[20:23], v[240:243], v[40:43]
    ds_read_b128 v[16:19], v6 offset:2048
    v_mfma_f32_16x16x32_bf16 v[44:47], v[20:23], v[244:247], v[44:47]
    v_mov_b32 v2, v6
    v_add_u32 v6, s35, v1
    v_mfma_f32_16x16x32_bf16 v[48:51], v[20:23], v[248:251], v[48:51]
    s_cmp_lt_u32 s22, 64
    v_mfma_f32_16x16x32_bf16 v[52:55], v[20:23], v[252:255], v[52:55]
    s_cbranch_scc1 Lpj13
    v_cvt_pk_bf16_f32 v58, v40, v41
    v_cvt_pk_bf16_f32 v59, v42, v43
    buffer_store_dwordx4 v[56:59], v1, s[4:7], s34 offen offset:0 sc1
    v_cvt_pk_bf16_f32 v62, v44, v45
    v_cvt_pk_bf16_f32 v63, v46, v47
    buffer_store_dwordx4 v[60:63], v1, s[4:7], s34 offen offset:1024 sc1
    v_cvt_pk_bf16_f32 v66, v48, v49
    v_cvt_pk_bf16_f32 v67, v50, v51
    buffer_store_dwordx4 v[64:67], v1, s[4:7], s34 offen offset:2048 sc1
    v_cvt_pk_bf16_f32 v70, v52, v53
    v_cvt_pk_bf16_f32 v71, v54, v55
    buffer_store_dwordx4 v[68:71], v1, s[4:7], s34 offen offset:3072 sc1
    s_branch Lpje15
Lpj14:
    s_waitcnt lgkmcnt(2)
    v_mfma_f32_16x16x32_bf16 v[24:27], a[0:3], v[8:11], 0
    ds_read_b128 v[20:23], v2 offset:3072
    v_mfma_f32_16x16x32_bf16 v[28:31], a[4:7], v[8:11], 0
    v_mfma_f32_16x16x32_bf16 v[32:35], a[8:11], v[8:11], 0
    v_mfma_f32_16x16x32_bf16 v[36:39], a[12:15], v[8:11], 0
    s_waitcnt lgkmcnt(2)
    v_cvt_pk_bf16_f32 v64, v40, v41
    v_cvt_pk_bf16_f32 v65, v42, v43
    v_mfma_f32_16x16x32_bf16 v[24:27], a[16:19], v[12:15], v[24:27]
    ds_read_b128 v[8:11], v2 offset:4096
    v_mfma_f32_16x16x32_bf16 v[28:31], a[20:23], v[12:15], v[28:31]
    v_cvt_pk_bf16_f32 v66, v48, v49
    v_cvt_pk_bf16_f32 v67, v50, v51
    v_mfma_f32_16x16x32_bf16 v[32:35], a[24:27], v[12:15], v[32:35]
    buffer_store_dwordx4 v[64:67], v1, s[4:7], s34 offen offset:0 sc1
    v_cvt_pk_bf16_f32 v68, v44, v45
    v_mfma_f32_16x16x32_bf16 v[36:39], a[28:31], v[12:15], v[36:39]
    s_waitcnt lgkmcnt(2)
    v_cvt_pk_bf16_f32 v69, v46, v47
    v_cvt_pk_bf16_f32 v70, v52, v53
    v_mfma_f32_16x16x32_bf16 v[24:27], a[32:35], v[16:19], v[24:27]
    ds_read_b128 v[12:15], v2 offset:5120
    v_mfma_f32_16x16x32_bf16 v[28:31], a[36:39], v[16:19], v[28:31]
    v_cvt_pk_bf16_f32 v71, v54, v55
    buffer_store_dwordx4 v[68:71], v1, s[4:7], s34 offen offset:1024 sc1
    v_mfma_f32_16x16x32_bf16 v[32:35], a[40:43], v[16:19], v[32:35]
    v_mfma_f32_16x16x32_bf16 v[36:39], a[44:47], v[16:19], v[36:39]
    s_waitcnt lgkmcnt(2)
    v_mfma_f32_16x16x32_bf16 v[24:27], a[48:51], v[20:23], v[24:27]
    ds_read_b128 v[16:19], v2 offset:6144
    v_mfma_f32_16x16x32_bf16 v[28:31], a[52:55], v[20:23], v[28:31]
    v_mfma_f32_16x16x32_bf16 v[32:35], a[56:59], v[20:23], v[32:35]
    v_mfma_f32_16x16x32_bf16 v[36:39], a[60:63], v[20:23], v[36:39]
    s_waitcnt lgkmcnt(2)
    v_mfma_f32_16x16x32_bf16 v[24:27], a[64:67], v[8:11], v[24:27]
    ds_read_b128 v[20:23], v2 offset:7168
    v_mfma_f32_16x16x32_bf16 v[28:31], a[68:71], v[8:11], v[28:31]
    v_mfma_f32_16x16x32_bf16 v[32:35], a[72:75], v[8:11], v[32:35]
    v_mfma_f32_16x16x32_bf16 v[36:39], a[76:79], v[8:11], v[36:39]
    s_waitcnt lgkmcnt(2)
    v_mfma_f32_16x16x32_bf16 v[24:27], a[80:83], v[12:15], v[24:27]
    ds_read_b128 v[8:11], v2 offset:8192
    v_mfma_f32_16x16x32_bf16 v[28:31], a[84:87], v[12:15], v[28:31]
    v_mfma_f32_16x16x32_bf16 v[32:35], a[88:91], v[12:15], v[32:35]
    v_mfma_f32_16x16x32_bf16 v[36:39], a[92:95], v[12:15], v[36:39]
    s_waitcnt lgkmcnt(2)
    v_mfma_f32_16x16x32_bf16 v[24:27], a[96:99], v[16:19], v[24:27]
    ds_read_b128 v[12:15], v2 offset:9216
    v_mfma_f32_16x16x32_bf16 v[28:31], a[100:103], v[16:19], v[28:31]
    v_mfma_f32_16x16x32_bf16 v[32:35], a[104:107], v[16:19], v[32:35]
    v_mfma_f32_16x16x32_bf16 v[36:39], a[108:111], v[16:19], v[36:39]
    s_waitcnt lgkmcnt(2)
    v_mfma_f32_16x16x32_bf16 v[24:27], a[112:115], v[20:23], v[24:27]
    ds_read_b128 v[16:19], v2 offset:10240
    v_mfma_f32_16x16x32_bf16 v[28:31], a[116:119], v[20:23], v[28:31]
    v_mfma_f32_16x16x32_bf16 v[32:35], a[120:123], v[20:23], v[32:35]
    v_mfma_f32_16x16x32_bf16 v[36:39], a[124:127], v[20:23], v[36:39]
    s_waitcnt lgkmcnt(2)
    v_mfma_f32_16x16x32_bf16 v[24:27], a[128:131], v[8:11], v[24:27]
    ds_read_b128 v[20:23], v2 offset:11264
    v_mfma_f32_16x16x32_bf16 v[28:31], a[132:135], v[8:11], v[28:31]
    v_mfma_f32_16x16x32_bf16 v[32:35], a[136:139], v[8:11], v[32:35]
    v_mfma_f32_16x16x32_bf16 v[36:39], a[140:143], v[8:11], v[36:39]
    s_waitcnt lgkmcnt(2)
    v_mfma_f32_16x16x32_bf16 v[24:27], a[144:147], v[12:15], v[24:27]
    ds_read_b128 v[8:11], v2 offset:12288
    v_mfma_f32_16x16x32_bf16 v[28:31], a[148:151], v[12:15], v[28:31]
    v_mfma_f32_16x16x32_bf16 v[32:35], a[152:155], v[12:15], v[32:35]
    v_mfma_f32_16x16x32_bf16 v[36:39], a[156:159], v[12:15], v[36:39]
    s_waitcnt lgkmcnt(2)
    v_mfma_f32_16x16x32_bf16 v[24:27], a[160:163], v[16:19], v[24:27]
    ds_read_b128 v[12:15], v2 offset:13312
    v_mfma_f32_16x16x32_bf16 v[28:31], a[164:167], v[16:19], v[28:31]
    v_mfma_f32_16x16x32_bf16 v[32:35], a[168:171], v[16:19], v[32:35]
    v_mfma_f32_16x16x32_bf16 v[36:39], a[172:175], v[16:19], v[36:39]
    s_waitcnt lgkmcnt(2)
    v_mfma_f32_16x16x32_bf16 v[24:27], a[176:179], v[20:23], v[24:27]
    ds_read_b128 v[16:19], v2 offset:14336
    v_mfma_f32_16x16x32_bf16 v[28:31], a[180:183], v[20:23], v[28:31]
    v_mfma_f32_16x16x32_bf16 v[32:35], a[184:187], v[20:23], v[32:35]
    v_mfma_f32_16x16x32_bf16 v[36:39], a[188:191], v[20:23], v[36:39]
    s_waitcnt lgkmcnt(2)
    v_mfma_f32_16x16x32_bf16 v[24:27], a[192:195], v[8:11], v[24:27]
    ds_read_b128 v[20:23], v2 offset:15360
    v_mfma_f32_16x16x32_bf16 v[28:31], a[196:199], v[8:11], v[28:31]
    v_mfma_f32_16x16x32_bf16 v[32:35], a[200:203], v[8:11], v[32:35]
    v_mfma_f32_16x16x32_bf16 v[36:39], a[204:207], v[8:11], v[36:39]
    s_waitcnt lgkmcnt(2)
    v_mfma_f32_16x16x32_bf16 v[24:27], a[208:211], v[12:15], v[24:27]
    ds_read_b128 v[8:11], v2 offset:16384
    v_mfma_f32_16x16x32_bf16 v[28:31], a[212:215], v[12:15], v[28:31]
    v_mfma_f32_16x16x32_bf16 v[32:35], a[216:219], v[12:15], v[32:35]
    v_mfma_f32_16x16x32_bf16 v[36:39], a[220:223], v[12:15], v[36:39]
    s_waitcnt lgkmcnt(2)
    v_mfma_f32_16x16x32_bf16 v[24:27], a[224:227], v[16:19], v[24:27]
    ds_read_b128 v[12:15], v2 offset:17408
    v_mfma_f32_16x16x32_bf16 v[28:31], a[228:231], v[16:19], v[28:31]
    v_mfma_f32_16x16x32_bf16 v[32:35], a[232:235], v[16:19], v[32:35]
    v_mfma_f32_16x16x32_bf16 v[36:39], a[236:239], v[16:19], v[36:39]
    s_waitcnt lgkmcnt(2)
    v_mfma_f32_16x16x32_bf16 v[24:27], a[240:243], v[20:23], v[24:27]
    ds_read_b128 v[16:19], v2 offset:18432
    v_mfma_f32_16x16x32_bf16 v[28:31], a[244:247], v[20:23], v[28:31]
    v_mfma_f32_16x16x32_bf16 v[32:35], a[248:251], v[20:23], v[32:35]
    v_mfma_f32_16x16x32_bf16 v[36:39], a[252:255], v[20:23], v[36:39]
    s_waitcnt lgkmcnt(2)
    v_mfma_f32_16x16x32_bf16 v[24:27], v[192:195], v[8:11], v[24:27]
    ds_read_b128 v[20:23], v2 offset:19456
    v_mfma_f32_16x16x32_bf16 v[28:31], v[196:199], v[8:11], v[28:31]
    v_mfma_f32_16x16x32_bf16 v[32:35], v[200:203], v[8:11], v[32:35]
    s_lshr_b32 s29, s17, 8
    s_and_b32 s29, s29, 0x2000
    s_xor_b32 s29, s17, s29
    s_add_u32 s17, s17, 1048576
    v_mfma_f32_16x16x32_bf16 v[36:39], v[204:207], v[8:11], v[36:39]
    s_waitcnt lgkmcnt(2)
    v_mfma_f32_16x16x32_bf16 v[24:27], v[208:211], v[12:15], v[24:27]
    ds_read_b128 v[8:11], v2 offset:20480
    v_mfma_f32_16x16x32_bf16 v[28:31], v[212:215], v[12:15], v[28:31]
    v_mfma_f32_16x16x32_bf16 v[32:35], v[216:219], v[12:15], v[32:35]
    v_mfma_f32_16x16x32_bf16 v[36:39], v[220:223], v[12:15], v[36:39]
    s_waitcnt lgkmcnt(2)
    v_mfma_f32_16x16x32_bf16 v[24:27], v[224:227], v[16:19], v[24:27]
    ds_read_b128 v[12:15], v2 offset:21504
    v_mfma_f32_16x16x32_bf16 v[28:31], v[228:231], v[16:19], v[28:31]
    v_mfma_f32_16x16x32_bf16 v[32:35], v[232:235], v[16:19], v[32:35]
    v_mfma_f32_16x16x32_bf16 v[36:39], v[236:239], v[16:19], v[36:39]
    s_waitcnt lgkmcnt(2)
    v_mfma_f32_16x16x32_bf16 v[24:27], v[240:243], v[20:23], v[24:27]
    ds_read_b128 v[16:19], v2 offset:22528
    v_mfma_f32_16x16x32_bf16 v[28:31], v[244:247], v[20:23], v[28:31]
    v_mfma_f32_16x16x32_bf16 v[32:35], v[248:251], v[20:23], v[32:35]
    s_waitcnt vmcnt(0)
    v_mov_b32 v4, s22
    v_mov_b32 v5, 0
    s_mov_b64 exec, 1
    buffer_store_dword v4, v5, s[4:7], s21 offen offset:0 sc1
    s_mov_b64 exec, -1
    v_mfma_f32_16x16x32_bf16 v[36:39], v[252:255], v[20:23], v[36:39]
    s_waitcnt lgkmcnt(2)
    v_mfma_f32_16x16x32_bf16 v[40:43], a[0:3], v[8:11], 0
    ds_read_b128 v[20:23], v2 offset:23552
    v_mfma_f32_16x16x32_bf16 v[44:47], a[4:7], v[8:11], 0
    v_mfma_f32_16x16x32_bf16 v[48:51], a[8:11], v[8:11], 0
    v_mfma_f32_16x16x32_bf16 v[52:55], a[12:15], v[8:11], 0
    s_waitcnt lgkmcnt(2)
    v_cvt_pk_bf16_f32 v56, v24, v25
    v_cvt_pk_bf16_f32 v57, v26, v27
    v_mfma_f32_16x16x32_bf16 v[40:43], a[16:19], v[12:15], v[40:43]
    ds_read_b128 v[8:11], v2 offset:24576
    v_mfma_f32_16x16x32_bf16 v[44:47], a[20:23], v[12:15], v[44:47]
    v_cvt_pk_bf16_f32 v58, v32, v33
    v_cvt_pk_bf16_f32 v59, v34, v35
    v_mfma_f32_16x16x32_bf16 v[48:51], a[24:27], v[12:15], v[48:51]
    buffer_store_dwordx4 v[56:59], v1, s[4:7], s29 offen offset:0 sc1
    v_cvt_pk_bf16_f32 v60, v28, v29
    v_mfma_f32_16x16x32_bf16 v[52:55], a[28:31], v[12:15], v[52:55]
    s_waitcnt lgkmcnt(2)
    v_cvt_pk_bf16_f32 v61, v30, v31
    v_cvt_pk_bf16_f32 v62, v36, v37
    v_mfma_f32_16x16x32_bf16 v[40:43], a[32:35], v[16:19], v[40:43]
    ds_read_b128 v[12:15], v2 offset:25600
    v_mfma_f32_16x16x32_bf16 v[44:47], a[36:39], v[16:19], v[44:47]
    v_cvt_pk_bf16_f32 v63, v38, v39
    buffer_store_dwordx4 v[60:63], v1, s[4:7], s29 offen offset:1024 sc1
    v_mfma_f32_16x16x32_bf16 v[48:51], a[40:43], v[16:19], v[48:51]
    v_mfma_f32_16x16x32_bf16 v[52:55], a[44:47], v[16:19], v[52:55]
    s_waitcnt lgkmcnt(2)
    v_mfma_f32_16x16x32_bf16 v[40:43], a[48:51], v[20:23], v[40:43]
    ds_read_b128 v[16:19], v2 offset:26624
    v_mfma_f32_16x16x32_bf16 v[44:47], a[52:55], v[20:23], v[44:47]
    v_mfma_f32_16x16x32_bf16 v[48:51], a[56:59], v[20:23], v[48:51]
    v_mfma_f32_16x16x32_bf16 v[52:55], a[60:63], v[20:23], v[52:55]
    s_waitcnt lgkmcnt(2)
    v_mfma_f32_16x16x32_bf16 v[40:43], a[64:67], v[8:11], v[40:43]
    ds_read_b128 v[20:23], v2 offset:27648
    v_mfma_f32_16x16x32_bf16 v[44:47], a[68:71], v[8:11], v[44:47]
    v_mfma_f32_16x16x32_bf16 v[48:51], a[72:75], v[8:11], v[48:51]
    v_mfma_f32_16x16x32_bf16 v[52:55], a[76:79], v[8:11], v[52:55]
    s_waitcnt lgkmcnt(2)
    v_mfma_f32_16x16x32_bf16 v[40:43], a[80:83], v[12:15], v[40:43]
    ds_read_b128 v[8:11], v2 offset:28672
    v_mfma_f32_16x16x32_bf16 v[44:47], a[84:87], v[12:15], v[44:47]
    v_mfma_f32_16x16x32_bf16 v[48:51], a[88:91], v[12:15], v[48:51]
    v_mfma_f32_16x16x32_bf16 v[52:55], a[92:95], v[12:15], v[52:55]
    s_waitcnt lgkmcnt(2)
    v_mfma_f32_16x16x32_bf16 v[40:43], a[96:99], v[16:19], v[40:43]
    ds_read_b128 v[12:15], v2 offset:29696
    v_mfma_f32_16x16x32_bf16 v[44:47], a[100:103], v[16:19], v[44:47]
    v_mfma_f32_16x16x32_bf16 v[48:51], a[104:107], v[16:19], v[48:51]
    s_barrier
    s_add_u32 s26, s26, 40960
    s_cmp_ge_u32 s26, 122880
    s_cselect_b32 s26, s20, s26
    s_add_u32 s19, s19, 40960
    v_mfma_f32_16x16x32_bf16 v[52:55], a[108:111], v[16:19], v[52:55]
    s_waitcnt lgkmcnt(2)
    v_mfma_f32_16x16x32_bf16 v[40:43], a[112:115], v[20:23], v[40:43]
    ds_read_b128 v[16:19], v2 offset:30720
    v_mfma_f32_16x16x32_bf16 v[44:47], a[116:119], v[20:23], v[44:47]
    v_mfma_f32_16x16x32_bf16 v[48:51], a[120:123], v[20:23], v[48:51]
    s_add_u32 m0, s26, 0
    s_add_u32 s25, s19, 0
    buffer_load_dwordx4 v1, s[4:7], s25 offen offset:0 sc1 lds
    v_mfma_f32_16x16x32_bf16 v[52:55], a[124:127], v[20:23], v[52:55]
    s_waitcnt lgkmcnt(2)
    v_mfma_f32_16x16x32_bf16 v[40:43], a[128:131], v[8:11], v[40:43]
    ds_read_b128 v[20:23], v2 offset:31744
    v_mfma_f32_16x16x32_bf16 v[44:47], a[132:135], v[8:11], v[44:47]
    v_mfma_f32_16x16x32_bf16 v[48:51], a[136:139], v[8:11], v[48:51]
    buffer_load_dwordx4 v1, s[4:7], s25 offen offset:1024 sc1 lds
    v_mfma_f32_16x16x32_bf16 v[52:55], a[140:143], v[8:11], v[52:55]
    s_waitcnt lgkmcnt(2)
    v_mfma_f32_16x16x32_bf16 v[40:43], a[144:147], v[12:15], v[40:43]
    ds_read_b128 v[8:11], v2 offset:32768
    v_mfma_f32_16x16x32_bf16 v[44:47], a[148:151], v[12:15], v[44:47]
    v_mfma_f32_16x16x32_bf16 v[48:51], a[152:155], v[12:15], v[48:51]
    buffer_load_dwordx4 v1, s[4:7], s25 offen offset:2048 sc1 lds
    v_mfma_f32_16x16x32_bf16 v[52:55], a[156:159], v[12:15], v[52:55]
    s_waitcnt lgkmcnt(2)
    v_mfma_f32_16x16x32_bf16 v[40:43], a[160:163], v[16:19], v[40:43]
    ds_read_b128 v[12:15], v2 offset:33792
    v_mfma_f32_16x16x32_bf16 v[44:47], a[164:167], v[16:19], v[44:47]
    v_mfma_f32_16x16x32_bf16 v[48:51], a[168:171], v[16:19], v[48:51]
    buffer_load_dwordx4 v1, s[4:7], s25 offen offset:3072 sc1 lds
    v_mfma_f32_16x16x32_bf16 v[52:55], a[172:175], v[16:19], v[52:55]
    s_waitcnt lgkmcnt(2)
    v_mfma_f32_16x16x32_bf16 v[40:43], a[176:179], v[20:23], v[40:43]
    ds_read_b128 v[16:19], v2 offset:34816
    v_mfma_f32_16x16x32_bf16 v[44:47], a[180:183], v[20:23], v[44:47]
    v_mfma_f32_16x16x32_bf16 v[48:51], a[184:187], v[20:23], v[48:51]
    s_add_u32 m0, s26, 4096
    s_add_u32 s25, s19, 4096
    buffer_load_dwordx4 v1, s[4:7], s25 offen offset:0 sc1 lds
    v_mfma_f32_16x16x32_bf16 v[52:55], a[188:191], v[20:23], v[52:55]
    s_waitcnt lgkmcnt(2)
    v_mfma_f32_16x16x32_bf16 v[40:43], a[192:195], v[8:11], v[40:43]
    ds_read_b128 v[20:23], v2 offset:35840
    v_mfma_f32_16x16x32_bf16 v[44:47], a[196:199], v[8:11], v[44:47]
    v_mfma_f32_16x16x32_bf16 v[48:51], a[200:203], v[8:11], v[48:51]
    buffer_load_dwordx4 v1, s[4:7], s25 offen offset:1024 sc1 lds
    v_mfma_f32_16x16x32_bf16 v[52:55], a[204:207], v[8:11], v[52:55]
    s_waitcnt lgkmcnt(2)
    v_mfma_f32_16x16x32_bf16 v[40:43], a[208:211], v[12:15], v[40:43]
    ds_read_b128 v[8:11], v2 offset:36864
    v_mfma_f32_16x16x32_bf16 v[44:47], a[212:215], v[12:15], v[44:47]
    v_mfma_f32_16x16x32_bf16 v[48:51], a[216:219], v[12:15], v[48:51]
    buffer_load_dwordx4 v1, s[4:7], s25 offen offset:2048 sc1 lds
    v_mfma_f32_16x16x32_bf16 v[52:55], a[220:223], v[12:15], v[52:55]
    s_waitcnt lgkmcnt(2)
    v_mfma_f32_16x16x32_bf16 v[40:43], a[224:227], v[16:19], v[40:43]
    ds_read_b128 v[12:15], v2 offset:37888
    v_mfma_f32_16x16x32_bf16 v[44:47], a[228:231], v[16:19], v[44:47]
    v_mfma_f32_16x16x32_bf16 v[48:51], a[232:235], v[16:19], v[48:51]
    buffer_load_dwordx4 v1, s[4:7], s25 offen offset:3072 sc1 lds
    v_mfma_f32_16x16x32_bf16 v[52:55], a[236:239], v[16:19], v[52:55]
    s_waitcnt lgkmcnt(2)
    v_mfma_f32_16x16x32_bf16 v[40:43], a[240:243], v[20:23], v[40:43]
    ds_read_b128 v[16:19], v2 offset:38912
    v_mfma_f32_16x16x32_bf16 v[44:47], a[244:247], v[20:23], v[44:47]
    v_mfma_f32_16x16x32_bf16 v[48:51], a[248:251], v[20:23], v[48:51]
    s_add_u32 m0, s26, 8192
    s_add_u32 s25, s19, 8192
    buffer_load_dwordx4 v1, s[4:7], s25 offen offset:0 sc1 lds
    v_mfma_f32_16x16x32_bf16 v[52:55], a[252:255], v[20:23], v[52:55]
    s_waitcnt lgkmcnt(2)
    v_mfma_f32_16x16x32_bf16 v[40:43], v[192:195], v[8:11], v[40:43]
    ds_read_b128 v[20:23], v2 offset:39936
    v_mfma_f32_16x16x32_bf16 v[44:47], v[196:199], v[8:11], v[44:47]
    v_mfma_f32_16x16x32_bf16 v[48:51], v[200:203], v[8:11], v[48:51]
    buffer_load_dwordx4 v1, s[4:7], s25 offen offset:1024 sc1 lds
    v_mfma_f32_16x16x32_bf16 v[52:55], v[204:207], v[8:11], v[52:55]
    s_waitcnt lgkmcnt(2)
    v_mfma_f32_16x16x32_bf16 v[40:43], v[208:211], v[12:15], v[40:43]
    ds_read_b128 v[8:11], v6 offset:0
    v_mfma_f32_16x16x32_bf16 v[44:47], v[212:215], v[12:15], v[44:47]
    v_mfma_f32_16x16x32_bf16 v[48:51], v[216:219], v[12:15], v[48:51]
    v_mfma_f32_16x16x32_bf16 v[52:55], v[220:223], v[12:15], v[52:55]
    s_waitcnt lgkmcnt(2)
    v_mfma_f32_16x16x32_bf16 v[40:43], v[224:227], v[16:19], v[40:43]
    ds_read_b128 v[12:15], v6 offset:1024
    v_mfma_f32_16x16x32_bf16 v[44:47], v[228:231], v[16:19], v[44:47]
    v_mfma_f32_16x16x32_bf16 v[48:51], v[232:235], v[16:19], v[48:51]
    s_add_u32 s34, s29, 4096
    s_add_u32 s22, s22, 1
    s_add_u32 s35, s35, 40960
    s_cmp_ge_u32 s35, 122880
    s_cselect_b32 s35, 0, s35
    v_mfma_f32_16x16x32_bf16 v[52:55], v[236:239], v[16:19], v[52:55]
    s_waitcnt lgkmcnt(2)
    v_mfma_f32_16x16x32_bf16 v[40:43], v[240:243], v[20:23], v[40:43]
    ds_read_b128 v[16:19], v6 offset:2048
    v_mfma_f32_16x16x32_bf16 v[44:47], v[244:247], v[20:23], v[44:47]
    v_mov_b32 v2, v6
    v_add_u32 v6, s35, v1
    v_mfma_f32_16x16x32_bf16 v[48:51], v[248:251], v[20:23], v[48:51]
    s_nop 1
    s_cmp_lt_u32 s22, 64
    v_mfma_f32_16x16x32_bf16 v[52:55], v[252:255], v[20:23], v[52:55]
    s_cbranch_scc1 Lpj14
    v_cvt_pk_bf16_f32 v64, v40, v41
    v_cvt_pk_bf16_f32 v65, v42, v43
    s_nop 0
    v_cvt_pk_bf16_f32 v66, v48, v49
    v_cvt_pk_bf16_f32 v67, v50, v51
    buffer_store_dwordx4 v[64:67], v1, s[4:7], s34 offen offset:0 sc1
    v_cvt_pk_bf16_f32 v68, v44, v45
    v_cvt_pk_bf16_f32 v69, v46, v47
    v_cvt_pk_bf16_f32 v70, v52, v53
    v_cvt_pk_bf16_f32 v71, v54, v55
    buffer_store_dwordx4 v[68:71], v1, s[4:7], s34 offen offset:1024 sc1
    s_branch Lpje15
Lpje15:
    s_waitcnt vmcnt(0)
    v_mov_b32 v4, s22
    v_mov_b32 v5, 0
    s_mov_b64 exec, 1
    buffer_store_dword v4, v5, s[4:7], s21 offen offset:0 sc1
    s_mov_b64 exec, -1
    s_waitcnt vmcnt(0)
    s_endpgm
L_post:
    s_sub_u32 s16, s3, 4
    s_lshl_b32 s16, s16, 5
    s_add_u32 s24, s12, 24
    s_and_b32 s24, s24, 31
    s_add_u32 s16, s16, s24
    s_load_dwordx2 s[8:9], s[0:1], 0
    s_waitcnt lgkmcnt(0)
    s_mov_b32 s10, 2621440
    s_mov_b32 s11, 0x20000
    s_sub_u32 s19, 127, s16
    v_and_b32 v2, 3, v0
    v_lshrrev_b32 v3, 2, v0
    v_lshlrev_b32 v12, 4, v3
    v_mul_u32_u24 v4, 1280, v2
    v_add_u32 v4, v4, v12
    v_lshlrev_b32 v13, 8, v3
    v_lshl_add_u32 v13, v2, 4, v13
    s_lshl_b32 s17, s19, 2
    s_add_u32 s17, s17, s13
    s_mul_i32 s17, s17, 5120
    buffer_load_dwordx4 v[80:83], v4, s[8:11], s17 offen offset:0
    buffer_load_dwordx4 v[84:87], v4, s[8:11], s17 offen offset:256
    buffer_load_dwordx4 v[88:91], v4, s[8:11], s17 offen offset:512
    buffer_load_dwordx4 v[92:95], v4, s[8:11], s17 offen offset:768
    buffer_load_dwordx4 v[96:99], v4, s[8:11], s17 offen offset:1024
    s_sub_u32 s17, s16, 0
    s_cmp_ge_u32 s17, 40
    s_cbranch_scc1 Lnomod16
    s_load_dwordx2 s[8:9], s[0:1], 104
    s_waitcnt lgkmcnt(0)
    s_mov_b32 s10, 4915200
    s_mov_b32 s11, 0x20000
    s_load_dwordx2 s[20:21], s[0:1], 96
    s_waitcnt lgkmcnt(0)
    s_mov_b32 s22, 1280
    s_mov_b32 s23, 0x20000
    v_lshrrev_b32 v2, 2, v0
    v_and_b32 v3, 3, v0
    v_mul_u32_u24 v4, 7680, v2
    v_lshl_add_u32 v4, v3, 4, v4
    v_lshlrev_b32 v5, 1, v2
    s_mul_i32 s17, s13, 1228800
    s_lshl_b32 s18, s16, 6
    s_add_u32 s17, s17, s18
    s_mul_i32 s18, s13, 320
    buffer_load_ushort v56, v5, s[20:23], s18 offen offset:0
    buffer_load_ushort v57, v5, s[20:23], s18 offen offset:32
    buffer_load_ushort v58, v5, s[20:23], s18 offen offset:64
    buffer_load_ushort v59, v5, s[20:23], s18 offen offset:96
    buffer_load_ushort v60, v5, s[20:23], s18 offen offset:128
    buffer_load_ushort v61, v5, s[20:23], s18 offen offset:160
    buffer_load_ushort v62, v5, s[20:23], s18 offen offset:192
    buffer_load_ushort v63, v5, s[20:23], s18 offen offset:224
    buffer_load_ushort v64, v5, s[20:23], s18 offen offset:256
    buffer_load_ushort v65, v5, s[20:23], s18 offen offset:288
    buffer_load_dwordx4 v[16:19], v4, s[8:11], s17 offen
    s_add_u32 s17, s17, 122880
    buffer_load_dwordx4 v[20:23], v4, s[8:11], s17 offen
    s_add_u32 s17, s17, 122880
    buffer_load_dwordx4 v[24:27], v4, s[8:11], s17 offen
    s_add_u32 s17, s17, 122880
    buffer_load_dwordx4 v[28:31], v4, s[8:11], s17 offen
    s_add_u32 s17, s17, 122880
    buffer_load_dwordx4 v[32:35], v4, s[8:11], s17 offen
    s_add_u32 s17, s17, 122880
    buffer_load_dwordx4 v[36:39], v4, s[8:11], s17 offen
    s_add_u32 s17, s17, 122880
    buffer_load_dwordx4 v[40:43], v4, s[8:11], s17 offen
    s_add_u32 s17, s17, 122880
    buffer_load_dwordx4 v[44:47], v4, s[8:11], s17 offen
    s_add_u32 s17, s17, 122880
    buffer_load_dwordx4 v[48:51], v4, s[8:11], s17 offen
    s_add_u32 s17, s17, 122880
    buffer_load_dwordx4 v[52:55], v4, s[8:11], s17 offen
    buffer_load_dword v14, off, s[72:75], 0 offset:48 sc1
    s_waitcnt vmcnt(20)
    v_lshlrev_b32 v56, 16, v56
    v_mul_f32 v76, 3216550459, v56
    v_exp_f32 v76, v76
    s_nop 0
    v_add_f32 v76, 1.0, v76
    v_rcp_f32 v76, v76
    s_nop 0
    v_mul_f32 v56, v56, v76
    v_cvt_pk_bf16_f32 v56, v56, v56
    v_lshlrev_b32 v56, 16, v56
    s_waitcnt vmcnt(19)
    v_lshlrev_b32 v57, 16, v57
    v_mul_f32 v76, 3216550459, v57
    v_exp_f32 v76, v76
    s_nop 0
    v_add_f32 v76, 1.0, v76
    v_rcp_f32 v76, v76
    s_nop 0
    v_mul_f32 v57, v57, v76
    v_cvt_pk_bf16_f32 v57, v57, v57
    v_lshlrev_b32 v57, 16, v57
    s_waitcnt vmcnt(18)
    v_lshlrev_b32 v58, 16, v58
    v_mul_f32 v76, 3216550459, v58
    v_exp_f32 v76, v76
    s_nop 0
    v_add_f32 v76, 1.0, v76
    v_rcp_f32 v76, v76
    s_nop 0
    v_mul_f32 v58, v58, v76
    v_cvt_pk_bf16_f32 v58, v58, v58
    v_lshlrev_b32 v58, 16, v58
    s_waitcnt vmcnt(17)
    v_lshlrev_b32 v59, 16, v59
    v_mul_f32 v76, 3216550459, v59
    v_exp_f32 v76, v76
    s_nop 0
    v_add_f32 v76, 1.0, v76
    v_rcp_f32 v76, v76
    s_nop 0
    v_mul_f32 v59, v59, v76
    v_cvt_pk_bf16_f32 v59, v59, v59
    v_lshlrev_b32 v59, 16, v59
    s_waitcnt vmcnt(16)
    v_lshlrev_b32 v60, 16, v60
    v_mul_f32 v76, 3216550459, v60
    v_exp_f32 v76, v76
    s_nop 0
    v_add_f32 v76, 1.0, v76
    v_rcp_f32 v76, v76
    s_nop 0
    v_mul_f32 v60, v60, v76
    v_cvt_pk_bf16_f32 v60, v60, v60
    v_lshlrev_b32 v60, 16, v60
    s_waitcnt vmcnt(15)
    v_lshlrev_b32 v61, 16, v61
    v_mul_f32 v76, 3216550459, v61
    v_exp_f32 v76, v76
    s_nop 0
    v_add_f32 v76, 1.0, v76
    v_rcp_f32 v76, v76
    s_nop 0
    v_mul_f32 v61, v61, v76
    v_cvt_pk_bf16_f32 v61, v61, v61
    v_lshlrev_b32 v61, 16, v61
    s_waitcnt vmcnt(14)
    v_lshlrev_b32 v62, 16, v62
    v_mul_f32 v76, 3216550459, v62
    v_exp_f32 v76, v76
    s_nop 0
    v_add_f32 v76, 1.0, v76
    v_rcp_f32 v76, v76
    s_nop 0
    v_mul_f32 v62, v62, v76
    v_cvt_pk_bf16_f32 v62, v62, v62
    v_lshlrev_b32 v62, 16, v62
    s_waitcnt vmcnt(13)
    v_lshlrev_b32 v63, 16, v63
    v_mul_f32 v76, 3216550459, v63
    v_exp_f32 v76, v76
    s_nop 0
    v_add_f32 v76, 1.0, v76
    v_rcp_f32 v76, v76
    s_nop 0
    v_mul_f32 v63, v63, v76
    v_cvt_pk_bf16_f32 v63, v63, v63
    v_lshlrev_b32 v63, 16, v63
    s_waitcnt vmcnt(12)
    v_lshlrev_b32 v64, 16, v64
    v_mul_f32 v76, 3216550459, v64
    v_exp_f32 v76, v76
    s_nop 0
    v_add_f32 v76, 1.0, v76
    v_rcp_f32 v76, v76
    s_nop 0
    v_mul_f32 v64, v64, v76
    v_cvt_pk_bf16_f32 v64, v64, v64
    v_lshlrev_b32 v64, 16, v64
    s_waitcnt vmcnt(11)
    v_lshlrev_b32 v65, 16, v65
    v_mul_f32 v76, 3216550459, v65
    v_exp_f32 v76, v76
    s_nop 0
    v_add_f32 v76, 1.0, v76
    v_rcp_f32 v76, v76
    s_nop 0
    v_mul_f32 v65, v65, v76
    v_cvt_pk_bf16_f32 v65, v65, v65
    v_lshlrev_b32 v65, 16, v65
    s_waitcnt vmcnt(10)
    v_and_b32 v77, 0xffff0000, v16
    v_lshlrev_b32 v76, 16, v16
    v_mul_f32 v68, v56, v76
    v_mul_f32 v69, v56, v77
    v_and_b32 v77, 0xffff0000, v17
    v_lshlrev_b32 v76, 16, v17
    v_mul_f32 v70, v56, v76
    v_mul_f32 v71, v56, v77
    v_and_b32 v77, 0xffff0000, v18
    v_lshlrev_b32 v76, 16, v18
    v_mul_f32 v72, v56, v76
    v_mul_f32 v73, v56, v77
    v_and_b32 v77, 0xffff0000, v19
    v_lshlrev_b32 v76, 16, v19
    v_mul_f32 v74, v56, v76
    v_mul_f32 v75, v56, v77
    s_waitcnt vmcnt(9)
    v_and_b32 v77, 0xffff0000, v20
    v_lshlrev_b32 v76, 16, v20
    v_fmac_f32 v68, v57, v76
    v_fmac_f32 v69, v57, v77
    v_and_b32 v77, 0xffff0000, v21
    v_lshlrev_b32 v76, 16, v21
    v_fmac_f32 v70, v57, v76
    v_fmac_f32 v71, v57, v77
    v_and_b32 v77, 0xffff0000, v22
    v_lshlrev_b32 v76, 16, v22
    v_fmac_f32 v72, v57, v76
    v_fmac_f32 v73, v57, v77
    v_and_b32 v77, 0xffff0000, v23
    v_lshlrev_b32 v76, 16, v23
    v_fmac_f32 v74, v57, v76
    v_fmac_f32 v75, v57, v77
    s_waitcnt vmcnt(8)
    v_and_b32 v77, 0xffff0000, v24
    v_lshlrev_b32 v76, 16, v24
    v_fmac_f32 v68, v58, v76
    v_fmac_f32 v69, v58, v77
    v_and_b32 v77, 0xffff0000, v25
    v_lshlrev_b32 v76, 16, v25
    v_fmac_f32 v70, v58, v76
    v_fmac_f32 v71, v58, v77
    v_and_b32 v77, 0xffff0000, v26
    v_lshlrev_b32 v76, 16, v26
    v_fmac_f32 v72, v58, v76
    v_fmac_f32 v73, v58, v77
    v_and_b32 v77, 0xffff0000, v27
    v_lshlrev_b32 v76, 16, v27
    v_fmac_f32 v74, v58, v76
    v_fmac_f32 v75, v58, v77
    s_waitcnt vmcnt(7)
    v_and_b32 v77, 0xffff0000, v28
    v_lshlrev_b32 v76, 16, v28
    v_fmac_f32 v68, v59, v76
    v_fmac_f32 v69, v59, v77
    v_and_b32 v77, 0xffff0000, v29
    v_lshlrev_b32 v76, 16, v29
    v_fmac_f32 v70, v59, v76
    v_fmac_f32 v71, v59, v77
    v_and_b32 v77, 0xffff0000, v30
    v_lshlrev_b32 v76, 16, v30
    v_fmac_f32 v72, v59, v76
    v_fmac_f32 v73, v59, v77
    v_and_b32 v77, 0xffff0000, v31
    v_lshlrev_b32 v76, 16, v31
    v_fmac_f32 v74, v59, v76
    v_fmac_f32 v75, v59, v77
    s_waitcnt vmcnt(6)
    v_and_b32 v77, 0xffff0000, v32
    v_lshlrev_b32 v76, 16, v32
    v_fmac_f32 v68, v60, v76
    v_fmac_f32 v69, v60, v77
    v_and_b32 v77, 0xffff0000, v33
    v_lshlrev_b32 v76, 16, v33
    v_fmac_f32 v70, v60, v76
    v_fmac_f32 v71, v60, v77
    v_and_b32 v77, 0xffff0000, v34
    v_lshlrev_b32 v76, 16, v34
    v_fmac_f32 v72, v60, v76
    v_fmac_f32 v73, v60, v77
    v_and_b32 v77, 0xffff0000, v35
    v_lshlrev_b32 v76, 16, v35
    v_fmac_f32 v74, v60, v76
    v_fmac_f32 v75, v60, v77
    s_waitcnt vmcnt(5)
    v_and_b32 v77, 0xffff0000, v36
    v_lshlrev_b32 v76, 16, v36
    v_fmac_f32 v68, v61, v76
    v_fmac_f32 v69, v61, v77
    v_and_b32 v77, 0xffff0000, v37
    v_lshlrev_b32 v76, 16, v37
    v_fmac_f32 v70, v61, v76
    v_fmac_f32 v71, v61, v77
    v_and_b32 v77, 0xffff0000, v38
    v_lshlrev_b32 v76, 16, v38
    v_fmac_f32 v72, v61, v76
    v_fmac_f32 v73, v61, v77
    v_and_b32 v77, 0xffff0000, v39
    v_lshlrev_b32 v76, 16, v39
    v_fmac_f32 v74, v61, v76
    v_fmac_f32 v75, v61, v77
    s_waitcnt vmcnt(4)
    v_and_b32 v77, 0xffff0000, v40
    v_lshlrev_b32 v76, 16, v40
    v_fmac_f32 v68, v62, v76
    v_fmac_f32 v69, v62, v77
    v_and_b32 v77, 0xffff0000, v41
    v_lshlrev_b32 v76, 16, v41
    v_fmac_f32 v70, v62, v76
    v_fmac_f32 v71, v62, v77
    v_and_b32 v77, 0xffff0000, v42
    v_lshlrev_b32 v76, 16, v42
    v_fmac_f32 v72, v62, v76
    v_fmac_f32 v73, v62, v77
    v_and_b32 v77, 0xffff0000, v43
    v_lshlrev_b32 v76, 16, v43
    v_fmac_f32 v74, v62, v76
    v_fmac_f32 v75, v62, v77
    s_waitcnt vmcnt(3)
    v_and_b32 v77, 0xffff0000, v44
    v_lshlrev_b32 v76, 16, v44
    v_fmac_f32 v68, v63, v76
    v_fmac_f32 v69, v63, v77
    v_and_b32 v77, 0xffff0000, v45
    v_lshlrev_b32 v76, 16, v45
    v_fmac_f32 v70, v63, v76
    v_fmac_f32 v71, v63, v77
    v_and_b32 v77, 0xffff0000, v46
    v_lshlrev_b32 v76, 16, v46
    v_fmac_f32 v72, v63, v76
    v_fmac_f32 v73, v63, v77
    v_and_b32 v77, 0xffff0000, v47
    v_lshlrev_b32 v76, 16, v47
    v_fmac_f32 v74, v63, v76
    v_fmac_f32 v75, v63, v77
    s_waitcnt vmcnt(2)
    v_and_b32 v77, 0xffff0000, v48
    v_lshlrev_b32 v76, 16, v48
    v_fmac_f32 v68, v64, v76
    v_fmac_f32 v69, v64, v77
    v_and_b32 v77, 0xffff0000, v49
    v_lshlrev_b32 v76, 16, v49
    v_fmac_f32 v70, v64, v76
    v_fmac_f32 v71, v64, v77
    v_and_b32 v77, 0xffff0000, v50
    v_lshlrev_b32 v76, 16, v50
    v_fmac_f32 v72, v64, v76
    v_fmac_f32 v73, v64, v77
    v_and_b32 v77, 0xffff0000, v51
    v_lshlrev_b32 v76, 16, v51
    v_fmac_f32 v74, v64, v76
    v_fmac_f32 v75, v64, v77
    s_waitcnt vmcnt(1)
    v_and_b32 v77, 0xffff0000, v52
    v_lshlrev_b32 v76, 16, v52
    v_fmac_f32 v68, v65, v76
    v_fmac_f32 v69, v65, v77
    v_and_b32 v77, 0xffff0000, v53
    v_lshlrev_b32 v76, 16, v53
    v_fmac_f32 v70, v65, v76
    v_fmac_f32 v71, v65, v77
    v_and_b32 v77, 0xffff0000, v54
    v_lshlrev_b32 v76, 16, v54
    v_fmac_f32 v72, v65, v76
    v_fmac_f32 v73, v65, v77
    v_and_b32 v77, 0xffff0000, v55
    v_lshlrev_b32 v76, 16, v55
    v_fmac_f32 v74, v65, v76
    v_fmac_f32 v75, v65, v77
    v_lshlrev_b32 v2, 5, v0
    s_lshl_b32 s17, s13, 11
    v_add_u32 v2, s17, v2
    ds_write_b128 v2, v[68:71]
    ds_write_b128 v2, v[72:75] offset:16
    s_waitcnt vmcnt(0)
    v_cmp_gt_u32 vcc, 2, v14
    s_cbranch_vccz Lini17
    v_mov_b32 v15, 0
    s_mov_b32 exec_lo, 0x1
    s_mov_b32 exec_hi, 0x0
Lwf18:
    buffer_load_dword v14, v15, s[72:75], 0 offen offset:48 sc1
    s_waitcnt vmcnt(0)
    v_cmp_gt_u32 vcc, 2, v14
    s_cbranch_vccz Lwf18d
    s_sub_u32 s15, s15, 1
    s_cbranch_scc0 Lwf18
    s_mov_b32 s15, 0
Lwf18d:
    s_mov_b64 exec, -1
Lini17:
    s_waitcnt lgkmcnt(0)
    s_barrier
    s_cmp_lg_u32 s13, 0
    s_cbranch_scc1 Lmodw19
    v_lshlrev_b32 v2, 2, v0
    ds_read_b32 v16, v2 offset:0
    ds_read_b32 v17, v2 offset:256
    ds_read_b32 v18, v2 offset:512
    ds_read_b32 v19, v2 offset:768
    ds_read_b32 v20, v2 offset:1024
    ds_read_b32 v21, v2 offset:1280
    ds_read_b32 v22, v2 offset:1536
    ds_read_b32 v23, v2 offset:1792
    ds_read_b32 v24, v2 offset:2048
    ds_read_b32 v25, v2 offset:2304
    ds_read_b32 v26, v2 offset:2560
    ds_read_b32 v27, v2 offset:2816
    ds_read_b32 v28, v2 offset:3072
    ds_read_b32 v29, v2 offset:3328
    ds_read_b32 v30, v2 offset:3584
    ds_read_b32 v31, v2 offset:3840
    ds_read_b32 v32, v2 offset:4096
    ds_read_b32 v33, v2 offset:4352
    ds_read_b32 v34, v2 offset:4608
    ds_read_b32 v35, v2 offset:4864
    ds_read_b32 v36, v2 offset:5120
    ds_read_b32 v37, v2 offset:5376
    ds_read_b32 v38, v2 offset:5632
    ds_read_b32 v39, v2 offset:5888
    ds_read_b32 v40, v2 offset:6144
    ds_read_b32 v41, v2 offset:6400
    ds_read_b32 v42, v2 offset:6656
    ds_read_b32 v43, v2 offset:6912
    ds_read_b32 v44, v2 offset:7168
    ds_read_b32 v45, v2 offset:7424
    ds_read_b32 v46, v2 offset:7680
    ds_read_b32 v47, v2 offset:7936
    s_waitcnt lgkmcnt(15)
    v_add_f32 v16, v16, v17
    v_add_f32 v16, v16, v18
    v_add_f32 v16, v16, v19
    v_add_f32 v16, v16, v20
    v_add_f32 v16, v16, v21
    v_add_f32 v16, v16, v22
    v_add_f32 v16, v16, v23
    v_add_f32 v16, v16, v24
    v_add_f32 v16, v16, v25
    v_add_f32 v16, v16, v26
    v_add_f32 v16, v16, v27
    v_add_f32 v16, v16, v28
    v_add_f32 v16, v16, v29
    v_add_f32 v16, v16, v30
    v_add_f32 v16, v16, v31
    v_add_f32 v16, v16, v32
    s_waitcnt lgkmcnt(14)
    v_add_f32 v16, v16, v33
    s_waitcnt lgkmcnt(13)
    v_add_f32 v16, v16, v34
    s_waitcnt lgkmcnt(12)
    v_add_f32 v16, v16, v35
    s_waitcnt lgkmcnt(11)
    v_add_f32 v16, v16, v36
    s_waitcnt lgkmcnt(10)
    v_add_f32 v16, v16, v37
    s_waitcnt lgkmcnt(9)
    v_add_f32 v16, v16, v38
    s_waitcnt lgkmcnt(8)
    v_add_f32 v16, v16, v39
    s_waitcnt lgkmcnt(7)
    v_add_f32 v16, v16, v40
    s_waitcnt lgkmcnt(6)
    v_add_f32 v16, v16, v41
    s_waitcnt lgkmcnt(5)
    v_add_f32 v16, v16, v42
    s_waitcnt lgkmcnt(4)
    v_add_f32 v16, v16, v43
    s_waitcnt lgkmcnt(3)
    v_add_f32 v16, v16, v44
    s_waitcnt lgkmcnt(2)
    v_add_f32 v16, v16, v45
    s_waitcnt lgkmcnt(1)
    v_add_f32 v16, v16, v46
    s_waitcnt lgkmcnt(0)
    v_add_f32 v16, v16, v47
    v_mov_b32 v76, v16
    s_nop 1
    v_permlane32_swap_b32 v16, v76
    v_add_f32 v16, v16, v76
    v_cvt_pk_bf16_f32 v16, v16, v16
    v_lshlrev_b32 v16, 16, v16
    s_sub_u32 s17, s16, 20
    s_sub_u32 s18, s16, 80
    s_min_u32 s17, s17, s18
    s_cmp_lt_u32 s17, 20
    s_cselect_b32 s17, 1.0, 0
    v_add_f32 v16, s17, v16
    v_cvt_pk_bf16_f32 v16, v16, v16
    v_and_b32 v2, 31, v0
    v_lshlrev_b32 v2, 1, v2
    s_lshl_b32 s17, s16, 6
    s_add_u32 s17, s17, 65536
    buffer_store_short v16, v2, s[4:7], s17 offen sc1
    s_lshl_b32 s17, s16, 7
    s_add_u32 s17, s17, 16384
    s_waitcnt vmcnt(0)
    v_mov_b32 v76, 1
    v_mov_b32 v77, 0
    s_mov_b64 exec, 1
    buffer_store_dword v76, v77, s[4:7], s17 offen offset:0 sc1
    s_mov_b64 exec, -1
    s_branch Lmodw19
Lnomod16:
    s_cmp_lt_u32 s16, 120
    s_cbranch_scc1 Lnp20
    s_cmp_lg_u32 s13, 0
    s_cbranch_scc1 Lnp20
    s_lshl_b32 s26, s12, 7
    s_add_u32 s26, s26, 2097152
    s_add_u32 s24, s4, s26
    s_addc_u32 s25, s5, 0
    s_load_dword s36, s[24:25], 524288 glc
    s_load_dword s37, s[24:25], 532480 glc
    s_load_dword s38, s[24:25], 529408 glc
    s_load_dword s39, s[24:25], 537600 glc
    s_load_dword s40, s[24:25], 542720 glc
    s_load_dword s41, s[24:25], 550912 glc
    s_load_dword s42, s[24:25], 547840 glc
    s_load_dword s43, s[24:25], 556032 glc
    s_mov_b32 s28, -1
    s_mov_b32 s29, -1
    s_mov_b32 s32, 1
    s_waitcnt lgkmcnt(0)
Lpn21r:
    s_not_b32 s30, s36
    s_mov_b32 s26, 0
    s_load_dword s30, s[24:25], 524288 glc
Lpn21s0:
    s_add_u32 s26, s26, 0x100000
    s_cbranch_scc1 Lpn21s0x
    s_cmp_eq_u32 s30, s36
    s_cbranch_scc0 Lpn21s0
Lpn21s0x:
    s_waitcnt lgkmcnt(0)
    s_not_b32 s30, s37
    s_mov_b32 s27, 0
    s_load_dword s30, s[24:25], 532480 glc
Lpn21s1:
    s_add_u32 s27, s27, 0x100000
    s_cbranch_scc1 Lpn21s1x
    s_cmp_eq_u32 s30, s37
    s_cbranch_scc0 Lpn21s1
Lpn21s1x:
    s_waitcnt lgkmcnt(0)
    s_min_u32 s28, s28, s26
    s_min_u32 s29, s29, s27
    s_not_b32 s30, s38
    s_mov_b32 s26, 0
    s_load_dword s30, s[24:25], 529408 glc
Lpn21s2:
    s_add_u32 s26, s26, 0x100000
    s_cbranch_scc1 Lpn21s2x
    s_cmp_eq_u32 s30, s38
    s_cbranch_scc0 Lpn21s2
Lpn21s2x:
    s_waitcnt lgkmcnt(0)
    s_not_b32 s30, s39
    s_mov_b32 s27, 0
    s_load_dword s30, s[24:25], 537600 glc
Lpn21s3:
    s_add_u32 s27, s27, 0x100000
    s_cbranch_scc1 Lpn21s3x
    s_cmp_eq_u32 s30, s39
    s_cbranch_scc0 Lpn21s3
Lpn21s3x:
    s_waitcnt lgkmcnt(0)
    s_min_u32 s28, s28, s26
    s_min_u32 s29, s29, s27
    s_not_b32 s30, s40
    s_mov_b32 s26, 0
    s_load_dword s30, s[24:25], 542720 glc
Lpn21s4:
    s_add_u32 s26, s26, 0x100000
    s_cbranch_scc1 Lpn21s4x
    s_cmp_eq_u32 s30, s40
    s_cbranch_scc0 Lpn21s4
Lpn21s4x:
    s_waitcnt lgkmcnt(0)
    s_not_b32 s30, s41
    s_mov_b32 s27, 0
    s_load_dword s30, s[24:25], 550912 glc
Lpn21s5:
    s_add_u32 s27, s27, 0x100000
    s_cbranch_scc1 Lpn21s5x
    s_cmp_eq_u32 s30, s41
    s_cbranch_scc0 Lpn21s5
Lpn21s5x:
    s_waitcnt lgkmcnt(0)
    s_min_u32 s28, s28, s26
    s_min_u32 s29, s29, s27
    s_not_b32 s30, s42
    s_mov_b32 s26, 0
    s_load_dword s30, s[24:25], 547840 glc
Lpn21s6:
    s_add_u32 s26, s26, 0x100000
    s_cbranch_scc1 Lpn21s6x
    s_cmp_eq_u32 s30, s42
    s_cbranch_scc0 Lpn21s6
Lpn21s6x:
    s_waitcnt lgkmcnt(0)
    s_not_b32 s30, s43
    s_mov_b32 s27, 0
    s_load_dword s30, s[24:25], 556032 glc
Lpn21s7:
    s_add_u32 s27, s27, 0x100000
    s_cbranch_scc1 Lpn21s7x
    s_cmp_eq_u32 s30, s43
    s_cbranch_scc0 Lpn21s7
Lpn21s7x:
    s_waitcnt lgkmcnt(0)
    s_min_u32 s28, s28, s26
    s_min_u32 s29, s29, s27
    s_sub_u32 s32, s32, 1
    s_cbranch_scc0 Lpn21r
    s_cmp_gt_u32 s29, s28
    s_cselect_b32 s24, 8, 0
    s_cmp_eq_u32 s29, s28
    s_cselect_b32 s24, 4, s24
    s_add_u32 s24, s24, 0x10000
    v_mov_b32 v14, s24
    s_mov_b64 exec, 1
    buffer_atomic_add v14, off, s[72:75], 0 offset:52
    s_mov_b64 exec, -1
Lnp20:
    v_mov_b32 v15, 0
    s_mov_b32 exec_lo, 0x1
    s_mov_b32 exec_hi, 0x0
    s_waitcnt vmcnt(0)
Lwf22:
    buffer_load_dword v14, v15, s[72:75], 0 offen offset:48 sc1
    s_waitcnt vmcnt(0)
    v_cmp_gt_u32 vcc, 2, v14
    s_cbranch_vccz Lwf22d
    s_sub_u32 s15, s15, 1
    s_cbranch_scc0 Lwf22
    s_mov_b32 s15, 0
Lwf22d:
    s_mov_b64 exec, -1
Lmodw19:
    v_and_b32 v101, 0xffff0000, v80
    v_lshlrev_b32 v100, 16, v80
    v_and_b32 v103, 0xffff0000, v81
    v_lshlrev_b32 v102, 16, v81
    v_and_b32 v105, 0xffff0000, v82
    v_lshlrev_b32 v104, 16, v82
    v_and_b32 v107, 0xffff0000, v83
    v_lshlrev_b32 v106, 16, v83
    v_and_b32 v109, 0xffff0000, v84
    v_lshlrev_b32 v108, 16, v84
    v_and_b32 v111, 0xffff0000, v85
    v_lshlrev_b32 v110, 16, v85
    v_and_b32 v113, 0xffff0000, v86
    v_lshlrev_b32 v112, 16, v86
    v_and_b32 v115, 0xffff0000, v87
    v_lshlrev_b32 v114, 16, v87
    v_and_b32 v117, 0xffff0000, v88
    v_lshlrev_b32 v116, 16, v88
    v_and_b32 v119, 0xffff0000, v89
    v_lshlrev_b32 v118, 16, v89
    v_and_b32 v121, 0xffff0000, v90
    v_lshlrev_b32 v120, 16, v90
    v_and_b32 v123, 0xffff0000, v91
    v_lshlrev_b32 v122, 16, v91
    v_and_b32 v125, 0xffff0000, v92
    v_lshlrev_b32 v124, 16, v92
    v_and_b32 v127, 0xffff0000, v93
    v_lshlrev_b32 v126, 16, v93
    v_and_b32 v129, 0xffff0000, v94
    v_lshlrev_b32 v128, 16, v94
    v_and_b32 v131, 0xffff0000, v95
    v_lshlrev_b32 v130, 16, v95
    v_and_b32 v133, 0xffff0000, v96
    v_lshlrev_b32 v132, 16, v96
    v_and_b32 v135, 0xffff0000, v97
    v_lshlrev_b32 v134, 16, v97
    v_and_b32 v137, 0xffff0000, v98
    v_lshlrev_b32 v136, 16, v98
    v_and_b32 v139, 0xffff0000, v99
    v_lshlrev_b32 v138, 16, v99
    v_add_f32 v8, v100, v101
    v_add_f32 v9, v102, v103
    v_add_f32 v8, v8, v104
    v_add_f32 v9, v9, v105
    v_add_f32 v8, v8, v106
    v_add_f32 v9, v9, v107
    v_add_f32 v8, v8, v108
    v_add_f32 v9, v9, v109
    v_add_f32 v8, v8, v110
    v_add_f32 v9, v9, v111
    v_add_f32 v8, v8, v112
    v_add_f32 v9, v9, v113
    v_add_f32 v8, v8, v114
    v_add_f32 v9, v9, v115
    v_add_f32 v8, v8, v116
    v_add_f32 v9, v9, v117
    v_add_f32 v8, v8, v118
    v_add_f32 v9, v9, v119
    v_add_f32 v8, v8, v120
    v_add_f32 v9, v9, v121
    v_add_f32 v8, v8, v122
    v_add_f32 v9, v9, v123
    v_add_f32 v8, v8, v124
    v_add_f32 v9, v9, v125
    v_add_f32 v8, v8, v126
    v_add_f32 v9, v9, v127
    v_add_f32 v8, v8, v128
    v_add_f32 v9, v9, v129
    v_add_f32 v8, v8, v130
    v_add_f32 v9, v9, v131
    v_add_f32 v8, v8, v132
    v_add_f32 v9, v9, v133
    v_add_f32 v8, v8, v134
    v_add_f32 v9, v9, v135
    v_add_f32 v8, v8, v136
    v_add_f32 v9, v9, v137
    v_add_f32 v8, v8, v138
    v_add_f32 v9, v9, v139
    v_add_f32 v8, v8, v9
    s_nop 1
    v_add_f32_dpp v8, v8, v8 row_ror:4 row_mask:0xf bank_mask:0xf
    s_nop 1
    v_add_f32_dpp v8, v8, v8 row_ror:8 row_mask:0xf bank_mask:0xf
    v_mov_b32 v9, v8
    s_nop 1
    v_permlane16_swap_b32 v8, v9
    v_add_f32 v8, v8, v9
    v_mov_b32 v9, v8
    s_nop 1
    v_permlane32_swap_b32 v8, v9
    v_add_f32 v8, v8, v9
    v_mul_f32 v8, 986500301, v8
    v_sub_f32 v100, v100, v8
    v_sub_f32 v101, v101, v8
    v_sub_f32 v102, v102, v8
    v_sub_f32 v103, v103, v8
    v_sub_f32 v104, v104, v8
    v_sub_f32 v105, v105, v8
    v_sub_f32 v106, v106, v8
    v_sub_f32 v107, v107, v8
    v_sub_f32 v108, v108, v8
    v_sub_f32 v109, v109, v8
    v_sub_f32 v110, v110, v8
    v_sub_f32 v111, v111, v8
    v_sub_f32 v112, v112, v8
    v_sub_f32 v113, v113, v8
    v_sub_f32 v114, v114, v8
    v_sub_f32 v115, v115, v8
    v_sub_f32 v116, v116, v8
    v_sub_f32 v117, v117, v8
    v_sub_f32 v118, v118, v8
    v_sub_f32 v119, v119, v8
    v_sub_f32 v120, v120, v8
    v_sub_f32 v121, v121, v8
    v_sub_f32 v122, v122, v8
    v_sub_f32 v123, v123, v8
    v_sub_f32 v124, v124, v8
    v_sub_f32 v125, v125, v8
    v_sub_f32 v126, v126, v8
    v_sub_f32 v127, v127, v8
    v_sub_f32 v128, v128, v8
    v_sub_f32 v129, v129, v8
    v_sub_f32 v130, v130, v8
    v_sub_f32 v131, v131, v8
    v_sub_f32 v132, v132, v8
    v_sub_f32 v133, v133, v8
    v_sub_f32 v134, v134, v8
    v_sub_f32 v135, v135, v8
    v_sub_f32 v136, v136, v8
    v_sub_f32 v137, v137, v8
    v_sub_f32 v138, v138, v8
    v_sub_f32 v139, v139, v8
    v_mul_f32 v8, v100, v100
    v_mul_f32 v9, v101, v101
    v_fmac_f32 v8, v102, v102
    v_fmac_f32 v9, v103, v103
    v_fmac_f32 v8, v104, v104
    v_fmac_f32 v9, v105, v105
    v_fmac_f32 v8, v106, v106
    v_fmac_f32 v9, v107, v107
    v_fmac_f32 v8, v108, v108
    v_fmac_f32 v9, v109, v109
    v_fmac_f32 v8, v110, v110
    v_fmac_f32 v9, v111, v111
    v_fmac_f32 v8, v112, v112
    v_fmac_f32 v9, v113, v113
    v_fmac_f32 v8, v114, v114
    v_fmac_f32 v9, v115, v115
    v_fmac_f32 v8, v116, v116
    v_fmac_f32 v9, v117, v117
    v_fmac_f32 v8, v118, v118
    v_fmac_f32 v9, v119, v119
    v_fmac_f32 v8, v120, v120
    v_fmac_f32 v9, v121, v121
    v_fmac_f32 v8, v122, v122
    v_fmac_f32 v9, v123, v123
    v_fmac_f32 v8, v124, v124
    v_fmac_f32 v9, v125, v125
    v_fmac_f32 v8, v126, v126
    v_fmac_f32 v9, v127, v127
    v_fmac_f32 v8, v128, v128
    v_fmac_f32 v9, v129, v129
    v_fmac_f32 v8, v130, v130
    v_fmac_f32 v9, v131, v131
    v_fmac_f32 v8, v132, v132
    v_fmac_f32 v9, v133, v133
    v_fmac_f32 v8, v134, v134
    v_fmac_f32 v9, v135, v135
    v_fmac_f32 v8, v136, v136
    v_fmac_f32 v9, v137, v137
    v_fmac_f32 v8, v138, v138
    v_fmac_f32 v9, v139, v139
    v_add_f32 v8, v8, v9
    s_nop 1
    v_add_f32_dpp v8, v8, v8 row_ror:4 row_mask:0xf bank_mask:0xf
    s_nop 1
    v_add_f32_dpp v8, v8, v8 row_ror:8 row_mask:0xf bank_mask:0xf
    v_mov_b32 v9, v8
    s_nop 1
    v_permlane16_swap_b32 v8, v9
    v_add_f32 v8, v8, v9
    v_mov_b32 v9, v8
    s_nop 1
    v_permlane32_swap_b32 v8, v9
    v_add_f32 v8, v8, v9
    v_mov_b32 v9, 925353388
    v_fmac_f32 v9, 986500301, v8
    v_rsq_f32 v8, v9
    s_nop 0
    v_mul_f32 v100, v8, v100
    v_mul_f32 v101, v8, v101
    v_mul_f32 v102, v8, v102
    v_mul_f32 v103, v8, v103
    v_mul_f32 v104, v8, v104
    v_mul_f32 v105, v8, v105
    v_mul_f32 v106, v8, v106
    v_mul_f32 v107, v8, v107
    v_mul_f32 v108, v8, v108
    v_mul_f32 v109, v8, v109
    v_mul_f32 v110, v8, v110
    v_mul_f32 v111, v8, v111
    v_mul_f32 v112, v8, v112
    v_mul_f32 v113, v8, v113
    v_mul_f32 v114, v8, v114
    v_mul_f32 v115, v8, v115
    v_mul_f32 v116, v8, v116
    v_mul_f32 v117, v8, v117
    v_mul_f32 v118, v8, v118
    v_mul_f32 v119, v8, v119
    v_mul_f32 v120, v8, v120
    v_mul_f32 v121, v8, v121
    v_mul_f32 v122, v8, v122
    v_mul_f32 v123, v8, v123
    v_mul_f32 v124, v8, v124
    v_mul_f32 v125, v8, v125
    v_mul_f32 v126, v8, v126
    v_mul_f32 v127, v8, v127
    v_mul_f32 v128, v8, v128
    v_mul_f32 v129, v8, v129
    v_mul_f32 v130, v8, v130
    v_mul_f32 v131, v8, v131
    v_mul_f32 v132, v8, v132
    v_mul_f32 v133, v8, v133
    v_mul_f32 v134, v8, v134
    v_mul_f32 v135, v8, v135
    v_mul_f32 v136, v8, v136
    v_mul_f32 v137, v8, v137
    v_mul_f32 v138, v8, v138
    v_mul_f32 v139, v8, v139
    s_cmp_lg_u32 s13, 0
    s_cbranch_scc1 Lnw23
    v_lshlrev_b32 v11, 7, v0
    s_mov_b32 s17, 16384
    s_mov_b32 exec_lo, 0xffffffff
    s_mov_b32 exec_hi, 0xff
Lwf24:
    buffer_load_dword v10, v11, s[4:7], s17 offen offset:0 sc1
    s_waitcnt vmcnt(0)
    v_cmp_gt_u32 vcc, 1, v10
    s_cbranch_vccz Lwf24d
    s_sub_u32 s15, s15, 1
    s_cbranch_scc0 Lwf24
    s_mov_b32 s15, 0
Lwf24d:
    s_mov_b64 exec, -1
Lnw23:
    s_barrier
    s_mov_b32 s17, 65536
    buffer_load_dwordx4 v[140:143], v12, s[4:7], s17 offen offset:0 sc1
    buffer_load_dwordx4 v[160:163], v12, s[4:7], s17 offen offset:1280 sc1
    buffer_load_dwordx4 v[144:147], v12, s[4:7], s17 offen offset:256 sc1
    buffer_load_dwordx4 v[164:167], v12, s[4:7], s17 offen offset:1536 sc1
    buffer_load_dwordx4 v[148:151], v12, s[4:7], s17 offen offset:512 sc1
    buffer_load_dwordx4 v[168:171], v12, s[4:7], s17 offen offset:1792 sc1
    buffer_load_dwordx4 v[152:155], v12, s[4:7], s17 offen offset:768 sc1
    buffer_load_dwordx4 v[172:175], v12, s[4:7], s17 offen offset:2048 sc1
    buffer_load_dwordx4 v[156:159], v12, s[4:7], s17 offen offset:1024 sc1
    buffer_load_dwordx4 v[176:179], v12, s[4:7], s17 offen offset:2304 sc1
    s_mul_i32 s17, s19, 20480
    s_lshl_b32 s18, s13, 6
    s_add_u32 s17, s17, s18
    s_add_u32 s17, s17, 4194304
    s_waitcnt vmcnt(9)
    v_and_b32 v9, 0xffff0000, v140
    v_lshlrev_b32 v8, 16, v140
    s_waitcnt vmcnt(8)
    v_and_b32 v11, 0xffff0000, v160
    v_lshlrev_b32 v10, 16, v160
    v_fmac_f32 v8, v100, v10
    v_fmac_f32 v9, v101, v11
    v_cvt_pk_bf16_f32 v80, v8, v9
    v_and_b32 v9, 0xffff0000, v141
    v_lshlrev_b32 v8, 16, v141
    v_and_b32 v11, 0xffff0000, v161
    v_lshlrev_b32 v10, 16, v161
    v_fmac_f32 v8, v102, v10
    v_fmac_f32 v9, v103, v11
    v_cvt_pk_bf16_f32 v81, v8, v9
    v_and_b32 v9, 0xffff0000, v142
    v_lshlrev_b32 v8, 16, v142
    v_and_b32 v11, 0xffff0000, v162
    v_lshlrev_b32 v10, 16, v162
    v_fmac_f32 v8, v104, v10
    v_fmac_f32 v9, v105, v11
    v_cvt_pk_bf16_f32 v82, v8, v9
    v_and_b32 v9, 0xffff0000, v143
    v_lshlrev_b32 v8, 16, v143
    v_and_b32 v11, 0xffff0000, v163
    v_lshlrev_b32 v10, 16, v163
    v_fmac_f32 v8, v106, v10
    v_fmac_f32 v9, v107, v11
    v_cvt_pk_bf16_f32 v83, v8, v9
    buffer_store_dwordx4 v[80:83], v13, s[4:7], s17 offen sc1
    s_add_u32 s17, s17, 4096
    s_waitcnt vmcnt(8)
    v_and_b32 v9, 0xffff0000, v144
    v_lshlrev_b32 v8, 16, v144
    s_waitcnt vmcnt(7)
    v_and_b32 v11, 0xffff0000, v164
    v_lshlrev_b32 v10, 16, v164
    v_fmac_f32 v8, v108, v10
    v_fmac_f32 v9, v109, v11
    v_cvt_pk_bf16_f32 v84, v8, v9
    v_and_b32 v9, 0xffff0000, v145
    v_lshlrev_b32 v8, 16, v145
    v_and_b32 v11, 0xffff0000, v165
    v_lshlrev_b32 v10, 16, v165
    v_fmac_f32 v8, v110, v10
    v_fmac_f32 v9, v111, v11
    v_cvt_pk_bf16_f32 v85, v8, v9
    v_and_b32 v9, 0xffff0000, v146
    v_lshlrev_b32 v8, 16, v146
    v_and_b32 v11, 0xffff0000, v166
    v_lshlrev_b32 v10, 16, v166
    v_fmac_f32 v8, v112, v10
    v_fmac_f32 v9, v113, v11
    v_cvt_pk_bf16_f32 v86, v8, v9
    v_and_b32 v9, 0xffff0000, v147
    v_lshlrev_b32 v8, 16, v147
    v_and_b32 v11, 0xffff0000, v167
    v_lshlrev_b32 v10, 16, v167
    v_fmac_f32 v8, v114, v10
    v_fmac_f32 v9, v115, v11
    v_cvt_pk_bf16_f32 v87, v8, v9
    buffer_store_dwordx4 v[84:87], v13, s[4:7], s17 offen sc1
    s_add_u32 s17, s17, 4096
    s_waitcnt vmcnt(7)
    v_and_b32 v9, 0xffff0000, v148
    v_lshlrev_b32 v8, 16, v148
    s_waitcnt vmcnt(6)
    v_and_b32 v11, 0xffff0000, v168
    v_lshlrev_b32 v10, 16, v168
    v_fmac_f32 v8, v116, v10
    v_fmac_f32 v9, v117, v11
    v_cvt_pk_bf16_f32 v88, v8, v9
    v_and_b32 v9, 0xffff0000, v149
    v_lshlrev_b32 v8, 16, v149
    v_and_b32 v11, 0xffff0000, v169
    v_lshlrev_b32 v10, 16, v169
    v_fmac_f32 v8, v118, v10
    v_fmac_f32 v9, v119, v11
    v_cvt_pk_bf16_f32 v89, v8, v9
    v_and_b32 v9, 0xffff0000, v150
    v_lshlrev_b32 v8, 16, v150
    v_and_b32 v11, 0xffff0000, v170
    v_lshlrev_b32 v10, 16, v170
    v_fmac_f32 v8, v120, v10
    v_fmac_f32 v9, v121, v11
    v_cvt_pk_bf16_f32 v90, v8, v9
    v_and_b32 v9, 0xffff0000, v151
    v_lshlrev_b32 v8, 16, v151
    v_and_b32 v11, 0xffff0000, v171
    v_lshlrev_b32 v10, 16, v171
    v_fmac_f32 v8, v122, v10
    v_fmac_f32 v9, v123, v11
    v_cvt_pk_bf16_f32 v91, v8, v9
    buffer_store_dwordx4 v[88:91], v13, s[4:7], s17 offen sc1
    s_add_u32 s17, s17, 4096
    s_waitcnt vmcnt(6)
    v_and_b32 v9, 0xffff0000, v152
    v_lshlrev_b32 v8, 16, v152
    s_waitcnt vmcnt(5)
    v_and_b32 v11, 0xffff0000, v172
    v_lshlrev_b32 v10, 16, v172
    v_fmac_f32 v8, v124, v10
    v_fmac_f32 v9, v125, v11
    v_cvt_pk_bf16_f32 v92, v8, v9
    v_and_b32 v9, 0xffff0000, v153
    v_lshlrev_b32 v8, 16, v153
    v_and_b32 v11, 0xffff0000, v173
    v_lshlrev_b32 v10, 16, v173
    v_fmac_f32 v8, v126, v10
    v_fmac_f32 v9, v127, v11
    v_cvt_pk_bf16_f32 v93, v8, v9
    v_and_b32 v9, 0xffff0000, v154
    v_lshlrev_b32 v8, 16, v154
    v_and_b32 v11, 0xffff0000, v174
    v_lshlrev_b32 v10, 16, v174
    v_fmac_f32 v8, v128, v10
    v_fmac_f32 v9, v129, v11
    v_cvt_pk_bf16_f32 v94, v8, v9
    v_and_b32 v9, 0xffff0000, v155
    v_lshlrev_b32 v8, 16, v155
    v_and_b32 v11, 0xffff0000, v175
    v_lshlrev_b32 v10, 16, v175
    v_fmac_f32 v8, v130, v10
    v_fmac_f32 v9, v131, v11
    v_cvt_pk_bf16_f32 v95, v8, v9
    buffer_store_dwordx4 v[92:95], v13, s[4:7], s17 offen sc1
    s_add_u32 s17, s17, 4096
    s_waitcnt vmcnt(5)
    v_and_b32 v9, 0xffff0000, v156
    v_lshlrev_b32 v8, 16, v156
    s_waitcnt vmcnt(4)
    v_and_b32 v11, 0xffff0000, v176
    v_lshlrev_b32 v10, 16, v176
    v_fmac_f32 v8, v132, v10
    v_fmac_f32 v9, v133, v11
    v_cvt_pk_bf16_f32 v96, v8, v9
    v_and_b32 v9, 0xffff0000, v157
    v_lshlrev_b32 v8, 16, v157
    v_and_b32 v11, 0xffff0000, v177
    v_lshlrev_b32 v10, 16, v177
    v_fmac_f32 v8, v134, v10
    v_fmac_f32 v9, v135, v11
    v_cvt_pk_bf16_f32 v97, v8, v9
    v_and_b32 v9, 0xffff0000, v158
    v_lshlrev_b32 v8, 16, v158
    v_and_b32 v11, 0xffff0000, v178
    v_lshlrev_b32 v10, 16, v178
    v_fmac_f32 v8, v136, v10
    v_fmac_f32 v9, v137, v11
    v_cvt_pk_bf16_f32 v98, v8, v9
    v_and_b32 v9, 0xffff0000, v159
    v_lshlrev_b32 v8, 16, v159
    v_and_b32 v11, 0xffff0000, v179
    v_lshlrev_b32 v10, 16, v179
    v_fmac_f32 v8, v138, v10
    v_fmac_f32 v9, v139, v11
    v_cvt_pk_bf16_f32 v99, v8, v9
    buffer_store_dwordx4 v[96:99], v13, s[4:7], s17 offen sc1
    s_add_u32 s17, s17, 4096
    s_waitcnt vmcnt(0)
    s_barrier
    s_cmp_lg_u32 s13, 0
    s_cbranch_scc1 Lnw25
    s_lshl_b32 s17, s19, 7
    s_add_u32 s17, s17, 32768
    v_mov_b32 v8, 1
    v_mov_b32 v9, 0
    s_mov_b64 exec, 1
    buffer_store_dword v8, v9, s[4:7], s17 offen offset:0 sc1
    s_mov_b64 exec, -1
Lnw25:
    s_waitcnt vmcnt(0) lgkmcnt(0)
    s_nop 11
    s_sub_u32 s17, s16, 40
    s_cmp_ge_u32 s17, 80
    s_cbranch_scc1 Lnomod26
    s_load_dwordx2 s[8:9], s[0:1], 104
    s_waitcnt lgkmcnt(0)
    s_mov_b32 s10, 4915200
    s_mov_b32 s11, 0x20000
    s_load_dwordx2 s[20:21], s[0:1], 96
    s_waitcnt lgkmcnt(0)
    s_mov_b32 s22, 1280
    s_mov_b32 s23, 0x20000
    v_lshrrev_b32 v2, 2, v0
    v_and_b32 v3, 3, v0
    v_mul_u32_u24 v4, 7680, v2
    v_lshl_add_u32 v4, v3, 4, v4
    v_lshlrev_b32 v5, 1, v2
    s_mul_i32 s17, s13, 1228800
    s_lshl_b32 s18, s16, 6
    s_add_u32 s17, s17, s18
    s_mul_i32 s18, s13, 320
    buffer_load_ushort v56, v5, s[20:23], s18 offen offset:0
    buffer_load_ushort v57, v5, s[20:23], s18 offen offset:32
    buffer_load_ushort v58, v5, s[20:23], s18 offen offset:64
    buffer_load_ushort v59, v5, s[20:23], s18 offen offset:96
    buffer_load_ushort v60, v5, s[20:23], s18 offen offset:128
    buffer_load_ushort v61, v5, s[20:23], s18 offen offset:160
    buffer_load_ushort v62, v5, s[20:23], s18 offen offset:192
    buffer_load_ushort v63, v5, s[20:23], s18 offen offset:224
    buffer_load_ushort v64, v5, s[20:23], s18 offen offset:256
    buffer_load_ushort v65, v5, s[20:23], s18 offen offset:288
    buffer_load_dwordx4 v[16:19], v4, s[8:11], s17 offen
    s_add_u32 s17, s17, 122880
    buffer_load_dwordx4 v[20:23], v4, s[8:11], s17 offen
    s_add_u32 s17, s17, 122880
    buffer_load_dwordx4 v[24:27], v4, s[8:11], s17 offen
    s_add_u32 s17, s17, 122880
    buffer_load_dwordx4 v[28:31], v4, s[8:11], s17 offen
    s_add_u32 s17, s17, 122880
    buffer_load_dwordx4 v[32:35], v4, s[8:11], s17 offen
    s_add_u32 s17, s17, 122880
    buffer_load_dwordx4 v[36:39], v4, s[8:11], s17 offen
    s_add_u32 s17, s17, 122880
    buffer_load_dwordx4 v[40:43], v4, s[8:11], s17 offen
    s_add_u32 s17, s17, 122880
    buffer_load_dwordx4 v[44:47], v4, s[8:11], s17 offen
    s_add_u32 s17, s17, 122880
    buffer_load_dwordx4 v[48:51], v4, s[8:11], s17 offen
    s_add_u32 s17, s17, 122880
    buffer_load_dwordx4 v[52:55], v4, s[8:11], s17 offen
    buffer_load_dword v14, off, s[72:75], 0 offset:48 sc1
    s_waitcnt vmcnt(20)
    v_lshlrev_b32 v56, 16, v56
    v_mul_f32 v76, 3216550459, v56
    v_exp_f32 v76, v76
    s_nop 0
    v_add_f32 v76, 1.0, v76
    v_rcp_f32 v76, v76
    s_nop 0
    v_mul_f32 v56, v56, v76
    v_cvt_pk_bf16_f32 v56, v56, v56
    v_lshlrev_b32 v56, 16, v56
    s_waitcnt vmcnt(19)
    v_lshlrev_b32 v57, 16, v57
    v_mul_f32 v76, 3216550459, v57
    v_exp_f32 v76, v76
    s_nop 0
    v_add_f32 v76, 1.0, v76
    v_rcp_f32 v76, v76
    s_nop 0
    v_mul_f32 v57, v57, v76
    v_cvt_pk_bf16_f32 v57, v57, v57
    v_lshlrev_b32 v57, 16, v57
    s_waitcnt vmcnt(18)
    v_lshlrev_b32 v58, 16, v58
    v_mul_f32 v76, 3216550459, v58
    v_exp_f32 v76, v76
    s_nop 0
    v_add_f32 v76, 1.0, v76
    v_rcp_f32 v76, v76
    s_nop 0
    v_mul_f32 v58, v58, v76
    v_cvt_pk_bf16_f32 v58, v58, v58
    v_lshlrev_b32 v58, 16, v58
    s_waitcnt vmcnt(17)
    v_lshlrev_b32 v59, 16, v59
    v_mul_f32 v76, 3216550459, v59
    v_exp_f32 v76, v76
    s_nop 0
    v_add_f32 v76, 1.0, v76
    v_rcp_f32 v76, v76
    s_nop 0
    v_mul_f32 v59, v59, v76
    v_cvt_pk_bf16_f32 v59, v59, v59
    v_lshlrev_b32 v59, 16, v59
    s_waitcnt vmcnt(16)
    v_lshlrev_b32 v60, 16, v60
    v_mul_f32 v76, 3216550459, v60
    v_exp_f32 v76, v76
    s_nop 0
    v_add_f32 v76, 1.0, v76
    v_rcp_f32 v76, v76
    s_nop 0
    v_mul_f32 v60, v60, v76
    v_cvt_pk_bf16_f32 v60, v60, v60
    v_lshlrev_b32 v60, 16, v60
    s_waitcnt vmcnt(15)
    v_lshlrev_b32 v61, 16, v61
    v_mul_f32 v76, 3216550459, v61
    v_exp_f32 v76, v76
    s_nop 0
    v_add_f32 v76, 1.0, v76
    v_rcp_f32 v76, v76
    s_nop 0
    v_mul_f32 v61, v61, v76
    v_cvt_pk_bf16_f32 v61, v61, v61
    v_lshlrev_b32 v61, 16, v61
    s_waitcnt vmcnt(14)
    v_lshlrev_b32 v62, 16, v62
    v_mul_f32 v76, 3216550459, v62
    v_exp_f32 v76, v76
    s_nop 0
    v_add_f32 v76, 1.0, v76
    v_rcp_f32 v76, v76
    s_nop 0
    v_mul_f32 v62, v62, v76
    v_cvt_pk_bf16_f32 v62, v62, v62
    v_lshlrev_b32 v62, 16, v62
    s_waitcnt vmcnt(13)
    v_lshlrev_b32 v63, 16, v63
    v_mul_f32 v76, 3216550459, v63
    v_exp_f32 v76, v76
    s_nop 0
    v_add_f32 v76, 1.0, v76
    v_rcp_f32 v76, v76
    s_nop 0
    v_mul_f32 v63, v63, v76
    v_cvt_pk_bf16_f32 v63, v63, v63
    v_lshlrev_b32 v63, 16, v63
    s_waitcnt vmcnt(12)
    v_lshlrev_b32 v64, 16, v64
    v_mul_f32 v76, 3216550459, v64
    v_exp_f32 v76, v76
    s_nop 0
    v_add_f32 v76, 1.0, v76
    v_rcp_f32 v76, v76
    s_nop 0
    v_mul_f32 v64, v64, v76
    v_cvt_pk_bf16_f32 v64, v64, v64
    v_lshlrev_b32 v64, 16, v64
    s_waitcnt vmcnt(11)
    v_lshlrev_b32 v65, 16, v65
    v_mul_f32 v76, 3216550459, v65
    v_exp_f32 v76, v76
    s_nop 0
    v_add_f32 v76, 1.0, v76
    v_rcp_f32 v76, v76
    s_nop 0
    v_mul_f32 v65, v65, v76
    v_cvt_pk_bf16_f32 v65, v65, v65
    v_lshlrev_b32 v65, 16, v65
    s_waitcnt vmcnt(10)
    v_and_b32 v77, 0xffff0000, v16
    v_lshlrev_b32 v76, 16, v16
    v_mul_f32 v68, v56, v76
    v_mul_f32 v69, v56, v77
    v_and_b32 v77, 0xffff0000, v17
    v_lshlrev_b32 v76, 16, v17
    v_mul_f32 v70, v56, v76
    v_mul_f32 v71, v56, v77
    v_and_b32 v77, 0xffff0000, v18
    v_lshlrev_b32 v76, 16, v18
    v_mul_f32 v72, v56, v76
    v_mul_f32 v73, v56, v77
    v_and_b32 v77, 0xffff0000, v19
    v_lshlrev_b32 v76, 16, v19
    v_mul_f32 v74, v56, v76
    v_mul_f32 v75, v56, v77
    s_waitcnt vmcnt(9)
    v_and_b32 v77, 0xffff0000, v20
    v_lshlrev_b32 v76, 16, v20
    v_fmac_f32 v68, v57, v76
    v_fmac_f32 v69, v57, v77
    v_and_b32 v77, 0xffff0000, v21
    v_lshlrev_b32 v76, 16, v21
    v_fmac_f32 v70, v57, v76
    v_fmac_f32 v71, v57, v77
    v_and_b32 v77, 0xffff0000, v22
    v_lshlrev_b32 v76, 16, v22
    v_fmac_f32 v72, v57, v76
    v_fmac_f32 v73, v57, v77
    v_and_b32 v77, 0xffff0000, v23
    v_lshlrev_b32 v76, 16, v23
    v_fmac_f32 v74, v57, v76
    v_fmac_f32 v75, v57, v77
    s_waitcnt vmcnt(8)
    v_and_b32 v77, 0xffff0000, v24
    v_lshlrev_b32 v76, 16, v24
    v_fmac_f32 v68, v58, v76
    v_fmac_f32 v69, v58, v77
    v_and_b32 v77, 0xffff0000, v25
    v_lshlrev_b32 v76, 16, v25
    v_fmac_f32 v70, v58, v76
    v_fmac_f32 v71, v58, v77
    v_and_b32 v77, 0xffff0000, v26
    v_lshlrev_b32 v76, 16, v26
    v_fmac_f32 v72, v58, v76
    v_fmac_f32 v73, v58, v77
    v_and_b32 v77, 0xffff0000, v27
    v_lshlrev_b32 v76, 16, v27
    v_fmac_f32 v74, v58, v76
    v_fmac_f32 v75, v58, v77
    s_waitcnt vmcnt(7)
    v_and_b32 v77, 0xffff0000, v28
    v_lshlrev_b32 v76, 16, v28
    v_fmac_f32 v68, v59, v76
    v_fmac_f32 v69, v59, v77
    v_and_b32 v77, 0xffff0000, v29
    v_lshlrev_b32 v76, 16, v29
    v_fmac_f32 v70, v59, v76
    v_fmac_f32 v71, v59, v77
    v_and_b32 v77, 0xffff0000, v30
    v_lshlrev_b32 v76, 16, v30
    v_fmac_f32 v72, v59, v76
    v_fmac_f32 v73, v59, v77
    v_and_b32 v77, 0xffff0000, v31
    v_lshlrev_b32 v76, 16, v31
    v_fmac_f32 v74, v59, v76
    v_fmac_f32 v75, v59, v77
    s_waitcnt vmcnt(6)
    v_and_b32 v77, 0xffff0000, v32
    v_lshlrev_b32 v76, 16, v32
    v_fmac_f32 v68, v60, v76
    v_fmac_f32 v69, v60, v77
    v_and_b32 v77, 0xffff0000, v33
    v_lshlrev_b32 v76, 16, v33
    v_fmac_f32 v70, v60, v76
    v_fmac_f32 v71, v60, v77
    v_and_b32 v77, 0xffff0000, v34
    v_lshlrev_b32 v76, 16, v34
    v_fmac_f32 v72, v60, v76
    v_fmac_f32 v73, v60, v77
    v_and_b32 v77, 0xffff0000, v35
    v_lshlrev_b32 v76, 16, v35
    v_fmac_f32 v74, v60, v76
    v_fmac_f32 v75, v60, v77
    s_waitcnt vmcnt(5)
    v_and_b32 v77, 0xffff0000, v36
    v_lshlrev_b32 v76, 16, v36
    v_fmac_f32 v68, v61, v76
    v_fmac_f32 v69, v61, v77
    v_and_b32 v77, 0xffff0000, v37
    v_lshlrev_b32 v76, 16, v37
    v_fmac_f32 v70, v61, v76
    v_fmac_f32 v71, v61, v77
    v_and_b32 v77, 0xffff0000, v38
    v_lshlrev_b32 v76, 16, v38
    v_fmac_f32 v72, v61, v76
    v_fmac_f32 v73, v61, v77
    v_and_b32 v77, 0xffff0000, v39
    v_lshlrev_b32 v76, 16, v39
    v_fmac_f32 v74, v61, v76
    v_fmac_f32 v75, v61, v77
    s_waitcnt vmcnt(4)
    v_and_b32 v77, 0xffff0000, v40
    v_lshlrev_b32 v76, 16, v40
    v_fmac_f32 v68, v62, v76
    v_fmac_f32 v69, v62, v77
    v_and_b32 v77, 0xffff0000, v41
    v_lshlrev_b32 v76, 16, v41
    v_fmac_f32 v70, v62, v76
    v_fmac_f32 v71, v62, v77
    v_and_b32 v77, 0xffff0000, v42
    v_lshlrev_b32 v76, 16, v42
    v_fmac_f32 v72, v62, v76
    v_fmac_f32 v73, v62, v77
    v_and_b32 v77, 0xffff0000, v43
    v_lshlrev_b32 v76, 16, v43
    v_fmac_f32 v74, v62, v76
    v_fmac_f32 v75, v62, v77
    s_waitcnt vmcnt(3)
    v_and_b32 v77, 0xffff0000, v44
    v_lshlrev_b32 v76, 16, v44
    v_fmac_f32 v68, v63, v76
    v_fmac_f32 v69, v63, v77
    v_and_b32 v77, 0xffff0000, v45
    v_lshlrev_b32 v76, 16, v45
    v_fmac_f32 v70, v63, v76
    v_fmac_f32 v71, v63, v77
    v_and_b32 v77, 0xffff0000, v46
    v_lshlrev_b32 v76, 16, v46
    v_fmac_f32 v72, v63, v76
    v_fmac_f32 v73, v63, v77
    v_and_b32 v77, 0xffff0000, v47
    v_lshlrev_b32 v76, 16, v47
    v_fmac_f32 v74, v63, v76
    v_fmac_f32 v75, v63, v77
    s_waitcnt vmcnt(2)
    v_and_b32 v77, 0xffff0000, v48
    v_lshlrev_b32 v76, 16, v48
    v_fmac_f32 v68, v64, v76
    v_fmac_f32 v69, v64, v77
    v_and_b32 v77, 0xffff0000, v49
    v_lshlrev_b32 v76, 16, v49
    v_fmac_f32 v70, v64, v76
    v_fmac_f32 v71, v64, v77
    v_and_b32 v77, 0xffff0000, v50
    v_lshlrev_b32 v76, 16, v50
    v_fmac_f32 v72, v64, v76
    v_fmac_f32 v73, v64, v77
    v_and_b32 v77, 0xffff0000, v51
    v_lshlrev_b32 v76, 16, v51
    v_fmac_f32 v74, v64, v76
    v_fmac_f32 v75, v64, v77
    s_waitcnt vmcnt(1)
    v_and_b32 v77, 0xffff0000, v52
    v_lshlrev_b32 v76, 16, v52
    v_fmac_f32 v68, v65, v76
    v_fmac_f32 v69, v65, v77
    v_and_b32 v77, 0xffff0000, v53
    v_lshlrev_b32 v76, 16, v53
    v_fmac_f32 v70, v65, v76
    v_fmac_f32 v71, v65, v77
    v_and_b32 v77, 0xffff0000, v54
    v_lshlrev_b32 v76, 16, v54
    v_fmac_f32 v72, v65, v76
    v_fmac_f32 v73, v65, v77
    v_and_b32 v77, 0xffff0000, v55
    v_lshlrev_b32 v76, 16, v55
    v_fmac_f32 v74, v65, v76
    v_fmac_f32 v75, v65, v77
    v_lshlrev_b32 v2, 5, v0
    s_lshl_b32 s17, s13, 11
    v_add_u32 v2, s17, v2
    ds_write_b128 v2, v[68:71]
    ds_write_b128 v2, v[72:75] offset:16
    s_waitcnt vmcnt(0)
    v_cmp_gt_u32 vcc, 2, v14
    s_cbranch_vccz Lini27
    v_mov_b32 v15, 0
    s_mov_b32 exec_lo, 0x1
    s_mov_b32 exec_hi, 0x0
Lwf28:
    buffer_load_dword v14, v15, s[72:75], 0 offen offset:48 sc1
    s_waitcnt vmcnt(0)
    v_cmp_gt_u32 vcc, 2, v14
    s_cbranch_vccz Lwf28d
    s_sub_u32 s15, s15, 1
    s_cbranch_scc0 Lwf28
    s_mov_b32 s15, 0
Lwf28d:
    s_mov_b64 exec, -1
Lini27:
    s_waitcnt lgkmcnt(0)
    s_barrier
    s_cmp_lg_u32 s13, 0
    s_cbranch_scc1 Lmodw29
    v_lshlrev_b32 v2, 2, v0
    ds_read_b32 v16, v2 offset:0
    ds_read_b32 v17, v2 offset:256
    ds_read_b32 v18, v2 offset:512
    ds_read_b32 v19, v2 offset:768
    ds_read_b32 v20, v2 offset:1024
    ds_read_b32 v21, v2 offset:1280
    ds_read_b32 v22, v2 offset:1536
    ds_read_b32 v23, v2 offset:1792
    ds_read_b32 v24, v2 offset:2048
    ds_read_b32 v25, v2 offset:2304
    ds_read_b32 v26, v2 offset:2560
    ds_read_b32 v27, v2 offset:2816
    ds_read_b32 v28, v2 offset:3072
    ds_read_b32 v29, v2 offset:3328
    ds_read_b32 v30, v2 offset:3584
    ds_read_b32 v31, v2 offset:3840
    ds_read_b32 v32, v2 offset:4096
    ds_read_b32 v33, v2 offset:4352
    ds_read_b32 v34, v2 offset:4608
    ds_read_b32 v35, v2 offset:4864
    ds_read_b32 v36, v2 offset:5120
    ds_read_b32 v37, v2 offset:5376
    ds_read_b32 v38, v2 offset:5632
    ds_read_b32 v39, v2 offset:5888
    ds_read_b32 v40, v2 offset:6144
    ds_read_b32 v41, v2 offset:6400
    ds_read_b32 v42, v2 offset:6656
    ds_read_b32 v43, v2 offset:6912
    ds_read_b32 v44, v2 offset:7168
    ds_read_b32 v45, v2 offset:7424
    ds_read_b32 v46, v2 offset:7680
    ds_read_b32 v47, v2 offset:7936
    s_waitcnt lgkmcnt(15)
    v_add_f32 v16, v16, v17
    v_add_f32 v16, v16, v18
    v_add_f32 v16, v16, v19
    v_add_f32 v16, v16, v20
    v_add_f32 v16, v16, v21
    v_add_f32 v16, v16, v22
    v_add_f32 v16, v16, v23
    v_add_f32 v16, v16, v24
    v_add_f32 v16, v16, v25
    v_add_f32 v16, v16, v26
    v_add_f32 v16, v16, v27
    v_add_f32 v16, v16, v28
    v_add_f32 v16, v16, v29
    v_add_f32 v16, v16, v30
    v_add_f32 v16, v16, v31
    v_add_f32 v16, v16, v32
    s_waitcnt lgkmcnt(14)
    v_add_f32 v16, v16, v33
    s_waitcnt lgkmcnt(13)
    v_add_f32 v16, v16, v34
    s_waitcnt lgkmcnt(12)
    v_add_f32 v16, v16, v35
    s_waitcnt lgkmcnt(11)
    v_add_f32 v16, v16, v36
    s_waitcnt lgkmcnt(10)
    v_add_f32 v16, v16, v37
    s_waitcnt lgkmcnt(9)
    v_add_f32 v16, v16, v38
    s_waitcnt lgkmcnt(8)
    v_add_f32 v16, v16, v39
    s_waitcnt lgkmcnt(7)
    v_add_f32 v16, v16, v40
    s_waitcnt lgkmcnt(6)
    v_add_f32 v16, v16, v41
    s_waitcnt lgkmcnt(5)
    v_add_f32 v16, v16, v42
    s_waitcnt lgkmcnt(4)
    v_add_f32 v16, v16, v43
    s_waitcnt lgkmcnt(3)
    v_add_f32 v16, v16, v44
    s_waitcnt lgkmcnt(2)
    v_add_f32 v16, v16, v45
    s_waitcnt lgkmcnt(1)
    v_add_f32 v16, v16, v46
    s_waitcnt lgkmcnt(0)
    v_add_f32 v16, v16, v47
    v_mov_b32 v76, v16
    s_nop 1
    v_permlane32_swap_b32 v16, v76
    v_add_f32 v16, v16, v76
    v_cvt_pk_bf16_f32 v16, v16, v16
    v_lshlrev_b32 v16, 16, v16
    s_sub_u32 s17, s16, 20
    s_sub_u32 s18, s16, 80
    s_min_u32 s17, s17, s18
    s_cmp_lt_u32 s17, 20
    s_cselect_b32 s17, 1.0, 0
    v_add_f32 v16, s17, v16
    v_cvt_pk_bf16_f32 v16, v16, v16
    v_and_b32 v2, 31, v0
    v_lshlrev_b32 v2, 1, v2
    s_lshl_b32 s17, s16, 6
    s_add_u32 s17, s17, 65536
    buffer_store_short v16, v2, s[4:7], s17 offen sc1
    s_lshl_b32 s17, s16, 7
    s_add_u32 s17, s17, 16384
    s_waitcnt vmcnt(0)
    v_mov_b32 v76, 1
    v_mov_b32 v77, 0
    s_mov_b64 exec, 1
    buffer_store_dword v76, v77, s[4:7], s17 offen offset:0 sc1
    s_mov_b64 exec, -1
    s_branch Lmodw29
Lnomod26:
Lmodw29:
    s_waitcnt vmcnt(0) lgkmcnt(0)
    s_nop 11
    v_mov_b32 v5, 0
    s_mov_b32 exec_lo, 0x1
    s_mov_b32 exec_hi, 0x0
Lwf30:
    buffer_load_dword v4, v5, s[72:75], 0 offen offset:52 sc1
    s_waitcnt vmcnt(0)
    v_cmp_gt_u32 vcc, 524288, v4
    s_cbranch_vccz Lwf30d
    s_sub_u32 s15, s15, 1
    s_cbranch_scc0 Lwf30
    s_mov_b32 s15, 0
Lwf30d:
    s_mov_b64 exec, -1
    v_readfirstlane_b32 s55, v4
    s_nop 3
    s_and_b32 s55, s55, 0x60
    s_cselect_b32 s55, 0x2000, 0
    s_lshl_b32 s18, s12, 7
    v_mov_b32 v5, 0
    s_mov_b32 exec_lo, 0x1
    s_mov_b32 exec_hi, 0x0
Lwf31:
    buffer_load_dword v4, v5, s[4:7], s18 offen offset:0 sc1
    s_waitcnt vmcnt(0)
    v_cmp_gt_u32 vcc, 4, v4
    s_cbranch_vccz Lwf31d
    s_sub_u32 s15, s15, 1
    s_cbranch_scc0 Lwf31
    s_mov_b32 s15, 0
Lwf31d:
    s_mov_b64 exec, -1
    s_cmp_ge_u32 s12, 16
    s_cbranch_scc1 Lst232
    s_and_b32 s50, s12, 15
    s_and_b32 s26, s13, 1
    s_lshr_b32 s27, s13, 1
    s_lshl_b32 s51, s50, 1
    s_add_u32 s51, s51, s27
    v_and_b32 v48, 15, v0
    v_lshrrev_b32 v49, 4, v0
    v_lshlrev_b32 v1, 4, v0
    v_lshlrev_b32 v2, 2, v0
    v_lshlrev_b32 v3, 3, v0
    v_mul_u32_u24 v50, 262144, v49
    v_lshl_add_u32 v4, v48, 4, v50
    v_lshl_add_u32 v5, v48, 2, v50
    v_mul_u32_u24 v50, 1280, v49
    v_lshl_add_u32 v6, v48, 4, v50
    v_lshlrev_b32 v50, 4, v49
    v_lshl_add_u32 v8, v48, 5, v50
    s_mul_i32 s18, s13, 2560
    v_add_u32 v8, s18, v8
    v_add_u32 v9, s18, v3
    s_mov_b32 s48, 0x05040100
    s_mov_b32 s49, 0x07060302
    s_sub_u32 s16, s3, 4
    s_mul_i32 s21, s16, 4194304
    s_add_u32 s21, s21, 100663296
    s_xor_b32 s21, s21, s55
    s_lshl_b32 s28, s16, 18
    s_add_u32 s28, s28, 92274688
    s_mul_i32 s18, s51, 65536
    s_lshl_b32 s19, s26, 15
    s_add_u32 s22, s21, s18
    s_add_u32 s22, s22, s19
    s_lshr_b32 s18, s50, 2
    s_lshl_b32 s18, s18, 14
    s_add_u32 s21, s21, s18
    s_and_b32 s18, s50, 3
    s_mul_i32 s18, s18, 1280
    s_mul_i32 s19, s13, 320
    s_add_u32 s21, s21, s18
    s_add_u32 s21, s21, s19
    s_lshl_b32 s23, s16, 11
    s_add_u32 s23, s23, 8192
    s_mov_b32 s17, 1
    s_lshl_b32 s52, s50, 2
    s_add_u32 s52, s52, s13
    s_lshl_b32 s52, s52, 2
    s_add_u32 s52, s52, s23
    v_mov_b32 v7, v6
    v_lshrrev_b32 v50, 2, v48
    v_lshlrev_b32 v50, 6, v50
    v_lshl_add_u32 v50, v49, 8, v50
    v_and_b32 v51, 1, v48
    v_lshl_add_u32 v11, v51, 4, v50
    v_bfe_u32 v51, v48, 1, 1
    v_lshl_add_u32 v10, v51, 11, v11
    v_lshrrev_b32 v50, 1, v49
    v_lshlrev_b32 v50, 6, v50
    v_lshlrev_b32 v51, 3, v48
    v_xor_b32 v50, v50, v51
    v_lshl_add_u32 v12, v49, 7, v50
    s_lshl_b32 s18, s26, 13
    s_lshl_b32 s19, s27, 12
    s_add_u32 s18, s18, s19
    v_add_u32 v13, s18, v1
    s_mul_i32 s18, s27, 24576
    s_add_u32 s18, s18, 32768
    v_add_u32 v15, s18, v1
    v_add_u32 v10, s18, v10
    s_lshl_b32 s19, s26, 12
    v_add_u32 v14, s19, v15
    s_mov_b32 s24, 1040356334
    s_mov_b32 s25, 3467377551
    s_lshl_b32 s29, s51, 7
    s_add_u32 s29, s29, 0
    s_mov_b32 s30, 0
    s_lshl_b32 s56, s50, 14
    s_lshl_b32 s18, s27, 12
    s_add_u32 s56, s56, s18
    s_add_u32 s56, s56, 75505664
    s_xor_b32 s56, s56, s55
    s_lshl_b32 s18, s26, 4
    v_add_u32 v50, s18, v48
    v_lshlrev_b32 v51, 2, v49
    v_sub_u32 v50, v50, v51
    v_cmp_le_i32 s[32:33], 0, v50
    v_cmp_le_i32 s[34:35], 1, v50
    v_cmp_le_i32 s[36:37], 2, v50
    v_cmp_le_i32 s[38:39], 3, v50
    v_cmp_le_i32 s[40:41], 16, v50
    v_cmp_le_i32 s[42:43], 17, v50
    v_cmp_le_i32 s[44:45], 18, v50
    v_cmp_le_i32 s[46:47], 19, v50
    v_mov_b32 v16, 0
    v_mov_b32 v50, 0x3f80
    v_cmp_eq_u32 vcc, 0, v48
    s_nop 1
    v_cndmask_b32 v16, v16, v50, vcc
    v_mov_b32 v50, 1.0
    v_cmp_eq_u32 vcc, 1, v48
    s_nop 1
    v_cndmask_b32 v16, v16, v50, vcc
    v_mov_b32 v17, 0
    v_mov_b32 v50, 0x3f80
    v_cmp_eq_u32 vcc, 2, v48
    s_nop 1
    v_cndmask_b32 v17, v17, v50, vcc
    v_mov_b32 v50, 1.0
    v_cmp_eq_u32 vcc, 3, v48
    s_nop 1
    v_cndmask_b32 v17, v17, v50, vcc
    v_mov_b32 v18, 0
    v_mov_b32 v50, 0x3f80
    v_cmp_eq_u32 vcc, 4, v48
    s_nop 1
    v_cndmask_b32 v18, v18, v50, vcc
    v_mov_b32 v50, 1.0
    v_cmp_eq_u32 vcc, 5, v48
    s_nop 1
    v_cndmask_b32 v18, v18, v50, vcc
    v_mov_b32 v19, 0
    v_mov_b32 v50, 0x3f80
    v_cmp_eq_u32 vcc, 6, v48
    s_nop 1
    v_cndmask_b32 v19, v19, v50, vcc
    v_mov_b32 v50, 1.0
    v_cmp_eq_u32 vcc, 7, v48
    s_nop 1
    v_cndmask_b32 v19, v19, v50, vcc
    s_load_dwordx2 s[8:9], s[0:1], 40
    s_waitcnt lgkmcnt(0)
    s_mov_b32 s10, 5242880
    s_mov_b32 s11, 0x20000
    s_lshl_b32 s20, s50, 8
    v_lshrrev_b32 v50, 4, v0
    v_mul_u32_u24 v50, 5120, v50
    s_mul_i32 s19, s20, 1280
    s_mul_i32 s18, s13, 320
    s_add_u32 s19, s19, s18
    v_add_u32 v50, s19, v50
    v_and_b32 v49, 15, v0
    v_lshl_add_u32 v48, v49, 4, v50
    v_lshl_add_u32 v49, v49, 2, v50
    v_add_u32 v49, 256, v49
    buffer_load_dwordx4 v[56:59], v48, s[8:11], 0 offen offset:0
    buffer_load_dword v88, v49, s[8:11], 0 offen offset:0
    buffer_load_dwordx4 v[60:63], v48, s[8:11], 0 offen offset:1280
    buffer_load_dword v89, v49, s[8:11], 0 offen offset:1280
    buffer_load_dwordx4 v[64:67], v48, s[8:11], 0 offen offset:2560
    buffer_load_dword v90, v49, s[8:11], 0 offen offset:2560
    buffer_load_dwordx4 v[68:71], v48, s[8:11], 0 offen offset:3840
    buffer_load_dword v91, v49, s[8:11], 0 offen offset:3840
    v_add_u32 v48, 20480, v48
    v_add_u32 v49, 20480, v49
    buffer_load_dwordx4 v[72:75], v48, s[8:11], 0 offen offset:0
    buffer_load_dword v92, v49, s[8:11], 0 offen offset:0
    buffer_load_dwordx4 v[76:79], v48, s[8:11], 0 offen offset:1280
    buffer_load_dword v93, v49, s[8:11], 0 offen offset:1280
    buffer_load_dwordx4 v[80:83], v48, s[8:11], 0 offen offset:2560
    buffer_load_dword v94, v49, s[8:11], 0 offen offset:2560
    buffer_load_dwordx4 v[84:87], v48, s[8:11], 0 offen offset:3840
    buffer_load_dword v95, v49, s[8:11], 0 offen offset:3840
    v_add_u32 v48, 20480, v48
    v_add_u32 v49, 20480, v49
    buffer_load_dwordx4 v[96:99], v48, s[8:11], 0 offen offset:0
    buffer_load_dword v128, v49, s[8:11], 0 offen offset:0
    buffer_load_dwordx4 v[100:103], v48, s[8:11], 0 offen offset:1280
    buffer_load_dword v129, v49, s[8:11], 0 offen offset:1280
    buffer_load_dwordx4 v[104:107], v48, s[8:11], 0 offen offset:2560
    buffer_load_dword v130, v49, s[8:11], 0 offen offset:2560
    buffer_load_dwordx4 v[108:111], v48, s[8:11], 0 offen offset:3840
    buffer_load_dword v131, v49, s[8:11], 0 offen offset:3840
    v_add_u32 v48, 20480, v48
    v_add_u32 v49, 20480, v49
    buffer_load_dwordx4 v[112:115], v48, s[8:11], 0 offen offset:0
    buffer_load_dword v132, v49, s[8:11], 0 offen offset:0
    buffer_load_dwordx4 v[116:119], v48, s[8:11], 0 offen offset:1280
    buffer_load_dword v133, v49, s[8:11], 0 offen offset:1280
    buffer_load_dwordx4 v[120:123], v48, s[8:11], 0 offen offset:2560
    buffer_load_dword v134, v49, s[8:11], 0 offen offset:2560
    buffer_load_dwordx4 v[124:127], v48, s[8:11], 0 offen offset:3840
    buffer_load_dword v135, v49, s[8:11], 0 offen offset:3840
    v_add_u32 v48, 20480, v48
    v_add_u32 v49, 20480, v49
    buffer_load_dwordx4 v[136:139], v48, s[8:11], 0 offen offset:0
    buffer_load_dword v168, v49, s[8:11], 0 offen offset:0
    buffer_load_dwordx4 v[140:143], v48, s[8:11], 0 offen offset:1280
    buffer_load_dword v169, v49, s[8:11], 0 offen offset:1280
    buffer_load_dwordx4 v[144:147], v48, s[8:11], 0 offen offset:2560
    buffer_load_dword v170, v49, s[8:11], 0 offen offset:2560
    buffer_load_dwordx4 v[148:151], v48, s[8:11], 0 offen offset:3840
    buffer_load_dword v171, v49, s[8:11], 0 offen offset:3840
    v_add_u32 v48, 20480, v48
    v_add_u32 v49, 20480, v49
    buffer_load_dwordx4 v[152:155], v48, s[8:11], 0 offen offset:0
    buffer_load_dword v172, v49, s[8:11], 0 offen offset:0
    buffer_load_dwordx4 v[156:159], v48, s[8:11], 0 offen offset:1280
    buffer_load_dword v173, v49, s[8:11], 0 offen offset:1280
    buffer_load_dwordx4 v[160:163], v48, s[8:11], 0 offen offset:2560
    buffer_load_dword v174, v49, s[8:11], 0 offen offset:2560
    buffer_load_dwordx4 v[164:167], v48, s[8:11], 0 offen offset:3840
    buffer_load_dword v175, v49, s[8:11], 0 offen offset:3840
    v_add_u32 v48, 20480, v48
    v_add_u32 v49, 20480, v49
    s_waitcnt vmcnt(45)
    v_perm_b32 v50, v60, v56, s48
    v_accvgpr_write_b32 a0, v50
    s_waitcnt vmcnt(41)
    v_perm_b32 v51, v68, v64, s48
    v_accvgpr_write_b32 a1, v51
    s_waitcnt vmcnt(37)
    v_perm_b32 v50, v76, v72, s48
    v_accvgpr_write_b32 a2, v50
    s_waitcnt vmcnt(33)
    v_perm_b32 v51, v84, v80, s48
    v_accvgpr_write_b32 a3, v51
    v_perm_b32 v50, v60, v56, s49
    v_accvgpr_write_b32 a4, v50
    v_perm_b32 v51, v68, v64, s49
    v_accvgpr_write_b32 a5, v51
    v_perm_b32 v50, v76, v72, s49
    v_accvgpr_write_b32 a6, v50
    v_perm_b32 v51, v84, v80, s49
    v_accvgpr_write_b32 a7, v51
    v_perm_b32 v50, v61, v57, s48
    v_accvgpr_write_b32 a8, v50
    v_perm_b32 v51, v69, v65, s48
    v_accvgpr_write_b32 a9, v51
    v_perm_b32 v50, v77, v73, s48
    v_accvgpr_write_b32 a10, v50
    v_perm_b32 v51, v85, v81, s48
    v_accvgpr_write_b32 a11, v51
    v_perm_b32 v50, v61, v57, s49
    v_accvgpr_write_b32 a12, v50
    v_perm_b32 v51, v69, v65, s49
    v_accvgpr_write_b32 a13, v51
    v_perm_b32 v50, v77, v73, s49
    v_accvgpr_write_b32 a14, v50
    v_perm_b32 v51, v85, v81, s49
    v_accvgpr_write_b32 a15, v51
    v_perm_b32 v50, v62, v58, s48
    v_accvgpr_write_b32 a16, v50
    v_perm_b32 v51, v70, v66, s48
    v_accvgpr_write_b32 a17, v51
    v_perm_b32 v50, v78, v74, s48
    v_accvgpr_write_b32 a18, v50
    v_perm_b32 v51, v86, v82, s48
    v_accvgpr_write_b32 a19, v51
    v_perm_b32 v50, v62, v58, s49
    v_accvgpr_write_b32 a20, v50
    v_perm_b32 v51, v70, v66, s49
    v_accvgpr_write_b32 a21, v51
    v_perm_b32 v50, v78, v74, s49
    v_accvgpr_write_b32 a22, v50
    v_perm_b32 v51, v86, v82, s49
    v_accvgpr_write_b32 a23, v51
    v_perm_b32 v50, v63, v59, s48
    v_accvgpr_write_b32 a24, v50
    v_perm_b32 v51, v71, v67, s48
    v_accvgpr_write_b32 a25, v51
    v_perm_b32 v50, v79, v75, s48
    v_accvgpr_write_b32 a26, v50
    v_perm_b32 v51, v87, v83, s48
    v_accvgpr_write_b32 a27, v51
    v_perm_b32 v50, v63, v59, s49
    v_accvgpr_write_b32 a28, v50
    v_perm_b32 v51, v71, v67, s49
    v_accvgpr_write_b32 a29, v51
    v_perm_b32 v50, v79, v75, s49
    v_accvgpr_write_b32 a30, v50
    v_perm_b32 v51, v87, v83, s49
    v_accvgpr_write_b32 a31, v51
    v_perm_b32 v50, v89, v88, s48
    v_accvgpr_write_b32 a32, v50
    v_perm_b32 v51, v91, v90, s48
    v_accvgpr_write_b32 a33, v51
    v_perm_b32 v50, v93, v92, s48
    v_accvgpr_write_b32 a34, v50
    s_waitcnt vmcnt(32)
    v_perm_b32 v51, v95, v94, s48
    v_accvgpr_write_b32 a35, v51
    v_perm_b32 v50, v89, v88, s49
    v_accvgpr_write_b32 a36, v50
    v_perm_b32 v51, v91, v90, s49
    v_accvgpr_write_b32 a37, v51
    v_perm_b32 v50, v93, v92, s49
    v_accvgpr_write_b32 a38, v50
    v_perm_b32 v51, v95, v94, s49
    v_accvgpr_write_b32 a39, v51
    buffer_load_dwordx4 v[56:59], v48, s[8:11], 0 offen offset:0
    buffer_load_dword v88, v49, s[8:11], 0 offen offset:0
    buffer_load_dwordx4 v[60:63], v48, s[8:11], 0 offen offset:1280
    buffer_load_dword v89, v49, s[8:11], 0 offen offset:1280
    buffer_load_dwordx4 v[64:67], v48, s[8:11], 0 offen offset:2560
    buffer_load_dword v90, v49, s[8:11], 0 offen offset:2560
    buffer_load_dwordx4 v[68:71], v48, s[8:11], 0 offen offset:3840
    buffer_load_dword v91, v49, s[8:11], 0 offen offset:3840
    v_add_u32 v48, 20480, v48
    v_add_u32 v49, 20480, v49
    buffer_load_dwordx4 v[72:75], v48, s[8:11], 0 offen offset:0
    buffer_load_dword v92, v49, s[8:11], 0 offen offset:0
    buffer_load_dwordx4 v[76:79], v48, s[8:11], 0 offen offset:1280
    buffer_load_dword v93, v49, s[8:11], 0 offen offset:1280
    buffer_load_dwordx4 v[80:83], v48, s[8:11], 0 offen offset:2560
    buffer_load_dword v94, v49, s[8:11], 0 offen offset:2560
    buffer_load_dwordx4 v[84:87], v48, s[8:11], 0 offen offset:3840
    buffer_load_dword v95, v49, s[8:11], 0 offen offset:3840
    v_add_u32 v48, 20480, v48
    v_add_u32 v49, 20480, v49
    s_waitcnt vmcnt(45)
    v_perm_b32 v50, v100, v96, s48
    v_accvgpr_write_b32 a40, v50
    s_waitcnt vmcnt(41)
    v_perm_b32 v51, v108, v104, s48
    v_accvgpr_write_b32 a41, v51
    s_waitcnt vmcnt(37)
    v_perm_b32 v50, v116, v112, s48
    v_accvgpr_write_b32 a42, v50
    s_waitcnt vmcnt(33)
    v_perm_b32 v51, v124, v120, s48
    v_accvgpr_write_b32 a43, v51
    v_perm_b32 v50, v100, v96, s49
    v_accvgpr_write_b32 a44, v50
    v_perm_b32 v51, v108, v104, s49
    v_accvgpr_write_b32 a45, v51
    v_perm_b32 v50, v116, v112, s49
    v_accvgpr_write_b32 a46, v50
    v_perm_b32 v51, v124, v120, s49
    v_accvgpr_write_b32 a47, v51
    v_perm_b32 v50, v101, v97, s48
    v_accvgpr_write_b32 a48, v50
    v_perm_b32 v51, v109, v105, s48
    v_accvgpr_write_b32 a49, v51
    v_perm_b32 v50, v117, v113, s48
    v_accvgpr_write_b32 a50, v50
    v_perm_b32 v51, v125, v121, s48
    v_accvgpr_write_b32 a51, v51
    v_perm_b32 v50, v101, v97, s49
    v_accvgpr_write_b32 a52, v50
    v_perm_b32 v51, v109, v105, s49
    v_accvgpr_write_b32 a53, v51
    v_perm_b32 v50, v117, v113, s49
    v_accvgpr_write_b32 a54, v50
    v_perm_b32 v51, v125, v121, s49
    v_accvgpr_write_b32 a55, v51
    v_perm_b32 v50, v102, v98, s48
    v_accvgpr_write_b32 a56, v50
    v_perm_b32 v51, v110, v106, s48
    v_accvgpr_write_b32 a57, v51
    v_perm_b32 v50, v118, v114, s48
    v_accvgpr_write_b32 a58, v50
    v_perm_b32 v51, v126, v122, s48
    v_accvgpr_write_b32 a59, v51
    v_perm_b32 v50, v102, v98, s49
    v_accvgpr_write_b32 a60, v50
    v_perm_b32 v51, v110, v106, s49
    v_accvgpr_write_b32 a61, v51
    v_perm_b32 v50, v118, v114, s49
    v_accvgpr_write_b32 a62, v50
    v_perm_b32 v51, v126, v122, s49
    v_accvgpr_write_b32 a63, v51
    v_perm_b32 v50, v103, v99, s48
    v_accvgpr_write_b32 a64, v50
    v_perm_b32 v51, v111, v107, s48
    v_accvgpr_write_b32 a65, v51
    v_perm_b32 v50, v119, v115, s48
    v_accvgpr_write_b32 a66, v50
    v_perm_b32 v51, v127, v123, s48
    v_accvgpr_write_b32 a67, v51
    v_perm_b32 v50, v103, v99, s49
    v_accvgpr_write_b32 a68, v50
    v_perm_b32 v51, v111, v107, s49
    v_accvgpr_write_b32 a69, v51
    v_perm_b32 v50, v119, v115, s49
    v_accvgpr_write_b32 a70, v50
    v_perm_b32 v51, v127, v123, s49
    v_accvgpr_write_b32 a71, v51
    v_perm_b32 v50, v129, v128, s48
    v_accvgpr_write_b32 a72, v50
    v_perm_b32 v51, v131, v130, s48
    v_accvgpr_write_b32 a73, v51
    v_perm_b32 v50, v133, v132, s48
    v_accvgpr_write_b32 a74, v50
    s_waitcnt vmcnt(32)
    v_perm_b32 v51, v135, v134, s48
    v_accvgpr_write_b32 a75, v51
    v_perm_b32 v50, v129, v128, s49
    v_accvgpr_write_b32 a76, v50
    v_perm_b32 v51, v131, v130, s49
    v_accvgpr_write_b32 a77, v51
    v_perm_b32 v50, v133, v132, s49
    v_accvgpr_write_b32 a78, v50
    v_perm_b32 v51, v135, v134, s49
    v_accvgpr_write_b32 a79, v51
    buffer_load_dwordx4 v[96:99], v48, s[8:11], 0 offen offset:0
    buffer_load_dword v128, v49, s[8:11], 0 offen offset:0
    buffer_load_dwordx4 v[100:103], v48, s[8:11], 0 offen offset:1280
    buffer_load_dword v129, v49, s[8:11], 0 offen offset:1280
    buffer_load_dwordx4 v[104:107], v48, s[8:11], 0 offen offset:2560
    buffer_load_dword v130, v49, s[8:11], 0 offen offset:2560
    buffer_load_dwordx4 v[108:111], v48, s[8:11], 0 offen offset:3840
    buffer_load_dword v131, v49, s[8:11], 0 offen offset:3840
    v_add_u32 v48, 20480, v48
    v_add_u32 v49, 20480, v49
    buffer_load_dwordx4 v[112:115], v48, s[8:11], 0 offen offset:0
    buffer_load_dword v132, v49, s[8:11], 0 offen offset:0
    buffer_load_dwordx4 v[116:119], v48, s[8:11], 0 offen offset:1280
    buffer_load_dword v133, v49, s[8:11], 0 offen offset:1280
    buffer_load_dwordx4 v[120:123], v48, s[8:11], 0 offen offset:2560
    buffer_load_dword v134, v49, s[8:11], 0 offen offset:2560
    buffer_load_dwordx4 v[124:127], v48, s[8:11], 0 offen offset:3840
    buffer_load_dword v135, v49, s[8:11], 0 offen offset:3840
    v_add_u32 v48, 20480, v48
    v_add_u32 v49, 20480, v49
    s_waitcnt vmcnt(45)
    v_perm_b32 v50, v140, v136, s48
    v_accvgpr_write_b32 a80, v50
    s_waitcnt vmcnt(41)
    v_perm_b32 v51, v148, v144, s48
    v_accvgpr_write_b32 a81, v51
    s_waitcnt vmcnt(37)
    v_perm_b32 v50, v156, v152, s48
    v_accvgpr_write_b32 a82, v50
    s_waitcnt vmcnt(33)
    v_perm_b32 v51, v164, v160, s48
    v_accvgpr_write_b32 a83, v51
    v_perm_b32 v50, v140, v136, s49
    v_accvgpr_write_b32 a84, v50
    v_perm_b32 v51, v148, v144, s49
    v_accvgpr_write_b32 a85, v51
    v_perm_b32 v50, v156, v152, s49
    v_accvgpr_write_b32 a86, v50
    v_perm_b32 v51, v164, v160, s49
    v_accvgpr_write_b32 a87, v51
    v_perm_b32 v50, v141, v137, s48
    v_accvgpr_write_b32 a88, v50
    v_perm_b32 v51, v149, v145, s48
    v_accvgpr_write_b32 a89, v51
    v_perm_b32 v50, v157, v153, s48
    v_accvgpr_write_b32 a90, v50
    v_perm_b32 v51, v165, v161, s48
    v_accvgpr_write_b32 a91, v51
    v_perm_b32 v50, v141, v137, s49
    v_accvgpr_write_b32 a92, v50
    v_perm_b32 v51, v149, v145, s49
    v_accvgpr_write_b32 a93, v51
    v_perm_b32 v50, v157, v153, s49
    v_accvgpr_write_b32 a94, v50
    v_perm_b32 v51, v165, v161, s49
    v_accvgpr_write_b32 a95, v51
    v_perm_b32 v50, v142, v138, s48
    v_accvgpr_write_b32 a96, v50
    v_perm_b32 v51, v150, v146, s48
    v_accvgpr_write_b32 a97, v51
    v_perm_b32 v50, v158, v154, s48
    v_accvgpr_write_b32 a98, v50
    v_perm_b32 v51, v166, v162, s48
    v_accvgpr_write_b32 a99, v51
    v_perm_b32 v50, v142, v138, s49
    v_accvgpr_write_b32 a100, v50
    v_perm_b32 v51, v150, v146, s49
    v_accvgpr_write_b32 a101, v51
    v_perm_b32 v50, v158, v154, s49
    v_accvgpr_write_b32 a102, v50
    v_perm_b32 v51, v166, v162, s49
    v_accvgpr_write_b32 a103, v51
    v_perm_b32 v50, v143, v139, s48
    v_accvgpr_write_b32 a104, v50
    v_perm_b32 v51, v151, v147, s48
    v_accvgpr_write_b32 a105, v51
    v_perm_b32 v50, v159, v155, s48
    v_accvgpr_write_b32 a106, v50
    v_perm_b32 v51, v167, v163, s48
    v_accvgpr_write_b32 a107, v51
    v_perm_b32 v50, v143, v139, s49
    v_accvgpr_write_b32 a108, v50
    v_perm_b32 v51, v151, v147, s49
    v_accvgpr_write_b32 a109, v51
    v_perm_b32 v50, v159, v155, s49
    v_accvgpr_write_b32 a110, v50
    v_perm_b32 v51, v167, v163, s49
    v_accvgpr_write_b32 a111, v51
    v_perm_b32 v50, v169, v168, s48
    v_accvgpr_write_b32 a112, v50
    v_perm_b32 v51, v171, v170, s48
    v_accvgpr_write_b32 a113, v51
    v_perm_b32 v50, v173, v172, s48
    v_accvgpr_write_b32 a114, v50
    s_waitcnt vmcnt(32)
    v_perm_b32 v51, v175, v174, s48
    v_accvgpr_write_b32 a115, v51
    v_perm_b32 v50, v169, v168, s49
    v_accvgpr_write_b32 a116, v50
    v_perm_b32 v51, v171, v170, s49
    v_accvgpr_write_b32 a117, v51
    v_perm_b32 v50, v173, v172, s49
    v_accvgpr_write_b32 a118, v50
    v_perm_b32 v51, v175, v174, s49
    v_accvgpr_write_b32 a119, v51
    buffer_load_dwordx4 v[136:139], v48, s[8:11], 0 offen offset:0
    buffer_load_dword v168, v49, s[8:11], 0 offen offset:0
    buffer_load_dwordx4 v[140:143], v48, s[8:11], 0 offen offset:1280
    buffer_load_dword v169, v49, s[8:11], 0 offen offset:1280
    buffer_load_dwordx4 v[144:147], v48, s[8:11], 0 offen offset:2560
    buffer_load_dword v170, v49, s[8:11], 0 offen offset:2560
    buffer_load_dwordx4 v[148:151], v48, s[8:11], 0 offen offset:3840
    buffer_load_dword v171, v49, s[8:11], 0 offen offset:3840
    v_add_u32 v48, 20480, v48
    v_add_u32 v49, 20480, v49
    buffer_load_dwordx4 v[152:155], v48, s[8:11], 0 offen offset:0
    buffer_load_dword v172, v49, s[8:11], 0 offen offset:0
    buffer_load_dwordx4 v[156:159], v48, s[8:11], 0 offen offset:1280
    buffer_load_dword v173, v49, s[8:11], 0 offen offset:1280
    buffer_load_dwordx4 v[160:163], v48, s[8:11], 0 offen offset:2560
    buffer_load_dword v174, v49, s[8:11], 0 offen offset:2560
    buffer_load_dwordx4 v[164:167], v48, s[8:11], 0 offen offset:3840
    buffer_load_dword v175, v49, s[8:11], 0 offen offset:3840
    v_add_u32 v48, 20480, v48
    v_add_u32 v49, 20480, v49
    s_waitcnt vmcnt(45)
    v_perm_b32 v50, v60, v56, s48
    v_accvgpr_write_b32 a120, v50
    s_waitcnt vmcnt(41)
    v_perm_b32 v51, v68, v64, s48
    v_accvgpr_write_b32 a121, v51
    s_waitcnt vmcnt(37)
    v_perm_b32 v50, v76, v72, s48
    v_accvgpr_write_b32 a122, v50
    s_waitcnt vmcnt(33)
    v_perm_b32 v51, v84, v80, s48
    v_accvgpr_write_b32 a123, v51
    v_perm_b32 v50, v60, v56, s49
    v_accvgpr_write_b32 a124, v50
    v_perm_b32 v51, v68, v64, s49
    v_accvgpr_write_b32 a125, v51
    v_perm_b32 v50, v76, v72, s49
    v_accvgpr_write_b32 a126, v50
    v_perm_b32 v51, v84, v80, s49
    v_accvgpr_write_b32 a127, v51
    v_perm_b32 v50, v61, v57, s48
    v_accvgpr_write_b32 a128, v50
    v_perm_b32 v51, v69, v65, s48
    v_accvgpr_write_b32 a129, v51
    v_perm_b32 v50, v77, v73, s48
    v_accvgpr_write_b32 a130, v50
    v_perm_b32 v51, v85, v81, s48
    v_accvgpr_write_b32 a131, v51
    v_perm_b32 v50, v61, v57, s49
    v_accvgpr_write_b32 a132, v50
    v_perm_b32 v51, v69, v65, s49
    v_accvgpr_write_b32 a133, v51
    v_perm_b32 v50, v77, v73, s49
    v_accvgpr_write_b32 a134, v50
    v_perm_b32 v51, v85, v81, s49
    v_accvgpr_write_b32 a135, v51
    v_perm_b32 v50, v62, v58, s48
    v_accvgpr_write_b32 a136, v50
    v_perm_b32 v51, v70, v66, s48
    v_accvgpr_write_b32 a137, v51
    v_perm_b32 v50, v78, v74, s48
    v_accvgpr_write_b32 a138, v50
    v_perm_b32 v51, v86, v82, s48
    v_accvgpr_write_b32 a139, v51
    v_perm_b32 v50, v62, v58, s49
    v_accvgpr_write_b32 a140, v50
    v_perm_b32 v51, v70, v66, s49
    v_accvgpr_write_b32 a141, v51
    v_perm_b32 v50, v78, v74, s49
    v_accvgpr_write_b32 a142, v50
    v_perm_b32 v51, v86, v82, s49
    v_accvgpr_write_b32 a143, v51
    v_perm_b32 v50, v63, v59, s48
    v_accvgpr_write_b32 a144, v50
    v_perm_b32 v51, v71, v67, s48
    v_accvgpr_write_b32 a145, v51
    v_perm_b32 v50, v79, v75, s48
    v_accvgpr_write_b32 a146, v50
    v_perm_b32 v51, v87, v83, s48
    v_accvgpr_write_b32 a147, v51
    v_perm_b32 v50, v63, v59, s49
    v_accvgpr_write_b32 a148, v50
    v_perm_b32 v51, v71, v67, s49
    v_accvgpr_write_b32 a149, v51
    v_perm_b32 v50, v79, v75, s49
    v_accvgpr_write_b32 a150, v50
    v_perm_b32 v51, v87, v83, s49
    v_accvgpr_write_b32 a151, v51
    v_perm_b32 v50, v89, v88, s48
    v_accvgpr_write_b32 a152, v50
    v_perm_b32 v51, v91, v90, s48
    v_accvgpr_write_b32 a153, v51
    v_perm_b32 v50, v93, v92, s48
    v_accvgpr_write_b32 a154, v50
    s_waitcnt vmcnt(32)
    v_perm_b32 v51, v95, v94, s48
    v_accvgpr_write_b32 a155, v51
    v_perm_b32 v50, v89, v88, s49
    v_accvgpr_write_b32 a156, v50
    v_perm_b32 v51, v91, v90, s49
    v_accvgpr_write_b32 a157, v51
    v_perm_b32 v50, v93, v92, s49
    v_accvgpr_write_b32 a158, v50
    v_perm_b32 v51, v95, v94, s49
    v_accvgpr_write_b32 a159, v51
    buffer_load_dwordx4 v[56:59], v48, s[8:11], 0 offen offset:0
    buffer_load_dword v88, v49, s[8:11], 0 offen offset:0
    buffer_load_dwordx4 v[60:63], v48, s[8:11], 0 offen offset:1280
    buffer_load_dword v89, v49, s[8:11], 0 offen offset:1280
    buffer_load_dwordx4 v[64:67], v48, s[8:11], 0 offen offset:2560
    buffer_load_dword v90, v49, s[8:11], 0 offen offset:2560
    buffer_load_dwordx4 v[68:71], v48, s[8:11], 0 offen offset:3840
    buffer_load_dword v91, v49, s[8:11], 0 offen offset:3840
    v_add_u32 v48, 20480, v48
    v_add_u32 v49, 20480, v49
    buffer_load_dwordx4 v[72:75], v48, s[8:11], 0 offen offset:0
    buffer_load_dword v92, v49, s[8:11], 0 offen offset:0
    buffer_load_dwordx4 v[76:79], v48, s[8:11], 0 offen offset:1280
    buffer_load_dword v93, v49, s[8:11], 0 offen offset:1280
    buffer_load_dwordx4 v[80:83], v48, s[8:11], 0 offen offset:2560
    buffer_load_dword v94, v49, s[8:11], 0 offen offset:2560
    buffer_load_dwordx4 v[84:87], v48, s[8:11], 0 offen offset:3840
    buffer_load_dword v95, v49, s[8:11], 0 offen offset:3840
    v_add_u32 v48, 20480, v48
    v_add_u32 v49, 20480, v49
    s_waitcnt vmcnt(45)
    v_perm_b32 v50, v100, v96, s48
    v_accvgpr_write_b32 a160, v50
    s_waitcnt vmcnt(41)
    v_perm_b32 v51, v108, v104, s48
    v_accvgpr_write_b32 a161, v51
    s_waitcnt vmcnt(37)
    v_perm_b32 v50, v116, v112, s48
    v_accvgpr_write_b32 a162, v50
    s_waitcnt vmcnt(33)
    v_perm_b32 v51, v124, v120, s48
    v_accvgpr_write_b32 a163, v51
    v_perm_b32 v50, v100, v96, s49
    v_accvgpr_write_b32 a164, v50
    v_perm_b32 v51, v108, v104, s49
    v_accvgpr_write_b32 a165, v51
    v_perm_b32 v50, v116, v112, s49
    v_accvgpr_write_b32 a166, v50
    v_perm_b32 v51, v124, v120, s49
    v_accvgpr_write_b32 a167, v51
    v_perm_b32 v50, v101, v97, s48
    v_accvgpr_write_b32 a168, v50
    v_perm_b32 v51, v109, v105, s48
    v_accvgpr_write_b32 a169, v51
    v_perm_b32 v50, v117, v113, s48
    v_accvgpr_write_b32 a170, v50
    v_perm_b32 v51, v125, v121, s48
    v_accvgpr_write_b32 a171, v51
    v_perm_b32 v50, v101, v97, s49
    v_accvgpr_write_b32 a172, v50
    v_perm_b32 v51, v109, v105, s49
    v_accvgpr_write_b32 a173, v51
    v_perm_b32 v50, v117, v113, s49
    v_accvgpr_write_b32 a174, v50
    v_perm_b32 v51, v125, v121, s49
    v_accvgpr_write_b32 a175, v51
    v_perm_b32 v50, v102, v98, s48
    v_accvgpr_write_b32 a176, v50
    v_perm_b32 v51, v110, v106, s48
    v_accvgpr_write_b32 a177, v51
    v_perm_b32 v50, v118, v114, s48
    v_accvgpr_write_b32 a178, v50
    v_perm_b32 v51, v126, v122, s48
    v_accvgpr_write_b32 a179, v51
    v_perm_b32 v50, v102, v98, s49
    v_accvgpr_write_b32 a180, v50
    v_perm_b32 v51, v110, v106, s49
    v_accvgpr_write_b32 a181, v51
    v_perm_b32 v50, v118, v114, s49
    v_accvgpr_write_b32 a182, v50
    v_perm_b32 v51, v126, v122, s49
    v_accvgpr_write_b32 a183, v51
    v_perm_b32 v50, v103, v99, s48
    v_accvgpr_write_b32 a184, v50
    v_perm_b32 v51, v111, v107, s48
    v_accvgpr_write_b32 a185, v51
    v_perm_b32 v50, v119, v115, s48
    v_accvgpr_write_b32 a186, v50
    v_perm_b32 v51, v127, v123, s48
    v_accvgpr_write_b32 a187, v51
    v_perm_b32 v50, v103, v99, s49
    v_accvgpr_write_b32 a188, v50
    v_perm_b32 v51, v111, v107, s49
    v_accvgpr_write_b32 a189, v51
    v_perm_b32 v50, v119, v115, s49
    v_accvgpr_write_b32 a190, v50
    v_perm_b32 v51, v127, v123, s49
    v_accvgpr_write_b32 a191, v51
    v_perm_b32 v50, v129, v128, s48
    v_accvgpr_write_b32 a192, v50
    v_perm_b32 v51, v131, v130, s48
    v_accvgpr_write_b32 a193, v51
    v_perm_b32 v50, v133, v132, s48
    v_accvgpr_write_b32 a194, v50
    s_waitcnt vmcnt(32)
    v_perm_b32 v51, v135, v134, s48
    v_accvgpr_write_b32 a195, v51
    v_perm_b32 v50, v129, v128, s49
    v_accvgpr_write_b32 a196, v50
    v_perm_b32 v51, v131, v130, s49
    v_accvgpr_write_b32 a197, v51
    v_perm_b32 v50, v133, v132, s49
    v_accvgpr_write_b32 a198, v50
    v_perm_b32 v51, v135, v134, s49
    v_accvgpr_write_b32 a199, v51
    buffer_load_dwordx4 v[96:99], v48, s[8:11], 0 offen offset:0
    buffer_load_dword v128, v49, s[8:11], 0 offen offset:0
    buffer_load_dwordx4 v[100:103], v48, s[8:11], 0 offen offset:1280
    buffer_load_dword v129, v49, s[8:11], 0 offen offset:1280
    buffer_load_dwordx4 v[104:107], v48, s[8:11], 0 offen offset:2560
    buffer_load_dword v130, v49, s[8:11], 0 offen offset:2560
    buffer_load_dwordx4 v[108:111], v48, s[8:11], 0 offen offset:3840
    buffer_load_dword v131, v49, s[8:11], 0 offen offset:3840
    v_add_u32 v48, 20480, v48
    v_add_u32 v49, 20480, v49
    buffer_load_dwordx4 v[112:115], v48, s[8:11], 0 offen offset:0
    buffer_load_dword v132, v49, s[8:11], 0 offen offset:0
    buffer_load_dwordx4 v[116:119], v48, s[8:11], 0 offen offset:1280
    buffer_load_dword v133, v49, s[8:11], 0 offen offset:1280
    buffer_load_dwordx4 v[120:123], v48, s[8:11], 0 offen offset:2560
    buffer_load_dword v134, v49, s[8:11], 0 offen offset:2560
    buffer_load_dwordx4 v[124:127], v48, s[8:11], 0 offen offset:3840
    buffer_load_dword v135, v49, s[8:11], 0 offen offset:3840
    v_add_u32 v48, 20480, v48
    v_add_u32 v49, 20480, v49
    s_waitcnt vmcnt(45)
    v_perm_b32 v50, v140, v136, s48
    v_accvgpr_write_b32 a200, v50
    s_waitcnt vmcnt(41)
    v_perm_b32 v51, v148, v144, s48
    v_accvgpr_write_b32 a201, v51
    s_waitcnt vmcnt(37)
    v_perm_b32 v50, v156, v152, s48
    v_accvgpr_write_b32 a202, v50
    s_waitcnt vmcnt(33)
    v_perm_b32 v51, v164, v160, s48
    v_accvgpr_write_b32 a203, v51
    v_perm_b32 v50, v140, v136, s49
    v_accvgpr_write_b32 a204, v50
    v_perm_b32 v51, v148, v144, s49
    v_accvgpr_write_b32 a205, v51
    v_perm_b32 v50, v156, v152, s49
    v_accvgpr_write_b32 a206, v50
    v_perm_b32 v51, v164, v160, s49
    v_accvgpr_write_b32 a207, v51
    v_perm_b32 v50, v141, v137, s48
    v_accvgpr_write_b32 a208, v50
    v_perm_b32 v51, v149, v145, s48
    v_accvgpr_write_b32 a209, v51
    v_perm_b32 v50, v157, v153, s48
    v_accvgpr_write_b32 a210, v50
    v_perm_b32 v51, v165, v161, s48
    v_accvgpr_write_b32 a211, v51
    v_perm_b32 v50, v141, v137, s49
    v_accvgpr_write_b32 a212, v50
    v_perm_b32 v51, v149, v145, s49
    v_accvgpr_write_b32 a213, v51
    v_perm_b32 v50, v157, v153, s49
    v_accvgpr_write_b32 a214, v50
    v_perm_b32 v51, v165, v161, s49
    v_accvgpr_write_b32 a215, v51
    v_perm_b32 v50, v142, v138, s48
    v_accvgpr_write_b32 a216, v50
    v_perm_b32 v51, v150, v146, s48
    v_accvgpr_write_b32 a217, v51
    v_perm_b32 v50, v158, v154, s48
    v_accvgpr_write_b32 a218, v50
    v_perm_b32 v51, v166, v162, s48
    v_accvgpr_write_b32 a219, v51
    v_perm_b32 v50, v142, v138, s49
    v_accvgpr_write_b32 a220, v50
    v_perm_b32 v51, v150, v146, s49
    v_accvgpr_write_b32 a221, v51
    v_perm_b32 v50, v158, v154, s49
    v_accvgpr_write_b32 a222, v50
    v_perm_b32 v51, v166, v162, s49
    v_accvgpr_write_b32 a223, v51
    v_perm_b32 v50, v143, v139, s48
    v_accvgpr_write_b32 a224, v50
    v_perm_b32 v51, v151, v147, s48
    v_accvgpr_write_b32 a225, v51
    v_perm_b32 v50, v159, v155, s48
    v_accvgpr_write_b32 a226, v50
    v_perm_b32 v51, v167, v163, s48
    v_accvgpr_write_b32 a227, v51
    v_perm_b32 v50, v143, v139, s49
    v_accvgpr_write_b32 a228, v50
    v_perm_b32 v51, v151, v147, s49
    v_accvgpr_write_b32 a229, v51
    v_perm_b32 v50, v159, v155, s49
    v_accvgpr_write_b32 a230, v50
    v_perm_b32 v51, v167, v163, s49
    v_accvgpr_write_b32 a231, v51
    v_perm_b32 v50, v169, v168, s48
    v_accvgpr_write_b32 a232, v50
    v_perm_b32 v51, v171, v170, s48
    v_accvgpr_write_b32 a233, v51
    v_perm_b32 v50, v173, v172, s48
    v_accvgpr_write_b32 a234, v50
    s_waitcnt vmcnt(32)
    v_perm_b32 v51, v175, v174, s48
    v_accvgpr_write_b32 a235, v51
    v_perm_b32 v50, v169, v168, s49
    v_accvgpr_write_b32 a236, v50
    v_perm_b32 v51, v171, v170, s49
    v_accvgpr_write_b32 a237, v51
    v_perm_b32 v50, v173, v172, s49
    v_accvgpr_write_b32 a238, v50
    v_perm_b32 v51, v175, v174, s49
    v_accvgpr_write_b32 a239, v51
    s_waitcnt vmcnt(29)
    v_perm_b32 v50, v60, v56, s48
    v_accvgpr_write_b32 a240, v50
    s_waitcnt vmcnt(25)
    v_perm_b32 v51, v68, v64, s48
    v_accvgpr_write_b32 a241, v51
    s_waitcnt vmcnt(21)
    v_perm_b32 v50, v76, v72, s48
    v_accvgpr_write_b32 a242, v50
    s_waitcnt vmcnt(17)
    v_perm_b32 v51, v84, v80, s48
    v_accvgpr_write_b32 a243, v51
    v_perm_b32 v50, v60, v56, s49
    v_accvgpr_write_b32 a244, v50
    v_perm_b32 v51, v68, v64, s49
    v_accvgpr_write_b32 a245, v51
    v_perm_b32 v50, v76, v72, s49
    v_accvgpr_write_b32 a246, v50
    v_perm_b32 v51, v84, v80, s49
    v_accvgpr_write_b32 a247, v51
    v_perm_b32 v50, v61, v57, s48
    v_accvgpr_write_b32 a248, v50
    v_perm_b32 v51, v69, v65, s48
    v_accvgpr_write_b32 a249, v51
    v_perm_b32 v50, v77, v73, s48
    v_accvgpr_write_b32 a250, v50
    v_perm_b32 v51, v85, v81, s48
    v_accvgpr_write_b32 a251, v51
    v_perm_b32 v50, v61, v57, s49
    v_accvgpr_write_b32 a252, v50
    v_perm_b32 v51, v69, v65, s49
    v_accvgpr_write_b32 a253, v51
    v_perm_b32 v50, v77, v73, s49
    v_accvgpr_write_b32 a254, v50
    v_perm_b32 v51, v85, v81, s49
    v_accvgpr_write_b32 a255, v51
    v_perm_b32 v192, v62, v58, s48
    v_perm_b32 v193, v70, v66, s48
    v_perm_b32 v194, v78, v74, s48
    v_perm_b32 v195, v86, v82, s48
    v_perm_b32 v196, v62, v58, s49
    v_perm_b32 v197, v70, v66, s49
    v_perm_b32 v198, v78, v74, s49
    v_perm_b32 v199, v86, v82, s49
    v_perm_b32 v200, v63, v59, s48
    v_perm_b32 v201, v71, v67, s48
    v_perm_b32 v202, v79, v75, s48
    v_perm_b32 v203, v87, v83, s48
    v_perm_b32 v204, v63, v59, s49
    v_perm_b32 v205, v71, v67, s49
    v_perm_b32 v206, v79, v75, s49
    v_perm_b32 v207, v87, v83, s49
    v_perm_b32 v208, v89, v88, s48
    v_perm_b32 v209, v91, v90, s48
    v_perm_b32 v210, v93, v92, s48
    s_waitcnt vmcnt(16)
    v_perm_b32 v211, v95, v94, s48
    v_perm_b32 v212, v89, v88, s49
    v_perm_b32 v213, v91, v90, s49
    v_perm_b32 v214, v93, v92, s49
    v_perm_b32 v215, v95, v94, s49
    s_waitcnt vmcnt(13)
    v_perm_b32 v216, v100, v96, s48
    s_waitcnt vmcnt(9)
    v_perm_b32 v217, v108, v104, s48
    s_waitcnt vmcnt(5)
    v_perm_b32 v218, v116, v112, s48
    s_waitcnt vmcnt(1)
    v_perm_b32 v219, v124, v120, s48
    v_perm_b32 v220, v100, v96, s49
    v_perm_b32 v221, v108, v104, s49
    v_perm_b32 v222, v116, v112, s49
    v_perm_b32 v223, v124, v120, s49
    v_perm_b32 v224, v101, v97, s48
    v_perm_b32 v225, v109, v105, s48
    v_perm_b32 v226, v117, v113, s48
    v_perm_b32 v227, v125, v121, s48
    v_perm_b32 v228, v101, v97, s49
    v_perm_b32 v229, v109, v105, s49
    v_perm_b32 v230, v117, v113, s49
    v_perm_b32 v231, v125, v121, s49
    v_perm_b32 v232, v102, v98, s48
    v_perm_b32 v233, v110, v106, s48
    v_perm_b32 v234, v118, v114, s48
    v_perm_b32 v235, v126, v122, s48
    v_perm_b32 v236, v102, v98, s49
    v_perm_b32 v237, v110, v106, s49
    v_perm_b32 v238, v118, v114, s49
    v_perm_b32 v239, v126, v122, s49
    v_perm_b32 v240, v103, v99, s48
    v_perm_b32 v241, v111, v107, s48
    v_perm_b32 v242, v119, v115, s48
    v_perm_b32 v243, v127, v123, s48
    v_perm_b32 v244, v103, v99, s49
    v_perm_b32 v245, v111, v107, s49
    v_perm_b32 v246, v119, v115, s49
    v_perm_b32 v247, v127, v123, s49
    v_perm_b32 v248, v129, v128, s48
    v_perm_b32 v249, v131, v130, s48
    v_perm_b32 v250, v133, v132, s48
    s_waitcnt vmcnt(0)
    v_perm_b32 v251, v135, v134, s48
    v_perm_b32 v252, v129, v128, s49
    v_perm_b32 v253, v131, v130, s49
    v_perm_b32 v254, v133, v132, s49
    v_perm_b32 v255, v135, v134, s49
    v_lshlrev_b32 v49, 7, v0
    s_mov_b32 s18, 21504
    s_mov_b32 exec_lo, 0xffffffff
    s_mov_b32 exec_hi, 0xfffffff
Lwf33:
    buffer_load_dword v48, v49, s[4:7], s18 offen offset:0 sc1
    s_waitcnt vmcnt(0)
    v_cmp_gt_u32 vcc, 1, v48
    s_cbranch_vccz Lwf33d
    s_sub_u32 s15, s15, 1
    s_cbranch_scc0 Lwf33
    s_mov_b32 s15, 0
Lwf33d:
    s_mov_b64 exec, -1
    s_mov_b32 s18, 68096
    buffer_load_dword v20, v2, s[4:7], s18 offen offset:0 sc1
    buffer_load_dword v21, v2, s[4:7], s18 offen offset:256 sc1
    buffer_load_dword v22, v2, s[4:7], s18 offen offset:512 sc1
    buffer_load_dword v23, v2, s[4:7], s18 offen offset:768 sc1
    buffer_load_dword v24, v2, s[4:7], s18 offen offset:1024 sc1
    s_mov_b32 s18, 69376
    buffer_load_dword v25, v2, s[4:7], s18 offen offset:0 sc1
    buffer_load_dword v26, v2, s[4:7], s18 offen offset:256 sc1
    buffer_load_dword v27, v2, s[4:7], s18 offen offset:512 sc1
    buffer_load_dword v28, v2, s[4:7], s18 offen offset:768 sc1
    buffer_load_dword v29, v2, s[4:7], s18 offen offset:1024 sc1
    s_mov_b32 s18, 70656
    buffer_load_dword v30, v2, s[4:7], s18 offen offset:0 sc1
    buffer_load_dword v31, v2, s[4:7], s18 offen offset:256 sc1
    buffer_load_dword v32, v2, s[4:7], s18 offen offset:512 sc1
    buffer_load_dword v33, v2, s[4:7], s18 offen offset:768 sc1
    buffer_load_dword v34, v2, s[4:7], s18 offen offset:1024 sc1
    s_load_dwordx2 s[76:77], s[0:1], 0
    s_waitcnt lgkmcnt(0)
    s_mov_b32 s78, 2621440
    s_mov_b32 s79, 0x20000
    s_waitcnt vmcnt(0)
    v_mbcnt_lo_u32_b32 v49, -1, 0
    v_and_b32 v49, 7, v49
    v_lshlrev_b32 v49, 5, v49
Lcen36:
    buffer_load_dword v48, v49, s[72:75], 0 offen sc1
    s_waitcnt vmcnt(0)
    v_readlane_b32 s18, v48, s3
    s_mov_b32 s19, 0
    s_nop 2
    s_cmp_ge_u32 s18, 32
    s_cbranch_scc1 Lcen36d
    s_mov_b32 s19, 1
    v_mov_b32 v50, v48
    s_nop 1
    v_add_u32_dpp v50, v50, v50 row_ror:1 row_mask:0xf bank_mask:0xf
    s_nop 1
    v_add_u32_dpp v50, v50, v50 row_ror:2 row_mask:0xf bank_mask:0xf
    s_nop 1
    v_add_u32_dpp v50, v50, v50 row_ror:4 row_mask:0xf bank_mask:0xf
    s_nop 0
    v_readfirstlane_b32 s18, v50
    s_nop 3
    s_cmp_ge_u32 s18, 256
    s_cbranch_scc1 Lcen36d
    s_sub_u32 s15, s15, 1
    s_cbranch_scc0 Lcen36
    s_mov_b32 s15, 0
Lcen36d:
    s_waitcnt vmcnt(0) lgkmcnt(0)
    s_nop 11
    s_cmp_lg_u32 s19, 0
    s_cbranch_scc1 Lunit35
Lunit34:
    v_mov_b32 v46, s17
    s_cmp_lg_u32 s30, 0
    s_cbranch_scc1 Lhave37
    s_add_u32 s19, s16, 1
    s_mov_b32 exec_lo, 0x3f
    s_mov_b32 exec_hi, 0x0
    s_waitcnt vmcnt(0)
Lwf38:
    buffer_load_dword v164, v1, s[4:7], s29 offen offset:0 sc1
    s_waitcnt vmcnt(0)
    v_cmp_gt_u32 vcc, s19, v164
    s_cbranch_vccz Lwf38d
    s_sub_u32 s15, s15, 1
    s_cbranch_scc0 Lwf38
    s_mov_b32 s15, 0
Lwf38d:
    s_mov_b64 exec, -1
    s_lshl_b32 s31, s16, 5
    s_add_u32 s31, s31, s51
    s_lshl_b32 s19, s31, 3
    s_add_u32 s19, s19, s26
    s_lshl_b32 s19, s19, 12
    s_add_u32 s19, s19, s55
    s_add_u32 s19, s19, 8388608
    s_lshr_b32 s18, s19, 8
    s_and_b32 s18, s18, 0x2000
    s_xor_b32 s18, s19, s18
    s_mul_i32 s19, s27, 24576
    s_lshl_b32 m0, s26, 12
    s_add_u32 m0, m0, s19
    s_add_u32 m0, m0, 32768
    s_mul_i32 s31, s31, 1280
    buffer_load_dwordx4 v1, s[4:7], s18 offen offset:0 sc1 lds
    buffer_load_dwordx4 v1, s[4:7], s18 offen offset:1024 sc1 lds
    buffer_load_dwordx4 v1, s[4:7], s18 offen offset:2048 sc1 lds
    buffer_load_dwordx4 v1, s[4:7], s18 offen offset:3072 sc1 lds
    s_add_u32 m0, m0, 8192
    s_xor_b32 s18, s18, 8192
    buffer_load_dwordx4 v1, s[4:7], s18 offen offset:0 sc1 lds
    buffer_load_dwordx4 v1, s[4:7], s18 offen offset:1024 sc1 lds
    buffer_load_dwordx4 v1, s[4:7], s18 offen offset:2048 sc1 lds
    buffer_load_dwordx4 v1, s[4:7], s18 offen offset:3072 sc1 lds
    s_add_u32 m0, m0, 8192
    s_xor_b32 s18, s18, 16384
    buffer_load_dwordx4 v1, s[4:7], s18 offen offset:0 sc1 lds
    buffer_load_dwordx4 v1, s[4:7], s18 offen offset:1024 sc1 lds
    buffer_load_dwordx4 v1, s[4:7], s18 offen offset:2048 sc1 lds
    buffer_load_dwordx4 v1, s[4:7], s18 offen offset:3072 sc1 lds
    buffer_load_dword v40, v2, s[76:79], s31 offen offset:0
    buffer_load_dword v41, v2, s[76:79], s31 offen offset:256
    buffer_load_dword v42, v2, s[76:79], s31 offen offset:512
    buffer_load_dword v43, v2, s[76:79], s31 offen offset:768
    buffer_load_dword v44, v2, s[76:79], s31 offen offset:1024
    s_waitcnt vmcnt(0)
Lhave37:
    s_barrier
    ds_read_b128 v[48:51], v14 offset:0
    ds_read_b128 v[52:55], v14 offset:1024
    ds_read_b128 v[56:59], v14 offset:2048
    ds_read_b128 v[60:63], v14 offset:3072
    ds_read_b128 v[64:67], v10 offset:8192
    ds_read_b128 v[68:71], v10 offset:8224
    ds_read_b128 v[72:75], v10 offset:9216
    ds_read_b128 v[76:79], v10 offset:9248
    ds_read_b128 v[80:83], v10 offset:12288
    ds_read_b128 v[84:87], v10 offset:12320
    ds_read_b128 v[88:91], v10 offset:13312
    ds_read_b128 v[92:95], v10 offset:13344
    s_lshl_b32 s19, s16, 18
    s_add_u32 s19, s19, s56
    s_lshr_b32 s20, s19, 8
    s_and_b32 s20, s20, 0x2000
    s_xor_b32 s20, s19, s20
    v_mov_b32 v35, v40
    v_mov_b32 v36, v41
    v_mov_b32 v37, v42
    v_mov_b32 v38, v43
    v_mov_b32 v39, v44
    s_waitcnt lgkmcnt(7)
    v_mfma_f32_16x16x32_bf16 v[152:155], v[64:67], v[48:51], 0
    ds_read_b128 v[96:99], v15 offset:16384
    s_waitcnt lgkmcnt(7)
    v_mfma_f32_16x16x32_bf16 v[152:155], v[68:71], v[52:55], v[152:155]
    ds_read_b128 v[100:103], v15 offset:17408
    s_waitcnt lgkmcnt(7)
    v_mfma_f32_16x16x32_bf16 v[152:155], v[72:75], v[56:59], v[152:155]
    ds_read_b128 v[104:107], v15 offset:18432
    s_waitcnt lgkmcnt(7)
    v_mfma_f32_16x16x32_bf16 v[152:155], v[76:79], v[60:63], v[152:155]
    ds_read_b128 v[108:111], v15 offset:19456
    s_waitcnt lgkmcnt(7)
    v_mfma_f32_16x16x32_bf16 v[156:159], v[80:83], v[48:51], 0
    ds_read_b128 v[112:115], v15 offset:20480
    s_waitcnt lgkmcnt(7)
    v_mfma_f32_16x16x32_bf16 v[156:159], v[84:87], v[52:55], v[156:159]
    ds_read_b128 v[116:119], v15 offset:21504
    s_waitcnt lgkmcnt(7)
    v_mfma_f32_16x16x32_bf16 v[156:159], v[88:91], v[56:59], v[156:159]
    ds_read_b128 v[120:123], v15 offset:22528
    s_waitcnt lgkmcnt(7)
    v_mfma_f32_16x16x32_bf16 v[156:159], v[92:95], v[60:63], v[156:159]
    ds_read_b128 v[124:127], v15 offset:23552
    v_mov_b32 v164, s25
    v_cndmask_b32 v152, v164, v152, s[32:33]
    v_cndmask_b32 v153, v164, v153, s[34:35]
    v_cndmask_b32 v154, v164, v154, s[36:37]
    v_cndmask_b32 v155, v164, v155, s[38:39]
    s_nop 1
    v_cndmask_b32 v156, v164, v156, s[40:41]
    v_cndmask_b32 v157, v164, v157, s[42:43]
    v_cndmask_b32 v158, v164, v158, s[44:45]
    v_cndmask_b32 v159, v164, v159, s[46:47]
    v_max_f32 v165, v152, v153
    v_max3_f32 v165, v165, v154, v155
    v_max3_f32 v165, v165, v156, v157
    v_max3_f32 v165, v165, v158, v159
    s_waitcnt lgkmcnt(0)
    s_lshl_b32 s31, s26, 5
    s_add_u32 s31, s31, s51
    s_lshl_b32 s31, s31, 6
    s_add_u32 s31, s31, 4096
Lkc39:
    s_load_dword s54, s[4:5], s31 glc
    s_waitcnt lgkmcnt(0)
    s_cmp_gt_u32 s54, s16
    s_cbranch_scc1 Lkc39d
    s_sub_u32 s15, s15, 1
    s_cbranch_scc0 Lkc39
    s_mov_b32 s15, 0
Lkc39d:
    s_barrier
    buffer_load_dwordx4 v[128:131], v11, s[4:7], s20 offen offset:0 sc1
    buffer_load_dwordx4 v[132:135], v11, s[4:7], s20 offen offset:32 sc1
    buffer_load_dwordx4 v[136:139], v11, s[4:7], s20 offen offset:1024 sc1
    buffer_load_dwordx4 v[140:143], v11, s[4:7], s20 offen offset:1056 sc1
    buffer_load_dwordx2 v[144:145], v12, s[4:7], s20 offen offset:2048 sc1
    buffer_load_dwordx2 v[146:147], v12, s[4:7], s20 offen offset:2560 sc1
    buffer_load_dwordx2 v[148:149], v12, s[4:7], s20 offen offset:3072 sc1
    buffer_load_dwordx2 v[150:151], v12, s[4:7], s20 offen offset:3584 sc1
    v_and_b32 v191, 0x70, v1
    v_min_u32 v191, 0x50, v191
    buffer_load_dword v190, v191, s[4:7], s29 offen sc1
    s_waitcnt vmcnt(8)
    v_mfma_f32_16x16x32_bf16 v[160:163], v[128:131], v[48:51], 0
    s_waitcnt vmcnt(7)
    v_mfma_f32_16x16x32_bf16 v[160:163], v[132:135], v[52:55], v[160:163]
    s_waitcnt vmcnt(6)
    v_mfma_f32_16x16x32_bf16 v[160:163], v[136:139], v[56:59], v[160:163]
    s_waitcnt vmcnt(5)
    v_mfma_f32_16x16x32_bf16 v[160:163], v[140:143], v[60:63], v[160:163]
    s_nop 3
    v_mov_b32 v3, v3
    s_nop 2
    v_mul_f32 v160, s24, v160
    v_mul_f32 v161, s24, v161
    v_max3_f32 v165, v165, v160, v161
    v_mov_b32 v164, v165
    s_nop 1
    v_permlane16_swap_b32 v165, v164
    v_max_f32 v165, v165, v164
    v_mov_b32 v164, v165
    s_nop 1
    v_permlane32_swap_b32 v165, v164
    v_max_f32 v165, v165, v164
    v_sub_f32 v152, v152, v165
    v_sub_f32 v153, v153, v165
    v_sub_f32 v154, v154, v165
    v_sub_f32 v155, v155, v165
    v_sub_f32 v156, v156, v165
    v_sub_f32 v157, v157, v165
    v_sub_f32 v158, v158, v165
    v_sub_f32 v159, v159, v165
    v_sub_f32 v160, v160, v165
    v_sub_f32 v161, v161, v165
    v_exp_f32 v152, v152
    v_exp_f32 v153, v153
    v_exp_f32 v154, v154
    v_exp_f32 v155, v155
    v_exp_f32 v156, v156
    v_exp_f32 v157, v157
    v_exp_f32 v158, v158
    v_exp_f32 v159, v159
    v_exp_f32 v160, v160
    v_exp_f32 v161, v161
    v_mov_b32 v133, 0
    v_mov_b32 v134, 0
    v_cvt_pk_bf16_f32 v128, v152, v153
    v_mov_b32 v136, 0x3f803f80
    v_cvt_pk_bf16_f32 v129, v154, v155
    v_mov_b32 v137, 0x3f803f80
    v_cvt_pk_bf16_f32 v130, v156, v157
    v_mov_b32 v138, 0x3f803f80
    v_cvt_pk_bf16_f32 v131, v158, v159
    v_mov_b32 v139, 0x3f803f80
    v_cvt_pk_bf16_f32 v132, v160, v161
    v_cvt_pk_bf16_f32 v135, v160, v161
    v_mfma_f32_16x16x32_bf16 v[140:143], v[136:139], v[128:131], 0
    s_nop 1
    v_mfma_f32_16x16x32_bf16 v[64:67], v[96:99], v[128:131], 0
    s_nop 0
    v_mfma_f32_16x16x32_bf16 v[68:71], v[100:103], v[128:131], 0
    s_nop 0
    v_mfma_f32_16x16x32_bf16 v[72:75], v[104:107], v[128:131], 0
    v_mfma_f32_16x16x32_bf16 v[76:79], v[108:111], v[128:131], 0
    v_mfma_f32_16x16x16_bf16 v[140:143], v[136:137], v[132:133], v[140:143]
    s_nop 1
    s_waitcnt vmcnt(4)
    v_mfma_f32_16x16x16_bf16 v[64:67], v[144:145], v[132:133], v[64:67]
    s_nop 1
    v_mfma_f32_16x16x16_bf16 v[68:71], v[144:145], v[134:135], v[68:71]
    s_waitcnt vmcnt(3)
    v_mfma_f32_16x16x16_bf16 v[72:75], v[146:147], v[132:133], v[72:75]
    v_mfma_f32_16x16x16_bf16 v[76:79], v[146:147], v[134:135], v[76:79]
    v_rcp_f32 v164, v140
    v_mfma_f32_16x16x32_bf16 v[80:83], v[112:115], v[128:131], 0
    v_mul_f32 v64, v164, v64
    v_mul_f32 v65, v164, v65
    v_mfma_f32_16x16x32_bf16 v[84:87], v[116:119], v[128:131], 0
    v_mul_f32 v66, v164, v66
    v_mul_f32 v67, v164, v67
    v_mfma_f32_16x16x32_bf16 v[88:91], v[120:123], v[128:131], 0
    v_mul_f32 v68, v164, v68
    v_mul_f32 v69, v164, v69
    v_mfma_f32_16x16x32_bf16 v[92:95], v[124:127], v[128:131], 0
    s_waitcnt vmcnt(2)
    v_mul_f32 v70, v164, v70
    v_mul_f32 v71, v164, v71
    v_mfma_f32_16x16x16_bf16 v[80:83], v[148:149], v[132:133], v[80:83]
    v_cvt_pk_bf16_f32 v48, v64, v65
    v_cvt_pk_bf16_f32 v49, v66, v67
    v_mfma_f32_16x16x16_bf16 v[84:87], v[148:149], v[134:135], v[84:87]
    s_waitcnt vmcnt(1)
    v_cvt_pk_bf16_f32 v50, v68, v69
    v_cvt_pk_bf16_f32 v51, v70, v71
    v_mfma_f32_16x16x16_bf16 v[88:91], v[150:151], v[132:133], v[88:91]
    ds_write_b128 v13, v[48:51] offset:0
    v_mul_f32 v72, v164, v72
    v_mfma_f32_16x16x16_bf16 v[92:95], v[150:151], v[134:135], v[92:95]
    v_mul_f32 v73, v164, v73
    v_mul_f32 v74, v164, v74
    v_mul_f32 v75, v164, v75
    v_mul_f32 v76, v164, v76
    v_mul_f32 v77, v164, v77
    v_mul_f32 v78, v164, v78
    v_mul_f32 v79, v164, v79
    v_cvt_pk_bf16_f32 v52, v72, v73
    v_cvt_pk_bf16_f32 v53, v74, v75
    v_cvt_pk_bf16_f32 v54, v76, v77
    v_cvt_pk_bf16_f32 v55, v78, v79
    ds_write_b128 v13, v[52:55] offset:1024
    v_mul_f32 v80, v164, v80
    v_mul_f32 v81, v164, v81
    v_mul_f32 v82, v164, v82
    v_mul_f32 v83, v164, v83
    v_mul_f32 v84, v164, v84
    v_mul_f32 v85, v164, v85
    v_mul_f32 v86, v164, v86
    v_mul_f32 v87, v164, v87
    v_cvt_pk_bf16_f32 v56, v80, v81
    v_cvt_pk_bf16_f32 v57, v82, v83
    v_cvt_pk_bf16_f32 v58, v84, v85
    v_cvt_pk_bf16_f32 v59, v86, v87
    ds_write_b128 v13, v[56:59] offset:2048
    v_mul_f32 v88, v164, v88
    v_mul_f32 v89, v164, v89
    v_mul_f32 v90, v164, v90
    v_mul_f32 v91, v164, v91
    v_mul_f32 v92, v164, v92
    v_mul_f32 v93, v164, v93
    v_mul_f32 v94, v164, v94
    v_mul_f32 v95, v164, v95
    v_cvt_pk_bf16_f32 v60, v88, v89
    v_cvt_pk_bf16_f32 v61, v90, v91
    v_cvt_pk_bf16_f32 v62, v92, v93
    v_cvt_pk_bf16_f32 v63, v94, v95
    ds_write_b128 v13, v[60:63] offset:3072
    s_waitcnt lgkmcnt(0)
    s_barrier
    ds_read_b128 v[48:51], v1 offset:0
    ds_read_b128 v[52:55], v1 offset:1024
    ds_read_b128 v[56:59], v1 offset:2048
    ds_read_b128 v[60:63], v1 offset:3072
    ds_read_b128 v[64:67], v1 offset:4096
    ds_read_b128 v[68:71], v1 offset:5120
    ds_read_b128 v[72:75], v1 offset:6144
    ds_read_b128 v[76:79], v1 offset:7168
    s_mov_b32 s20, s16
    s_add_u32 s16, s16, 4
    s_waitcnt vmcnt(0)
    v_cmp_ge_u32 vcc, s16, v190
    v_and_b32 v191, 0x7c, v2
    s_waitcnt lgkmcnt(7)
    v_mfma_f32_16x16x32_bf16 v[80:83], v[48:51], a[0:3], 0
    v_mfma_f32_16x16x32_bf16 v[84:87], v[48:51], a[4:7], 0
    s_cmp_eq_u64 vcc, 0
    s_cselect_b32 s30, 1, 0
    s_cselect_b32 s20, s16, s20
    v_mfma_f32_16x16x32_bf16 v[88:91], v[48:51], a[8:11], 0
    buffer_load_dword v47, v191, s[4:7], s23 offen offset:512 sc1
    v_mfma_f32_16x16x32_bf16 v[92:95], v[48:51], a[12:15], 0
    s_lshl_b32 s31, s20, 5
    v_mfma_f32_16x16x32_bf16 v[96:99], v[48:51], a[16:19], 0
    s_add_u32 s31, s31, s51
    v_mfma_f32_16x16x32_bf16 v[100:103], v[48:51], a[20:23], 0
    s_lshl_b32 s19, s31, 3
    v_mfma_f32_16x16x32_bf16 v[104:107], v[48:51], a[24:27], 0
    s_add_u32 s19, s19, s26
    v_mfma_f32_16x16x32_bf16 v[108:111], v[48:51], a[28:31], 0
    s_lshl_b32 s19, s19, 12
    v_mfma_f32_16x16x32_bf16 v[112:115], v[48:51], a[32:35], 0
    s_add_u32 s19, s19, s55
    v_mfma_f32_16x16x32_bf16 v[116:119], v[48:51], a[36:39], 0
    s_waitcnt lgkmcnt(6)
    s_add_u32 s19, s19, 8388608
    ds_read_b128 v[48:51], v1 offset:8192
    v_mfma_f32_16x16x32_bf16 v[80:83], v[52:55], a[40:43], v[80:83]
    s_lshr_b32 s18, s19, 8
    v_mfma_f32_16x16x32_bf16 v[84:87], v[52:55], a[44:47], v[84:87]
    s_and_b32 s18, s18, 0x2000
    v_mfma_f32_16x16x32_bf16 v[88:91], v[52:55], a[48:51], v[88:91]
    s_xor_b32 s18, s19, s18
    v_mfma_f32_16x16x32_bf16 v[92:95], v[52:55], a[52:55], v[92:95]
    s_mul_i32 s19, s27, 24576
    v_mfma_f32_16x16x32_bf16 v[96:99], v[52:55], a[56:59], v[96:99]
    s_lshl_b32 m0, s26, 12
    v_mfma_f32_16x16x32_bf16 v[100:103], v[52:55], a[60:63], v[100:103]
    s_add_u32 m0, m0, s19
    v_mfma_f32_16x16x32_bf16 v[104:107], v[52:55], a[64:67], v[104:107]
    s_add_u32 m0, m0, 32768
    v_mfma_f32_16x16x32_bf16 v[108:111], v[52:55], a[68:71], v[108:111]
    s_mul_i32 s31, s31, 1280
    v_mfma_f32_16x16x32_bf16 v[112:115], v[52:55], a[72:75], v[112:115]
    buffer_load_dwordx4 v1, s[4:7], s18 offen offset:0 sc1 lds
    v_mfma_f32_16x16x32_bf16 v[116:119], v[52:55], a[76:79], v[116:119]
    ds_read_b128 v[52:55], v1 offset:9216
    s_waitcnt lgkmcnt(7)
    v_mfma_f32_16x16x32_bf16 v[80:83], v[56:59], a[80:83], v[80:83]
    v_mfma_f32_16x16x32_bf16 v[84:87], v[56:59], a[84:87], v[84:87]
    buffer_load_dwordx4 v1, s[4:7], s18 offen offset:1024 sc1 lds
    v_mfma_f32_16x16x32_bf16 v[88:91], v[56:59], a[88:91], v[88:91]
    v_mfma_f32_16x16x32_bf16 v[92:95], v[56:59], a[92:95], v[92:95]
    v_mfma_f32_16x16x32_bf16 v[96:99], v[56:59], a[96:99], v[96:99]
    buffer_load_dwordx4 v1, s[4:7], s18 offen offset:2048 sc1 lds
    v_mfma_f32_16x16x32_bf16 v[100:103], v[56:59], a[100:103], v[100:103]
    v_mfma_f32_16x16x32_bf16 v[104:107], v[56:59], a[104:107], v[104:107]
    v_mfma_f32_16x16x32_bf16 v[108:111], v[56:59], a[108:111], v[108:111]
    buffer_load_dwordx4 v1, s[4:7], s18 offen offset:3072 sc1 lds
    v_mfma_f32_16x16x32_bf16 v[112:115], v[56:59], a[112:115], v[112:115]
    v_mfma_f32_16x16x32_bf16 v[116:119], v[56:59], a[116:119], v[116:119]
    ds_read_b128 v[56:59], v1 offset:10240
    s_waitcnt lgkmcnt(7)
    v_mfma_f32_16x16x32_bf16 v[80:83], v[60:63], a[120:123], v[80:83]
    s_add_u32 m0, m0, 8192
    v_mfma_f32_16x16x32_bf16 v[84:87], v[60:63], a[124:127], v[84:87]
    s_xor_b32 s18, s18, 8192
    v_mfma_f32_16x16x32_bf16 v[88:91], v[60:63], a[128:131], v[88:91]
    buffer_load_dwordx4 v1, s[4:7], s18 offen offset:0 sc1 lds
    v_mfma_f32_16x16x32_bf16 v[92:95], v[60:63], a[132:135], v[92:95]
    v_mfma_f32_16x16x32_bf16 v[96:99], v[60:63], a[136:139], v[96:99]
    v_mfma_f32_16x16x32_bf16 v[100:103], v[60:63], a[140:143], v[100:103]
    buffer_load_dwordx4 v1, s[4:7], s18 offen offset:1024 sc1 lds
    v_mfma_f32_16x16x32_bf16 v[104:107], v[60:63], a[144:147], v[104:107]
    v_mfma_f32_16x16x32_bf16 v[108:111], v[60:63], a[148:151], v[108:111]
    v_mfma_f32_16x16x32_bf16 v[112:115], v[60:63], a[152:155], v[112:115]
    buffer_load_dwordx4 v1, s[4:7], s18 offen offset:2048 sc1 lds
    v_mfma_f32_16x16x32_bf16 v[116:119], v[60:63], a[156:159], v[116:119]
    ds_read_b128 v[60:63], v1 offset:11264
    s_waitcnt lgkmcnt(7)
    v_mfma_f32_16x16x32_bf16 v[80:83], v[64:67], a[160:163], v[80:83]
    v_mfma_f32_16x16x32_bf16 v[84:87], v[64:67], a[164:167], v[84:87]
    buffer_load_dwordx4 v1, s[4:7], s18 offen offset:3072 sc1 lds
    v_mfma_f32_16x16x32_bf16 v[88:91], v[64:67], a[168:171], v[88:91]
    v_mfma_f32_16x16x32_bf16 v[92:95], v[64:67], a[172:175], v[92:95]
    v_mfma_f32_16x16x32_bf16 v[96:99], v[64:67], a[176:179], v[96:99]
    s_add_u32 m0, m0, 8192
    v_mfma_f32_16x16x32_bf16 v[100:103], v[64:67], a[180:183], v[100:103]
    s_xor_b32 s18, s18, 16384
    v_mfma_f32_16x16x32_bf16 v[104:107], v[64:67], a[184:187], v[104:107]
    buffer_load_dwordx4 v1, s[4:7], s18 offen offset:0 sc1 lds
    v_mfma_f32_16x16x32_bf16 v[108:111], v[64:67], a[188:191], v[108:111]
    v_mfma_f32_16x16x32_bf16 v[112:115], v[64:67], a[192:195], v[112:115]
    v_mfma_f32_16x16x32_bf16 v[116:119], v[64:67], a[196:199], v[116:119]
    s_waitcnt lgkmcnt(6)
    buffer_load_dwordx4 v1, s[4:7], s18 offen offset:1024 sc1 lds
    ds_read_b128 v[64:67], v1 offset:12288
    v_mfma_f32_16x16x32_bf16 v[80:83], v[68:71], a[200:203], v[80:83]
    v_mfma_f32_16x16x32_bf16 v[84:87], v[68:71], a[204:207], v[84:87]
    v_mfma_f32_16x16x32_bf16 v[88:91], v[68:71], a[208:211], v[88:91]
    buffer_load_dwordx4 v1, s[4:7], s18 offen offset:2048 sc1 lds
    v_mfma_f32_16x16x32_bf16 v[92:95], v[68:71], a[212:215], v[92:95]
    v_mfma_f32_16x16x32_bf16 v[96:99], v[68:71], a[216:219], v[96:99]
    v_mfma_f32_16x16x32_bf16 v[100:103], v[68:71], a[220:223], v[100:103]
    buffer_load_dwordx4 v1, s[4:7], s18 offen offset:3072 sc1 lds
    v_mfma_f32_16x16x32_bf16 v[104:107], v[68:71], a[224:227], v[104:107]
    v_mfma_f32_16x16x32_bf16 v[108:111], v[68:71], a[228:231], v[108:111]
    v_mfma_f32_16x16x32_bf16 v[112:115], v[68:71], a[232:235], v[112:115]
    buffer_load_dword v40, v2, s[76:79], s31 offen offset:0
    v_mfma_f32_16x16x32_bf16 v[116:119], v[68:71], a[236:239], v[116:119]
    ds_read_b128 v[68:71], v1 offset:13312
    s_waitcnt lgkmcnt(7)
    v_mfma_f32_16x16x32_bf16 v[80:83], v[72:75], a[240:243], v[80:83]
    v_mfma_f32_16x16x32_bf16 v[84:87], v[72:75], a[244:247], v[84:87]
    buffer_load_dword v41, v2, s[76:79], s31 offen offset:256
    v_mfma_f32_16x16x32_bf16 v[88:91], v[72:75], a[248:251], v[88:91]
    v_mfma_f32_16x16x32_bf16 v[92:95], v[72:75], a[252:255], v[92:95]
    v_mfma_f32_16x16x32_bf16 v[96:99], v[72:75], v[192:195], v[96:99]
    buffer_load_dword v42, v2, s[76:79], s31 offen offset:512
    v_mfma_f32_16x16x32_bf16 v[100:103], v[72:75], v[196:199], v[100:103]
    v_mfma_f32_16x16x32_bf16 v[104:107], v[72:75], v[200:203], v[104:107]
    v_mfma_f32_16x16x32_bf16 v[108:111], v[72:75], v[204:207], v[108:111]
    buffer_load_dword v43, v2, s[76:79], s31 offen offset:768
    v_mfma_f32_16x16x32_bf16 v[112:115], v[72:75], v[208:211], v[112:115]
    v_mfma_f32_16x16x32_bf16 v[116:119], v[72:75], v[212:215], v[116:119]
    ds_read_b128 v[72:75], v1 offset:14336
    s_waitcnt lgkmcnt(7)
    v_mfma_f32_16x16x32_bf16 v[80:83], v[76:79], v[216:219], v[80:83]
    buffer_load_dword v44, v2, s[76:79], s31 offen offset:1024
    v_mfma_f32_16x16x32_bf16 v[84:87], v[76:79], v[220:223], v[84:87]
    v_mfma_f32_16x16x32_bf16 v[88:91], v[76:79], v[224:227], v[88:91]
    v_mfma_f32_16x16x32_bf16 v[92:95], v[76:79], v[228:231], v[92:95]
    v_mfma_f32_16x16x32_bf16 v[96:99], v[76:79], v[232:235], v[96:99]
    v_mfma_f32_16x16x32_bf16 v[100:103], v[76:79], v[236:239], v[100:103]
    v_mfma_f32_16x16x32_bf16 v[104:107], v[76:79], v[240:243], v[104:107]
    v_mfma_f32_16x16x32_bf16 v[108:111], v[76:79], v[244:247], v[108:111]
    v_mfma_f32_16x16x32_bf16 v[112:115], v[76:79], v[248:251], v[112:115]
    v_mfma_f32_16x16x32_bf16 v[116:119], v[76:79], v[252:255], v[116:119]
    ds_read_b128 v[76:79], v1 offset:15360
    s_sub_u32 s19, s17, 1
    s_waitcnt vmcnt(17)
    v_cmp_gt_u32 vcc, s19, v47
    s_cbranch_vccz Loky40
    s_mov_b32 exec_lo, 0xffffffff
    s_mov_b32 exec_hi, 0x0
    s_waitcnt vmcnt(0)
Lwf41:
    buffer_load_dword v47, v2, s[4:7], s23 offen offset:512 sc1
    s_waitcnt vmcnt(0)
    v_cmp_gt_u32 vcc, s19, v47
    s_cbranch_vccz Lwf41d
    s_sub_u32 s15, s15, 1
    s_cbranch_scc0 Lwf41
    s_mov_b32 s15, 0
Lwf41d:
    s_mov_b64 exec, -1
Loky40:
    s_waitcnt lgkmcnt(7)
    v_mfma_f32_16x16x32_bf16 v[120:123], v[48:51], a[0:3], 0
    v_mfma_f32_16x16x32_bf16 v[124:127], v[48:51], a[4:7], 0
    v_cvt_pk_bf16_f32 v160, v80, v84
    v_mfma_f32_16x16x32_bf16 v[128:131], v[48:51], a[8:11], 0
    v_cvt_pk_bf16_f32 v161, v88, v92
    v_mfma_f32_16x16x32_bf16 v[132:135], v[48:51], a[12:15], 0
    v_cvt_pk_bf16_f32 v162, v96, v100
    v_mfma_f32_16x16x32_bf16 v[136:139], v[48:51], a[16:19], 0
    v_cvt_pk_bf16_f32 v163, v104, v108
    v_mfma_f32_16x16x32_bf16 v[140:143], v[48:51], a[20:23], 0
    s_add_u32 s18, s21, 0
    buffer_store_dwordx4 v[160:163], v4, s[4:7], s18 offen
    v_mfma_f32_16x16x32_bf16 v[144:147], v[48:51], a[24:27], 0
    v_cvt_pk_bf16_f32 v166, v81, v85
    v_mfma_f32_16x16x32_bf16 v[148:151], v[48:51], a[28:31], 0
    s_waitcnt lgkmcnt(6)
    v_cvt_pk_bf16_f32 v167, v89, v93
    v_mfma_f32_16x16x32_bf16 v[120:123], v[52:55], a[40:43], v[120:123]
    v_cvt_pk_bf16_f32 v168, v97, v101
    v_mfma_f32_16x16x32_bf16 v[124:127], v[52:55], a[44:47], v[124:127]
    v_cvt_pk_bf16_f32 v169, v105, v109
    v_mfma_f32_16x16x32_bf16 v[128:131], v[52:55], a[48:51], v[128:131]
    s_add_u32 s18, s21, 65536
    buffer_store_dwordx4 v[166:169], v4, s[4:7], s18 offen
    v_mfma_f32_16x16x32_bf16 v[132:135], v[52:55], a[52:55], v[132:135]
    v_cvt_pk_bf16_f32 v172, v82, v86
    v_mfma_f32_16x16x32_bf16 v[136:139], v[52:55], a[56:59], v[136:139]
    v_cvt_pk_bf16_f32 v173, v90, v94
    v_mfma_f32_16x16x32_bf16 v[140:143], v[52:55], a[60:63], v[140:143]
    v_cvt_pk_bf16_f32 v174, v98, v102
    v_mfma_f32_16x16x32_bf16 v[144:147], v[52:55], a[64:67], v[144:147]
    v_cvt_pk_bf16_f32 v175, v106, v110
    v_mfma_f32_16x16x32_bf16 v[148:151], v[52:55], a[68:71], v[148:151]
    s_waitcnt lgkmcnt(5)
    s_add_u32 s18, s21, 131072
    buffer_store_dwordx4 v[172:175], v4, s[4:7], s18 offen
    v_mfma_f32_16x16x32_bf16 v[120:123], v[56:59], a[80:83], v[120:123]
    v_cvt_pk_bf16_f32 v178, v83, v87
    v_mfma_f32_16x16x32_bf16 v[124:127], v[56:59], a[84:87], v[124:127]
    v_cvt_pk_bf16_f32 v179, v91, v95
    v_mfma_f32_16x16x32_bf16 v[128:131], v[56:59], a[88:91], v[128:131]
    v_cvt_pk_bf16_f32 v180, v99, v103
    v_mfma_f32_16x16x32_bf16 v[132:135], v[56:59], a[92:95], v[132:135]
    v_cvt_pk_bf16_f32 v181, v107, v111
    v_mfma_f32_16x16x32_bf16 v[136:139], v[56:59], a[96:99], v[136:139]
    s_add_u32 s18, s21, 196608
    buffer_store_dwordx4 v[178:181], v4, s[4:7], s18 offen
    v_mfma_f32_16x16x32_bf16 v[140:143], v[56:59], a[100:103], v[140:143]
    v_cvt_pk_bf16_f32 v164, v112, v116
    v_mfma_f32_16x16x32_bf16 v[144:147], v[56:59], a[104:107], v[144:147]
    v_cvt_pk_bf16_f32 v170, v113, v117
    v_mfma_f32_16x16x32_bf16 v[148:151], v[56:59], a[108:111], v[148:151]
    s_waitcnt lgkmcnt(4)
    v_cvt_pk_bf16_f32 v176, v114, v118
    v_mfma_f32_16x16x32_bf16 v[120:123], v[60:63], a[120:123], v[120:123]
    v_cvt_pk_bf16_f32 v182, v115, v119
    v_mfma_f32_16x16x32_bf16 v[124:127], v[60:63], a[124:127], v[124:127]
    s_add_u32 s18, s21, 0
    buffer_store_dword v164, v5, s[4:7], s18 offen offset:256
    v_mfma_f32_16x16x32_bf16 v[128:131], v[60:63], a[128:131], v[128:131]
    s_add_u32 s18, s21, 65536
    buffer_store_dword v170, v5, s[4:7], s18 offen offset:256
    v_mfma_f32_16x16x32_bf16 v[132:135], v[60:63], a[132:135], v[132:135]
    s_add_u32 s18, s21, 131072
    buffer_store_dword v176, v5, s[4:7], s18 offen offset:256
    v_mfma_f32_16x16x32_bf16 v[136:139], v[60:63], a[136:139], v[136:139]
    s_add_u32 s18, s21, 196608
    buffer_store_dword v182, v5, s[4:7], s18 offen offset:256
    v_mfma_f32_16x16x32_bf16 v[140:143], v[60:63], a[140:143], v[140:143]
    v_mfma_f32_16x16x32_bf16 v[144:147], v[60:63], a[144:147], v[144:147]
    v_mfma_f32_16x16x32_bf16 v[148:151], v[60:63], a[148:151], v[148:151]
    s_waitcnt lgkmcnt(3)
    v_mfma_f32_16x16x32_bf16 v[120:123], v[64:67], a[160:163], v[120:123]
    v_mfma_f32_16x16x32_bf16 v[124:127], v[64:67], a[164:167], v[124:127]
    v_mfma_f32_16x16x32_bf16 v[128:131], v[64:67], a[168:171], v[128:131]
    v_mfma_f32_16x16x32_bf16 v[132:135], v[64:67], a[172:175], v[132:135]
    v_mfma_f32_16x16x32_bf16 v[136:139], v[64:67], a[176:179], v[136:139]
    v_mfma_f32_16x16x32_bf16 v[140:143], v[64:67], a[180:183], v[140:143]
    v_mfma_f32_16x16x32_bf16 v[144:147], v[64:67], a[184:187], v[144:147]
    v_mfma_f32_16x16x32_bf16 v[148:151], v[64:67], a[188:191], v[148:151]
    s_waitcnt lgkmcnt(2)
    v_mfma_f32_16x16x32_bf16 v[120:123], v[68:71], a[200:203], v[120:123]
    v_mfma_f32_16x16x32_bf16 v[124:127], v[68:71], a[204:207], v[124:127]
    v_mfma_f32_16x16x32_bf16 v[128:131], v[68:71], a[208:211], v[128:131]
    v_mfma_f32_16x16x32_bf16 v[132:135], v[68:71], a[212:215], v[132:135]
    v_mfma_f32_16x16x32_bf16 v[136:139], v[68:71], a[216:219], v[136:139]
    v_mfma_f32_16x16x32_bf16 v[140:143], v[68:71], a[220:223], v[140:143]
    v_mfma_f32_16x16x32_bf16 v[144:147], v[68:71], a[224:227], v[144:147]
    v_mfma_f32_16x16x32_bf16 v[148:151], v[68:71], a[228:231], v[148:151]
    s_waitcnt lgkmcnt(1)
    v_mfma_f32_16x16x32_bf16 v[120:123], v[72:75], a[240:243], v[120:123]
    v_mfma_f32_16x16x32_bf16 v[124:127], v[72:75], a[244:247], v[124:127]
    v_mfma_f32_16x16x32_bf16 v[128:131], v[72:75], a[248:251], v[128:131]
    v_mfma_f32_16x16x32_bf16 v[132:135], v[72:75], a[252:255], v[132:135]
    v_mfma_f32_16x16x32_bf16 v[136:139], v[72:75], v[192:195], v[136:139]
    v_mfma_f32_16x16x32_bf16 v[140:143], v[72:75], v[196:199], v[140:143]
    v_mfma_f32_16x16x32_bf16 v[144:147], v[72:75], v[200:203], v[144:147]
    v_mfma_f32_16x16x32_bf16 v[148:151], v[72:75], v[204:207], v[148:151]
    s_waitcnt lgkmcnt(0)
    v_mfma_f32_16x16x32_bf16 v[120:123], v[76:79], v[216:219], v[120:123]
    v_mfma_f32_16x16x32_bf16 v[124:127], v[76:79], v[220:223], v[124:127]
    v_mfma_f32_16x16x32_bf16 v[128:131], v[76:79], v[224:227], v[128:131]
    v_mfma_f32_16x16x32_bf16 v[132:135], v[76:79], v[228:231], v[132:135]
    s_nop 0
    v_mfma_f32_16x16x32_bf16 v[136:139], v[76:79], v[232:235], v[136:139]
    v_mfma_f32_16x16x32_bf16 v[140:143], v[76:79], v[236:239], v[140:143]
    s_nop 0
    v_mfma_f32_16x16x32_bf16 v[144:147], v[76:79], v[240:243], v[144:147]
    v_mfma_f32_16x16x32_bf16 v[148:151], v[76:79], v[244:247], v[148:151]
    s_nop 1
    v_mfma_f32_16x16x32_bf16 v[152:155], v[48:51], a[32:35], 0
    v_mfma_f32_16x16x32_bf16 v[156:159], v[48:51], a[36:39], 0
    v_cvt_pk_bf16_f32 v160, v120, v124
    v_cvt_pk_bf16_f32 v161, v128, v132
    v_mfma_f32_16x16x32_bf16 v[152:155], v[52:55], a[72:75], v[152:155]
    v_cvt_pk_bf16_f32 v162, v136, v140
    v_cvt_pk_bf16_f32 v163, v144, v148
    v_mfma_f32_16x16x32_bf16 v[156:159], v[52:55], a[76:79], v[156:159]
    s_add_u32 s18, s21, 1048576
    buffer_store_dwordx4 v[160:163], v4, s[4:7], s18 offen
    v_cvt_pk_bf16_f32 v166, v121, v125
    v_mfma_f32_16x16x32_bf16 v[152:155], v[56:59], a[112:115], v[152:155]
    v_cvt_pk_bf16_f32 v167, v129, v133
    v_cvt_pk_bf16_f32 v168, v137, v141
    v_mfma_f32_16x16x32_bf16 v[156:159], v[56:59], a[116:119], v[156:159]
    v_cvt_pk_bf16_f32 v169, v145, v149
    s_add_u32 s18, s21, 1114112
    buffer_store_dwordx4 v[166:169], v4, s[4:7], s18 offen
    v_mfma_f32_16x16x32_bf16 v[152:155], v[60:63], a[152:155], v[152:155]
    v_cvt_pk_bf16_f32 v172, v122, v126
    v_cvt_pk_bf16_f32 v173, v130, v134
    v_mfma_f32_16x16x32_bf16 v[156:159], v[60:63], a[156:159], v[156:159]
    v_cvt_pk_bf16_f32 v174, v138, v142
    v_cvt_pk_bf16_f32 v175, v146, v150
    v_mfma_f32_16x16x32_bf16 v[152:155], v[64:67], a[192:195], v[152:155]
    s_add_u32 s18, s21, 1179648
    buffer_store_dwordx4 v[172:175], v4, s[4:7], s18 offen
    v_cvt_pk_bf16_f32 v178, v123, v127
    v_mfma_f32_16x16x32_bf16 v[156:159], v[64:67], a[196:199], v[156:159]
    v_cvt_pk_bf16_f32 v179, v131, v135
    v_cvt_pk_bf16_f32 v180, v139, v143
    v_mfma_f32_16x16x32_bf16 v[152:155], v[68:71], a[232:235], v[152:155]
    v_cvt_pk_bf16_f32 v181, v147, v151
    s_add_u32 s18, s21, 1245184
    buffer_store_dwordx4 v[178:181], v4, s[4:7], s18 offen
    v_mfma_f32_16x16x32_bf16 v[156:159], v[68:71], a[236:239], v[156:159]
    v_mfma_f32_16x16x32_bf16 v[152:155], v[72:75], v[208:211], v[152:155]
    v_mfma_f32_16x16x32_bf16 v[156:159], v[72:75], v[212:215], v[156:159]
    v_mfma_f32_16x16x32_bf16 v[152:155], v[76:79], v[248:251], v[152:155]
    v_mfma_f32_16x16x32_bf16 v[156:159], v[76:79], v[252:255], v[156:159]
    s_nop 3
    v_mov_b32 v3, v3
    s_nop 2
    v_cvt_pk_bf16_f32 v164, v152, v156
    v_cvt_pk_bf16_f32 v170, v153, v157
    v_cvt_pk_bf16_f32 v176, v154, v158
    v_cvt_pk_bf16_f32 v182, v155, v159
    s_add_u32 s18, s21, 1048576
    buffer_store_dword v164, v5, s[4:7], s18 offen offset:256
    s_add_u32 s18, s21, 1114112
    buffer_store_dword v170, v5, s[4:7], s18 offen offset:256
    s_add_u32 s18, s21, 1179648
    buffer_store_dword v176, v5, s[4:7], s18 offen offset:256
    s_add_u32 s18, s21, 1245184
    buffer_store_dword v182, v5, s[4:7], s18 offen offset:256
    s_waitcnt vmcnt(0)
    buffer_store_dword v46, off, s[4:7], s52 offset:0
    v_mov_b32 v45, 0
Lpf42:
    buffer_load_dword v45, v2, s[4:7], s23 offen offset:0 sc1
    s_waitcnt vmcnt(1)
    v_cmp_gt_u32 vcc, s17, v45
    s_cbranch_vccz Lpf42d
    s_sub_u32 s15, s15, 1
    s_cbranch_scc0 Lpf42
    s_mov_b32 s15, 0
Lpf42d:
    s_add_u32 s18, s22, 0
    buffer_load_dwordx4 v[48:51], v6, s[4:7], s18 offen offset:0 sc1
    buffer_load_dwordx4 v[52:55], v6, s[4:7], s18 offen offset:256 sc1
    buffer_load_dwordx4 v[56:59], v6, s[4:7], s18 offen offset:512 sc1
    buffer_load_dwordx4 v[60:63], v6, s[4:7], s18 offen offset:768 sc1
    buffer_load_dwordx4 v[64:67], v6, s[4:7], s18 offen offset:1024 sc1
    s_add_u32 s18, s22, 16384
    buffer_load_dwordx4 v[68:71], v7, s[4:7], s18 offen offset:0 sc1
    buffer_load_dwordx4 v[72:75], v7, s[4:7], s18 offen offset:256 sc1
    buffer_load_dwordx4 v[76:79], v7, s[4:7], s18 offen offset:512 sc1
    buffer_load_dwordx4 v[80:83], v7, s[4:7], s18 offen offset:768 sc1
    buffer_load_dwordx4 v[84:87], v7, s[4:7], s18 offen offset:1024 sc1
    buffer_load_dword v148, v2, s[4:7], s23 offen offset:1536 sc1
    v_and_b32 v109, 0xffff0000, v35
    v_lshlrev_b32 v108, 16, v35
    v_and_b32 v119, 0xffff0000, v20
    v_lshlrev_b32 v118, 16, v20
    v_and_b32 v129, 0xffff0000, v25
    v_lshlrev_b32 v128, 16, v25
    v_and_b32 v139, 0xffff0000, v30
    v_lshlrev_b32 v138, 16, v30
    v_and_b32 v111, 0xffff0000, v36
    v_lshlrev_b32 v110, 16, v36
    v_and_b32 v121, 0xffff0000, v21
    v_lshlrev_b32 v120, 16, v21
    v_and_b32 v131, 0xffff0000, v26
    v_lshlrev_b32 v130, 16, v26
    v_and_b32 v141, 0xffff0000, v31
    v_lshlrev_b32 v140, 16, v31
    v_and_b32 v113, 0xffff0000, v37
    v_lshlrev_b32 v112, 16, v37
    v_and_b32 v123, 0xffff0000, v22
    v_lshlrev_b32 v122, 16, v22
    v_and_b32 v133, 0xffff0000, v27
    v_lshlrev_b32 v132, 16, v27
    v_and_b32 v143, 0xffff0000, v32
    v_lshlrev_b32 v142, 16, v32
    v_and_b32 v115, 0xffff0000, v38
    v_lshlrev_b32 v114, 16, v38
    v_and_b32 v125, 0xffff0000, v23
    v_lshlrev_b32 v124, 16, v23
    v_and_b32 v135, 0xffff0000, v28
    v_lshlrev_b32 v134, 16, v28
    v_and_b32 v145, 0xffff0000, v33
    v_lshlrev_b32 v144, 16, v33
    v_and_b32 v117, 0xffff0000, v39
    v_lshlrev_b32 v116, 16, v39
    v_and_b32 v127, 0xffff0000, v24
    v_lshlrev_b32 v126, 16, v24
    v_and_b32 v137, 0xffff0000, v29
    v_lshlrev_b32 v136, 16, v29
    v_and_b32 v147, 0xffff0000, v34
    v_lshlrev_b32 v146, 16, v34
    s_mul_i32 s20, s51, 1280
    s_add_u32 s20, s20, s28
    s_add_u32 s20, s20, 65536
    s_mul_i32 s31, s51, 1296
    s_add_u32 s31, s31, s28
    s_max_u32 s19, s17, 2
    s_sub_u32 s19, s19, 2
    s_waitcnt vmcnt(10)
    v_mfma_f32_16x16x32_bf16 v[88:91], v[16:19], v[48:51], 0
    s_waitcnt vmcnt(9)
    v_mfma_f32_16x16x32_bf16 v[92:95], v[16:19], v[52:55], 0
    s_waitcnt vmcnt(8)
    v_mfma_f32_16x16x32_bf16 v[96:99], v[16:19], v[56:59], 0
    s_waitcnt vmcnt(7)
    v_mfma_f32_16x16x32_bf16 v[100:103], v[16:19], v[60:63], 0
    s_waitcnt vmcnt(6)
    v_mfma_f32_16x16x32_bf16 v[104:107], v[16:19], v[64:67], 0
    s_waitcnt vmcnt(5)
    v_mfma_f32_16x16x32_bf16 v[88:91], v[16:19], v[68:71], v[88:91]
    s_waitcnt vmcnt(4)
    v_mfma_f32_16x16x32_bf16 v[92:95], v[16:19], v[72:75], v[92:95]
    s_waitcnt vmcnt(3)
    v_mfma_f32_16x16x32_bf16 v[96:99], v[16:19], v[76:79], v[96:99]
    s_nop 0
    s_waitcnt vmcnt(2)
    v_mfma_f32_16x16x32_bf16 v[100:103], v[16:19], v[80:83], v[100:103]
    s_nop 1
    s_waitcnt vmcnt(1)
    v_mfma_f32_16x16x32_bf16 v[104:107], v[16:19], v[84:87], v[104:107]
    s_mov_b32 exec_hi, 0
    ds_write_b128 v8, v[88:91] offset:16384
    ds_write_b128 v8, v[92:95] offset:16896
    ds_write_b128 v8, v[96:99] offset:17408
    ds_write_b128 v8, v[100:103] offset:17920
    s_nop 2
    ds_write_b128 v8, v[104:107] offset:18432
    s_mov_b64 exec, -1
    s_waitcnt lgkmcnt(0)
    s_barrier
    s_cmp_lg_u32 s26, 0
    s_cbranch_scc1 Lp543
    ds_read_b64 v[48:49], v9 offset:16384
    ds_read_b64 v[58:59], v9 offset:18944
    ds_read_b64 v[50:51], v9 offset:16896
    ds_read_b64 v[60:61], v9 offset:19456
    ds_read_b64 v[52:53], v9 offset:17408
    ds_read_b64 v[62:63], v9 offset:19968
    ds_read_b64 v[54:55], v9 offset:17920
    ds_read_b64 v[64:65], v9 offset:20480
    ds_read_b64 v[56:57], v9 offset:18432
    ds_read_b64 v[66:67], v9 offset:20992
    s_waitcnt vmcnt(0)
    v_cmp_gt_u32 vcc, s19, v148
    s_cbranch_vccz Lokd44
Lwf45:
    buffer_load_dword v148, v2, s[4:7], s23 offen offset:1536 sc1
    s_waitcnt vmcnt(0)
    v_cmp_gt_u32 vcc, s19, v148
    s_cbranch_vccz Lwf45d
    s_sub_u32 s15, s15, 1
    s_cbranch_scc0 Lwf45
    s_mov_b32 s15, 0
Lwf45d:
Lokd44:
    s_waitcnt lgkmcnt(8)
    v_add_f32 v48, v48, v58
    v_add_f32 v49, v49, v59
    s_waitcnt lgkmcnt(6)
    v_add_f32 v50, v50, v60
    v_add_f32 v51, v51, v61
    s_waitcnt lgkmcnt(4)
    v_add_f32 v52, v52, v62
    v_add_f32 v53, v53, v63
    s_waitcnt lgkmcnt(2)
    v_add_f32 v54, v54, v64
    v_add_f32 v55, v55, v65
    s_waitcnt lgkmcnt(0)
    v_add_f32 v56, v56, v66
    v_add_f32 v57, v57, v67
    v_fmac_f32 v108, v118, v48
    v_fmac_f32 v109, v119, v49
    v_cvt_pk_bf16_f32 v35, v108, v109
    v_and_b32 v109, 0xffff0000, v35
    v_lshlrev_b32 v108, 16, v35
    v_fmac_f32 v110, v120, v50
    v_fmac_f32 v111, v121, v51
    v_cvt_pk_bf16_f32 v36, v110, v111
    v_and_b32 v111, 0xffff0000, v36
    v_lshlrev_b32 v110, 16, v36
    v_fmac_f32 v112, v122, v52
    v_fmac_f32 v113, v123, v53
    v_cvt_pk_bf16_f32 v37, v112, v113
    v_and_b32 v113, 0xffff0000, v37
    v_lshlrev_b32 v112, 16, v37
    v_fmac_f32 v114, v124, v54
    v_fmac_f32 v115, v125, v55
    v_cvt_pk_bf16_f32 v38, v114, v115
    v_and_b32 v115, 0xffff0000, v38
    v_lshlrev_b32 v114, 16, v38
    v_fmac_f32 v116, v126, v56
    v_fmac_f32 v117, v127, v57
    v_cvt_pk_bf16_f32 v39, v116, v117
    v_and_b32 v117, 0xffff0000, v39
    v_lshlrev_b32 v116, 16, v39
    v_add_f32 v69, v108, v109
    v_mul_f32 v70, v108, v108
    v_fmac_f32 v70, v109, v109
    v_add_f32 v69, v69, v110
    v_fmac_f32 v70, v110, v110
    v_add_f32 v69, v69, v111
    v_fmac_f32 v70, v111, v111
    v_add_f32 v69, v69, v112
    v_fmac_f32 v70, v112, v112
    v_add_f32 v69, v69, v113
    v_fmac_f32 v70, v113, v113
    v_add_f32 v69, v69, v114
    v_fmac_f32 v70, v114, v114
    v_add_f32 v69, v69, v115
    v_fmac_f32 v70, v115, v115
    v_add_f32 v69, v69, v116
    v_fmac_f32 v70, v116, v116
    v_add_f32 v69, v69, v117
    v_fmac_f32 v70, v117, v117
    s_nop 0
    v_add_f32_dpp v69, v69, v69 row_ror:1 row_mask:0xf bank_mask:0xf
    v_add_f32_dpp v70, v70, v70 row_ror:1 row_mask:0xf bank_mask:0xf
    s_nop 0
    v_add_f32_dpp v69, v69, v69 row_ror:2 row_mask:0xf bank_mask:0xf
    v_add_f32_dpp v70, v70, v70 row_ror:2 row_mask:0xf bank_mask:0xf
    s_nop 0
    v_add_f32_dpp v69, v69, v69 row_ror:4 row_mask:0xf bank_mask:0xf
    v_add_f32_dpp v70, v70, v70 row_ror:4 row_mask:0xf bank_mask:0xf
    s_nop 0
    v_add_f32_dpp v69, v69, v69 row_ror:8 row_mask:0xf bank_mask:0xf
    v_add_f32_dpp v70, v70, v70 row_ror:8 row_mask:0xf bank_mask:0xf
    s_nop 1
    v_permlane16_swap_b32 v69, v70
    v_add_f32 v69, v69, v70
    v_mov_b32 v70, v69
    s_nop 1
    v_permlane32_swap_b32 v69, v70
    v_add_f32 v69, v69, v70
    v_mul_f32 v69, 986500301, v69
    v_mov_b32 v70, v69
    s_nop 1
    v_permlane16_swap_b32 v69, v70
    v_fma_f32 v70, -v69, v69, v70
    v_max_f32 v70, 0, v70
    v_add_f32 v70, 925353388, v70
    v_rsq_f32 v68, v70
    s_nop 0
    v_mul_f32_e64 v69, -v69, v68
    v_fma_f32 v108, v108, v68, v69
    v_fmac_f32 v128, v108, v138
    v_fma_f32 v109, v109, v68, v69
    v_fmac_f32 v129, v109, v139
    v_fma_f32 v110, v110, v68, v69
    v_fmac_f32 v130, v110, v140
    v_fma_f32 v111, v111, v68, v69
    v_fmac_f32 v131, v111, v141
    v_fma_f32 v112, v112, v68, v69
    v_fmac_f32 v132, v112, v142
    v_fma_f32 v113, v113, v68, v69
    v_fmac_f32 v133, v113, v143
    v_fma_f32 v114, v114, v68, v69
    v_fmac_f32 v134, v114, v144
    v_fma_f32 v115, v115, v68, v69
    v_fmac_f32 v135, v115, v145
    v_fma_f32 v116, v116, v68, v69
    v_fmac_f32 v136, v116, v146
    v_fma_f32 v117, v117, v68, v69
    v_fmac_f32 v137, v117, v147
    v_add_f32 v69, v128, v129
    v_mul_f32 v70, v128, v128
    v_fmac_f32 v70, v129, v129
    v_add_f32 v69, v69, v130
    v_fmac_f32 v70, v130, v130
    v_add_f32 v69, v69, v131
    v_fmac_f32 v70, v131, v131
    v_add_f32 v69, v69, v132
    v_fmac_f32 v70, v132, v132
    v_add_f32 v69, v69, v133
    v_fmac_f32 v70, v133, v133
    v_add_f32 v69, v69, v134
    v_fmac_f32 v70, v134, v134
    v_add_f32 v69, v69, v135
    v_fmac_f32 v70, v135, v135
    v_add_f32 v69, v69, v136
    v_fmac_f32 v70, v136, v136
    v_add_f32 v69, v69, v137
    v_fmac_f32 v70, v137, v137
    s_nop 0
    v_add_f32_dpp v69, v69, v69 row_ror:1 row_mask:0xf bank_mask:0xf
    v_add_f32_dpp v70, v70, v70 row_ror:1 row_mask:0xf bank_mask:0xf
    s_nop 0
    v_add_f32_dpp v69, v69, v69 row_ror:2 row_mask:0xf bank_mask:0xf
    v_add_f32_dpp v70, v70, v70 row_ror:2 row_mask:0xf bank_mask:0xf
    s_nop 0
    v_add_f32_dpp v69, v69, v69 row_ror:4 row_mask:0xf bank_mask:0xf
    v_add_f32_dpp v70, v70, v70 row_ror:4 row_mask:0xf bank_mask:0xf
    s_nop 0
    v_add_f32_dpp v69, v69, v69 row_ror:8 row_mask:0xf bank_mask:0xf
    v_add_f32_dpp v70, v70, v70 row_ror:8 row_mask:0xf bank_mask:0xf
    s_nop 1
    v_permlane16_swap_b32 v69, v70
    v_add_f32 v69, v69, v70
    v_mov_b32 v70, v69
    s_nop 1
    v_permlane32_swap_b32 v69, v70
    v_add_f32 v69, v69, v70
    v_mul_f32 v69, 986500301, v69
    v_mov_b32 v70, v69
    s_nop 1
    v_permlane16_swap_b32 v69, v70
    v_fma_f32 v70, -v69, v69, v70
    v_max_f32 v70, 0, v70
    v_add_f32 v70, 925353388, v70
    v_rsq_f32 v68, v70
    s_nop 0
    v_mul_f32_e64 v69, -v69, v68
    v_fma_f32 v128, v128, v68, v69
    v_fma_f32 v129, v129, v68, v69
    v_cvt_pk_bf16_f32 v48, v128, v129
    buffer_store_dword v48, v2, s[4:7], s31 offen offset:0
    v_fma_f32 v130, v130, v68, v69
    v_fma_f32 v131, v131, v68, v69
    v_cvt_pk_bf16_f32 v49, v130, v131
    buffer_store_dword v49, v2, s[4:7], s31 offen offset:256
    v_fma_f32 v132, v132, v68, v69
    v_fma_f32 v133, v133, v68, v69
    v_cvt_pk_bf16_f32 v50, v132, v133
    buffer_store_dword v50, v2, s[4:7], s31 offen offset:512
    v_fma_f32 v134, v134, v68, v69
    v_fma_f32 v135, v135, v68, v69
    v_cvt_pk_bf16_f32 v51, v134, v135
    buffer_store_dword v51, v2, s[4:7], s31 offen offset:768
    v_fma_f32 v136, v136, v68, v69
    v_fma_f32 v137, v137, v68, v69
    v_cvt_pk_bf16_f32 v52, v136, v137
    buffer_store_dword v52, v2, s[4:7], s31 offen offset:1024
    buffer_store_dword v35, v2, s[4:7], s20 offen offset:0
    buffer_store_dword v36, v2, s[4:7], s20 offen offset:256
    buffer_store_dword v37, v2, s[4:7], s20 offen offset:512
    buffer_store_dword v38, v2, s[4:7], s20 offen offset:768
    buffer_store_dword v39, v2, s[4:7], s20 offen offset:1024
    s_lshl_b32 s18, s51, 2
    s_add_u32 s18, s18, s23
    s_waitcnt vmcnt(0)
    buffer_store_dword v46, off, s[4:7], s18 offset:512
Lp543:
    s_add_u32 s17, s17, 1
    s_xor_b32 s28, s28, 0x20000
    s_cmp_lt_u32 s16, 64
    s_cbranch_scc1 Lunit34
    s_waitcnt vmcnt(0) lgkmcnt(0)
    s_endpgm
Lunit35:
    v_mov_b32 v46, s17
    s_cmp_lg_u32 s30, 0
    s_cbranch_scc1 Lhave46
    s_add_u32 s19, s16, 1
    s_mov_b32 exec_lo, 0x3f
    s_mov_b32 exec_hi, 0x0
    s_waitcnt vmcnt(0)
Lwf47:
    buffer_load_dword v164, v1, s[4:7], s29 offen offset:0 sc1
    s_waitcnt vmcnt(0)
    v_cmp_gt_u32 vcc, s19, v164
    s_cbranch_vccz Lwf47d
    s_sub_u32 s15, s15, 1
    s_cbranch_scc0 Lwf47
    s_mov_b32 s15, 0
Lwf47d:
    s_mov_b64 exec, -1
    s_lshl_b32 s31, s16, 5
    s_add_u32 s31, s31, s51
    s_lshl_b32 s19, s31, 3
    s_add_u32 s19, s19, s26
    s_lshl_b32 s19, s19, 12
    s_add_u32 s19, s19, s55
    s_add_u32 s19, s19, 8388608
    s_lshr_b32 s18, s19, 8
    s_and_b32 s18, s18, 0x2000
    s_xor_b32 s18, s19, s18
    s_mul_i32 s19, s27, 24576
    s_lshl_b32 m0, s26, 12
    s_add_u32 m0, m0, s19
    s_add_u32 m0, m0, 32768
    s_mul_i32 s31, s31, 1280
    buffer_load_dwordx4 v1, s[4:7], s18 offen offset:0 sc1 lds
    buffer_load_dwordx4 v1, s[4:7], s18 offen offset:1024 sc1 lds
    buffer_load_dwordx4 v1, s[4:7], s18 offen offset:2048 sc1 lds
    buffer_load_dwordx4 v1, s[4:7], s18 offen offset:3072 sc1 lds
    s_add_u32 m0, m0, 8192
    s_xor_b32 s18, s18, 8192
    buffer_load_dwordx4 v1, s[4:7], s18 offen offset:0 sc1 lds
    buffer_load_dwordx4 v1, s[4:7], s18 offen offset:1024 sc1 lds
    buffer_load_dwordx4 v1, s[4:7], s18 offen offset:2048 sc1 lds
    buffer_load_dwordx4 v1, s[4:7], s18 offen offset:3072 sc1 lds
    s_add_u32 m0, m0, 8192
    s_xor_b32 s18, s18, 16384
    buffer_load_dwordx4 v1, s[4:7], s18 offen offset:0 sc1 lds
    buffer_load_dwordx4 v1, s[4:7], s18 offen offset:1024 sc1 lds
    buffer_load_dwordx4 v1, s[4:7], s18 offen offset:2048 sc1 lds
    buffer_load_dwordx4 v1, s[4:7], s18 offen offset:3072 sc1 lds
    buffer_load_dword v40, v2, s[76:79], s31 offen offset:0
    buffer_load_dword v41, v2, s[76:79], s31 offen offset:256
    buffer_load_dword v42, v2, s[76:79], s31 offen offset:512
    buffer_load_dword v43, v2, s[76:79], s31 offen offset:768
    buffer_load_dword v44, v2, s[76:79], s31 offen offset:1024
    s_waitcnt vmcnt(0)
Lhave46:
    s_barrier
    ds_read_b128 v[48:51], v14 offset:0
    ds_read_b128 v[52:55], v14 offset:1024
    ds_read_b128 v[56:59], v14 offset:2048
    ds_read_b128 v[60:63], v14 offset:3072
    ds_read_b128 v[64:67], v10 offset:8192
    ds_read_b128 v[68:71], v10 offset:8224
    ds_read_b128 v[72:75], v10 offset:9216
    ds_read_b128 v[76:79], v10 offset:9248
    ds_read_b128 v[80:83], v10 offset:12288
    ds_read_b128 v[84:87], v10 offset:12320
    ds_read_b128 v[88:91], v10 offset:13312
    ds_read_b128 v[92:95], v10 offset:13344
    s_lshl_b32 s19, s16, 18
    s_add_u32 s19, s19, s56
    s_lshr_b32 s20, s19, 8
    s_and_b32 s20, s20, 0x2000
    s_xor_b32 s20, s19, s20
    v_mov_b32 v35, v40
    v_mov_b32 v36, v41
    v_mov_b32 v37, v42
    v_mov_b32 v38, v43
    v_mov_b32 v39, v44
    s_waitcnt lgkmcnt(7)
    v_mfma_f32_16x16x32_bf16 v[152:155], v[64:67], v[48:51], 0
    ds_read_b128 v[96:99], v15 offset:16384
    s_waitcnt lgkmcnt(7)
    v_mfma_f32_16x16x32_bf16 v[152:155], v[68:71], v[52:55], v[152:155]
    ds_read_b128 v[100:103], v15 offset:17408
    s_waitcnt lgkmcnt(7)
    v_mfma_f32_16x16x32_bf16 v[152:155], v[72:75], v[56:59], v[152:155]
    ds_read_b128 v[104:107], v15 offset:18432
    s_waitcnt lgkmcnt(7)
    v_mfma_f32_16x16x32_bf16 v[152:155], v[76:79], v[60:63], v[152:155]
    ds_read_b128 v[108:111], v15 offset:19456
    s_waitcnt lgkmcnt(7)
    v_mfma_f32_16x16x32_bf16 v[156:159], v[80:83], v[48:51], 0
    ds_read_b128 v[112:115], v15 offset:20480
    s_waitcnt lgkmcnt(7)
    v_mfma_f32_16x16x32_bf16 v[156:159], v[84:87], v[52:55], v[156:159]
    ds_read_b128 v[116:119], v15 offset:21504
    s_waitcnt lgkmcnt(7)
    v_mfma_f32_16x16x32_bf16 v[156:159], v[88:91], v[56:59], v[156:159]
    ds_read_b128 v[120:123], v15 offset:22528
    s_waitcnt lgkmcnt(7)
    v_mfma_f32_16x16x32_bf16 v[156:159], v[92:95], v[60:63], v[156:159]
    ds_read_b128 v[124:127], v15 offset:23552
    v_mov_b32 v164, s25
    v_cndmask_b32 v152, v164, v152, s[32:33]
    v_cndmask_b32 v153, v164, v153, s[34:35]
    v_cndmask_b32 v154, v164, v154, s[36:37]
    v_cndmask_b32 v155, v164, v155, s[38:39]
    s_nop 1
    v_cndmask_b32 v156, v164, v156, s[40:41]
    v_cndmask_b32 v157, v164, v157, s[42:43]
    v_cndmask_b32 v158, v164, v158, s[44:45]
    v_cndmask_b32 v159, v164, v159, s[46:47]
    v_max_f32 v165, v152, v153
    v_max3_f32 v165, v165, v154, v155
    v_max3_f32 v165, v165, v156, v157
    v_max3_f32 v165, v165, v158, v159
    s_waitcnt lgkmcnt(0)
    s_lshl_b32 s31, s26, 5
    s_add_u32 s31, s31, s51
    s_lshl_b32 s31, s31, 6
    s_add_u32 s31, s31, 4096
Lkc48:
    s_load_dword s54, s[4:5], s31 glc
    s_waitcnt lgkmcnt(0)
    s_cmp_gt_u32 s54, s16
    s_cbranch_scc1 Lkc48d
    s_sub_u32 s15, s15, 1
    s_cbranch_scc0 Lkc48
    s_mov_b32 s15, 0
Lkc48d:
    s_barrier
    buffer_load_dwordx4 v[128:131], v11, s[4:7], s20 offen offset:0 sc1
    buffer_load_dwordx4 v[132:135], v11, s[4:7], s20 offen offset:32 sc1
    buffer_load_dwordx4 v[136:139], v11, s[4:7], s20 offen offset:1024 sc1
    buffer_load_dwordx4 v[140:143], v11, s[4:7], s20 offen offset:1056 sc1
    buffer_load_dwordx2 v[144:145], v12, s[4:7], s20 offen offset:2048 sc1
    buffer_load_dwordx2 v[146:147], v12, s[4:7], s20 offen offset:2560 sc1
    buffer_load_dwordx2 v[148:149], v12, s[4:7], s20 offen offset:3072 sc1
    buffer_load_dwordx2 v[150:151], v12, s[4:7], s20 offen offset:3584 sc1
    v_and_b32 v191, 0x70, v1
    v_min_u32 v191, 0x50, v191
    buffer_load_dword v190, v191, s[4:7], s29 offen sc1
    s_waitcnt vmcnt(8)
    v_mfma_f32_16x16x32_bf16 v[160:163], v[128:131], v[48:51], 0
    s_waitcnt vmcnt(7)
    v_mfma_f32_16x16x32_bf16 v[160:163], v[132:135], v[52:55], v[160:163]
    s_waitcnt vmcnt(6)
    v_mfma_f32_16x16x32_bf16 v[160:163], v[136:139], v[56:59], v[160:163]
    s_waitcnt vmcnt(5)
    v_mfma_f32_16x16x32_bf16 v[160:163], v[140:143], v[60:63], v[160:163]
    s_nop 3
    v_mov_b32 v3, v3
    s_nop 2
    v_mul_f32 v160, s24, v160
    v_mul_f32 v161, s24, v161
    v_max3_f32 v165, v165, v160, v161
    v_mov_b32 v164, v165
    s_nop 1
    v_permlane16_swap_b32 v165, v164
    v_max_f32 v165, v165, v164
    v_mov_b32 v164, v165
    s_nop 1
    v_permlane32_swap_b32 v165, v164
    v_max_f32 v165, v165, v164
    v_sub_f32 v152, v152, v165
    v_sub_f32 v153, v153, v165
    v_sub_f32 v154, v154, v165
    v_sub_f32 v155, v155, v165
    v_sub_f32 v156, v156, v165
    v_sub_f32 v157, v157, v165
    v_sub_f32 v158, v158, v165
    v_sub_f32 v159, v159, v165
    v_sub_f32 v160, v160, v165
    v_sub_f32 v161, v161, v165
    v_exp_f32 v152, v152
    v_exp_f32 v153, v153
    v_exp_f32 v154, v154
    v_exp_f32 v155, v155
    v_exp_f32 v156, v156
    v_exp_f32 v157, v157
    v_exp_f32 v158, v158
    v_exp_f32 v159, v159
    v_exp_f32 v160, v160
    v_exp_f32 v161, v161
    v_mov_b32 v133, 0
    v_mov_b32 v134, 0
    v_cvt_pk_bf16_f32 v128, v152, v153
    v_mov_b32 v136, 0x3f803f80
    v_cvt_pk_bf16_f32 v129, v154, v155
    v_mov_b32 v137, 0x3f803f80
    v_cvt_pk_bf16_f32 v130, v156, v157
    v_mov_b32 v138, 0x3f803f80
    v_cvt_pk_bf16_f32 v131, v158, v159
    v_mov_b32 v139, 0x3f803f80
    v_cvt_pk_bf16_f32 v132, v160, v161
    v_cvt_pk_bf16_f32 v135, v160, v161
    v_mfma_f32_16x16x32_bf16 v[140:143], v[136:139], v[128:131], 0
    s_nop 1
    v_mfma_f32_16x16x32_bf16 v[64:67], v[96:99], v[128:131], 0
    s_nop 0
    v_mfma_f32_16x16x32_bf16 v[68:71], v[100:103], v[128:131], 0
    s_nop 0
    v_mfma_f32_16x16x32_bf16 v[72:75], v[104:107], v[128:131], 0
    v_mfma_f32_16x16x32_bf16 v[76:79], v[108:111], v[128:131], 0
    v_mfma_f32_16x16x16_bf16 v[140:143], v[136:137], v[132:133], v[140:143]
    s_nop 1
    s_waitcnt vmcnt(4)
    v_mfma_f32_16x16x16_bf16 v[64:67], v[144:145], v[132:133], v[64:67]
    s_nop 1
    v_mfma_f32_16x16x16_bf16 v[68:71], v[144:145], v[134:135], v[68:71]
    s_waitcnt vmcnt(3)
    v_mfma_f32_16x16x16_bf16 v[72:75], v[146:147], v[132:133], v[72:75]
    v_mfma_f32_16x16x16_bf16 v[76:79], v[146:147], v[134:135], v[76:79]
    v_rcp_f32 v164, v140
    v_mfma_f32_16x16x32_bf16 v[80:83], v[112:115], v[128:131], 0
    v_mul_f32 v64, v164, v64
    v_mul_f32 v65, v164, v65
    v_mfma_f32_16x16x32_bf16 v[84:87], v[116:119], v[128:131], 0
    v_mul_f32 v66, v164, v66
    v_mul_f32 v67, v164, v67
    v_mfma_f32_16x16x32_bf16 v[88:91], v[120:123], v[128:131], 0
    v_mul_f32 v68, v164, v68
    v_mul_f32 v69, v164, v69
    v_mfma_f32_16x16x32_bf16 v[92:95], v[124:127], v[128:131], 0
    s_waitcnt vmcnt(2)
    v_mul_f32 v70, v164, v70
    v_mul_f32 v71, v164, v71
    v_mfma_f32_16x16x16_bf16 v[80:83], v[148:149], v[132:133], v[80:83]
    v_cvt_pk_bf16_f32 v48, v64, v65
    v_cvt_pk_bf16_f32 v49, v66, v67
    v_mfma_f32_16x16x16_bf16 v[84:87], v[148:149], v[134:135], v[84:87]
    s_waitcnt vmcnt(1)
    v_cvt_pk_bf16_f32 v50, v68, v69
    v_cvt_pk_bf16_f32 v51, v70, v71
    v_mfma_f32_16x16x16_bf16 v[88:91], v[150:151], v[132:133], v[88:91]
    ds_write_b128 v13, v[48:51] offset:0
    v_mul_f32 v72, v164, v72
    v_mfma_f32_16x16x16_bf16 v[92:95], v[150:151], v[134:135], v[92:95]
    v_mul_f32 v73, v164, v73
    v_mul_f32 v74, v164, v74
    v_mul_f32 v75, v164, v75
    v_mul_f32 v76, v164, v76
    v_mul_f32 v77, v164, v77
    v_mul_f32 v78, v164, v78
    v_mul_f32 v79, v164, v79
    v_cvt_pk_bf16_f32 v52, v72, v73
    v_cvt_pk_bf16_f32 v53, v74, v75
    v_cvt_pk_bf16_f32 v54, v76, v77
    v_cvt_pk_bf16_f32 v55, v78, v79
    ds_write_b128 v13, v[52:55] offset:1024
    v_mul_f32 v80, v164, v80
    v_mul_f32 v81, v164, v81
    v_mul_f32 v82, v164, v82
    v_mul_f32 v83, v164, v83
    v_mul_f32 v84, v164, v84
    v_mul_f32 v85, v164, v85
    v_mul_f32 v86, v164, v86
    v_mul_f32 v87, v164, v87
    v_cvt_pk_bf16_f32 v56, v80, v81
    v_cvt_pk_bf16_f32 v57, v82, v83
    v_cvt_pk_bf16_f32 v58, v84, v85
    v_cvt_pk_bf16_f32 v59, v86, v87
    ds_write_b128 v13, v[56:59] offset:2048
    v_mul_f32 v88, v164, v88
    v_mul_f32 v89, v164, v89
    v_mul_f32 v90, v164, v90
    v_mul_f32 v91, v164, v91
    v_mul_f32 v92, v164, v92
    v_mul_f32 v93, v164, v93
    v_mul_f32 v94, v164, v94
    v_mul_f32 v95, v164, v95
    v_cvt_pk_bf16_f32 v60, v88, v89
    v_cvt_pk_bf16_f32 v61, v90, v91
    v_cvt_pk_bf16_f32 v62, v92, v93
    v_cvt_pk_bf16_f32 v63, v94, v95
    ds_write_b128 v13, v[60:63] offset:3072
    s_waitcnt lgkmcnt(0)
    s_barrier
    ds_read_b128 v[48:51], v1 offset:0
    ds_read_b128 v[52:55], v1 offset:1024
    ds_read_b128 v[56:59], v1 offset:2048
    ds_read_b128 v[60:63], v1 offset:3072
    ds_read_b128 v[64:67], v1 offset:4096
    ds_read_b128 v[68:71], v1 offset:5120
    ds_read_b128 v[72:75], v1 offset:6144
    ds_read_b128 v[76:79], v1 offset:7168
    s_mov_b32 s20, s16
    s_add_u32 s16, s16, 4
    s_waitcnt vmcnt(0)
    v_cmp_ge_u32 vcc, s16, v190
    v_and_b32 v191, 0x7c, v2
    s_waitcnt lgkmcnt(7)
    v_mfma_f32_16x16x32_bf16 v[80:83], v[48:51], a[0:3], 0
    v_mfma_f32_16x16x32_bf16 v[84:87], v[48:51], a[4:7], 0
    s_cmp_eq_u64 vcc, 0
    s_cselect_b32 s30, 1, 0
    s_cselect_b32 s20, s16, s20
    v_mfma_f32_16x16x32_bf16 v[88:91], v[48:51], a[8:11], 0
    buffer_load_dword v47, v191, s[4:7], s23 offen offset:512 sc1
    v_mfma_f32_16x16x32_bf16 v[92:95], v[48:51], a[12:15], 0
    s_lshl_b32 s31, s20, 5
    v_mfma_f32_16x16x32_bf16 v[96:99], v[48:51], a[16:19], 0
    s_add_u32 s31, s31, s51
    v_mfma_f32_16x16x32_bf16 v[100:103], v[48:51], a[20:23], 0
    s_lshl_b32 s19, s31, 3
    v_mfma_f32_16x16x32_bf16 v[104:107], v[48:51], a[24:27], 0
    s_add_u32 s19, s19, s26
    v_mfma_f32_16x16x32_bf16 v[108:111], v[48:51], a[28:31], 0
    s_lshl_b32 s19, s19, 12
    v_mfma_f32_16x16x32_bf16 v[112:115], v[48:51], a[32:35], 0
    s_add_u32 s19, s19, s55
    v_mfma_f32_16x16x32_bf16 v[116:119], v[48:51], a[36:39], 0
    s_waitcnt lgkmcnt(6)
    s_add_u32 s19, s19, 8388608
    ds_read_b128 v[48:51], v1 offset:8192
    v_mfma_f32_16x16x32_bf16 v[80:83], v[52:55], a[40:43], v[80:83]
    s_lshr_b32 s18, s19, 8
    v_mfma_f32_16x16x32_bf16 v[84:87], v[52:55], a[44:47], v[84:87]
    s_and_b32 s18, s18, 0x2000
    v_mfma_f32_16x16x32_bf16 v[88:91], v[52:55], a[48:51], v[88:91]
    s_xor_b32 s18, s19, s18
    v_mfma_f32_16x16x32_bf16 v[92:95], v[52:55], a[52:55], v[92:95]
    s_mul_i32 s19, s27, 24576
    v_mfma_f32_16x16x32_bf16 v[96:99], v[52:55], a[56:59], v[96:99]
    s_lshl_b32 m0, s26, 12
    v_mfma_f32_16x16x32_bf16 v[100:103], v[52:55], a[60:63], v[100:103]
    s_add_u32 m0, m0, s19
    v_mfma_f32_16x16x32_bf16 v[104:107], v[52:55], a[64:67], v[104:107]
    s_add_u32 m0, m0, 32768
    v_mfma_f32_16x16x32_bf16 v[108:111], v[52:55], a[68:71], v[108:111]
    s_mul_i32 s31, s31, 1280
    v_mfma_f32_16x16x32_bf16 v[112:115], v[52:55], a[72:75], v[112:115]
    buffer_load_dwordx4 v1, s[4:7], s18 offen offset:0 sc1 lds
    v_mfma_f32_16x16x32_bf16 v[116:119], v[52:55], a[76:79], v[116:119]
    ds_read_b128 v[52:55], v1 offset:9216
    s_waitcnt lgkmcnt(7)
    v_mfma_f32_16x16x32_bf16 v[80:83], v[56:59], a[80:83], v[80:83]
    v_mfma_f32_16x16x32_bf16 v[84:87], v[56:59], a[84:87], v[84:87]
    buffer_load_dwordx4 v1, s[4:7], s18 offen offset:1024 sc1 lds
    v_mfma_f32_16x16x32_bf16 v[88:91], v[56:59], a[88:91], v[88:91]
    v_mfma_f32_16x16x32_bf16 v[92:95], v[56:59], a[92:95], v[92:95]
    v_mfma_f32_16x16x32_bf16 v[96:99], v[56:59], a[96:99], v[96:99]
    buffer_load_dwordx4 v1, s[4:7], s18 offen offset:2048 sc1 lds
    v_mfma_f32_16x16x32_bf16 v[100:103], v[56:59], a[100:103], v[100:103]
    v_mfma_f32_16x16x32_bf16 v[104:107], v[56:59], a[104:107], v[104:107]
    v_mfma_f32_16x16x32_bf16 v[108:111], v[56:59], a[108:111], v[108:111]
    buffer_load_dwordx4 v1, s[4:7], s18 offen offset:3072 sc1 lds
    v_mfma_f32_16x16x32_bf16 v[112:115], v[56:59], a[112:115], v[112:115]
    v_mfma_f32_16x16x32_bf16 v[116:119], v[56:59], a[116:119], v[116:119]
    ds_read_b128 v[56:59], v1 offset:10240
    s_waitcnt lgkmcnt(7)
    v_mfma_f32_16x16x32_bf16 v[80:83], v[60:63], a[120:123], v[80:83]
    s_add_u32 m0, m0, 8192
    v_mfma_f32_16x16x32_bf16 v[84:87], v[60:63], a[124:127], v[84:87]
    s_xor_b32 s18, s18, 8192
    v_mfma_f32_16x16x32_bf16 v[88:91], v[60:63], a[128:131], v[88:91]
    buffer_load_dwordx4 v1, s[4:7], s18 offen offset:0 sc1 lds
    v_mfma_f32_16x16x32_bf16 v[92:95], v[60:63], a[132:135], v[92:95]
    v_mfma_f32_16x16x32_bf16 v[96:99], v[60:63], a[136:139], v[96:99]
    v_mfma_f32_16x16x32_bf16 v[100:103], v[60:63], a[140:143], v[100:103]
    buffer_load_dwordx4 v1, s[4:7], s18 offen offset:1024 sc1 lds
    v_mfma_f32_16x16x32_bf16 v[104:107], v[60:63], a[144:147], v[104:107]
    v_mfma_f32_16x16x32_bf16 v[108:111], v[60:63], a[148:151], v[108:111]
    v_mfma_f32_16x16x32_bf16 v[112:115], v[60:63], a[152:155], v[112:115]
    buffer_load_dwordx4 v1, s[4:7], s18 offen offset:2048 sc1 lds
    v_mfma_f32_16x16x32_bf16 v[116:119], v[60:63], a[156:159], v[116:119]
    ds_read_b128 v[60:63], v1 offset:11264
    s_waitcnt lgkmcnt(7)
    v_mfma_f32_16x16x32_bf16 v[80:83], v[64:67], a[160:163], v[80:83]
    v_mfma_f32_16x16x32_bf16 v[84:87], v[64:67], a[164:167], v[84:87]
    buffer_load_dwordx4 v1, s[4:7], s18 offen offset:3072 sc1 lds
    v_mfma_f32_16x16x32_bf16 v[88:91], v[64:67], a[168:171], v[88:91]
    v_mfma_f32_16x16x32_bf16 v[92:95], v[64:67], a[172:175], v[92:95]
    v_mfma_f32_16x16x32_bf16 v[96:99], v[64:67], a[176:179], v[96:99]
    s_add_u32 m0, m0, 8192
    v_mfma_f32_16x16x32_bf16 v[100:103], v[64:67], a[180:183], v[100:103]
    s_xor_b32 s18, s18, 16384
    v_mfma_f32_16x16x32_bf16 v[104:107], v[64:67], a[184:187], v[104:107]
    buffer_load_dwordx4 v1, s[4:7], s18 offen offset:0 sc1 lds
    v_mfma_f32_16x16x32_bf16 v[108:111], v[64:67], a[188:191], v[108:111]
    v_mfma_f32_16x16x32_bf16 v[112:115], v[64:67], a[192:195], v[112:115]
    v_mfma_f32_16x16x32_bf16 v[116:119], v[64:67], a[196:199], v[116:119]
    s_waitcnt lgkmcnt(6)
    buffer_load_dwordx4 v1, s[4:7], s18 offen offset:1024 sc1 lds
    ds_read_b128 v[64:67], v1 offset:12288
    v_mfma_f32_16x16x32_bf16 v[80:83], v[68:71], a[200:203], v[80:83]
    v_mfma_f32_16x16x32_bf16 v[84:87], v[68:71], a[204:207], v[84:87]
    v_mfma_f32_16x16x32_bf16 v[88:91], v[68:71], a[208:211], v[88:91]
    buffer_load_dwordx4 v1, s[4:7], s18 offen offset:2048 sc1 lds
    v_mfma_f32_16x16x32_bf16 v[92:95], v[68:71], a[212:215], v[92:95]
    v_mfma_f32_16x16x32_bf16 v[96:99], v[68:71], a[216:219], v[96:99]
    v_mfma_f32_16x16x32_bf16 v[100:103], v[68:71], a[220:223], v[100:103]
    buffer_load_dwordx4 v1, s[4:7], s18 offen offset:3072 sc1 lds
    v_mfma_f32_16x16x32_bf16 v[104:107], v[68:71], a[224:227], v[104:107]
    v_mfma_f32_16x16x32_bf16 v[108:111], v[68:71], a[228:231], v[108:111]
    v_mfma_f32_16x16x32_bf16 v[112:115], v[68:71], a[232:235], v[112:115]
    buffer_load_dword v40, v2, s[76:79], s31 offen offset:0
    v_mfma_f32_16x16x32_bf16 v[116:119], v[68:71], a[236:239], v[116:119]
    ds_read_b128 v[68:71], v1 offset:13312
    s_waitcnt lgkmcnt(7)
    v_mfma_f32_16x16x32_bf16 v[80:83], v[72:75], a[240:243], v[80:83]
    v_mfma_f32_16x16x32_bf16 v[84:87], v[72:75], a[244:247], v[84:87]
    buffer_load_dword v41, v2, s[76:79], s31 offen offset:256
    v_mfma_f32_16x16x32_bf16 v[88:91], v[72:75], a[248:251], v[88:91]
    v_mfma_f32_16x16x32_bf16 v[92:95], v[72:75], a[252:255], v[92:95]
    v_mfma_f32_16x16x32_bf16 v[96:99], v[72:75], v[192:195], v[96:99]
    buffer_load_dword v42, v2, s[76:79], s31 offen offset:512
    v_mfma_f32_16x16x32_bf16 v[100:103], v[72:75], v[196:199], v[100:103]
    v_mfma_f32_16x16x32_bf16 v[104:107], v[72:75], v[200:203], v[104:107]
    v_mfma_f32_16x16x32_bf16 v[108:111], v[72:75], v[204:207], v[108:111]
    buffer_load_dword v43, v2, s[76:79], s31 offen offset:768
    v_mfma_f32_16x16x32_bf16 v[112:115], v[72:75], v[208:211], v[112:115]
    v_mfma_f32_16x16x32_bf16 v[116:119], v[72:75], v[212:215], v[116:119]
    ds_read_b128 v[72:75], v1 offset:14336
    s_waitcnt lgkmcnt(7)
    v_mfma_f32_16x16x32_bf16 v[80:83], v[76:79], v[216:219], v[80:83]
    buffer_load_dword v44, v2, s[76:79], s31 offen offset:1024
    v_mfma_f32_16x16x32_bf16 v[84:87], v[76:79], v[220:223], v[84:87]
    v_mfma_f32_16x16x32_bf16 v[88:91], v[76:79], v[224:227], v[88:91]
    v_mfma_f32_16x16x32_bf16 v[92:95], v[76:79], v[228:231], v[92:95]
    v_mfma_f32_16x16x32_bf16 v[96:99], v[76:79], v[232:235], v[96:99]
    v_mfma_f32_16x16x32_bf16 v[100:103], v[76:79], v[236:239], v[100:103]
    v_mfma_f32_16x16x32_bf16 v[104:107], v[76:79], v[240:243], v[104:107]
    v_mfma_f32_16x16x32_bf16 v[108:111], v[76:79], v[244:247], v[108:111]
    v_mfma_f32_16x16x32_bf16 v[112:115], v[76:79], v[248:251], v[112:115]
    v_mfma_f32_16x16x32_bf16 v[116:119], v[76:79], v[252:255], v[116:119]
    ds_read_b128 v[76:79], v1 offset:15360
    s_sub_u32 s19, s17, 1
    s_waitcnt vmcnt(17)
    v_cmp_gt_u32 vcc, s19, v47
    s_cbranch_vccz Loky49
    s_mov_b32 exec_lo, 0xffffffff
    s_mov_b32 exec_hi, 0x0
    s_waitcnt vmcnt(0)
Lwf50:
    buffer_load_dword v47, v2, s[4:7], s23 offen offset:512 sc1
    s_waitcnt vmcnt(0)
    v_cmp_gt_u32 vcc, s19, v47
    s_cbranch_vccz Lwf50d
    s_sub_u32 s15, s15, 1
    s_cbranch_scc0 Lwf50
    s_mov_b32 s15, 0
Lwf50d:
    s_mov_b64 exec, -1
Loky49:
    s_waitcnt lgkmcnt(7)
    v_mfma_f32_16x16x32_bf16 v[120:123], v[48:51], a[0:3], 0
    v_mfma_f32_16x16x32_bf16 v[124:127], v[48:51], a[4:7], 0
    v_cvt_pk_bf16_f32 v160, v80, v84
    v_mfma_f32_16x16x32_bf16 v[128:131], v[48:51], a[8:11], 0
    v_cvt_pk_bf16_f32 v161, v88, v92
    v_mfma_f32_16x16x32_bf16 v[132:135], v[48:51], a[12:15], 0
    v_cvt_pk_bf16_f32 v162, v96, v100
    v_mfma_f32_16x16x32_bf16 v[136:139], v[48:51], a[16:19], 0
    v_cvt_pk_bf16_f32 v163, v104, v108
    v_mfma_f32_16x16x32_bf16 v[140:143], v[48:51], a[20:23], 0
    s_add_u32 s18, s21, 0
    buffer_store_dwordx4 v[160:163], v4, s[4:7], s18 offen sc1
    v_mfma_f32_16x16x32_bf16 v[144:147], v[48:51], a[24:27], 0
    v_cvt_pk_bf16_f32 v166, v81, v85
    v_mfma_f32_16x16x32_bf16 v[148:151], v[48:51], a[28:31], 0
    s_waitcnt lgkmcnt(6)
    v_cvt_pk_bf16_f32 v167, v89, v93
    v_mfma_f32_16x16x32_bf16 v[120:123], v[52:55], a[40:43], v[120:123]
    v_cvt_pk_bf16_f32 v168, v97, v101
    v_mfma_f32_16x16x32_bf16 v[124:127], v[52:55], a[44:47], v[124:127]
    v_cvt_pk_bf16_f32 v169, v105, v109
    v_mfma_f32_16x16x32_bf16 v[128:131], v[52:55], a[48:51], v[128:131]
    s_add_u32 s18, s21, 65536
    buffer_store_dwordx4 v[166:169], v4, s[4:7], s18 offen sc1
    v_mfma_f32_16x16x32_bf16 v[132:135], v[52:55], a[52:55], v[132:135]
    v_cvt_pk_bf16_f32 v172, v82, v86
    v_mfma_f32_16x16x32_bf16 v[136:139], v[52:55], a[56:59], v[136:139]
    v_cvt_pk_bf16_f32 v173, v90, v94
    v_mfma_f32_16x16x32_bf16 v[140:143], v[52:55], a[60:63], v[140:143]
    v_cvt_pk_bf16_f32 v174, v98, v102
    v_mfma_f32_16x16x32_bf16 v[144:147], v[52:55], a[64:67], v[144:147]
    v_cvt_pk_bf16_f32 v175, v106, v110
    v_mfma_f32_16x16x32_bf16 v[148:151], v[52:55], a[68:71], v[148:151]
    s_waitcnt lgkmcnt(5)
    s_add_u32 s18, s21, 131072
    buffer_store_dwordx4 v[172:175], v4, s[4:7], s18 offen sc1
    v_mfma_f32_16x16x32_bf16 v[120:123], v[56:59], a[80:83], v[120:123]
    v_cvt_pk_bf16_f32 v178, v83, v87
    v_mfma_f32_16x16x32_bf16 v[124:127], v[56:59], a[84:87], v[124:127]
    v_cvt_pk_bf16_f32 v179, v91, v95
    v_mfma_f32_16x16x32_bf16 v[128:131], v[56:59], a[88:91], v[128:131]
    v_cvt_pk_bf16_f32 v180, v99, v103
    v_mfma_f32_16x16x32_bf16 v[132:135], v[56:59], a[92:95], v[132:135]
    v_cvt_pk_bf16_f32 v181, v107, v111
    v_mfma_f32_16x16x32_bf16 v[136:139], v[56:59], a[96:99], v[136:139]
    s_add_u32 s18, s21, 196608
    buffer_store_dwordx4 v[178:181], v4, s[4:7], s18 offen sc1
    v_mfma_f32_16x16x32_bf16 v[140:143], v[56:59], a[100:103], v[140:143]
    v_cvt_pk_bf16_f32 v164, v112, v116
    v_mfma_f32_16x16x32_bf16 v[144:147], v[56:59], a[104:107], v[144:147]
    v_cvt_pk_bf16_f32 v170, v113, v117
    v_mfma_f32_16x16x32_bf16 v[148:151], v[56:59], a[108:111], v[148:151]
    s_waitcnt lgkmcnt(4)
    v_cvt_pk_bf16_f32 v176, v114, v118
    v_mfma_f32_16x16x32_bf16 v[120:123], v[60:63], a[120:123], v[120:123]
    v_cvt_pk_bf16_f32 v182, v115, v119
    v_mfma_f32_16x16x32_bf16 v[124:127], v[60:63], a[124:127], v[124:127]
    s_add_u32 s18, s21, 0
    buffer_store_dword v164, v5, s[4:7], s18 offen offset:256 sc1
    v_mfma_f32_16x16x32_bf16 v[128:131], v[60:63], a[128:131], v[128:131]
    s_add_u32 s18, s21, 65536
    buffer_store_dword v170, v5, s[4:7], s18 offen offset:256 sc1
    v_mfma_f32_16x16x32_bf16 v[132:135], v[60:63], a[132:135], v[132:135]
    s_add_u32 s18, s21, 131072
    buffer_store_dword v176, v5, s[4:7], s18 offen offset:256 sc1
    v_mfma_f32_16x16x32_bf16 v[136:139], v[60:63], a[136:139], v[136:139]
    s_add_u32 s18, s21, 196608
    buffer_store_dword v182, v5, s[4:7], s18 offen offset:256 sc1
    v_mfma_f32_16x16x32_bf16 v[140:143], v[60:63], a[140:143], v[140:143]
    v_mfma_f32_16x16x32_bf16 v[144:147], v[60:63], a[144:147], v[144:147]
    v_mfma_f32_16x16x32_bf16 v[148:151], v[60:63], a[148:151], v[148:151]
    s_waitcnt lgkmcnt(3)
    v_mfma_f32_16x16x32_bf16 v[120:123], v[64:67], a[160:163], v[120:123]
    v_mfma_f32_16x16x32_bf16 v[124:127], v[64:67], a[164:167], v[124:127]
    v_mfma_f32_16x16x32_bf16 v[128:131], v[64:67], a[168:171], v[128:131]
    v_mfma_f32_16x16x32_bf16 v[132:135], v[64:67], a[172:175], v[132:135]
    v_mfma_f32_16x16x32_bf16 v[136:139], v[64:67], a[176:179], v[136:139]
    v_mfma_f32_16x16x32_bf16 v[140:143], v[64:67], a[180:183], v[140:143]
    v_mfma_f32_16x16x32_bf16 v[144:147], v[64:67], a[184:187], v[144:147]
    v_mfma_f32_16x16x32_bf16 v[148:151], v[64:67], a[188:191], v[148:151]
    s_waitcnt lgkmcnt(2)
    v_mfma_f32_16x16x32_bf16 v[120:123], v[68:71], a[200:203], v[120:123]
    v_mfma_f32_16x16x32_bf16 v[124:127], v[68:71], a[204:207], v[124:127]
    v_mfma_f32_16x16x32_bf16 v[128:131], v[68:71], a[208:211], v[128:131]
    v_mfma_f32_16x16x32_bf16 v[132:135], v[68:71], a[212:215], v[132:135]
    v_mfma_f32_16x16x32_bf16 v[136:139], v[68:71], a[216:219], v[136:139]
    v_mfma_f32_16x16x32_bf16 v[140:143], v[68:71], a[220:223], v[140:143]
    v_mfma_f32_16x16x32_bf16 v[144:147], v[68:71], a[224:227], v[144:147]
    v_mfma_f32_16x16x32_bf16 v[148:151], v[68:71], a[228:231], v[148:151]
    s_waitcnt lgkmcnt(1)
    v_mfma_f32_16x16x32_bf16 v[120:123], v[72:75], a[240:243], v[120:123]
    v_mfma_f32_16x16x32_bf16 v[124:127], v[72:75], a[244:247], v[124:127]
    v_mfma_f32_16x16x32_bf16 v[128:131], v[72:75], a[248:251], v[128:131]
    v_mfma_f32_16x16x32_bf16 v[132:135], v[72:75], a[252:255], v[132:135]
    v_mfma_f32_16x16x32_bf16 v[136:139], v[72:75], v[192:195], v[136:139]
    v_mfma_f32_16x16x32_bf16 v[140:143], v[72:75], v[196:199], v[140:143]
    v_mfma_f32_16x16x32_bf16 v[144:147], v[72:75], v[200:203], v[144:147]
    v_mfma_f32_16x16x32_bf16 v[148:151], v[72:75], v[204:207], v[148:151]
    s_waitcnt lgkmcnt(0)
    v_mfma_f32_16x16x32_bf16 v[120:123], v[76:79], v[216:219], v[120:123]
    v_mfma_f32_16x16x32_bf16 v[124:127], v[76:79], v[220:223], v[124:127]
    v_mfma_f32_16x16x32_bf16 v[128:131], v[76:79], v[224:227], v[128:131]
    v_mfma_f32_16x16x32_bf16 v[132:135], v[76:79], v[228:231], v[132:135]
    s_nop 0
    v_mfma_f32_16x16x32_bf16 v[136:139], v[76:79], v[232:235], v[136:139]
    v_mfma_f32_16x16x32_bf16 v[140:143], v[76:79], v[236:239], v[140:143]
    s_nop 0
    v_mfma_f32_16x16x32_bf16 v[144:147], v[76:79], v[240:243], v[144:147]
    v_mfma_f32_16x16x32_bf16 v[148:151], v[76:79], v[244:247], v[148:151]
    s_nop 1
    v_mfma_f32_16x16x32_bf16 v[152:155], v[48:51], a[32:35], 0
    v_mfma_f32_16x16x32_bf16 v[156:159], v[48:51], a[36:39], 0
    v_cvt_pk_bf16_f32 v160, v120, v124
    v_cvt_pk_bf16_f32 v161, v128, v132
    v_mfma_f32_16x16x32_bf16 v[152:155], v[52:55], a[72:75], v[152:155]
    v_cvt_pk_bf16_f32 v162, v136, v140
    v_cvt_pk_bf16_f32 v163, v144, v148
    v_mfma_f32_16x16x32_bf16 v[156:159], v[52:55], a[76:79], v[156:159]
    s_add_u32 s18, s21, 1048576
    buffer_store_dwordx4 v[160:163], v4, s[4:7], s18 offen sc1
    v_cvt_pk_bf16_f32 v166, v121, v125
    v_mfma_f32_16x16x32_bf16 v[152:155], v[56:59], a[112:115], v[152:155]
    v_cvt_pk_bf16_f32 v167, v129, v133
    v_cvt_pk_bf16_f32 v168, v137, v141
    v_mfma_f32_16x16x32_bf16 v[156:159], v[56:59], a[116:119], v[156:159]
    v_cvt_pk_bf16_f32 v169, v145, v149
    s_add_u32 s18, s21, 1114112
    buffer_store_dwordx4 v[166:169], v4, s[4:7], s18 offen sc1
    v_mfma_f32_16x16x32_bf16 v[152:155], v[60:63], a[152:155], v[152:155]
    v_cvt_pk_bf16_f32 v172, v122, v126
    v_cvt_pk_bf16_f32 v173, v130, v134
    v_mfma_f32_16x16x32_bf16 v[156:159], v[60:63], a[156:159], v[156:159]
    v_cvt_pk_bf16_f32 v174, v138, v142
    v_cvt_pk_bf16_f32 v175, v146, v150
    v_mfma_f32_16x16x32_bf16 v[152:155], v[64:67], a[192:195], v[152:155]
    s_add_u32 s18, s21, 1179648
    buffer_store_dwordx4 v[172:175], v4, s[4:7], s18 offen sc1
    v_cvt_pk_bf16_f32 v178, v123, v127
    v_mfma_f32_16x16x32_bf16 v[156:159], v[64:67], a[196:199], v[156:159]
    v_cvt_pk_bf16_f32 v179, v131, v135
    v_cvt_pk_bf16_f32 v180, v139, v143
    v_mfma_f32_16x16x32_bf16 v[152:155], v[68:71], a[232:235], v[152:155]
    v_cvt_pk_bf16_f32 v181, v147, v151
    s_add_u32 s18, s21, 1245184
    buffer_store_dwordx4 v[178:181], v4, s[4:7], s18 offen sc1
    v_mfma_f32_16x16x32_bf16 v[156:159], v[68:71], a[236:239], v[156:159]
    v_mfma_f32_16x16x32_bf16 v[152:155], v[72:75], v[208:211], v[152:155]
    v_mfma_f32_16x16x32_bf16 v[156:159], v[72:75], v[212:215], v[156:159]
    v_mfma_f32_16x16x32_bf16 v[152:155], v[76:79], v[248:251], v[152:155]
    v_mfma_f32_16x16x32_bf16 v[156:159], v[76:79], v[252:255], v[156:159]
    s_nop 3
    v_mov_b32 v3, v3
    s_nop 2
    v_cvt_pk_bf16_f32 v164, v152, v156
    v_cvt_pk_bf16_f32 v170, v153, v157
    v_cvt_pk_bf16_f32 v176, v154, v158
    v_cvt_pk_bf16_f32 v182, v155, v159
    s_add_u32 s18, s21, 1048576
    buffer_store_dword v164, v5, s[4:7], s18 offen offset:256 sc1
    s_add_u32 s18, s21, 1114112
    buffer_store_dword v170, v5, s[4:7], s18 offen offset:256 sc1
    s_add_u32 s18, s21, 1179648
    buffer_store_dword v176, v5, s[4:7], s18 offen offset:256 sc1
    s_add_u32 s18, s21, 1245184
    buffer_store_dword v182, v5, s[4:7], s18 offen offset:256 sc1
    s_waitcnt vmcnt(0)
    buffer_store_dword v46, off, s[4:7], s52 offset:0 sc1
    v_mov_b32 v45, 0
Lpf51:
    buffer_load_dword v45, v2, s[4:7], s23 offen offset:0 sc1
    s_waitcnt vmcnt(1)
    v_cmp_gt_u32 vcc, s17, v45
    s_cbranch_vccz Lpf51d
    s_sub_u32 s15, s15, 1
    s_cbranch_scc0 Lpf51
    s_mov_b32 s15, 0
Lpf51d:
    s_add_u32 s18, s22, 0
    buffer_load_dwordx4 v[48:51], v6, s[4:7], s18 offen offset:0 sc1
    buffer_load_dwordx4 v[52:55], v6, s[4:7], s18 offen offset:256 sc1
    buffer_load_dwordx4 v[56:59], v6, s[4:7], s18 offen offset:512 sc1
    buffer_load_dwordx4 v[60:63], v6, s[4:7], s18 offen offset:768 sc1
    buffer_load_dwordx4 v[64:67], v6, s[4:7], s18 offen offset:1024 sc1
    s_add_u32 s18, s22, 16384
    buffer_load_dwordx4 v[68:71], v7, s[4:7], s18 offen offset:0 sc1
    buffer_load_dwordx4 v[72:75], v7, s[4:7], s18 offen offset:256 sc1
    buffer_load_dwordx4 v[76:79], v7, s[4:7], s18 offen offset:512 sc1
    buffer_load_dwordx4 v[80:83], v7, s[4:7], s18 offen offset:768 sc1
    buffer_load_dwordx4 v[84:87], v7, s[4:7], s18 offen offset:1024 sc1
    buffer_load_dword v148, v2, s[4:7], s23 offen offset:1536 sc1
    v_and_b32 v109, 0xffff0000, v35
    v_lshlrev_b32 v108, 16, v35
    v_and_b32 v119, 0xffff0000, v20
    v_lshlrev_b32 v118, 16, v20
    v_and_b32 v129, 0xffff0000, v25
    v_lshlrev_b32 v128, 16, v25
    v_and_b32 v139, 0xffff0000, v30
    v_lshlrev_b32 v138, 16, v30
    v_and_b32 v111, 0xffff0000, v36
    v_lshlrev_b32 v110, 16, v36
    v_and_b32 v121, 0xffff0000, v21
    v_lshlrev_b32 v120, 16, v21
    v_and_b32 v131, 0xffff0000, v26
    v_lshlrev_b32 v130, 16, v26
    v_and_b32 v141, 0xffff0000, v31
    v_lshlrev_b32 v140, 16, v31
    v_and_b32 v113, 0xffff0000, v37
    v_lshlrev_b32 v112, 16, v37
    v_and_b32 v123, 0xffff0000, v22
    v_lshlrev_b32 v122, 16, v22
    v_and_b32 v133, 0xffff0000, v27
    v_lshlrev_b32 v132, 16, v27
    v_and_b32 v143, 0xffff0000, v32
    v_lshlrev_b32 v142, 16, v32
    v_and_b32 v115, 0xffff0000, v38
    v_lshlrev_b32 v114, 16, v38
    v_and_b32 v125, 0xffff0000, v23
    v_lshlrev_b32 v124, 16, v23
    v_and_b32 v135, 0xffff0000, v28
    v_lshlrev_b32 v134, 16, v28
    v_and_b32 v145, 0xffff0000, v33
    v_lshlrev_b32 v144, 16, v33
    v_and_b32 v117, 0xffff0000, v39
    v_lshlrev_b32 v116, 16, v39
    v_and_b32 v127, 0xffff0000, v24
    v_lshlrev_b32 v126, 16, v24
    v_and_b32 v137, 0xffff0000, v29
    v_lshlrev_b32 v136, 16, v29
    v_and_b32 v147, 0xffff0000, v34
    v_lshlrev_b32 v146, 16, v34
    s_mul_i32 s20, s51, 1280
    s_add_u32 s20, s20, s28
    s_add_u32 s20, s20, 65536
    s_mul_i32 s31, s51, 1296
    s_add_u32 s31, s31, s28
    s_max_u32 s19, s17, 2
    s_sub_u32 s19, s19, 2
    s_waitcnt vmcnt(10)
    v_mfma_f32_16x16x32_bf16 v[88:91], v[16:19], v[48:51], 0
    s_waitcnt vmcnt(9)
    v_mfma_f32_16x16x32_bf16 v[92:95], v[16:19], v[52:55], 0
    s_waitcnt vmcnt(8)
    v_mfma_f32_16x16x32_bf16 v[96:99], v[16:19], v[56:59], 0
    s_waitcnt vmcnt(7)
    v_mfma_f32_16x16x32_bf16 v[100:103], v[16:19], v[60:63], 0
    s_waitcnt vmcnt(6)
    v_mfma_f32_16x16x32_bf16 v[104:107], v[16:19], v[64:67], 0
    s_waitcnt vmcnt(5)
    v_mfma_f32_16x16x32_bf16 v[88:91], v[16:19], v[68:71], v[88:91]
    s_waitcnt vmcnt(4)
    v_mfma_f32_16x16x32_bf16 v[92:95], v[16:19], v[72:75], v[92:95]
    s_waitcnt vmcnt(3)
    v_mfma_f32_16x16x32_bf16 v[96:99], v[16:19], v[76:79], v[96:99]
    s_nop 0
    s_waitcnt vmcnt(2)
    v_mfma_f32_16x16x32_bf16 v[100:103], v[16:19], v[80:83], v[100:103]
    s_nop 1
    s_waitcnt vmcnt(1)
    v_mfma_f32_16x16x32_bf16 v[104:107], v[16:19], v[84:87], v[104:107]
    s_mov_b32 exec_hi, 0
    ds_write_b128 v8, v[88:91] offset:16384
    ds_write_b128 v8, v[92:95] offset:16896
    ds_write_b128 v8, v[96:99] offset:17408
    ds_write_b128 v8, v[100:103] offset:17920
    s_nop 2
    ds_write_b128 v8, v[104:107] offset:18432
    s_mov_b64 exec, -1
    s_waitcnt lgkmcnt(0)
    s_barrier
    s_cmp_lg_u32 s26, 0
    s_cbranch_scc1 Lp552
    ds_read_b64 v[48:49], v9 offset:16384
    ds_read_b64 v[58:59], v9 offset:18944
    ds_read_b64 v[50:51], v9 offset:16896
    ds_read_b64 v[60:61], v9 offset:19456
    ds_read_b64 v[52:53], v9 offset:17408
    ds_read_b64 v[62:63], v9 offset:19968
    ds_read_b64 v[54:55], v9 offset:17920
    ds_read_b64 v[64:65], v9 offset:20480
    ds_read_b64 v[56:57], v9 offset:18432
    ds_read_b64 v[66:67], v9 offset:20992
    s_waitcnt vmcnt(0)
    v_cmp_gt_u32 vcc, s19, v148
    s_cbranch_vccz Lokd53
Lwf54:
    buffer_load_dword v148, v2, s[4:7], s23 offen offset:1536 sc1
    s_waitcnt vmcnt(0)
    v_cmp_gt_u32 vcc, s19, v148
    s_cbranch_vccz Lwf54d
    s_sub_u32 s15, s15, 1
    s_cbranch_scc0 Lwf54
    s_mov_b32 s15, 0
Lwf54d:
Lokd53:
    s_waitcnt lgkmcnt(8)
    v_add_f32 v48, v48, v58
    v_add_f32 v49, v49, v59
    s_waitcnt lgkmcnt(6)
    v_add_f32 v50, v50, v60
    v_add_f32 v51, v51, v61
    s_waitcnt lgkmcnt(4)
    v_add_f32 v52, v52, v62
    v_add_f32 v53, v53, v63
    s_waitcnt lgkmcnt(2)
    v_add_f32 v54, v54, v64
    v_add_f32 v55, v55, v65
    s_waitcnt lgkmcnt(0)
    v_add_f32 v56, v56, v66
    v_add_f32 v57, v57, v67
    v_fmac_f32 v108, v118, v48
    v_fmac_f32 v109, v119, v49
    v_cvt_pk_bf16_f32 v35, v108, v109
    v_and_b32 v109, 0xffff0000, v35
    v_lshlrev_b32 v108, 16, v35
    v_fmac_f32 v110, v120, v50
    v_fmac_f32 v111, v121, v51
    v_cvt_pk_bf16_f32 v36, v110, v111
    v_and_b32 v111, 0xffff0000, v36
    v_lshlrev_b32 v110, 16, v36
    v_fmac_f32 v112, v122, v52
    v_fmac_f32 v113, v123, v53
    v_cvt_pk_bf16_f32 v37, v112, v113
    v_and_b32 v113, 0xffff0000, v37
    v_lshlrev_b32 v112, 16, v37
    v_fmac_f32 v114, v124, v54
    v_fmac_f32 v115, v125, v55
    v_cvt_pk_bf16_f32 v38, v114, v115
    v_and_b32 v115, 0xffff0000, v38
    v_lshlrev_b32 v114, 16, v38
    v_fmac_f32 v116, v126, v56
    v_fmac_f32 v117, v127, v57
    v_cvt_pk_bf16_f32 v39, v116, v117
    v_and_b32 v117, 0xffff0000, v39
    v_lshlrev_b32 v116, 16, v39
    v_add_f32 v69, v108, v109
    v_mul_f32 v70, v108, v108
    v_fmac_f32 v70, v109, v109
    v_add_f32 v69, v69, v110
    v_fmac_f32 v70, v110, v110
    v_add_f32 v69, v69, v111
    v_fmac_f32 v70, v111, v111
    v_add_f32 v69, v69, v112
    v_fmac_f32 v70, v112, v112
    v_add_f32 v69, v69, v113
    v_fmac_f32 v70, v113, v113
    v_add_f32 v69, v69, v114
    v_fmac_f32 v70, v114, v114
    v_add_f32 v69, v69, v115
    v_fmac_f32 v70, v115, v115
    v_add_f32 v69, v69, v116
    v_fmac_f32 v70, v116, v116
    v_add_f32 v69, v69, v117
    v_fmac_f32 v70, v117, v117
    s_nop 0
    v_add_f32_dpp v69, v69, v69 row_ror:1 row_mask:0xf bank_mask:0xf
    v_add_f32_dpp v70, v70, v70 row_ror:1 row_mask:0xf bank_mask:0xf
    s_nop 0
    v_add_f32_dpp v69, v69, v69 row_ror:2 row_mask:0xf bank_mask:0xf
    v_add_f32_dpp v70, v70, v70 row_ror:2 row_mask:0xf bank_mask:0xf
    s_nop 0
    v_add_f32_dpp v69, v69, v69 row_ror:4 row_mask:0xf bank_mask:0xf
    v_add_f32_dpp v70, v70, v70 row_ror:4 row_mask:0xf bank_mask:0xf
    s_nop 0
    v_add_f32_dpp v69, v69, v69 row_ror:8 row_mask:0xf bank_mask:0xf
    v_add_f32_dpp v70, v70, v70 row_ror:8 row_mask:0xf bank_mask:0xf
    s_nop 1
    v_permlane16_swap_b32 v69, v70
    v_add_f32 v69, v69, v70
    v_mov_b32 v70, v69
    s_nop 1
    v_permlane32_swap_b32 v69, v70
    v_add_f32 v69, v69, v70
    v_mul_f32 v69, 986500301, v69
    v_mov_b32 v70, v69
    s_nop 1
    v_permlane16_swap_b32 v69, v70
    v_fma_f32 v70, -v69, v69, v70
    v_max_f32 v70, 0, v70
    v_add_f32 v70, 925353388, v70
    v_rsq_f32 v68, v70
    s_nop 0
    v_mul_f32_e64 v69, -v69, v68
    v_fma_f32 v108, v108, v68, v69
    v_fmac_f32 v128, v108, v138
    v_fma_f32 v109, v109, v68, v69
    v_fmac_f32 v129, v109, v139
    v_fma_f32 v110, v110, v68, v69
    v_fmac_f32 v130, v110, v140
    v_fma_f32 v111, v111, v68, v69
    v_fmac_f32 v131, v111, v141
    v_fma_f32 v112, v112, v68, v69
    v_fmac_f32 v132, v112, v142
    v_fma_f32 v113, v113, v68, v69
    v_fmac_f32 v133, v113, v143
    v_fma_f32 v114, v114, v68, v69
    v_fmac_f32 v134, v114, v144
    v_fma_f32 v115, v115, v68, v69
    v_fmac_f32 v135, v115, v145
    v_fma_f32 v116, v116, v68, v69
    v_fmac_f32 v136, v116, v146
    v_fma_f32 v117, v117, v68, v69
    v_fmac_f32 v137, v117, v147
    v_add_f32 v69, v128, v129
    v_mul_f32 v70, v128, v128
    v_fmac_f32 v70, v129, v129
    v_add_f32 v69, v69, v130
    v_fmac_f32 v70, v130, v130
    v_add_f32 v69, v69, v131
    v_fmac_f32 v70, v131, v131
    v_add_f32 v69, v69, v132
    v_fmac_f32 v70, v132, v132
    v_add_f32 v69, v69, v133
    v_fmac_f32 v70, v133, v133
    v_add_f32 v69, v69, v134
    v_fmac_f32 v70, v134, v134
    v_add_f32 v69, v69, v135
    v_fmac_f32 v70, v135, v135
    v_add_f32 v69, v69, v136
    v_fmac_f32 v70, v136, v136
    v_add_f32 v69, v69, v137
    v_fmac_f32 v70, v137, v137
    s_nop 0
    v_add_f32_dpp v69, v69, v69 row_ror:1 row_mask:0xf bank_mask:0xf
    v_add_f32_dpp v70, v70, v70 row_ror:1 row_mask:0xf bank_mask:0xf
    s_nop 0
    v_add_f32_dpp v69, v69, v69 row_ror:2 row_mask:0xf bank_mask:0xf
    v_add_f32_dpp v70, v70, v70 row_ror:2 row_mask:0xf bank_mask:0xf
    s_nop 0
    v_add_f32_dpp v69, v69, v69 row_ror:4 row_mask:0xf bank_mask:0xf
    v_add_f32_dpp v70, v70, v70 row_ror:4 row_mask:0xf bank_mask:0xf
    s_nop 0
    v_add_f32_dpp v69, v69, v69 row_ror:8 row_mask:0xf bank_mask:0xf
    v_add_f32_dpp v70, v70, v70 row_ror:8 row_mask:0xf bank_mask:0xf
    s_nop 1
    v_permlane16_swap_b32 v69, v70
    v_add_f32 v69, v69, v70
    v_mov_b32 v70, v69
    s_nop 1
    v_permlane32_swap_b32 v69, v70
    v_add_f32 v69, v69, v70
    v_mul_f32 v69, 986500301, v69
    v_mov_b32 v70, v69
    s_nop 1
    v_permlane16_swap_b32 v69, v70
    v_fma_f32 v70, -v69, v69, v70
    v_max_f32 v70, 0, v70
    v_add_f32 v70, 925353388, v70
    v_rsq_f32 v68, v70
    s_nop 0
    v_mul_f32_e64 v69, -v69, v68
    v_fma_f32 v128, v128, v68, v69
    v_fma_f32 v129, v129, v68, v69
    v_cvt_pk_bf16_f32 v48, v128, v129
    buffer_store_dword v48, v2, s[4:7], s31 offen offset:0 sc1
    v_fma_f32 v130, v130, v68, v69
    v_fma_f32 v131, v131, v68, v69
    v_cvt_pk_bf16_f32 v49, v130, v131
    buffer_store_dword v49, v2, s[4:7], s31 offen offset:256 sc1
    v_fma_f32 v132, v132, v68, v69
    v_fma_f32 v133, v133, v68, v69
    v_cvt_pk_bf16_f32 v50, v132, v133
    buffer_store_dword v50, v2, s[4:7], s31 offen offset:512 sc1
    v_fma_f32 v134, v134, v68, v69
    v_fma_f32 v135, v135, v68, v69
    v_cvt_pk_bf16_f32 v51, v134, v135
    buffer_store_dword v51, v2, s[4:7], s31 offen offset:768 sc1
    v_fma_f32 v136, v136, v68, v69
    v_fma_f32 v137, v137, v68, v69
    v_cvt_pk_bf16_f32 v52, v136, v137
    buffer_store_dword v52, v2, s[4:7], s31 offen offset:1024 sc1
    buffer_store_dword v35, v2, s[4:7], s20 offen offset:0 sc1
    buffer_store_dword v36, v2, s[4:7], s20 offen offset:256 sc1
    buffer_store_dword v37, v2, s[4:7], s20 offen offset:512 sc1
    buffer_store_dword v38, v2, s[4:7], s20 offen offset:768 sc1
    buffer_store_dword v39, v2, s[4:7], s20 offen offset:1024 sc1
    s_lshl_b32 s18, s51, 2
    s_add_u32 s18, s18, s23
    s_waitcnt vmcnt(0)
    buffer_store_dword v46, off, s[4:7], s18 offset:512 sc1
Lp552:
    s_add_u32 s17, s17, 1
    s_xor_b32 s28, s28, 0x20000
    s_cmp_lt_u32 s16, 64
    s_cbranch_scc1 Lunit35
    s_waitcnt vmcnt(0) lgkmcnt(0)
    s_endpgm
Lst232:
    s_waitcnt vmcnt(0) lgkmcnt(0)
    s_nop 11
    s_and_b32 s50, s12, 15
    s_and_b32 s26, s13, 1
    s_lshr_b32 s27, s13, 1
    s_lshl_b32 s51, s50, 1
    s_add_u32 s51, s51, s27
    v_and_b32 v48, 15, v0
    v_lshrrev_b32 v49, 4, v0
    v_lshlrev_b32 v1, 4, v0
    v_lshlrev_b32 v2, 2, v0
    v_lshlrev_b32 v3, 3, v0
    v_mul_u32_u24 v50, 262144, v49
    v_lshl_add_u32 v4, v48, 4, v50
    v_lshl_add_u32 v5, v48, 2, v50
    v_mul_u32_u24 v50, 1280, v49
    v_lshl_add_u32 v6, v48, 4, v50
    v_lshlrev_b32 v50, 4, v49
    v_lshl_add_u32 v8, v48, 5, v50
    s_mul_i32 s18, s13, 2560
    v_add_u32 v8, s18, v8
    v_add_u32 v9, s18, v3
    s_mov_b32 s48, 0x05040100
    s_mov_b32 s49, 0x07060302
    s_sub_u32 s16, s3, 4
    s_mul_i32 s21, s16, 4194304
    s_add_u32 s21, s21, 102768640
    s_xor_b32 s21, s21, s55
    s_lshl_b32 s28, s16, 18
    s_add_u32 s28, s28, 92274688
    s_mul_i32 s18, s51, 65536
    s_lshl_b32 s19, s26, 15
    s_add_u32 s22, s21, s18
    s_add_u32 s22, s22, s19
    s_lshr_b32 s18, s50, 2
    s_lshl_b32 s18, s18, 14
    s_add_u32 s21, s21, s18
    s_and_b32 s18, s50, 3
    s_mul_i32 s18, s18, 1280
    s_mul_i32 s19, s13, 320
    s_add_u32 s21, s21, s18
    s_add_u32 s21, s21, s19
    s_lshl_b32 s23, s16, 11
    s_add_u32 s23, s23, 8192
    s_mov_b32 s17, 1
    s_lshl_b32 s52, s50, 2
    s_add_u32 s52, s52, s13
    s_lshl_b32 s52, s52, 2
    s_add_u32 s52, s52, s23
    v_mul_u32_u24 v50, 1296, v48
    v_lshl_add_u32 v10, v49, 4, v50
    s_lshl_b32 s18, s13, 10
    v_add_u32 v11, s18, v1
    s_lshl_b32 s18, s26, 3
    v_add_u32 v50, s18, v49
    v_cmp_gt_u32 vcc, 10, v50
    v_mov_b32 v51, 268435456
    s_nop 0
    v_cndmask_b32 v7, v51, v6, vcc
    v_mov_b32 v16, 0
    v_mov_b32 v50, 0x3f80
    v_cmp_eq_u32 vcc, 0, v48
    s_nop 1
    v_cndmask_b32 v16, v16, v50, vcc
    v_mov_b32 v50, 1.0
    v_cmp_eq_u32 vcc, 1, v48
    s_nop 1
    v_cndmask_b32 v16, v16, v50, vcc
    v_mov_b32 v17, 0
    v_mov_b32 v50, 0x3f80
    v_cmp_eq_u32 vcc, 2, v48
    s_nop 1
    v_cndmask_b32 v17, v17, v50, vcc
    v_mov_b32 v50, 1.0
    v_cmp_eq_u32 vcc, 3, v48
    s_nop 1
    v_cndmask_b32 v17, v17, v50, vcc
    v_mov_b32 v18, 0
    v_mov_b32 v50, 0x3f80
    v_cmp_eq_u32 vcc, 4, v48
    s_nop 1
    v_cndmask_b32 v18, v18, v50, vcc
    v_mov_b32 v50, 1.0
    v_cmp_eq_u32 vcc, 5, v48
    s_nop 1
    v_cndmask_b32 v18, v18, v50, vcc
    v_mov_b32 v19, 0
    v_mov_b32 v50, 0x3f80
    v_cmp_eq_u32 vcc, 6, v48
    s_nop 1
    v_cndmask_b32 v19, v19, v50, vcc
    v_mov_b32 v50, 1.0
    v_cmp_eq_u32 vcc, 7, v48
    s_nop 1
    v_cndmask_b32 v19, v19, v50, vcc
    s_cmp_ge_u32 s50, 14
    s_cbranch_scc1 Lnow55
    s_load_dwordx2 s[8:9], s[0:1], 64
    s_waitcnt lgkmcnt(0)
    s_mov_b32 s10, 2211840
    s_mov_b32 s11, 0x20000
    v_lshrrev_b32 v48, 2, v0
    v_mul_u32_u24 v48, 3456, v48
    v_and_b32 v49, 3, v0
    v_lshl_add_u32 v48, v49, 4, v48
    s_lshl_b32 s19, s50, 8
    s_lshl_b32 s18, s13, 6
    s_add_u32 s19, s19, s18
    v_add_u32 v48, s19, v48
    s_mul_i32 s20, s13, 40960
    s_mov_b32 m0, s20
    s_nop 0
    buffer_load_dwordx4 v48, s[8:11], 0 offen lds
    v_add_u32 v48, 55296, v48
    s_add_u32 m0, m0, 1024
    s_nop 0
    buffer_load_dwordx4 v48, s[8:11], 0 offen lds
    v_add_u32 v48, 55296, v48
    s_add_u32 m0, m0, 1024
    s_nop 0
    buffer_load_dwordx4 v48, s[8:11], 0 offen lds
    v_add_u32 v48, 55296, v48
    s_add_u32 m0, m0, 1024
    s_nop 0
    buffer_load_dwordx4 v48, s[8:11], 0 offen lds
    v_add_u32 v48, 55296, v48
    s_add_u32 m0, m0, 1024
    s_nop 0
    buffer_load_dwordx4 v48, s[8:11], 0 offen lds
    v_add_u32 v48, 55296, v48
    s_add_u32 m0, m0, 1024
    s_nop 0
    buffer_load_dwordx4 v48, s[8:11], 0 offen lds
    v_add_u32 v48, 55296, v48
    s_add_u32 m0, m0, 1024
    s_nop 0
    buffer_load_dwordx4 v48, s[8:11], 0 offen lds
    v_add_u32 v48, 55296, v48
    s_add_u32 m0, m0, 1024
    s_nop 0
    buffer_load_dwordx4 v48, s[8:11], 0 offen lds
    v_add_u32 v48, 55296, v48
    s_add_u32 m0, m0, 1024
    s_nop 0
    buffer_load_dwordx4 v48, s[8:11], 0 offen lds
    v_add_u32 v48, 55296, v48
    s_add_u32 m0, m0, 1024
    s_nop 0
    buffer_load_dwordx4 v48, s[8:11], 0 offen lds
    v_add_u32 v48, 55296, v48
    s_add_u32 m0, m0, 1024
    s_nop 0
    buffer_load_dwordx4 v48, s[8:11], 0 offen lds
    v_add_u32 v48, 55296, v48
    s_add_u32 m0, m0, 1024
    s_nop 0
    buffer_load_dwordx4 v48, s[8:11], 0 offen lds
    v_add_u32 v48, 55296, v48
    s_add_u32 m0, m0, 1024
    s_nop 0
    buffer_load_dwordx4 v48, s[8:11], 0 offen lds
    v_add_u32 v48, 55296, v48
    s_add_u32 m0, m0, 1024
    s_nop 0
    buffer_load_dwordx4 v48, s[8:11], 0 offen lds
    v_add_u32 v48, 55296, v48
    s_add_u32 m0, m0, 1024
    s_nop 0
    buffer_load_dwordx4 v48, s[8:11], 0 offen lds
    v_add_u32 v48, 55296, v48
    s_add_u32 m0, m0, 1024
    s_nop 0
    buffer_load_dwordx4 v48, s[8:11], 0 offen lds
    v_add_u32 v48, 55296, v48
    s_add_u32 m0, m0, 1024
    s_nop 0
    buffer_load_dwordx4 v48, s[8:11], 0 offen lds
    v_add_u32 v48, 55296, v48
    s_add_u32 m0, m0, 1024
    s_nop 0
    buffer_load_dwordx4 v48, s[8:11], 0 offen lds
    v_add_u32 v48, 55296, v48
    s_add_u32 m0, m0, 1024
    s_nop 0
    buffer_load_dwordx4 v48, s[8:11], 0 offen lds
    v_add_u32 v48, 55296, v48
    s_add_u32 m0, m0, 1024
    s_nop 0
    buffer_load_dwordx4 v48, s[8:11], 0 offen lds
    v_add_u32 v48, 55296, v48
    s_add_u32 m0, m0, 1024
    s_nop 0
    buffer_load_dwordx4 v48, s[8:11], 0 offen lds
    v_add_u32 v48, 55296, v48
    s_add_u32 m0, m0, 1024
    s_nop 0
    buffer_load_dwordx4 v48, s[8:11], 0 offen lds
    v_add_u32 v48, 55296, v48
    s_add_u32 m0, m0, 1024
    s_nop 0
    buffer_load_dwordx4 v48, s[8:11], 0 offen lds
    v_add_u32 v48, 55296, v48
    s_add_u32 m0, m0, 1024
    s_nop 0
    buffer_load_dwordx4 v48, s[8:11], 0 offen lds
    v_add_u32 v48, 55296, v48
    s_add_u32 m0, m0, 1024
    s_nop 0
    buffer_load_dwordx4 v48, s[8:11], 0 offen lds
    v_add_u32 v48, 55296, v48
    s_add_u32 m0, m0, 1024
    s_nop 0
    buffer_load_dwordx4 v48, s[8:11], 0 offen lds
    v_add_u32 v48, 55296, v48
    s_add_u32 m0, m0, 1024
    s_nop 0
    buffer_load_dwordx4 v48, s[8:11], 0 offen lds
    v_add_u32 v48, 55296, v48
    s_add_u32 m0, m0, 1024
    s_nop 0
    buffer_load_dwordx4 v48, s[8:11], 0 offen lds
    v_add_u32 v48, 55296, v48
    s_add_u32 m0, m0, 1024
    s_nop 0
    buffer_load_dwordx4 v48, s[8:11], 0 offen lds
    v_add_u32 v48, 55296, v48
    s_add_u32 m0, m0, 1024
    s_nop 0
    buffer_load_dwordx4 v48, s[8:11], 0 offen lds
    v_add_u32 v48, 55296, v48
    s_add_u32 m0, m0, 1024
    s_nop 0
    buffer_load_dwordx4 v48, s[8:11], 0 offen lds
    v_add_u32 v48, 55296, v48
    s_add_u32 m0, m0, 1024
    s_nop 0
    buffer_load_dwordx4 v48, s[8:11], 0 offen lds
    v_add_u32 v48, 55296, v48
    s_add_u32 m0, m0, 1024
    s_nop 0
    buffer_load_dwordx4 v48, s[8:11], 0 offen lds
    v_add_u32 v48, 55296, v48
    s_add_u32 m0, m0, 1024
    s_nop 0
    buffer_load_dwordx4 v48, s[8:11], 0 offen lds
    v_add_u32 v48, 55296, v48
    s_add_u32 m0, m0, 1024
    s_nop 0
    buffer_load_dwordx4 v48, s[8:11], 0 offen lds
    v_add_u32 v48, 55296, v48
    s_add_u32 m0, m0, 1024
    s_nop 0
    buffer_load_dwordx4 v48, s[8:11], 0 offen lds
    v_add_u32 v48, 55296, v48
    s_add_u32 m0, m0, 1024
    s_nop 0
    buffer_load_dwordx4 v48, s[8:11], 0 offen lds
    v_add_u32 v48, 55296, v48
    s_add_u32 m0, m0, 1024
    s_nop 0
    buffer_load_dwordx4 v48, s[8:11], 0 offen lds
    v_add_u32 v48, 55296, v48
    s_add_u32 m0, m0, 1024
    s_nop 0
    buffer_load_dwordx4 v48, s[8:11], 0 offen lds
    v_add_u32 v48, 55296, v48
    s_add_u32 m0, m0, 1024
    s_nop 0
    buffer_load_dwordx4 v48, s[8:11], 0 offen lds
    s_load_dwordx2 s[8:9], s[0:1], 72
    s_waitcnt lgkmcnt(0)
    s_mov_b32 s10, 3456
    s_mov_b32 s11, 0x20000
    v_lshrrev_b32 v49, 4, v0
    v_lshlrev_b32 v49, 3, v49
    v_add_u32 v49, s19, v49
    buffer_load_dwordx2 v[52:53], v49, s[8:11], 0 offen
    buffer_load_dwordx2 v[54:55], v49, s[8:11], 0 offen offset:32
    s_waitcnt vmcnt(1)
    v_and_b32 v33, 0xffff0000, v52
    v_lshlrev_b32 v32, 16, v52
    v_and_b32 v35, 0xffff0000, v53
    v_lshlrev_b32 v34, 16, v53
    s_waitcnt vmcnt(0)
    v_and_b32 v37, 0xffff0000, v54
    v_lshlrev_b32 v36, 16, v54
    v_and_b32 v39, 0xffff0000, v55
    v_lshlrev_b32 v38, 16, v55
    v_lshrrev_b32 v48, 4, v0
    v_bfe_u32 v49, v0, 2, 2
    v_lshl_add_u32 v48, v48, 3, v49
    v_lshlrev_b32 v48, 6, v48
    v_and_b32 v49, 3, v0
    v_lshl_add_u32 v48, v49, 3, v48
    v_add_u32 v48, s20, v48
    ds_read_b64_tr_b16 a[160:161], v48 offset:0
    ds_read_b64_tr_b16 a[162:163], v48 offset:256
    ds_read_b64_tr_b16 a[164:165], v48 offset:32
    ds_read_b64_tr_b16 a[166:167], v48 offset:288
    ds_read_b64_tr_b16 a[168:169], v48 offset:2048
    ds_read_b64_tr_b16 a[170:171], v48 offset:2304
    ds_read_b64_tr_b16 a[172:173], v48 offset:2080
    ds_read_b64_tr_b16 a[174:175], v48 offset:2336
    ds_read_b64_tr_b16 a[176:177], v48 offset:4096
    ds_read_b64_tr_b16 a[178:179], v48 offset:4352
    ds_read_b64_tr_b16 a[180:181], v48 offset:4128
    ds_read_b64_tr_b16 a[182:183], v48 offset:4384
    ds_read_b64_tr_b16 a[184:185], v48 offset:6144
    ds_read_b64_tr_b16 a[186:187], v48 offset:6400
    ds_read_b64_tr_b16 a[188:189], v48 offset:6176
    ds_read_b64_tr_b16 a[190:191], v48 offset:6432
    ds_read_b64_tr_b16 a[192:193], v48 offset:8192
    ds_read_b64_tr_b16 a[194:195], v48 offset:8448
    ds_read_b64_tr_b16 a[196:197], v48 offset:8224
    ds_read_b64_tr_b16 a[198:199], v48 offset:8480
    ds_read_b64_tr_b16 a[200:201], v48 offset:10240
    ds_read_b64_tr_b16 a[202:203], v48 offset:10496
    ds_read_b64_tr_b16 a[204:205], v48 offset:10272
    ds_read_b64_tr_b16 a[206:207], v48 offset:10528
    ds_read_b64_tr_b16 a[208:209], v48 offset:12288
    ds_read_b64_tr_b16 a[210:211], v48 offset:12544
    ds_read_b64_tr_b16 a[212:213], v48 offset:12320
    ds_read_b64_tr_b16 a[214:215], v48 offset:12576
    ds_read_b64_tr_b16 a[216:217], v48 offset:14336
    ds_read_b64_tr_b16 a[218:219], v48 offset:14592
    ds_read_b64_tr_b16 a[220:221], v48 offset:14368
    ds_read_b64_tr_b16 a[222:223], v48 offset:14624
    ds_read_b64_tr_b16 a[224:225], v48 offset:16384
    ds_read_b64_tr_b16 a[226:227], v48 offset:16640
    ds_read_b64_tr_b16 a[228:229], v48 offset:16416
    ds_read_b64_tr_b16 a[230:231], v48 offset:16672
    ds_read_b64_tr_b16 a[232:233], v48 offset:18432
    ds_read_b64_tr_b16 a[234:235], v48 offset:18688
    ds_read_b64_tr_b16 a[236:237], v48 offset:18464
    ds_read_b64_tr_b16 a[238:239], v48 offset:18720
    ds_read_b64_tr_b16 a[240:241], v48 offset:20480
    ds_read_b64_tr_b16 a[242:243], v48 offset:20736
    ds_read_b64_tr_b16 a[244:245], v48 offset:20512
    ds_read_b64_tr_b16 a[246:247], v48 offset:20768
    ds_read_b64_tr_b16 a[248:249], v48 offset:22528
    ds_read_b64_tr_b16 a[250:251], v48 offset:22784
    ds_read_b64_tr_b16 a[252:253], v48 offset:22560
    ds_read_b64_tr_b16 a[254:255], v48 offset:22816
    ds_read_b64_tr_b16 v[192:193], v48 offset:24576
    ds_read_b64_tr_b16 v[194:195], v48 offset:24832
    ds_read_b64_tr_b16 v[196:197], v48 offset:24608
    ds_read_b64_tr_b16 v[198:199], v48 offset:24864
    ds_read_b64_tr_b16 v[200:201], v48 offset:26624
    ds_read_b64_tr_b16 v[202:203], v48 offset:26880
    ds_read_b64_tr_b16 v[204:205], v48 offset:26656
    ds_read_b64_tr_b16 v[206:207], v48 offset:26912
    ds_read_b64_tr_b16 v[208:209], v48 offset:28672
    ds_read_b64_tr_b16 v[210:211], v48 offset:28928
    ds_read_b64_tr_b16 v[212:213], v48 offset:28704
    ds_read_b64_tr_b16 v[214:215], v48 offset:28960
    ds_read_b64_tr_b16 v[216:217], v48 offset:30720
    ds_read_b64_tr_b16 v[218:219], v48 offset:30976
    ds_read_b64_tr_b16 v[220:221], v48 offset:30752
    ds_read_b64_tr_b16 v[222:223], v48 offset:31008
    ds_read_b64_tr_b16 v[224:225], v48 offset:32768
    ds_read_b64_tr_b16 v[226:227], v48 offset:33024
    ds_read_b64_tr_b16 v[228:229], v48 offset:32800
    ds_read_b64_tr_b16 v[230:231], v48 offset:33056
    ds_read_b64_tr_b16 v[232:233], v48 offset:34816
    ds_read_b64_tr_b16 v[234:235], v48 offset:35072
    ds_read_b64_tr_b16 v[236:237], v48 offset:34848
    ds_read_b64_tr_b16 v[238:239], v48 offset:35104
    ds_read_b64_tr_b16 v[240:241], v48 offset:36864
    ds_read_b64_tr_b16 v[242:243], v48 offset:37120
    ds_read_b64_tr_b16 v[244:245], v48 offset:36896
    ds_read_b64_tr_b16 v[246:247], v48 offset:37152
    ds_read_b64_tr_b16 v[248:249], v48 offset:38912
    ds_read_b64_tr_b16 v[250:251], v48 offset:39168
    ds_read_b64_tr_b16 v[252:253], v48 offset:38944
    ds_read_b64_tr_b16 v[254:255], v48 offset:39200
    s_waitcnt lgkmcnt(0)
    s_load_dwordx2 s[8:9], s[0:1], 80
    s_waitcnt lgkmcnt(0)
    s_mov_b32 s10, 2211840
    s_mov_b32 s11, 0x20000
    s_lshl_b32 s20, s50, 7
    v_lshrrev_b32 v50, 4, v0
    v_mul_u32_u24 v50, 5120, v50
    s_mul_i32 s19, s20, 1280
    s_mul_i32 s18, s13, 320
    s_add_u32 s19, s19, s18
    v_add_u32 v50, s19, v50
    v_and_b32 v49, 15, v0
    v_lshl_add_u32 v48, v49, 4, v50
    v_lshl_add_u32 v49, v49, 2, v50
    v_add_u32 v49, 256, v49
    buffer_load_dwordx4 v[56:59], v48, s[8:11], 0 offen offset:0
    buffer_load_dword v88, v49, s[8:11], 0 offen offset:0
    buffer_load_dwordx4 v[60:63], v48, s[8:11], 0 offen offset:1280
    buffer_load_dword v89, v49, s[8:11], 0 offen offset:1280
    buffer_load_dwordx4 v[64:67], v48, s[8:11], 0 offen offset:2560
    buffer_load_dword v90, v49, s[8:11], 0 offen offset:2560
    buffer_load_dwordx4 v[68:71], v48, s[8:11], 0 offen offset:3840
    buffer_load_dword v91, v49, s[8:11], 0 offen offset:3840
    v_add_u32 v48, 20480, v48
    v_add_u32 v49, 20480, v49
    buffer_load_dwordx4 v[72:75], v48, s[8:11], 0 offen offset:0
    buffer_load_dword v92, v49, s[8:11], 0 offen offset:0
    buffer_load_dwordx4 v[76:79], v48, s[8:11], 0 offen offset:1280
    buffer_load_dword v93, v49, s[8:11], 0 offen offset:1280
    buffer_load_dwordx4 v[80:83], v48, s[8:11], 0 offen offset:2560
    buffer_load_dword v94, v49, s[8:11], 0 offen offset:2560
    buffer_load_dwordx4 v[84:87], v48, s[8:11], 0 offen offset:3840
    buffer_load_dword v95, v49, s[8:11], 0 offen offset:3840
    v_add_u32 v48, 20480, v48
    v_add_u32 v49, 20480, v49
    buffer_load_dwordx4 v[96:99], v48, s[8:11], 0 offen offset:0
    buffer_load_dword v128, v49, s[8:11], 0 offen offset:0
    buffer_load_dwordx4 v[100:103], v48, s[8:11], 0 offen offset:1280
    buffer_load_dword v129, v49, s[8:11], 0 offen offset:1280
    buffer_load_dwordx4 v[104:107], v48, s[8:11], 0 offen offset:2560
    buffer_load_dword v130, v49, s[8:11], 0 offen offset:2560
    buffer_load_dwordx4 v[108:111], v48, s[8:11], 0 offen offset:3840
    buffer_load_dword v131, v49, s[8:11], 0 offen offset:3840
    v_add_u32 v48, 20480, v48
    v_add_u32 v49, 20480, v49
    buffer_load_dwordx4 v[112:115], v48, s[8:11], 0 offen offset:0
    buffer_load_dword v132, v49, s[8:11], 0 offen offset:0
    buffer_load_dwordx4 v[116:119], v48, s[8:11], 0 offen offset:1280
    buffer_load_dword v133, v49, s[8:11], 0 offen offset:1280
    buffer_load_dwordx4 v[120:123], v48, s[8:11], 0 offen offset:2560
    buffer_load_dword v134, v49, s[8:11], 0 offen offset:2560
    buffer_load_dwordx4 v[124:127], v48, s[8:11], 0 offen offset:3840
    buffer_load_dword v135, v49, s[8:11], 0 offen offset:3840
    v_add_u32 v48, 20480, v48
    v_add_u32 v49, 20480, v49
    buffer_load_dwordx4 v[136:139], v48, s[8:11], 0 offen offset:0
    buffer_load_dword v168, v49, s[8:11], 0 offen offset:0
    buffer_load_dwordx4 v[140:143], v48, s[8:11], 0 offen offset:1280
    buffer_load_dword v169, v49, s[8:11], 0 offen offset:1280
    buffer_load_dwordx4 v[144:147], v48, s[8:11], 0 offen offset:2560
    buffer_load_dword v170, v49, s[8:11], 0 offen offset:2560
    buffer_load_dwordx4 v[148:151], v48, s[8:11], 0 offen offset:3840
    buffer_load_dword v171, v49, s[8:11], 0 offen offset:3840
    v_add_u32 v48, 20480, v48
    v_add_u32 v49, 20480, v49
    buffer_load_dwordx4 v[152:155], v48, s[8:11], 0 offen offset:0
    buffer_load_dword v172, v49, s[8:11], 0 offen offset:0
    buffer_load_dwordx4 v[156:159], v48, s[8:11], 0 offen offset:1280
    buffer_load_dword v173, v49, s[8:11], 0 offen offset:1280
    buffer_load_dwordx4 v[160:163], v48, s[8:11], 0 offen offset:2560
    buffer_load_dword v174, v49, s[8:11], 0 offen offset:2560
    buffer_load_dwordx4 v[164:167], v48, s[8:11], 0 offen offset:3840
    buffer_load_dword v175, v49, s[8:11], 0 offen offset:3840
    v_add_u32 v48, 20480, v48
    v_add_u32 v49, 20480, v49
    s_waitcnt vmcnt(45)
    v_perm_b32 v50, v60, v56, s48
    v_accvgpr_write_b32 a0, v50
    s_waitcnt vmcnt(41)
    v_perm_b32 v51, v68, v64, s48
    v_accvgpr_write_b32 a1, v51
    s_waitcnt vmcnt(37)
    v_perm_b32 v50, v76, v72, s48
    v_accvgpr_write_b32 a2, v50
    s_waitcnt vmcnt(33)
    v_perm_b32 v51, v84, v80, s48
    v_accvgpr_write_b32 a3, v51
    v_perm_b32 v50, v60, v56, s49
    v_accvgpr_write_b32 a4, v50
    v_perm_b32 v51, v68, v64, s49
    v_accvgpr_write_b32 a5, v51
    v_perm_b32 v50, v76, v72, s49
    v_accvgpr_write_b32 a6, v50
    v_perm_b32 v51, v84, v80, s49
    v_accvgpr_write_b32 a7, v51
    v_perm_b32 v50, v61, v57, s48
    v_accvgpr_write_b32 a8, v50
    v_perm_b32 v51, v69, v65, s48
    v_accvgpr_write_b32 a9, v51
    v_perm_b32 v50, v77, v73, s48
    v_accvgpr_write_b32 a10, v50
    v_perm_b32 v51, v85, v81, s48
    v_accvgpr_write_b32 a11, v51
    v_perm_b32 v50, v61, v57, s49
    v_accvgpr_write_b32 a12, v50
    v_perm_b32 v51, v69, v65, s49
    v_accvgpr_write_b32 a13, v51
    v_perm_b32 v50, v77, v73, s49
    v_accvgpr_write_b32 a14, v50
    v_perm_b32 v51, v85, v81, s49
    v_accvgpr_write_b32 a15, v51
    v_perm_b32 v50, v62, v58, s48
    v_accvgpr_write_b32 a16, v50
    v_perm_b32 v51, v70, v66, s48
    v_accvgpr_write_b32 a17, v51
    v_perm_b32 v50, v78, v74, s48
    v_accvgpr_write_b32 a18, v50
    v_perm_b32 v51, v86, v82, s48
    v_accvgpr_write_b32 a19, v51
    v_perm_b32 v50, v62, v58, s49
    v_accvgpr_write_b32 a20, v50
    v_perm_b32 v51, v70, v66, s49
    v_accvgpr_write_b32 a21, v51
    v_perm_b32 v50, v78, v74, s49
    v_accvgpr_write_b32 a22, v50
    v_perm_b32 v51, v86, v82, s49
    v_accvgpr_write_b32 a23, v51
    v_perm_b32 v50, v63, v59, s48
    v_accvgpr_write_b32 a24, v50
    v_perm_b32 v51, v71, v67, s48
    v_accvgpr_write_b32 a25, v51
    v_perm_b32 v50, v79, v75, s48
    v_accvgpr_write_b32 a26, v50
    v_perm_b32 v51, v87, v83, s48
    v_accvgpr_write_b32 a27, v51
    v_perm_b32 v50, v63, v59, s49
    v_accvgpr_write_b32 a28, v50
    v_perm_b32 v51, v71, v67, s49
    v_accvgpr_write_b32 a29, v51
    v_perm_b32 v50, v79, v75, s49
    v_accvgpr_write_b32 a30, v50
    v_perm_b32 v51, v87, v83, s49
    v_accvgpr_write_b32 a31, v51
    v_perm_b32 v50, v89, v88, s48
    v_accvgpr_write_b32 a32, v50
    v_perm_b32 v51, v91, v90, s48
    v_accvgpr_write_b32 a33, v51
    v_perm_b32 v50, v93, v92, s48
    v_accvgpr_write_b32 a34, v50
    s_waitcnt vmcnt(32)
    v_perm_b32 v51, v95, v94, s48
    v_accvgpr_write_b32 a35, v51
    v_perm_b32 v50, v89, v88, s49
    v_accvgpr_write_b32 a36, v50
    v_perm_b32 v51, v91, v90, s49
    v_accvgpr_write_b32 a37, v51
    v_perm_b32 v50, v93, v92, s49
    v_accvgpr_write_b32 a38, v50
    v_perm_b32 v51, v95, v94, s49
    v_accvgpr_write_b32 a39, v51
    buffer_load_dwordx4 v[56:59], v48, s[8:11], 0 offen offset:0
    buffer_load_dword v88, v49, s[8:11], 0 offen offset:0
    buffer_load_dwordx4 v[60:63], v48, s[8:11], 0 offen offset:1280
    buffer_load_dword v89, v49, s[8:11], 0 offen offset:1280
    buffer_load_dwordx4 v[64:67], v48, s[8:11], 0 offen offset:2560
    buffer_load_dword v90, v49, s[8:11], 0 offen offset:2560
    buffer_load_dwordx4 v[68:71], v48, s[8:11], 0 offen offset:3840
    buffer_load_dword v91, v49, s[8:11], 0 offen offset:3840
    v_add_u32 v48, 20480, v48
    v_add_u32 v49, 20480, v49
    buffer_load_dwordx4 v[72:75], v48, s[8:11], 0 offen offset:0
    buffer_load_dword v92, v49, s[8:11], 0 offen offset:0
    buffer_load_dwordx4 v[76:79], v48, s[8:11], 0 offen offset:1280
    buffer_load_dword v93, v49, s[8:11], 0 offen offset:1280
    buffer_load_dwordx4 v[80:83], v48, s[8:11], 0 offen offset:2560
    buffer_load_dword v94, v49, s[8:11], 0 offen offset:2560
    buffer_load_dwordx4 v[84:87], v48, s[8:11], 0 offen offset:3840
    buffer_load_dword v95, v49, s[8:11], 0 offen offset:3840
    v_add_u32 v48, 20480, v48
    v_add_u32 v49, 20480, v49
    s_waitcnt vmcnt(45)
    v_perm_b32 v50, v100, v96, s48
    v_accvgpr_write_b32 a40, v50
    s_waitcnt vmcnt(41)
    v_perm_b32 v51, v108, v104, s48
    v_accvgpr_write_b32 a41, v51
    s_waitcnt vmcnt(37)
    v_perm_b32 v50, v116, v112, s48
    v_accvgpr_write_b32 a42, v50
    s_waitcnt vmcnt(33)
    v_perm_b32 v51, v124, v120, s48
    v_accvgpr_write_b32 a43, v51
    v_perm_b32 v50, v100, v96, s49
    v_accvgpr_write_b32 a44, v50
    v_perm_b32 v51, v108, v104, s49
    v_accvgpr_write_b32 a45, v51
    v_perm_b32 v50, v116, v112, s49
    v_accvgpr_write_b32 a46, v50
    v_perm_b32 v51, v124, v120, s49
    v_accvgpr_write_b32 a47, v51
    v_perm_b32 v50, v101, v97, s48
    v_accvgpr_write_b32 a48, v50
    v_perm_b32 v51, v109, v105, s48
    v_accvgpr_write_b32 a49, v51
    v_perm_b32 v50, v117, v113, s48
    v_accvgpr_write_b32 a50, v50
    v_perm_b32 v51, v125, v121, s48
    v_accvgpr_write_b32 a51, v51
    v_perm_b32 v50, v101, v97, s49
    v_accvgpr_write_b32 a52, v50
    v_perm_b32 v51, v109, v105, s49
    v_accvgpr_write_b32 a53, v51
    v_perm_b32 v50, v117, v113, s49
    v_accvgpr_write_b32 a54, v50
    v_perm_b32 v51, v125, v121, s49
    v_accvgpr_write_b32 a55, v51
    v_perm_b32 v50, v102, v98, s48
    v_accvgpr_write_b32 a56, v50
    v_perm_b32 v51, v110, v106, s48
    v_accvgpr_write_b32 a57, v51
    v_perm_b32 v50, v118, v114, s48
    v_accvgpr_write_b32 a58, v50
    v_perm_b32 v51, v126, v122, s48
    v_accvgpr_write_b32 a59, v51
    v_perm_b32 v50, v102, v98, s49
    v_accvgpr_write_b32 a60, v50
    v_perm_b32 v51, v110, v106, s49
    v_accvgpr_write_b32 a61, v51
    v_perm_b32 v50, v118, v114, s49
    v_accvgpr_write_b32 a62, v50
    v_perm_b32 v51, v126, v122, s49
    v_accvgpr_write_b32 a63, v51
    v_perm_b32 v50, v103, v99, s48
    v_accvgpr_write_b32 a64, v50
    v_perm_b32 v51, v111, v107, s48
    v_accvgpr_write_b32 a65, v51
    v_perm_b32 v50, v119, v115, s48
    v_accvgpr_write_b32 a66, v50
    v_perm_b32 v51, v127, v123, s48
    v_accvgpr_write_b32 a67, v51
    v_perm_b32 v50, v103, v99, s49
    v_accvgpr_write_b32 a68, v50
    v_perm_b32 v51, v111, v107, s49
    v_accvgpr_write_b32 a69, v51
    v_perm_b32 v50, v119, v115, s49
    v_accvgpr_write_b32 a70, v50
    v_perm_b32 v51, v127, v123, s49
    v_accvgpr_write_b32 a71, v51
    v_perm_b32 v50, v129, v128, s48
    v_accvgpr_write_b32 a72, v50
    v_perm_b32 v51, v131, v130, s48
    v_accvgpr_write_b32 a73, v51
    v_perm_b32 v50, v133, v132, s48
    v_accvgpr_write_b32 a74, v50
    s_waitcnt vmcnt(32)
    v_perm_b32 v51, v135, v134, s48
    v_accvgpr_write_b32 a75, v51
    v_perm_b32 v50, v129, v128, s49
    v_accvgpr_write_b32 a76, v50
    v_perm_b32 v51, v131, v130, s49
    v_accvgpr_write_b32 a77, v51
    v_perm_b32 v50, v133, v132, s49
    v_accvgpr_write_b32 a78, v50
    v_perm_b32 v51, v135, v134, s49
    v_accvgpr_write_b32 a79, v51
    s_waitcnt vmcnt(29)
    v_perm_b32 v50, v140, v136, s48
    v_accvgpr_write_b32 a80, v50
    s_waitcnt vmcnt(25)
    v_perm_b32 v51, v148, v144, s48
    v_accvgpr_write_b32 a81, v51
    s_waitcnt vmcnt(21)
    v_perm_b32 v50, v156, v152, s48
    v_accvgpr_write_b32 a82, v50
    s_waitcnt vmcnt(17)
    v_perm_b32 v51, v164, v160, s48
    v_accvgpr_write_b32 a83, v51
    v_perm_b32 v50, v140, v136, s49
    v_accvgpr_write_b32 a84, v50
    v_perm_b32 v51, v148, v144, s49
    v_accvgpr_write_b32 a85, v51
    v_perm_b32 v50, v156, v152, s49
    v_accvgpr_write_b32 a86, v50
    v_perm_b32 v51, v164, v160, s49
    v_accvgpr_write_b32 a87, v51
    v_perm_b32 v50, v141, v137, s48
    v_accvgpr_write_b32 a88, v50
    v_perm_b32 v51, v149, v145, s48
    v_accvgpr_write_b32 a89, v51
    v_perm_b32 v50, v157, v153, s48
    v_accvgpr_write_b32 a90, v50
    v_perm_b32 v51, v165, v161, s48
    v_accvgpr_write_b32 a91, v51
    v_perm_b32 v50, v141, v137, s49
    v_accvgpr_write_b32 a92, v50
    v_perm_b32 v51, v149, v145, s49
    v_accvgpr_write_b32 a93, v51
    v_perm_b32 v50, v157, v153, s49
    v_accvgpr_write_b32 a94, v50
    v_perm_b32 v51, v165, v161, s49
    v_accvgpr_write_b32 a95, v51
    v_perm_b32 v50, v142, v138, s48
    v_accvgpr_write_b32 a96, v50
    v_perm_b32 v51, v150, v146, s48
    v_accvgpr_write_b32 a97, v51
    v_perm_b32 v50, v158, v154, s48
    v_accvgpr_write_b32 a98, v50
    v_perm_b32 v51, v166, v162, s48
    v_accvgpr_write_b32 a99, v51
    v_perm_b32 v50, v142, v138, s49
    v_accvgpr_write_b32 a100, v50
    v_perm_b32 v51, v150, v146, s49
    v_accvgpr_write_b32 a101, v51
    v_perm_b32 v50, v158, v154, s49
    v_accvgpr_write_b32 a102, v50
    v_perm_b32 v51, v166, v162, s49
    v_accvgpr_write_b32 a103, v51
    v_perm_b32 v50, v143, v139, s48
    v_accvgpr_write_b32 a104, v50
    v_perm_b32 v51, v151, v147, s48
    v_accvgpr_write_b32 a105, v51
    v_perm_b32 v50, v159, v155, s48
    v_accvgpr_write_b32 a106, v50
    v_perm_b32 v51, v167, v163, s48
    v_accvgpr_write_b32 a107, v51
    v_perm_b32 v50, v143, v139, s49
    v_accvgpr_write_b32 a108, v50
    v_perm_b32 v51, v151, v147, s49
    v_accvgpr_write_b32 a109, v51
    v_perm_b32 v50, v159, v155, s49
    v_accvgpr_write_b32 a110, v50
    v_perm_b32 v51, v167, v163, s49
    v_accvgpr_write_b32 a111, v51
    v_perm_b32 v50, v169, v168, s48
    v_accvgpr_write_b32 a112, v50
    v_perm_b32 v51, v171, v170, s48
    v_accvgpr_write_b32 a113, v51
    v_perm_b32 v50, v173, v172, s48
    v_accvgpr_write_b32 a114, v50
    s_waitcnt vmcnt(16)
    v_perm_b32 v51, v175, v174, s48
    v_accvgpr_write_b32 a115, v51
    v_perm_b32 v50, v169, v168, s49
    v_accvgpr_write_b32 a116, v50
    v_perm_b32 v51, v171, v170, s49
    v_accvgpr_write_b32 a117, v51
    v_perm_b32 v50, v173, v172, s49
    v_accvgpr_write_b32 a118, v50
    v_perm_b32 v51, v175, v174, s49
    v_accvgpr_write_b32 a119, v51
    s_waitcnt vmcnt(13)
    v_perm_b32 v50, v60, v56, s48
    v_accvgpr_write_b32 a120, v50
    s_waitcnt vmcnt(9)
    v_perm_b32 v51, v68, v64, s48
    v_accvgpr_write_b32 a121, v51
    s_waitcnt vmcnt(5)
    v_perm_b32 v50, v76, v72, s48
    v_accvgpr_write_b32 a122, v50
    s_waitcnt vmcnt(1)
    v_perm_b32 v51, v84, v80, s48
    v_accvgpr_write_b32 a123, v51
    v_perm_b32 v50, v60, v56, s49
    v_accvgpr_write_b32 a124, v50
    v_perm_b32 v51, v68, v64, s49
    v_accvgpr_write_b32 a125, v51
    v_perm_b32 v50, v76, v72, s49
    v_accvgpr_write_b32 a126, v50
    v_perm_b32 v51, v84, v80, s49
    v_accvgpr_write_b32 a127, v51
    v_perm_b32 v50, v61, v57, s48
    v_accvgpr_write_b32 a128, v50
    v_perm_b32 v51, v69, v65, s48
    v_accvgpr_write_b32 a129, v51
    v_perm_b32 v50, v77, v73, s48
    v_accvgpr_write_b32 a130, v50
    v_perm_b32 v51, v85, v81, s48
    v_accvgpr_write_b32 a131, v51
    v_perm_b32 v50, v61, v57, s49
    v_accvgpr_write_b32 a132, v50
    v_perm_b32 v51, v69, v65, s49
    v_accvgpr_write_b32 a133, v51
    v_perm_b32 v50, v77, v73, s49
    v_accvgpr_write_b32 a134, v50
    v_perm_b32 v51, v85, v81, s49
    v_accvgpr_write_b32 a135, v51
    v_perm_b32 v50, v62, v58, s48
    v_accvgpr_write_b32 a136, v50
    v_perm_b32 v51, v70, v66, s48
    v_accvgpr_write_b32 a137, v51
    v_perm_b32 v50, v78, v74, s48
    v_accvgpr_write_b32 a138, v50
    v_perm_b32 v51, v86, v82, s48
    v_accvgpr_write_b32 a139, v51
    v_perm_b32 v50, v62, v58, s49
    v_accvgpr_write_b32 a140, v50
    v_perm_b32 v51, v70, v66, s49
    v_accvgpr_write_b32 a141, v51
    v_perm_b32 v50, v78, v74, s49
    v_accvgpr_write_b32 a142, v50
    v_perm_b32 v51, v86, v82, s49
    v_accvgpr_write_b32 a143, v51
    v_perm_b32 v50, v63, v59, s48
    v_accvgpr_write_b32 a144, v50
    v_perm_b32 v51, v71, v67, s48
    v_accvgpr_write_b32 a145, v51
    v_perm_b32 v50, v79, v75, s48
    v_accvgpr_write_b32 a146, v50
    v_perm_b32 v51, v87, v83, s48
    v_accvgpr_write_b32 a147, v51
    v_perm_b32 v50, v63, v59, s49
    v_accvgpr_write_b32 a148, v50
    v_perm_b32 v51, v71, v67, s49
    v_accvgpr_write_b32 a149, v51
    v_perm_b32 v50, v79, v75, s49
    v_accvgpr_write_b32 a150, v50
    v_perm_b32 v51, v87, v83, s49
    v_accvgpr_write_b32 a151, v51
    v_perm_b32 v50, v89, v88, s48
    v_accvgpr_write_b32 a152, v50
    v_perm_b32 v51, v91, v90, s48
    v_accvgpr_write_b32 a153, v51
    v_perm_b32 v50, v93, v92, s48
    v_accvgpr_write_b32 a154, v50
    s_waitcnt vmcnt(0)
    v_perm_b32 v51, v95, v94, s48
    v_accvgpr_write_b32 a155, v51
    v_perm_b32 v50, v89, v88, s49
    v_accvgpr_write_b32 a156, v50
    v_perm_b32 v51, v91, v90, s49
    v_accvgpr_write_b32 a157, v51
    v_perm_b32 v50, v93, v92, s49
    v_accvgpr_write_b32 a158, v50
    v_perm_b32 v51, v95, v94, s49
    v_accvgpr_write_b32 a159, v51
    s_waitcnt vmcnt(0) lgkmcnt(0)
    s_nop 11
Lnow55:
    s_load_dwordx2 s[8:9], s[0:1], 88
    s_waitcnt lgkmcnt(0)
    s_mov_b32 s10, 1280
    s_mov_b32 s11, 0x20000
    buffer_load_dword v25, v2, s[8:11], 0 offen offset:0
    buffer_load_dword v26, v2, s[8:11], 0 offen offset:256
    buffer_load_dword v27, v2, s[8:11], 0 offen offset:512
    buffer_load_dword v28, v2, s[8:11], 0 offen offset:768
    buffer_load_dword v29, v2, s[8:11], 0 offen offset:1024
    v_lshlrev_b32 v49, 7, v0
    s_mov_b32 s18, 29184
    s_mov_b32 exec_lo, 0xfffff
    s_mov_b32 exec_hi, 0x0
    s_waitcnt vmcnt(0)
Lwf56:
    buffer_load_dword v48, v49, s[4:7], s18 offen offset:0 sc1
    s_waitcnt vmcnt(0)
    v_cmp_gt_u32 vcc, 1, v48
    s_cbranch_vccz Lwf56d
    s_sub_u32 s15, s15, 1
    s_cbranch_scc0 Lwf56
    s_mov_b32 s15, 0
Lwf56d:
    s_mov_b64 exec, -1
    s_mov_b32 s18, 71936
    buffer_load_dword v20, v2, s[4:7], s18 offen offset:0 sc1
    buffer_load_dword v21, v2, s[4:7], s18 offen offset:256 sc1
    buffer_load_dword v22, v2, s[4:7], s18 offen offset:512 sc1
    buffer_load_dword v23, v2, s[4:7], s18 offen offset:768 sc1
    buffer_load_dword v24, v2, s[4:7], s18 offen offset:1024 sc1
    s_load_dwordx2 s[76:77], s[0:1], 112
    s_waitcnt lgkmcnt(0)
    s_mov_b32 s78, 2621440
    s_mov_b32 s79, 0x20000
    s_waitcnt vmcnt(0)
    s_barrier
    v_mbcnt_lo_u32_b32 v49, -1, 0
    v_and_b32 v49, 7, v49
    v_lshlrev_b32 v49, 5, v49
Lcen59:
    buffer_load_dword v48, v49, s[72:75], 0 offen sc1
    s_waitcnt vmcnt(0)
    v_readlane_b32 s18, v48, s3
    s_mov_b32 s19, 0
    s_nop 2
    s_cmp_ge_u32 s18, 32
    s_cbranch_scc1 Lcen59d
    s_mov_b32 s19, 1
    v_mov_b32 v50, v48
    s_nop 1
    v_add_u32_dpp v50, v50, v50 row_ror:1 row_mask:0xf bank_mask:0xf
    s_nop 1
    v_add_u32_dpp v50, v50, v50 row_ror:2 row_mask:0xf bank_mask:0xf
    s_nop 1
    v_add_u32_dpp v50, v50, v50 row_ror:4 row_mask:0xf bank_mask:0xf
    s_nop 0
    v_readfirstlane_b32 s18, v50
    s_nop 3
    s_cmp_ge_u32 s18, 256
    s_cbranch_scc1 Lcen59d
    s_sub_u32 s15, s15, 1
    s_cbranch_scc0 Lcen59
    s_mov_b32 s15, 0
Lcen59d:
    s_waitcnt vmcnt(0) lgkmcnt(0)
    s_nop 11
    s_cmp_lg_u32 s19, 0
    s_cbranch_scc1 Lunit58
Lunit57:
    v_mov_b32 v46, s17
    s_lshl_b32 s19, s13, 10
    s_add_u32 s18, s28, s19
    s_add_u32 m0, s19, 0
    s_mul_i32 s20, s51, 1280
    s_add_u32 s20, s20, s28
    s_add_u32 s20, s20, 65536
    s_mov_b32 exec_lo, 0xffffffff
    s_mov_b32 exec_hi, 0x0
    s_waitcnt vmcnt(0)
    v_mov_b32 v45, 0
Lpf61:
    buffer_load_dword v45, v2, s[4:7], s23 offen offset:512 sc1
    s_waitcnt vmcnt(0)
    v_cmp_gt_u32 vcc, s17, v45
    s_cbranch_vccz Lpf61d
    s_sub_u32 s15, s15, 1
    s_cbranch_scc0 Lpf61
    s_mov_b32 s15, 0
Lpf61d:
    s_mov_b64 exec, -1
    s_cmp_ge_u32 s50, 14
    s_cbranch_scc1 Lnomlp60a
    buffer_load_dwordx4 v1, s[4:7], s18 offen sc1 lds
    s_add_u32 m0, m0, 4096
    s_add_u32 s18, s18, 4096
    buffer_load_dwordx4 v1, s[4:7], s18 offen sc1 lds
    s_add_u32 m0, m0, 4096
    s_add_u32 s18, s18, 4096
    buffer_load_dwordx4 v1, s[4:7], s18 offen sc1 lds
    s_add_u32 m0, m0, 4096
    s_add_u32 s18, s18, 4096
    buffer_load_dwordx4 v1, s[4:7], s18 offen sc1 lds
    s_add_u32 m0, m0, 4096
    s_add_u32 s18, s18, 4096
    buffer_load_dwordx4 v1, s[4:7], s18 offen sc1 lds
    s_add_u32 m0, m0, 4096
    s_add_u32 s18, s18, 4096
    buffer_load_dwordx4 v1, s[4:7], s18 offen sc1 lds
    s_add_u32 m0, m0, 4096
    s_add_u32 s18, s18, 4096
    buffer_load_dwordx4 v1, s[4:7], s18 offen sc1 lds
    s_add_u32 m0, m0, 4096
    s_add_u32 s18, s18, 4096
    buffer_load_dwordx4 v1, s[4:7], s18 offen sc1 lds
    s_add_u32 m0, m0, 4096
    s_add_u32 s18, s18, 4096
    buffer_load_dwordx4 v1, s[4:7], s18 offen sc1 lds
    s_add_u32 m0, m0, 4096
    s_add_u32 s18, s18, 4096
    buffer_load_dwordx4 v1, s[4:7], s18 offen sc1 lds
    s_add_u32 m0, m0, 4096
    s_add_u32 s18, s18, 4096
    buffer_load_dwordx4 v1, s[4:7], s18 offen sc1 lds
    buffer_load_dword v40, v2, s[4:7], s20 offen offset:0 sc1
    buffer_load_dword v41, v2, s[4:7], s20 offen offset:256 sc1
    buffer_load_dword v42, v2, s[4:7], s20 offen offset:512 sc1
    buffer_load_dword v43, v2, s[4:7], s20 offen offset:768 sc1
    buffer_load_dword v44, v2, s[4:7], s20 offen offset:1024 sc1
    s_waitcnt vmcnt(10)
    s_barrier
    ds_read_b128 v[80:83], v10 offset:0
    ds_read_b128 v[84:87], v10 offset:64
    ds_read_b128 v[88:91], v10 offset:128
    ds_read_b128 v[92:95], v10 offset:192
    ds_read_b128 v[96:99], v10 offset:256
    s_waitcnt lgkmcnt(4)
    v_mfma_f32_16x16x32_bf16 v[120:123], a[160:163], v[80:83], v[32:35]
    ds_read_b128 v[100:103], v10 offset:320
    v_mfma_f32_16x16x32_bf16 v[124:127], a[164:167], v[80:83], v[36:39]
    s_waitcnt lgkmcnt(4)
    v_mfma_f32_16x16x32_bf16 v[120:123], a[168:171], v[84:87], v[120:123]
    ds_read_b128 v[80:83], v10 offset:384
    v_mfma_f32_16x16x32_bf16 v[124:127], a[172:175], v[84:87], v[124:127]
    s_waitcnt lgkmcnt(4)
    v_mfma_f32_16x16x32_bf16 v[120:123], a[176:179], v[88:91], v[120:123]
    ds_read_b128 v[84:87], v10 offset:448
    v_mfma_f32_16x16x32_bf16 v[124:127], a[180:183], v[88:91], v[124:127]
    s_waitcnt lgkmcnt(4)
    v_mfma_f32_16x16x32_bf16 v[120:123], a[184:187], v[92:95], v[120:123]
    ds_read_b128 v[88:91], v10 offset:512
    v_mfma_f32_16x16x32_bf16 v[124:127], a[188:191], v[92:95], v[124:127]
    s_waitcnt lgkmcnt(4)
    v_mfma_f32_16x16x32_bf16 v[120:123], a[192:195], v[96:99], v[120:123]
    ds_read_b128 v[92:95], v10 offset:576
    v_mfma_f32_16x16x32_bf16 v[124:127], a[196:199], v[96:99], v[124:127]
    s_waitcnt lgkmcnt(4)
    v_mfma_f32_16x16x32_bf16 v[120:123], a[200:203], v[100:103], v[120:123]
    ds_read_b128 v[96:99], v10 offset:640
    v_mfma_f32_16x16x32_bf16 v[124:127], a[204:207], v[100:103], v[124:127]
    s_waitcnt lgkmcnt(4)
    v_mfma_f32_16x16x32_bf16 v[120:123], a[208:211], v[80:83], v[120:123]
    ds_read_b128 v[100:103], v10 offset:704
    v_mfma_f32_16x16x32_bf16 v[124:127], a[212:215], v[80:83], v[124:127]
    s_waitcnt lgkmcnt(4)
    v_mfma_f32_16x16x32_bf16 v[120:123], a[216:219], v[84:87], v[120:123]
    ds_read_b128 v[80:83], v10 offset:768
    v_mfma_f32_16x16x32_bf16 v[124:127], a[220:223], v[84:87], v[124:127]
    s_waitcnt lgkmcnt(4)
    v_mov_b32 v144, 3222493025
    v_mfma_f32_16x16x32_bf16 v[120:123], a[224:227], v[88:91], v[120:123]
    ds_read_b128 v[84:87], v10 offset:832
    v_mfma_f32_16x16x32_bf16 v[124:127], a[228:231], v[88:91], v[124:127]
    s_waitcnt lgkmcnt(4)
    v_mfma_f32_16x16x32_bf16 v[120:123], a[232:235], v[92:95], v[120:123]
    ds_read_b128 v[88:91], v10 offset:896
    v_mfma_f32_16x16x32_bf16 v[124:127], a[236:239], v[92:95], v[124:127]
    s_waitcnt lgkmcnt(4)
    v_mfma_f32_16x16x32_bf16 v[120:123], a[240:243], v[96:99], v[120:123]
    ds_read_b128 v[92:95], v10 offset:960
    v_mfma_f32_16x16x32_bf16 v[124:127], a[244:247], v[96:99], v[124:127]
    s_waitcnt lgkmcnt(4)
    v_mfma_f32_16x16x32_bf16 v[120:123], a[248:251], v[100:103], v[120:123]
    ds_read_b128 v[96:99], v10 offset:1024
    v_mfma_f32_16x16x32_bf16 v[124:127], a[252:255], v[100:103], v[124:127]
    s_waitcnt lgkmcnt(4)
    v_mfma_f32_16x16x32_bf16 v[120:123], v[192:195], v[80:83], v[120:123]
    ds_read_b128 v[100:103], v10 offset:1088
    v_mfma_f32_16x16x32_bf16 v[124:127], v[196:199], v[80:83], v[124:127]
    s_waitcnt vmcnt(0)
    buffer_store_dword v46, off, s[4:7], s52 offset:1536
    s_barrier
    s_waitcnt lgkmcnt(4)
    v_mfma_f32_16x16x32_bf16 v[120:123], v[200:203], v[84:87], v[120:123]
    ds_read_b128 v[80:83], v10 offset:1152
    v_mfma_f32_16x16x32_bf16 v[124:127], v[204:207], v[84:87], v[124:127]
    s_waitcnt lgkmcnt(4)
    v_mfma_f32_16x16x32_bf16 v[120:123], v[208:211], v[88:91], v[120:123]
    ds_read_b128 v[84:87], v10 offset:1216
    v_mfma_f32_16x16x32_bf16 v[124:127], v[212:215], v[88:91], v[124:127]
    s_waitcnt lgkmcnt(4)
    v_mfma_f32_16x16x32_bf16 v[120:123], v[216:219], v[92:95], v[120:123]
    ds_read_b128 v[88:91], v10 offset:20736
    v_mfma_f32_16x16x32_bf16 v[124:127], v[220:223], v[92:95], v[124:127]
    s_waitcnt lgkmcnt(4)
    v_mfma_f32_16x16x32_bf16 v[120:123], v[224:227], v[96:99], v[120:123]
    ds_read_b128 v[92:95], v10 offset:20800
    v_mfma_f32_16x16x32_bf16 v[124:127], v[228:231], v[96:99], v[124:127]
    s_waitcnt lgkmcnt(4)
    v_mfma_f32_16x16x32_bf16 v[120:123], v[232:235], v[100:103], v[120:123]
    ds_read_b128 v[96:99], v10 offset:20864
    v_mfma_f32_16x16x32_bf16 v[124:127], v[236:239], v[100:103], v[124:127]
    s_waitcnt lgkmcnt(4)
    v_mfma_f32_16x16x32_bf16 v[120:123], v[240:243], v[80:83], v[120:123]
    ds_read_b128 v[100:103], v10 offset:20928
    v_mfma_f32_16x16x32_bf16 v[124:127], v[244:247], v[80:83], v[124:127]
    s_waitcnt lgkmcnt(4)
    v_mfma_f32_16x16x32_bf16 v[120:123], v[248:251], v[84:87], v[120:123]
    ds_read_b128 v[80:83], v10 offset:20992
    v_mfma_f32_16x16x32_bf16 v[124:127], v[252:255], v[84:87], v[124:127]
    s_waitcnt lgkmcnt(4)
    v_mfma_f32_16x16x32_bf16 v[128:131], a[160:163], v[88:91], v[32:35]
    ds_read_b128 v[84:87], v10 offset:21056
    v_mfma_f32_16x16x32_bf16 v[132:135], a[164:167], v[88:91], v[36:39]
    s_waitcnt lgkmcnt(4)
    v_mfma_f32_16x16x32_bf16 v[128:131], a[168:171], v[92:95], v[128:131]
    ds_read_b128 v[88:91], v10 offset:21120
    v_mul_f32 v136, v120, v120
    v_mul_f32 v137, v121, v121
    v_mfma_f32_16x16x32_bf16 v[132:135], a[172:175], v[92:95], v[132:135]
    s_waitcnt lgkmcnt(4)
    v_mul_f32 v138, v122, v122
    v_mul_f32 v139, v123, v123
    v_mul_f32 v140, v124, v124
    v_mfma_f32_16x16x32_bf16 v[128:131], a[176:179], v[96:99], v[128:131]
    ds_read_b128 v[92:95], v10 offset:21184
    v_mul_f32 v141, v125, v125
    v_mul_f32 v142, v126, v126
    v_mfma_f32_16x16x32_bf16 v[132:135], a[180:183], v[96:99], v[132:135]
    s_waitcnt lgkmcnt(4)
    v_mul_f32 v143, v127, v127
    v_fmamk_f32 v136, v136, 3184710632, v144
    v_fmamk_f32 v137, v137, 3184710632, v144
    v_mfma_f32_16x16x32_bf16 v[128:131], a[184:187], v[100:103], v[128:131]
    ds_read_b128 v[96:99], v10 offset:21248
    v_fmamk_f32 v138, v138, 3184710632, v144
    v_fmamk_f32 v139, v139, 3184710632, v144
    v_mfma_f32_16x16x32_bf16 v[132:135], a[188:191], v[100:103], v[132:135]
    s_waitcnt lgkmcnt(4)
    v_fmamk_f32 v140, v140, 3184710632, v144
    v_fmamk_f32 v141, v141, 3184710632, v144
    v_fmamk_f32 v142, v142, 3184710632, v144
    v_mfma_f32_16x16x32_bf16 v[128:131], a[192:195], v[80:83], v[128:131]
    ds_read_b128 v[100:103], v10 offset:21312
    v_fmamk_f32 v143, v143, 3184710632, v144
    v_mul_f32 v136, v136, v120
    v_mfma_f32_16x16x32_bf16 v[132:135], a[196:199], v[80:83], v[132:135]
    s_waitcnt lgkmcnt(4)
    v_mul_f32 v137, v137, v121
    v_mul_f32 v138, v138, v122
    v_mul_f32 v139, v139, v123
    v_mfma_f32_16x16x32_bf16 v[128:131], a[200:203], v[84:87], v[128:131]
    ds_read_b128 v[80:83], v10 offset:21376
    v_mul_f32 v140, v140, v124
    v_mul_f32 v141, v141, v125
    v_mfma_f32_16x16x32_bf16 v[132:135], a[204:207], v[84:87], v[132:135]
    s_waitcnt lgkmcnt(4)
    v_mul_f32 v142, v142, v126
    v_mul_f32 v143, v143, v127
    v_exp_f32 v136, v136
    v_mfma_f32_16x16x32_bf16 v[128:131], a[208:211], v[88:91], v[128:131]
    ds_read_b128 v[84:87], v10 offset:21440
    v_exp_f32 v137, v137
    v_mfma_f32_16x16x32_bf16 v[132:135], a[212:215], v[88:91], v[132:135]
    s_waitcnt lgkmcnt(4)
    v_exp_f32 v138, v138
    v_exp_f32 v139, v139
    v_mfma_f32_16x16x32_bf16 v[128:131], a[216:219], v[92:95], v[128:131]
    ds_read_b128 v[88:91], v10 offset:21504
    v_exp_f32 v140, v140
    v_mfma_f32_16x16x32_bf16 v[132:135], a[220:223], v[92:95], v[132:135]
    s_waitcnt lgkmcnt(4)
    v_exp_f32 v141, v141
    v_exp_f32 v142, v142
    v_mfma_f32_16x16x32_bf16 v[128:131], a[224:227], v[96:99], v[128:131]
    ds_read_b128 v[92:95], v10 offset:21568
    v_exp_f32 v143, v143
    v_mfma_f32_16x16x32_bf16 v[132:135], a[228:231], v[96:99], v[132:135]
    s_waitcnt lgkmcnt(4)
    v_add_f32 v136, 1.0, v136
    v_add_f32 v137, 1.0, v137
    v_add_f32 v138, 1.0, v138
    v_mfma_f32_16x16x32_bf16 v[128:131], a[232:235], v[100:103], v[128:131]
    ds_read_b128 v[96:99], v10 offset:21632
    v_add_f32 v139, 1.0, v139
    v_add_f32 v140, 1.0, v140
    v_mfma_f32_16x16x32_bf16 v[132:135], a[236:239], v[100:103], v[132:135]
    v_add_f32 v141, 1.0, v141
    v_add_f32 v142, 1.0, v142
    v_add_f32 v143, 1.0, v143
    buffer_load_dword v148, v2, s[4:7], s23 offen offset:1536 sc1
    s_waitcnt lgkmcnt(4)
    v_mfma_f32_16x16x32_bf16 v[128:131], a[240:243], v[80:83], v[128:131]
    ds_read_b128 v[100:103], v10 offset:21696
    v_rcp_f32 v136, v136
    v_mfma_f32_16x16x32_bf16 v[132:135], a[244:247], v[80:83], v[132:135]
    s_waitcnt lgkmcnt(4)
    v_rcp_f32 v137, v137
    v_rcp_f32 v138, v138
    v_mfma_f32_16x16x32_bf16 v[128:131], a[248:251], v[84:87], v[128:131]
    ds_read_b128 v[80:83], v10 offset:21760
    v_rcp_f32 v139, v139
    v_mfma_f32_16x16x32_bf16 v[132:135], a[252:255], v[84:87], v[132:135]
    s_waitcnt lgkmcnt(4)
    v_rcp_f32 v140, v140
    v_rcp_f32 v141, v141
    v_mfma_f32_16x16x32_bf16 v[128:131], v[192:195], v[88:91], v[128:131]
    ds_read_b128 v[84:87], v10 offset:21824
    v_rcp_f32 v142, v142
    v_mfma_f32_16x16x32_bf16 v[132:135], v[196:199], v[88:91], v[132:135]
    s_waitcnt lgkmcnt(4)
    v_rcp_f32 v143, v143
    v_mul_f32 v136, v136, v120
    v_mfma_f32_16x16x32_bf16 v[128:131], v[200:203], v[92:95], v[128:131]
    ds_read_b128 v[88:91], v10 offset:21888
    v_mul_f32 v137, v137, v121
    v_mul_f32 v138, v138, v122
    v_mfma_f32_16x16x32_bf16 v[132:135], v[204:207], v[92:95], v[132:135]
    s_waitcnt lgkmcnt(4)
    v_mul_f32 v139, v139, v123
    v_mul_f32 v140, v140, v124
    v_mul_f32 v141, v141, v125
    v_mfma_f32_16x16x32_bf16 v[128:131], v[208:211], v[96:99], v[128:131]
    ds_read_b128 v[92:95], v10 offset:21952
    v_mul_f32 v142, v142, v126
    v_mul_f32 v143, v143, v127
    v_mfma_f32_16x16x32_bf16 v[132:135], v[212:215], v[96:99], v[132:135]
    s_waitcnt lgkmcnt(4)
    v_cvt_pk_bf16_f32 v120, v136, v137
    v_cvt_pk_bf16_f32 v121, v138, v139
    v_cvt_pk_bf16_f32 v122, v140, v141
    v_mfma_f32_16x16x32_bf16 v[128:131], v[216:219], v[100:103], v[128:131]
    v_cvt_pk_bf16_f32 v123, v142, v143
    ds_write_b128 v11, v[120:123] offset:45056
    v_mfma_f32_16x16x32_bf16 v[132:135], v[220:223], v[100:103], v[132:135]
    s_waitcnt lgkmcnt(4)
    v_mfma_f32_16x16x32_bf16 v[128:131], v[224:227], v[80:83], v[128:131]
    v_mfma_f32_16x16x32_bf16 v[132:135], v[228:231], v[80:83], v[132:135]
    s_waitcnt lgkmcnt(3)
    v_mfma_f32_16x16x32_bf16 v[128:131], v[232:235], v[84:87], v[128:131]
    v_mfma_f32_16x16x32_bf16 v[132:135], v[236:239], v[84:87], v[132:135]
    s_waitcnt lgkmcnt(0)
    s_barrier
    ds_read_b128 v[48:51], v1 offset:45056
    ds_read_b128 v[52:55], v1 offset:46080
    ds_read_b128 v[56:59], v1 offset:47104
    ds_read_b128 v[60:63], v1 offset:48128
    v_mfma_f32_16x16x32_bf16 v[128:131], v[240:243], v[88:91], v[128:131]
    v_mfma_f32_16x16x32_bf16 v[132:135], v[244:247], v[88:91], v[132:135]
    v_mfma_f32_16x16x32_bf16 v[128:131], v[248:251], v[92:95], v[128:131]
    s_nop 2
    v_mfma_f32_16x16x32_bf16 v[132:135], v[252:255], v[92:95], v[132:135]
    s_nop 0
    s_waitcnt lgkmcnt(3)
    v_mfma_f32_16x16x32_bf16 v[80:83], v[48:51], a[0:3], 0
    v_mfma_f32_16x16x32_bf16 v[84:87], v[48:51], a[4:7], 0
    v_mul_f32 v136, v128, v128
    v_mul_f32 v137, v129, v129
    v_mul_f32 v138, v130, v130
    v_mfma_f32_16x16x32_bf16 v[88:91], v[48:51], a[8:11], 0
    v_mul_f32 v139, v131, v131
    v_mul_f32 v140, v132, v132
    v_mul_f32 v141, v133, v133
    v_mfma_f32_16x16x32_bf16 v[92:95], v[48:51], a[12:15], 0
    v_mul_f32 v142, v134, v134
    v_mul_f32 v143, v135, v135
    v_fmamk_f32 v136, v136, 3184710632, v144
    v_mfma_f32_16x16x32_bf16 v[96:99], v[48:51], a[16:19], 0
    v_fmamk_f32 v137, v137, 3184710632, v144
    v_fmamk_f32 v138, v138, 3184710632, v144
    v_fmamk_f32 v139, v139, 3184710632, v144
    v_mfma_f32_16x16x32_bf16 v[100:103], v[48:51], a[20:23], 0
    v_fmamk_f32 v140, v140, 3184710632, v144
    v_fmamk_f32 v141, v141, 3184710632, v144
    v_fmamk_f32 v142, v142, 3184710632, v144
    v_mfma_f32_16x16x32_bf16 v[104:107], v[48:51], a[24:27], 0
    v_fmamk_f32 v143, v143, 3184710632, v144
    v_mul_f32 v136, v136, v128
    v_mul_f32 v137, v137, v129
    v_mfma_f32_16x16x32_bf16 v[108:111], v[48:51], a[28:31], 0
    v_mul_f32 v138, v138, v130
    v_mul_f32 v139, v139, v131
    v_mul_f32 v140, v140, v132
    v_mfma_f32_16x16x32_bf16 v[112:115], v[48:51], a[32:35], 0
    v_mul_f32 v141, v141, v133
    v_mul_f32 v142, v142, v134
    v_mul_f32 v143, v143, v135
    v_mfma_f32_16x16x32_bf16 v[116:119], v[48:51], a[36:39], 0
    s_waitcnt lgkmcnt(2)
    v_exp_f32 v136, v136
    v_exp_f32 v137, v137
    v_mfma_f32_16x16x32_bf16 v[80:83], v[52:55], a[40:43], v[80:83]
    v_exp_f32 v138, v138
    v_exp_f32 v139, v139
    v_mfma_f32_16x16x32_bf16 v[84:87], v[52:55], a[44:47], v[84:87]
    v_exp_f32 v140, v140
    v_exp_f32 v141, v141
    v_mfma_f32_16x16x32_bf16 v[88:91], v[52:55], a[48:51], v[88:91]
    v_exp_f32 v142, v142
    v_exp_f32 v143, v143
    v_mfma_f32_16x16x32_bf16 v[92:95], v[52:55], a[52:55], v[92:95]
    v_add_f32 v136, 1.0, v136
    v_add_f32 v137, 1.0, v137
    v_add_f32 v138, 1.0, v138
    v_mfma_f32_16x16x32_bf16 v[96:99], v[52:55], a[56:59], v[96:99]
    v_add_f32 v139, 1.0, v139
    v_add_f32 v140, 1.0, v140
    v_add_f32 v141, 1.0, v141
    v_mfma_f32_16x16x32_bf16 v[100:103], v[52:55], a[60:63], v[100:103]
    v_add_f32 v142, 1.0, v142
    v_add_f32 v143, 1.0, v143
    v_rcp_f32 v136, v136
    v_mfma_f32_16x16x32_bf16 v[104:107], v[52:55], a[64:67], v[104:107]
    v_rcp_f32 v137, v137
    v_rcp_f32 v138, v138
    v_mfma_f32_16x16x32_bf16 v[108:111], v[52:55], a[68:71], v[108:111]
    v_rcp_f32 v139, v139
    v_rcp_f32 v140, v140
    v_mfma_f32_16x16x32_bf16 v[112:115], v[52:55], a[72:75], v[112:115]
    v_rcp_f32 v141, v141
    v_rcp_f32 v142, v142
    v_mfma_f32_16x16x32_bf16 v[116:119], v[52:55], a[76:79], v[116:119]
    s_waitcnt lgkmcnt(1)
    v_rcp_f32 v143, v143
    v_mul_f32 v136, v136, v128
    v_mfma_f32_16x16x32_bf16 v[80:83], v[56:59], a[80:83], v[80:83]
    v_mul_f32 v137, v137, v129
    v_mul_f32 v138, v138, v130
    v_mul_f32 v139, v139, v131
    v_mfma_f32_16x16x32_bf16 v[84:87], v[56:59], a[84:87], v[84:87]
    v_mul_f32 v140, v140, v132
    v_mul_f32 v141, v141, v133
    v_mul_f32 v142, v142, v134
    v_mfma_f32_16x16x32_bf16 v[88:91], v[56:59], a[88:91], v[88:91]
    v_mul_f32 v143, v143, v135
    v_cvt_pk_bf16_f32 v128, v136, v137
    v_cvt_pk_bf16_f32 v129, v138, v139
    v_mfma_f32_16x16x32_bf16 v[92:95], v[56:59], a[92:95], v[92:95]
    v_cvt_pk_bf16_f32 v130, v140, v141
    v_cvt_pk_bf16_f32 v131, v142, v143
    ds_write_b128 v11, v[128:131] offset:49152
    v_mfma_f32_16x16x32_bf16 v[96:99], v[56:59], a[96:99], v[96:99]
    v_mfma_f32_16x16x32_bf16 v[100:103], v[56:59], a[100:103], v[100:103]
    v_mfma_f32_16x16x32_bf16 v[104:107], v[56:59], a[104:107], v[104:107]
    v_mfma_f32_16x16x32_bf16 v[108:111], v[56:59], a[108:111], v[108:111]
    v_mfma_f32_16x16x32_bf16 v[112:115], v[56:59], a[112:115], v[112:115]
    s_waitcnt lgkmcnt(0)
    s_barrier
    ds_read_b128 v[64:67], v1 offset:49152
    ds_read_b128 v[68:71], v1 offset:50176
    ds_read_b128 v[72:75], v1 offset:51200
    ds_read_b128 v[76:79], v1 offset:52224
    v_mfma_f32_16x16x32_bf16 v[116:119], v[56:59], a[116:119], v[116:119]
    v_mfma_f32_16x16x32_bf16 v[80:83], v[60:63], a[120:123], v[80:83]
    v_mfma_f32_16x16x32_bf16 v[84:87], v[60:63], a[124:127], v[84:87]
    v_mfma_f32_16x16x32_bf16 v[88:91], v[60:63], a[128:131], v[88:91]
    v_mfma_f32_16x16x32_bf16 v[92:95], v[60:63], a[132:135], v[92:95]
    v_mfma_f32_16x16x32_bf16 v[96:99], v[60:63], a[136:139], v[96:99]
    v_mfma_f32_16x16x32_bf16 v[100:103], v[60:63], a[140:143], v[100:103]
    v_mfma_f32_16x16x32_bf16 v[104:107], v[60:63], a[144:147], v[104:107]
    v_mfma_f32_16x16x32_bf16 v[108:111], v[60:63], a[148:151], v[108:111]
    v_mfma_f32_16x16x32_bf16 v[112:115], v[60:63], a[152:155], v[112:115]
    v_mfma_f32_16x16x32_bf16 v[116:119], v[60:63], a[156:159], v[116:119]
    s_waitcnt vmcnt(0)
    v_cmp_gt_u32 vcc, s17, v148
    s_cbranch_vccz Lokd62
Lwf63:
    buffer_load_dword v148, v2, s[4:7], s23 offen offset:1536 sc1
    s_waitcnt vmcnt(0)
    v_cmp_gt_u32 vcc, s17, v148
    s_cbranch_vccz Lwf63d
    s_sub_u32 s15, s15, 1
    s_cbranch_scc0 Lwf63
    s_mov_b32 s15, 0
Lwf63d:
Lokd62:
    s_waitcnt lgkmcnt(3)
    v_mfma_f32_16x16x32_bf16 v[120:123], v[64:67], a[0:3], 0
    v_mfma_f32_16x16x32_bf16 v[124:127], v[64:67], a[4:7], 0
    v_cvt_pk_bf16_f32 v160, v80, v84
    v_mfma_f32_16x16x32_bf16 v[128:131], v[64:67], a[8:11], 0
    v_cvt_pk_bf16_f32 v161, v88, v92
    v_mfma_f32_16x16x32_bf16 v[132:135], v[64:67], a[12:15], 0
    v_cvt_pk_bf16_f32 v162, v96, v100
    v_mfma_f32_16x16x32_bf16 v[136:139], v[64:67], a[16:19], 0
    v_cvt_pk_bf16_f32 v163, v104, v108
    v_mfma_f32_16x16x32_bf16 v[140:143], v[64:67], a[20:23], 0
    s_add_u32 s18, s21, 0
    buffer_store_dwordx4 v[160:163], v4, s[4:7], s18 offen
    v_mfma_f32_16x16x32_bf16 v[144:147], v[64:67], a[24:27], 0
    v_cvt_pk_bf16_f32 v166, v81, v85
    v_mfma_f32_16x16x32_bf16 v[148:151], v[64:67], a[28:31], 0
    s_waitcnt lgkmcnt(2)
    v_cvt_pk_bf16_f32 v167, v89, v93
    v_mfma_f32_16x16x32_bf16 v[120:123], v[68:71], a[40:43], v[120:123]
    v_cvt_pk_bf16_f32 v168, v97, v101
    v_mfma_f32_16x16x32_bf16 v[124:127], v[68:71], a[44:47], v[124:127]
    v_cvt_pk_bf16_f32 v169, v105, v109
    v_mfma_f32_16x16x32_bf16 v[128:131], v[68:71], a[48:51], v[128:131]
    s_add_u32 s18, s21, 65536
    buffer_store_dwordx4 v[166:169], v4, s[4:7], s18 offen
    v_mfma_f32_16x16x32_bf16 v[132:135], v[68:71], a[52:55], v[132:135]
    v_cvt_pk_bf16_f32 v172, v82, v86
    v_mfma_f32_16x16x32_bf16 v[136:139], v[68:71], a[56:59], v[136:139]
    v_cvt_pk_bf16_f32 v173, v90, v94
    v_mfma_f32_16x16x32_bf16 v[140:143], v[68:71], a[60:63], v[140:143]
    v_cvt_pk_bf16_f32 v174, v98, v102
    v_mfma_f32_16x16x32_bf16 v[144:147], v[68:71], a[64:67], v[144:147]
    v_cvt_pk_bf16_f32 v175, v106, v110
    v_mfma_f32_16x16x32_bf16 v[148:151], v[68:71], a[68:71], v[148:151]
    s_waitcnt lgkmcnt(1)
    s_add_u32 s18, s21, 131072
    buffer_store_dwordx4 v[172:175], v4, s[4:7], s18 offen
    v_mfma_f32_16x16x32_bf16 v[120:123], v[72:75], a[80:83], v[120:123]
    v_cvt_pk_bf16_f32 v178, v83, v87
    v_mfma_f32_16x16x32_bf16 v[124:127], v[72:75], a[84:87], v[124:127]
    v_cvt_pk_bf16_f32 v179, v91, v95
    v_mfma_f32_16x16x32_bf16 v[128:131], v[72:75], a[88:91], v[128:131]
    v_cvt_pk_bf16_f32 v180, v99, v103
    v_mfma_f32_16x16x32_bf16 v[132:135], v[72:75], a[92:95], v[132:135]
    v_cvt_pk_bf16_f32 v181, v107, v111
    v_mfma_f32_16x16x32_bf16 v[136:139], v[72:75], a[96:99], v[136:139]
    s_add_u32 s18, s21, 196608
    buffer_store_dwordx4 v[178:181], v4, s[4:7], s18 offen
    v_mfma_f32_16x16x32_bf16 v[140:143], v[72:75], a[100:103], v[140:143]
    v_cvt_pk_bf16_f32 v164, v112, v116
    v_mfma_f32_16x16x32_bf16 v[144:147], v[72:75], a[104:107], v[144:147]
    v_cvt_pk_bf16_f32 v170, v113, v117
    v_mfma_f32_16x16x32_bf16 v[148:151], v[72:75], a[108:111], v[148:151]
    s_waitcnt lgkmcnt(0)
    v_cvt_pk_bf16_f32 v176, v114, v118
    v_mfma_f32_16x16x32_bf16 v[120:123], v[76:79], a[120:123], v[120:123]
    v_cvt_pk_bf16_f32 v182, v115, v119
    v_mfma_f32_16x16x32_bf16 v[124:127], v[76:79], a[124:127], v[124:127]
    s_add_u32 s18, s21, 0
    buffer_store_dword v164, v5, s[4:7], s18 offen offset:256
    v_mfma_f32_16x16x32_bf16 v[128:131], v[76:79], a[128:131], v[128:131]
    s_add_u32 s18, s21, 65536
    buffer_store_dword v170, v5, s[4:7], s18 offen offset:256
    v_mfma_f32_16x16x32_bf16 v[132:135], v[76:79], a[132:135], v[132:135]
    s_add_u32 s18, s21, 131072
    buffer_store_dword v176, v5, s[4:7], s18 offen offset:256
    v_mfma_f32_16x16x32_bf16 v[136:139], v[76:79], a[136:139], v[136:139]
    s_add_u32 s18, s21, 196608
    buffer_store_dword v182, v5, s[4:7], s18 offen offset:256
    v_mfma_f32_16x16x32_bf16 v[140:143], v[76:79], a[140:143], v[140:143]
    s_nop 1
    v_mfma_f32_16x16x32_bf16 v[144:147], v[76:79], a[144:147], v[144:147]
    v_mfma_f32_16x16x32_bf16 v[148:151], v[76:79], a[148:151], v[148:151]
    s_nop 1
    v_mfma_f32_16x16x32_bf16 v[152:155], v[64:67], a[32:35], 0
    v_mfma_f32_16x16x32_bf16 v[156:159], v[64:67], a[36:39], 0
    v_cvt_pk_bf16_f32 v160, v120, v124
    v_cvt_pk_bf16_f32 v161, v128, v132
    v_cvt_pk_bf16_f32 v162, v136, v140
    v_mfma_f32_16x16x32_bf16 v[152:155], v[68:71], a[72:75], v[152:155]
    v_cvt_pk_bf16_f32 v163, v144, v148
    s_add_u32 s18, s21, 1048576
    buffer_store_dwordx4 v[160:163], v4, s[4:7], s18 offen
    v_cvt_pk_bf16_f32 v166, v121, v125
    v_mfma_f32_16x16x32_bf16 v[156:159], v[68:71], a[76:79], v[156:159]
    v_cvt_pk_bf16_f32 v167, v129, v133
    v_cvt_pk_bf16_f32 v168, v137, v141
    v_cvt_pk_bf16_f32 v169, v145, v149
    v_mfma_f32_16x16x32_bf16 v[152:155], v[72:75], a[112:115], v[152:155]
    s_add_u32 s18, s21, 1114112
    buffer_store_dwordx4 v[166:169], v4, s[4:7], s18 offen
    v_cvt_pk_bf16_f32 v172, v122, v126
    v_cvt_pk_bf16_f32 v173, v130, v134
    v_mfma_f32_16x16x32_bf16 v[156:159], v[72:75], a[116:119], v[156:159]
    v_cvt_pk_bf16_f32 v174, v138, v142
    v_cvt_pk_bf16_f32 v175, v146, v150
    s_add_u32 s18, s21, 1179648
    buffer_store_dwordx4 v[172:175], v4, s[4:7], s18 offen
    v_mfma_f32_16x16x32_bf16 v[152:155], v[76:79], a[152:155], v[152:155]
    v_cvt_pk_bf16_f32 v178, v123, v127
    v_cvt_pk_bf16_f32 v179, v131, v135
    v_cvt_pk_bf16_f32 v180, v139, v143
    v_mfma_f32_16x16x32_bf16 v[156:159], v[76:79], a[156:159], v[156:159]
    s_nop 0
    v_cvt_pk_bf16_f32 v181, v147, v151
    s_add_u32 s18, s21, 1245184
    buffer_store_dwordx4 v[178:181], v4, s[4:7], s18 offen
    s_nop 1
    v_mov_b32 v3, v3
    s_nop 0
    v_cvt_pk_bf16_f32 v164, v152, v156
    v_cvt_pk_bf16_f32 v170, v153, v157
    v_cvt_pk_bf16_f32 v176, v154, v158
    v_cvt_pk_bf16_f32 v182, v155, v159
    s_add_u32 s18, s21, 1048576
    buffer_store_dword v164, v5, s[4:7], s18 offen offset:256
    s_add_u32 s18, s21, 1114112
    buffer_store_dword v170, v5, s[4:7], s18 offen offset:256
    s_add_u32 s18, s21, 1179648
    buffer_store_dword v176, v5, s[4:7], s18 offen offset:256
    s_add_u32 s18, s21, 1245184
    buffer_store_dword v182, v5, s[4:7], s18 offen offset:256
    s_waitcnt vmcnt(0)
    buffer_store_dword v46, off, s[4:7], s52 offset:1024
    s_branch Lnomlp60
Lnomlp60a:
    buffer_load_dword v40, v2, s[4:7], s20 offen offset:0 sc1
    buffer_load_dword v41, v2, s[4:7], s20 offen offset:256 sc1
    buffer_load_dword v42, v2, s[4:7], s20 offen offset:512 sc1
    buffer_load_dword v43, v2, s[4:7], s20 offen offset:768 sc1
    buffer_load_dword v44, v2, s[4:7], s20 offen offset:1024 sc1
    s_waitcnt vmcnt(0)
    buffer_store_dword v46, off, s[4:7], s52 offset:1536
Lnomlp60:
    s_mov_b32 exec_lo, 0xffffffff
    s_mov_b32 exec_hi, 0xffffff
    v_mov_b32 v45, 0
Lpf64:
    buffer_load_dword v45, v2, s[4:7], s23 offen offset:1024 sc1
    s_waitcnt vmcnt(1)
    v_cmp_gt_u32 vcc, s17, v45
    s_cbranch_vccz Lpf64d
    s_sub_u32 s15, s15, 1
    s_cbranch_scc0 Lpf64
    s_mov_b32 s15, 0
Lpf64d:
    s_mov_b64 exec, -1
    s_add_u32 s18, s22, 0
    buffer_load_dwordx4 v[48:51], v6, s[4:7], s18 offen offset:0 sc1
    buffer_load_dwordx4 v[52:55], v6, s[4:7], s18 offen offset:256 sc1
    buffer_load_dwordx4 v[56:59], v6, s[4:7], s18 offen offset:512 sc1
    buffer_load_dwordx4 v[60:63], v6, s[4:7], s18 offen offset:768 sc1
    buffer_load_dwordx4 v[64:67], v6, s[4:7], s18 offen offset:1024 sc1
    s_add_u32 s18, s22, 16384
    buffer_load_dwordx4 v[68:71], v7, s[4:7], s18 offen offset:0 sc1
    buffer_load_dwordx4 v[72:75], v7, s[4:7], s18 offen offset:256 sc1
    buffer_load_dwordx4 v[76:79], v7, s[4:7], s18 offen offset:512 sc1
    buffer_load_dwordx4 v[80:83], v7, s[4:7], s18 offen offset:768 sc1
    buffer_load_dwordx4 v[84:87], v7, s[4:7], s18 offen offset:1024 sc1
    s_lshl_b32 s19, s16, 5
    s_add_u32 s19, s19, s51
    s_mul_i32 s19, s19, 1280
    v_and_b32 v109, 0xffff0000, v40
    v_lshlrev_b32 v108, 16, v40
    v_and_b32 v119, 0xffff0000, v20
    v_lshlrev_b32 v118, 16, v20
    v_and_b32 v129, 0xffff0000, v25
    v_lshlrev_b32 v128, 16, v25
    v_and_b32 v111, 0xffff0000, v41
    v_lshlrev_b32 v110, 16, v41
    v_and_b32 v121, 0xffff0000, v21
    v_lshlrev_b32 v120, 16, v21
    v_and_b32 v131, 0xffff0000, v26
    v_lshlrev_b32 v130, 16, v26
    v_and_b32 v113, 0xffff0000, v42
    v_lshlrev_b32 v112, 16, v42
    v_and_b32 v123, 0xffff0000, v22
    v_lshlrev_b32 v122, 16, v22
    v_and_b32 v133, 0xffff0000, v27
    v_lshlrev_b32 v132, 16, v27
    v_and_b32 v115, 0xffff0000, v43
    v_lshlrev_b32 v114, 16, v43
    v_and_b32 v125, 0xffff0000, v23
    v_lshlrev_b32 v124, 16, v23
    v_and_b32 v135, 0xffff0000, v28
    v_lshlrev_b32 v134, 16, v28
    v_and_b32 v117, 0xffff0000, v44
    v_lshlrev_b32 v116, 16, v44
    v_and_b32 v127, 0xffff0000, v24
    v_lshlrev_b32 v126, 16, v24
    v_and_b32 v137, 0xffff0000, v29
    v_lshlrev_b32 v136, 16, v29
    v_fmac_f32 v108, v118, v128
    v_fmac_f32 v109, v119, v129
    v_fmac_f32 v110, v120, v130
    v_fmac_f32 v111, v121, v131
    v_fmac_f32 v112, v122, v132
    v_fmac_f32 v113, v123, v133
    v_fmac_f32 v114, v124, v134
    v_fmac_f32 v115, v125, v135
    v_fmac_f32 v116, v126, v136
    v_fmac_f32 v117, v127, v137
    s_waitcnt vmcnt(9)
    v_mfma_f32_16x16x32_bf16 v[88:91], v[16:19], v[48:51], 0
    s_waitcnt vmcnt(8)
    v_mfma_f32_16x16x32_bf16 v[92:95], v[16:19], v[52:55], 0
    s_waitcnt vmcnt(7)
    v_mfma_f32_16x16x32_bf16 v[96:99], v[16:19], v[56:59], 0
    s_waitcnt vmcnt(6)
    v_mfma_f32_16x16x32_bf16 v[100:103], v[16:19], v[60:63], 0
    s_waitcnt vmcnt(5)
    v_mfma_f32_16x16x32_bf16 v[104:107], v[16:19], v[64:67], 0
    s_waitcnt vmcnt(4)
    v_mfma_f32_16x16x32_bf16 v[88:91], v[16:19], v[68:71], v[88:91]
    s_waitcnt vmcnt(3)
    v_mfma_f32_16x16x32_bf16 v[92:95], v[16:19], v[72:75], v[92:95]
    s_waitcnt vmcnt(2)
    v_mfma_f32_16x16x32_bf16 v[96:99], v[16:19], v[76:79], v[96:99]
    s_nop 0
    s_waitcnt vmcnt(1)
    v_mfma_f32_16x16x32_bf16 v[100:103], v[16:19], v[80:83], v[100:103]
    s_nop 1
    s_waitcnt vmcnt(0)
    v_mfma_f32_16x16x32_bf16 v[104:107], v[16:19], v[84:87], v[104:107]
    s_mov_b32 exec_hi, 0
    ds_write_b128 v8, v[88:91] offset:53248
    ds_write_b128 v8, v[92:95] offset:53760
    ds_write_b128 v8, v[96:99] offset:54272
    ds_write_b128 v8, v[100:103] offset:54784
    s_nop 2
    ds_write_b128 v8, v[104:107] offset:55296
    s_mov_b64 exec, -1
    s_waitcnt lgkmcnt(0)
    s_barrier
    s_cmp_lg_u32 s26, 0
    s_cbranch_scc1 Lp865
    ds_read_b64 v[48:49], v9 offset:53248
    ds_read_b64 v[58:59], v9 offset:55808
    ds_read_b64 v[50:51], v9 offset:53760
    ds_read_b64 v[60:61], v9 offset:56320
    ds_read_b64 v[52:53], v9 offset:54272
    ds_read_b64 v[62:63], v9 offset:56832
    ds_read_b64 v[54:55], v9 offset:54784
    ds_read_b64 v[64:65], v9 offset:57344
    ds_read_b64 v[56:57], v9 offset:55296
    ds_read_b64 v[66:67], v9 offset:57856
    s_waitcnt lgkmcnt(8)
    v_add_f32 v48, v48, v58
    v_add_f32 v49, v49, v59
    s_waitcnt lgkmcnt(6)
    v_add_f32 v50, v50, v60
    v_add_f32 v51, v51, v61
    s_waitcnt lgkmcnt(4)
    v_add_f32 v52, v52, v62
    v_add_f32 v53, v53, v63
    s_waitcnt lgkmcnt(2)
    v_add_f32 v54, v54, v64
    v_add_f32 v55, v55, v65
    s_waitcnt lgkmcnt(0)
    v_add_f32 v56, v56, v66
    v_add_f32 v57, v57, v67
    v_fmac_f32 v108, v118, v48
    v_fmac_f32 v109, v119, v49
    v_cvt_pk_bf16_f32 v68, v108, v109
    buffer_store_dword v68, v2, s[76:79], s19 offen offset:0
    v_fmac_f32 v110, v120, v50
    v_fmac_f32 v111, v121, v51
    v_cvt_pk_bf16_f32 v69, v110, v111
    buffer_store_dword v69, v2, s[76:79], s19 offen offset:256
    v_fmac_f32 v112, v122, v52
    v_fmac_f32 v113, v123, v53
    v_cvt_pk_bf16_f32 v70, v112, v113
    buffer_store_dword v70, v2, s[76:79], s19 offen offset:512
    v_fmac_f32 v114, v124, v54
    v_fmac_f32 v115, v125, v55
    v_cvt_pk_bf16_f32 v71, v114, v115
    buffer_store_dword v71, v2, s[76:79], s19 offen offset:768
    v_fmac_f32 v116, v126, v56
    v_fmac_f32 v117, v127, v57
    v_cvt_pk_bf16_f32 v72, v116, v117
    buffer_store_dword v72, v2, s[76:79], s19 offen offset:1024
Lp865:
    s_add_u32 s17, s17, 1
    s_xor_b32 s28, s28, 0x20000
    s_add_u32 s16, s16, 4
    s_cmp_lt_u32 s16, 64
    s_cbranch_scc1 Lunit57
    s_waitcnt vmcnt(0) lgkmcnt(0)
    s_endpgm
Lunit58:
    v_mov_b32 v46, s17
    s_lshl_b32 s19, s13, 10
    s_add_u32 s18, s28, s19
    s_add_u32 m0, s19, 0
    s_mul_i32 s20, s51, 1280
    s_add_u32 s20, s20, s28
    s_add_u32 s20, s20, 65536
    s_mov_b32 exec_lo, 0xffffffff
    s_mov_b32 exec_hi, 0x0
    s_waitcnt vmcnt(0)
    v_mov_b32 v45, 0
Lpf67:
    buffer_load_dword v45, v2, s[4:7], s23 offen offset:512 sc1
    s_waitcnt vmcnt(0)
    v_cmp_gt_u32 vcc, s17, v45
    s_cbranch_vccz Lpf67d
    s_sub_u32 s15, s15, 1
    s_cbranch_scc0 Lpf67
    s_mov_b32 s15, 0
Lpf67d:
    s_mov_b64 exec, -1
    s_cmp_ge_u32 s50, 14
    s_cbranch_scc1 Lnomlp66a
    buffer_load_dwordx4 v1, s[4:7], s18 offen sc1 lds
    s_add_u32 m0, m0, 4096
    s_add_u32 s18, s18, 4096
    buffer_load_dwordx4 v1, s[4:7], s18 offen sc1 lds
    s_add_u32 m0, m0, 4096
    s_add_u32 s18, s18, 4096
    buffer_load_dwordx4 v1, s[4:7], s18 offen sc1 lds
    s_add_u32 m0, m0, 4096
    s_add_u32 s18, s18, 4096
    buffer_load_dwordx4 v1, s[4:7], s18 offen sc1 lds
    s_add_u32 m0, m0, 4096
    s_add_u32 s18, s18, 4096
    buffer_load_dwordx4 v1, s[4:7], s18 offen sc1 lds
    s_add_u32 m0, m0, 4096
    s_add_u32 s18, s18, 4096
    buffer_load_dwordx4 v1, s[4:7], s18 offen sc1 lds
    s_add_u32 m0, m0, 4096
    s_add_u32 s18, s18, 4096
    buffer_load_dwordx4 v1, s[4:7], s18 offen sc1 lds
    s_add_u32 m0, m0, 4096
    s_add_u32 s18, s18, 4096
    buffer_load_dwordx4 v1, s[4:7], s18 offen sc1 lds
    s_add_u32 m0, m0, 4096
    s_add_u32 s18, s18, 4096
    buffer_load_dwordx4 v1, s[4:7], s18 offen sc1 lds
    s_add_u32 m0, m0, 4096
    s_add_u32 s18, s18, 4096
    buffer_load_dwordx4 v1, s[4:7], s18 offen sc1 lds
    s_add_u32 m0, m0, 4096
    s_add_u32 s18, s18, 4096
    buffer_load_dwordx4 v1, s[4:7], s18 offen sc1 lds
    buffer_load_dword v40, v2, s[4:7], s20 offen offset:0 sc1
    buffer_load_dword v41, v2, s[4:7], s20 offen offset:256 sc1
    buffer_load_dword v42, v2, s[4:7], s20 offen offset:512 sc1
    buffer_load_dword v43, v2, s[4:7], s20 offen offset:768 sc1
    buffer_load_dword v44, v2, s[4:7], s20 offen offset:1024 sc1
    s_waitcnt vmcnt(10)
    s_barrier
    ds_read_b128 v[80:83], v10 offset:0
    ds_read_b128 v[84:87], v10 offset:64
    ds_read_b128 v[88:91], v10 offset:128
    ds_read_b128 v[92:95], v10 offset:192
    ds_read_b128 v[96:99], v10 offset:256
    s_waitcnt lgkmcnt(4)
    v_mfma_f32_16x16x32_bf16 v[120:123], a[160:163], v[80:83], v[32:35]
    ds_read_b128 v[100:103], v10 offset:320
    v_mfma_f32_16x16x32_bf16 v[124:127], a[164:167], v[80:83], v[36:39]
    s_waitcnt lgkmcnt(4)
    v_mfma_f32_16x16x32_bf16 v[120:123], a[168:171], v[84:87], v[120:123]
    ds_read_b128 v[80:83], v10 offset:384
    v_mfma_f32_16x16x32_bf16 v[124:127], a[172:175], v[84:87], v[124:127]
    s_waitcnt lgkmcnt(4)
    v_mfma_f32_16x16x32_bf16 v[120:123], a[176:179], v[88:91], v[120:123]
    ds_read_b128 v[84:87], v10 offset:448
    v_mfma_f32_16x16x32_bf16 v[124:127], a[180:183], v[88:91], v[124:127]
    s_waitcnt lgkmcnt(4)
    v_mfma_f32_16x16x32_bf16 v[120:123], a[184:187], v[92:95], v[120:123]
    ds_read_b128 v[88:91], v10 offset:512
    v_mfma_f32_16x16x32_bf16 v[124:127], a[188:191], v[92:95], v[124:127]
    s_waitcnt lgkmcnt(4)
    v_mfma_f32_16x16x32_bf16 v[120:123], a[192:195], v[96:99], v[120:123]
    ds_read_b128 v[92:95], v10 offset:576
    v_mfma_f32_16x16x32_bf16 v[124:127], a[196:199], v[96:99], v[124:127]
    s_waitcnt lgkmcnt(4)
    v_mfma_f32_16x16x32_bf16 v[120:123], a[200:203], v[100:103], v[120:123]
    ds_read_b128 v[96:99], v10 offset:640
    v_mfma_f32_16x16x32_bf16 v[124:127], a[204:207], v[100:103], v[124:127]
    s_waitcnt lgkmcnt(4)
    v_mfma_f32_16x16x32_bf16 v[120:123], a[208:211], v[80:83], v[120:123]
    ds_read_b128 v[100:103], v10 offset:704
    v_mfma_f32_16x16x32_bf16 v[124:127], a[212:215], v[80:83], v[124:127]
    s_waitcnt lgkmcnt(4)
    v_mfma_f32_16x16x32_bf16 v[120:123], a[216:219], v[84:87], v[120:123]
    ds_read_b128 v[80:83], v10 offset:768
    v_mfma_f32_16x16x32_bf16 v[124:127], a[220:223], v[84:87], v[124:127]
    s_waitcnt lgkmcnt(4)
    v_mov_b32 v144, 3222493025
    v_mfma_f32_16x16x32_bf16 v[120:123], a[224:227], v[88:91], v[120:123]
    ds_read_b128 v[84:87], v10 offset:832
    v_mfma_f32_16x16x32_bf16 v[124:127], a[228:231], v[88:91], v[124:127]
    s_waitcnt lgkmcnt(4)
    v_mfma_f32_16x16x32_bf16 v[120:123], a[232:235], v[92:95], v[120:123]
    ds_read_b128 v[88:91], v10 offset:896
    v_mfma_f32_16x16x32_bf16 v[124:127], a[236:239], v[92:95], v[124:127]
    s_waitcnt lgkmcnt(4)
    v_mfma_f32_16x16x32_bf16 v[120:123], a[240:243], v[96:99], v[120:123]
    ds_read_b128 v[92:95], v10 offset:960
    v_mfma_f32_16x16x32_bf16 v[124:127], a[244:247], v[96:99], v[124:127]
    s_waitcnt lgkmcnt(4)
    v_mfma_f32_16x16x32_bf16 v[120:123], a[248:251], v[100:103], v[120:123]
    ds_read_b128 v[96:99], v10 offset:1024
    v_mfma_f32_16x16x32_bf16 v[124:127], a[252:255], v[100:103], v[124:127]
    s_waitcnt lgkmcnt(4)
    v_mfma_f32_16x16x32_bf16 v[120:123], v[192:195], v[80:83], v[120:123]
    ds_read_b128 v[100:103], v10 offset:1088
    v_mfma_f32_16x16x32_bf16 v[124:127], v[196:199], v[80:83], v[124:127]
    s_waitcnt vmcnt(0)
    buffer_store_dword v46, off, s[4:7], s52 offset:1536 sc1
    s_barrier
    s_waitcnt lgkmcnt(4)
    v_mfma_f32_16x16x32_bf16 v[120:123], v[200:203], v[84:87], v[120:123]
    ds_read_b128 v[80:83], v10 offset:1152
    v_mfma_f32_16x16x32_bf16 v[124:127], v[204:207], v[84:87], v[124:127]
    s_waitcnt lgkmcnt(4)
    v_mfma_f32_16x16x32_bf16 v[120:123], v[208:211], v[88:91], v[120:123]
    ds_read_b128 v[84:87], v10 offset:1216
    v_mfma_f32_16x16x32_bf16 v[124:127], v[212:215], v[88:91], v[124:127]
    s_waitcnt lgkmcnt(4)
    v_mfma_f32_16x16x32_bf16 v[120:123], v[216:219], v[92:95], v[120:123]
    ds_read_b128 v[88:91], v10 offset:20736
    v_mfma_f32_16x16x32_bf16 v[124:127], v[220:223], v[92:95], v[124:127]
    s_waitcnt lgkmcnt(4)
    v_mfma_f32_16x16x32_bf16 v[120:123], v[224:227], v[96:99], v[120:123]
    ds_read_b128 v[92:95], v10 offset:20800
    v_mfma_f32_16x16x32_bf16 v[124:127], v[228:231], v[96:99], v[124:127]
    s_waitcnt lgkmcnt(4)
    v_mfma_f32_16x16x32_bf16 v[120:123], v[232:235], v[100:103], v[120:123]
    ds_read_b128 v[96:99], v10 offset:20864
    v_mfma_f32_16x16x32_bf16 v[124:127], v[236:239], v[100:103], v[124:127]
    s_waitcnt lgkmcnt(4)
    v_mfma_f32_16x16x32_bf16 v[120:123], v[240:243], v[80:83], v[120:123]
    ds_read_b128 v[100:103], v10 offset:20928
    v_mfma_f32_16x16x32_bf16 v[124:127], v[244:247], v[80:83], v[124:127]
    s_waitcnt lgkmcnt(4)
    v_mfma_f32_16x16x32_bf16 v[120:123], v[248:251], v[84:87], v[120:123]
    ds_read_b128 v[80:83], v10 offset:20992
    v_mfma_f32_16x16x32_bf16 v[124:127], v[252:255], v[84:87], v[124:127]
    s_waitcnt lgkmcnt(4)
    v_mfma_f32_16x16x32_bf16 v[128:131], a[160:163], v[88:91], v[32:35]
    ds_read_b128 v[84:87], v10 offset:21056
    v_mfma_f32_16x16x32_bf16 v[132:135], a[164:167], v[88:91], v[36:39]
    s_waitcnt lgkmcnt(4)
    v_mfma_f32_16x16x32_bf16 v[128:131], a[168:171], v[92:95], v[128:131]
    ds_read_b128 v[88:91], v10 offset:21120
    v_mul_f32 v136, v120, v120
    v_mul_f32 v137, v121, v121
    v_mfma_f32_16x16x32_bf16 v[132:135], a[172:175], v[92:95], v[132:135]
    s_waitcnt lgkmcnt(4)
    v_mul_f32 v138, v122, v122
    v_mul_f32 v139, v123, v123
    v_mul_f32 v140, v124, v124
    v_mfma_f32_16x16x32_bf16 v[128:131], a[176:179], v[96:99], v[128:131]
    ds_read_b128 v[92:95], v10 offset:21184
    v_mul_f32 v141, v125, v125
    v_mul_f32 v142, v126, v126
    v_mfma_f32_16x16x32_bf16 v[132:135], a[180:183], v[96:99], v[132:135]
    s_waitcnt lgkmcnt(4)
    v_mul_f32 v143, v127, v127
    v_fmamk_f32 v136, v136, 3184710632, v144
    v_fmamk_f32 v137, v137, 3184710632, v144
    v_mfma_f32_16x16x32_bf16 v[128:131], a[184:187], v[100:103], v[128:131]
    ds_read_b128 v[96:99], v10 offset:21248
    v_fmamk_f32 v138, v138, 3184710632, v144
    v_fmamk_f32 v139, v139, 3184710632, v144
    v_mfma_f32_16x16x32_bf16 v[132:135], a[188:191], v[100:103], v[132:135]
    s_waitcnt lgkmcnt(4)
    v_fmamk_f32 v140, v140, 3184710632, v144
    v_fmamk_f32 v141, v141, 3184710632, v144
    v_fmamk_f32 v142, v142, 3184710632, v144
    v_mfma_f32_16x16x32_bf16 v[128:131], a[192:195], v[80:83], v[128:131]
    ds_read_b128 v[100:103], v10 offset:21312
    v_fmamk_f32 v143, v143, 3184710632, v144
    v_mul_f32 v136, v136, v120
    v_mfma_f32_16x16x32_bf16 v[132:135], a[196:199], v[80:83], v[132:135]
    s_waitcnt lgkmcnt(4)
    v_mul_f32 v137, v137, v121
    v_mul_f32 v138, v138, v122
    v_mul_f32 v139, v139, v123
    v_mfma_f32_16x16x32_bf16 v[128:131], a[200:203], v[84:87], v[128:131]
    ds_read_b128 v[80:83], v10 offset:21376
    v_mul_f32 v140, v140, v124
    v_mul_f32 v141, v141, v125
    v_mfma_f32_16x16x32_bf16 v[132:135], a[204:207], v[84:87], v[132:135]
    s_waitcnt lgkmcnt(4)
    v_mul_f32 v142, v142, v126
    v_mul_f32 v143, v143, v127
    v_exp_f32 v136, v136
    v_mfma_f32_16x16x32_bf16 v[128:131], a[208:211], v[88:91], v[128:131]
    ds_read_b128 v[84:87], v10 offset:21440
    v_exp_f32 v137, v137
    v_mfma_f32_16x16x32_bf16 v[132:135], a[212:215], v[88:91], v[132:135]
    s_waitcnt lgkmcnt(4)
    v_exp_f32 v138, v138
    v_exp_f32 v139, v139
    v_mfma_f32_16x16x32_bf16 v[128:131], a[216:219], v[92:95], v[128:131]
    ds_read_b128 v[88:91], v10 offset:21504
    v_exp_f32 v140, v140
    v_mfma_f32_16x16x32_bf16 v[132:135], a[220:223], v[92:95], v[132:135]
    s_waitcnt lgkmcnt(4)
    v_exp_f32 v141, v141
    v_exp_f32 v142, v142
    v_mfma_f32_16x16x32_bf16 v[128:131], a[224:227], v[96:99], v[128:131]
    ds_read_b128 v[92:95], v10 offset:21568
    v_exp_f32 v143, v143
    v_mfma_f32_16x16x32_bf16 v[132:135], a[228:231], v[96:99], v[132:135]
    s_waitcnt lgkmcnt(4)
    v_add_f32 v136, 1.0, v136
    v_add_f32 v137, 1.0, v137
    v_add_f32 v138, 1.0, v138
    v_mfma_f32_16x16x32_bf16 v[128:131], a[232:235], v[100:103], v[128:131]
    ds_read_b128 v[96:99], v10 offset:21632
    v_add_f32 v139, 1.0, v139
    v_add_f32 v140, 1.0, v140
    v_mfma_f32_16x16x32_bf16 v[132:135], a[236:239], v[100:103], v[132:135]
    v_add_f32 v141, 1.0, v141
    v_add_f32 v142, 1.0, v142
    v_add_f32 v143, 1.0, v143
    buffer_load_dword v148, v2, s[4:7], s23 offen offset:1536 sc1
    s_waitcnt lgkmcnt(4)
    v_mfma_f32_16x16x32_bf16 v[128:131], a[240:243], v[80:83], v[128:131]
    ds_read_b128 v[100:103], v10 offset:21696
    v_rcp_f32 v136, v136
    v_mfma_f32_16x16x32_bf16 v[132:135], a[244:247], v[80:83], v[132:135]
    s_waitcnt lgkmcnt(4)
    v_rcp_f32 v137, v137
    v_rcp_f32 v138, v138
    v_mfma_f32_16x16x32_bf16 v[128:131], a[248:251], v[84:87], v[128:131]
    ds_read_b128 v[80:83], v10 offset:21760
    v_rcp_f32 v139, v139
    v_mfma_f32_16x16x32_bf16 v[132:135], a[252:255], v[84:87], v[132:135]
    s_waitcnt lgkmcnt(4)
    v_rcp_f32 v140, v140
    v_rcp_f32 v141, v141
    v_mfma_f32_16x16x32_bf16 v[128:131], v[192:195], v[88:91], v[128:131]
    ds_read_b128 v[84:87], v10 offset:21824
    v_rcp_f32 v142, v142
    v_mfma_f32_16x16x32_bf16 v[132:135], v[196:199], v[88:91], v[132:135]
    s_waitcnt lgkmcnt(4)
    v_rcp_f32 v143, v143
    v_mul_f32 v136, v136, v120
    v_mfma_f32_16x16x32_bf16 v[128:131], v[200:203], v[92:95], v[128:131]
    ds_read_b128 v[88:91], v10 offset:21888
    v_mul_f32 v137, v137, v121
    v_mul_f32 v138, v138, v122
    v_mfma_f32_16x16x32_bf16 v[132:135], v[204:207], v[92:95], v[132:135]
    s_waitcnt lgkmcnt(4)
    v_mul_f32 v139, v139, v123
    v_mul_f32 v140, v140, v124
    v_mul_f32 v141, v141, v125
    v_mfma_f32_16x16x32_bf16 v[128:131], v[208:211], v[96:99], v[128:131]
    ds_read_b128 v[92:95], v10 offset:21952
    v_mul_f32 v142, v142, v126
    v_mul_f32 v143, v143, v127
    v_mfma_f32_16x16x32_bf16 v[132:135], v[212:215], v[96:99], v[132:135]
    s_waitcnt lgkmcnt(4)
    v_cvt_pk_bf16_f32 v120, v136, v137
    v_cvt_pk_bf16_f32 v121, v138, v139
    v_cvt_pk_bf16_f32 v122, v140, v141
    v_mfma_f32_16x16x32_bf16 v[128:131], v[216:219], v[100:103], v[128:131]
    v_cvt_pk_bf16_f32 v123, v142, v143
    ds_write_b128 v11, v[120:123] offset:45056
    v_mfma_f32_16x16x32_bf16 v[132:135], v[220:223], v[100:103], v[132:135]
    s_waitcnt lgkmcnt(4)
    v_mfma_f32_16x16x32_bf16 v[128:131], v[224:227], v[80:83], v[128:131]
    v_mfma_f32_16x16x32_bf16 v[132:135], v[228:231], v[80:83], v[132:135]
    s_waitcnt lgkmcnt(3)
    v_mfma_f32_16x16x32_bf16 v[128:131], v[232:235], v[84:87], v[128:131]
    v_mfma_f32_16x16x32_bf16 v[132:135], v[236:239], v[84:87], v[132:135]
    s_waitcnt lgkmcnt(0)
    s_barrier
    ds_read_b128 v[48:51], v1 offset:45056
    ds_read_b128 v[52:55], v1 offset:46080
    ds_read_b128 v[56:59], v1 offset:47104
    ds_read_b128 v[60:63], v1 offset:48128
    v_mfma_f32_16x16x32_bf16 v[128:131], v[240:243], v[88:91], v[128:131]
    v_mfma_f32_16x16x32_bf16 v[132:135], v[244:247], v[88:91], v[132:135]
    v_mfma_f32_16x16x32_bf16 v[128:131], v[248:251], v[92:95], v[128:131]
    s_nop 2
    v_mfma_f32_16x16x32_bf16 v[132:135], v[252:255], v[92:95], v[132:135]
    s_nop 0
    s_waitcnt lgkmcnt(3)
    v_mfma_f32_16x16x32_bf16 v[80:83], v[48:51], a[0:3], 0
    v_mfma_f32_16x16x32_bf16 v[84:87], v[48:51], a[4:7], 0
    v_mul_f32 v136, v128, v128
    v_mul_f32 v137, v129, v129
    v_mul_f32 v138, v130, v130
    v_mfma_f32_16x16x32_bf16 v[88:91], v[48:51], a[8:11], 0
    v_mul_f32 v139, v131, v131
    v_mul_f32 v140, v132, v132
    v_mul_f32 v141, v133, v133
    v_mfma_f32_16x16x32_bf16 v[92:95], v[48:51], a[12:15], 0
    v_mul_f32 v142, v134, v134
    v_mul_f32 v143, v135, v135
    v_fmamk_f32 v136, v136, 3184710632, v144
    v_mfma_f32_16x16x32_bf16 v[96:99], v[48:51], a[16:19], 0
    v_fmamk_f32 v137, v137, 3184710632, v144
    v_fmamk_f32 v138, v138, 3184710632, v144
    v_fmamk_f32 v139, v139, 3184710632, v144
    v_mfma_f32_16x16x32_bf16 v[100:103], v[48:51], a[20:23], 0
    v_fmamk_f32 v140, v140, 3184710632, v144
    v_fmamk_f32 v141, v141, 3184710632, v144
    v_fmamk_f32 v142, v142, 3184710632, v144
    v_mfma_f32_16x16x32_bf16 v[104:107], v[48:51], a[24:27], 0
    v_fmamk_f32 v143, v143, 3184710632, v144
    v_mul_f32 v136, v136, v128
    v_mul_f32 v137, v137, v129
    v_mfma_f32_16x16x32_bf16 v[108:111], v[48:51], a[28:31], 0
    v_mul_f32 v138, v138, v130
    v_mul_f32 v139, v139, v131
    v_mul_f32 v140, v140, v132
    v_mfma_f32_16x16x32_bf16 v[112:115], v[48:51], a[32:35], 0
    v_mul_f32 v141, v141, v133
    v_mul_f32 v142, v142, v134
    v_mul_f32 v143, v143, v135
    v_mfma_f32_16x16x32_bf16 v[116:119], v[48:51], a[36:39], 0
    s_waitcnt lgkmcnt(2)
    v_exp_f32 v136, v136
    v_exp_f32 v137, v137
    v_mfma_f32_16x16x32_bf16 v[80:83], v[52:55], a[40:43], v[80:83]
    v_exp_f32 v138, v138
    v_exp_f32 v139, v139
    v_mfma_f32_16x16x32_bf16 v[84:87], v[52:55], a[44:47], v[84:87]
    v_exp_f32 v140, v140
    v_exp_f32 v141, v141
    v_mfma_f32_16x16x32_bf16 v[88:91], v[52:55], a[48:51], v[88:91]
    v_exp_f32 v142, v142
    v_exp_f32 v143, v143
    v_mfma_f32_16x16x32_bf16 v[92:95], v[52:55], a[52:55], v[92:95]
    v_add_f32 v136, 1.0, v136
    v_add_f32 v137, 1.0, v137
    v_add_f32 v138, 1.0, v138
    v_mfma_f32_16x16x32_bf16 v[96:99], v[52:55], a[56:59], v[96:99]
    v_add_f32 v139, 1.0, v139
    v_add_f32 v140, 1.0, v140
    v_add_f32 v141, 1.0, v141
    v_mfma_f32_16x16x32_bf16 v[100:103], v[52:55], a[60:63], v[100:103]
    v_add_f32 v142, 1.0, v142
    v_add_f32 v143, 1.0, v143
    v_rcp_f32 v136, v136
    v_mfma_f32_16x16x32_bf16 v[104:107], v[52:55], a[64:67], v[104:107]
    v_rcp_f32 v137, v137
    v_rcp_f32 v138, v138
    v_mfma_f32_16x16x32_bf16 v[108:111], v[52:55], a[68:71], v[108:111]
    v_rcp_f32 v139, v139
    v_rcp_f32 v140, v140
    v_mfma_f32_16x16x32_bf16 v[112:115], v[52:55], a[72:75], v[112:115]
    v_rcp_f32 v141, v141
    v_rcp_f32 v142, v142
    v_mfma_f32_16x16x32_bf16 v[116:119], v[52:55], a[76:79], v[116:119]
    s_waitcnt lgkmcnt(1)
    v_rcp_f32 v143, v143
    v_mul_f32 v136, v136, v128
    v_mfma_f32_16x16x32_bf16 v[80:83], v[56:59], a[80:83], v[80:83]
    v_mul_f32 v137, v137, v129
    v_mul_f32 v138, v138, v130
    v_mul_f32 v139, v139, v131
    v_mfma_f32_16x16x32_bf16 v[84:87], v[56:59], a[84:87], v[84:87]
    v_mul_f32 v140, v140, v132
    v_mul_f32 v141, v141, v133
    v_mul_f32 v142, v142, v134
    v_mfma_f32_16x16x32_bf16 v[88:91], v[56:59], a[88:91], v[88:91]
    v_mul_f32 v143, v143, v135
    v_cvt_pk_bf16_f32 v128, v136, v137
    v_cvt_pk_bf16_f32 v129, v138, v139
    v_mfma_f32_16x16x32_bf16 v[92:95], v[56:59], a[92:95], v[92:95]
    v_cvt_pk_bf16_f32 v130, v140, v141
    v_cvt_pk_bf16_f32 v131, v142, v143
    ds_write_b128 v11, v[128:131] offset:49152
    v_mfma_f32_16x16x32_bf16 v[96:99], v[56:59], a[96:99], v[96:99]
    v_mfma_f32_16x16x32_bf16 v[100:103], v[56:59], a[100:103], v[100:103]
    v_mfma_f32_16x16x32_bf16 v[104:107], v[56:59], a[104:107], v[104:107]
    v_mfma_f32_16x16x32_bf16 v[108:111], v[56:59], a[108:111], v[108:111]
    v_mfma_f32_16x16x32_bf16 v[112:115], v[56:59], a[112:115], v[112:115]
    s_waitcnt lgkmcnt(0)
    s_barrier
    ds_read_b128 v[64:67], v1 offset:49152
    ds_read_b128 v[68:71], v1 offset:50176
    ds_read_b128 v[72:75], v1 offset:51200
    ds_read_b128 v[76:79], v1 offset:52224
    v_mfma_f32_16x16x32_bf16 v[116:119], v[56:59], a[116:119], v[116:119]
    v_mfma_f32_16x16x32_bf16 v[80:83], v[60:63], a[120:123], v[80:83]
    v_mfma_f32_16x16x32_bf16 v[84:87], v[60:63], a[124:127], v[84:87]
    v_mfma_f32_16x16x32_bf16 v[88:91], v[60:63], a[128:131], v[88:91]
    v_mfma_f32_16x16x32_bf16 v[92:95], v[60:63], a[132:135], v[92:95]
    v_mfma_f32_16x16x32_bf16 v[96:99], v[60:63], a[136:139], v[96:99]
    v_mfma_f32_16x16x32_bf16 v[100:103], v[60:63], a[140:143], v[100:103]
    v_mfma_f32_16x16x32_bf16 v[104:107], v[60:63], a[144:147], v[104:107]
    v_mfma_f32_16x16x32_bf16 v[108:111], v[60:63], a[148:151], v[108:111]
    v_mfma_f32_16x16x32_bf16 v[112:115], v[60:63], a[152:155], v[112:115]
    v_mfma_f32_16x16x32_bf16 v[116:119], v[60:63], a[156:159], v[116:119]
    s_waitcnt vmcnt(0)
    v_cmp_gt_u32 vcc, s17, v148
    s_cbranch_vccz Lokd68
Lwf69:
    buffer_load_dword v148, v2, s[4:7], s23 offen offset:1536 sc1
    s_waitcnt vmcnt(0)
    v_cmp_gt_u32 vcc, s17, v148
    s_cbranch_vccz Lwf69d
    s_sub_u32 s15, s15, 1
    s_cbranch_scc0 Lwf69
    s_mov_b32 s15, 0
Lwf69d:
Lokd68:
    s_waitcnt lgkmcnt(3)
    v_mfma_f32_16x16x32_bf16 v[120:123], v[64:67], a[0:3], 0
    v_mfma_f32_16x16x32_bf16 v[124:127], v[64:67], a[4:7], 0
    v_cvt_pk_bf16_f32 v160, v80, v84
    v_mfma_f32_16x16x32_bf16 v[128:131], v[64:67], a[8:11], 0
    v_cvt_pk_bf16_f32 v161, v88, v92
    v_mfma_f32_16x16x32_bf16 v[132:135], v[64:67], a[12:15], 0
    v_cvt_pk_bf16_f32 v162, v96, v100
    v_mfma_f32_16x16x32_bf16 v[136:139], v[64:67], a[16:19], 0
    v_cvt_pk_bf16_f32 v163, v104, v108
    v_mfma_f32_16x16x32_bf16 v[140:143], v[64:67], a[20:23], 0
    s_add_u32 s18, s21, 0
    buffer_store_dwordx4 v[160:163], v4, s[4:7], s18 offen sc1
    v_mfma_f32_16x16x32_bf16 v[144:147], v[64:67], a[24:27], 0
    v_cvt_pk_bf16_f32 v166, v81, v85
    v_mfma_f32_16x16x32_bf16 v[148:151], v[64:67], a[28:31], 0
    s_waitcnt lgkmcnt(2)
    v_cvt_pk_bf16_f32 v167, v89, v93
    v_mfma_f32_16x16x32_bf16 v[120:123], v[68:71], a[40:43], v[120:123]
    v_cvt_pk_bf16_f32 v168, v97, v101
    v_mfma_f32_16x16x32_bf16 v[124:127], v[68:71], a[44:47], v[124:127]
    v_cvt_pk_bf16_f32 v169, v105, v109
    v_mfma_f32_16x16x32_bf16 v[128:131], v[68:71], a[48:51], v[128:131]
    s_add_u32 s18, s21, 65536
    buffer_store_dwordx4 v[166:169], v4, s[4:7], s18 offen sc1
    v_mfma_f32_16x16x32_bf16 v[132:135], v[68:71], a[52:55], v[132:135]
    v_cvt_pk_bf16_f32 v172, v82, v86
    v_mfma_f32_16x16x32_bf16 v[136:139], v[68:71], a[56:59], v[136:139]
    v_cvt_pk_bf16_f32 v173, v90, v94
    v_mfma_f32_16x16x32_bf16 v[140:143], v[68:71], a[60:63], v[140:143]
    v_cvt_pk_bf16_f32 v174, v98, v102
    v_mfma_f32_16x16x32_bf16 v[144:147], v[68:71], a[64:67], v[144:147]
    v_cvt_pk_bf16_f32 v175, v106, v110
    v_mfma_f32_16x16x32_bf16 v[148:151], v[68:71], a[68:71], v[148:151]
    s_waitcnt lgkmcnt(1)
    s_add_u32 s18, s21, 131072
    buffer_store_dwordx4 v[172:175], v4, s[4:7], s18 offen sc1
    v_mfma_f32_16x16x32_bf16 v[120:123], v[72:75], a[80:83], v[120:123]
    v_cvt_pk_bf16_f32 v178, v83, v87
    v_mfma_f32_16x16x32_bf16 v[124:127], v[72:75], a[84:87], v[124:127]
    v_cvt_pk_bf16_f32 v179, v91, v95
    v_mfma_f32_16x16x32_bf16 v[128:131], v[72:75], a[88:91], v[128:131]
    v_cvt_pk_bf16_f32 v180, v99, v103
    v_mfma_f32_16x16x32_bf16 v[132:135], v[72:75], a[92:95], v[132:135]
    v_cvt_pk_bf16_f32 v181, v107, v111
    v_mfma_f32_16x16x32_bf16 v[136:139], v[72:75], a[96:99], v[136:139]
    s_add_u32 s18, s21, 196608
    buffer_store_dwordx4 v[178:181], v4, s[4:7], s18 offen sc1
    v_mfma_f32_16x16x32_bf16 v[140:143], v[72:75], a[100:103], v[140:143]
    v_cvt_pk_bf16_f32 v164, v112, v116
    v_mfma_f32_16x16x32_bf16 v[144:147], v[72:75], a[104:107], v[144:147]
    v_cvt_pk_bf16_f32 v170, v113, v117
    v_mfma_f32_16x16x32_bf16 v[148:151], v[72:75], a[108:111], v[148:151]
    s_waitcnt lgkmcnt(0)
    v_cvt_pk_bf16_f32 v176, v114, v118
    v_mfma_f32_16x16x32_bf16 v[120:123], v[76:79], a[120:123], v[120:123]
    v_cvt_pk_bf16_f32 v182, v115, v119
    v_mfma_f32_16x16x32_bf16 v[124:127], v[76:79], a[124:127], v[124:127]
    s_add_u32 s18, s21, 0
    buffer_store_dword v164, v5, s[4:7], s18 offen offset:256 sc1
    v_mfma_f32_16x16x32_bf16 v[128:131], v[76:79], a[128:131], v[128:131]
    s_add_u32 s18, s21, 65536
    buffer_store_dword v170, v5, s[4:7], s18 offen offset:256 sc1
    v_mfma_f32_16x16x32_bf16 v[132:135], v[76:79], a[132:135], v[132:135]
    s_add_u32 s18, s21, 131072
    buffer_store_dword v176, v5, s[4:7], s18 offen offset:256 sc1
    v_mfma_f32_16x16x32_bf16 v[136:139], v[76:79], a[136:139], v[136:139]
    s_add_u32 s18, s21, 196608
    buffer_store_dword v182, v5, s[4:7], s18 offen offset:256 sc1
    v_mfma_f32_16x16x32_bf16 v[140:143], v[76:79], a[140:143], v[140:143]
    s_nop 1
    v_mfma_f32_16x16x32_bf16 v[144:147], v[76:79], a[144:147], v[144:147]
    v_mfma_f32_16x16x32_bf16 v[148:151], v[76:79], a[148:151], v[148:151]
    s_nop 1
    v_mfma_f32_16x16x32_bf16 v[152:155], v[64:67], a[32:35], 0
    v_mfma_f32_16x16x32_bf16 v[156:159], v[64:67], a[36:39], 0
    v_cvt_pk_bf16_f32 v160, v120, v124
    v_cvt_pk_bf16_f32 v161, v128, v132
    v_cvt_pk_bf16_f32 v162, v136, v140
    v_mfma_f32_16x16x32_bf16 v[152:155], v[68:71], a[72:75], v[152:155]
    v_cvt_pk_bf16_f32 v163, v144, v148
    s_add_u32 s18, s21, 1048576
    buffer_store_dwordx4 v[160:163], v4, s[4:7], s18 offen sc1
    v_cvt_pk_bf16_f32 v166, v121, v125
    v_mfma_f32_16x16x32_bf16 v[156:159], v[68:71], a[76:79], v[156:159]
    v_cvt_pk_bf16_f32 v167, v129, v133
    v_cvt_pk_bf16_f32 v168, v137, v141
    v_cvt_pk_bf16_f32 v169, v145, v149
    v_mfma_f32_16x16x32_bf16 v[152:155], v[72:75], a[112:115], v[152:155]
    s_add_u32 s18, s21, 1114112
    buffer_store_dwordx4 v[166:169], v4, s[4:7], s18 offen sc1
    v_cvt_pk_bf16_f32 v172, v122, v126
    v_cvt_pk_bf16_f32 v173, v130, v134
    v_mfma_f32_16x16x32_bf16 v[156:159], v[72:75], a[116:119], v[156:159]
    v_cvt_pk_bf16_f32 v174, v138, v142
    v_cvt_pk_bf16_f32 v175, v146, v150
    s_add_u32 s18, s21, 1179648
    buffer_store_dwordx4 v[172:175], v4, s[4:7], s18 offen sc1
    v_mfma_f32_16x16x32_bf16 v[152:155], v[76:79], a[152:155], v[152:155]
    v_cvt_pk_bf16_f32 v178, v123, v127
    v_cvt_pk_bf16_f32 v179, v131, v135
    v_cvt_pk_bf16_f32 v180, v139, v143
    v_mfma_f32_16x16x32_bf16 v[156:159], v[76:79], a[156:159], v[156:159]
    s_nop 0
    v_cvt_pk_bf16_f32 v181, v147, v151
    s_add_u32 s18, s21, 1245184
    buffer_store_dwordx4 v[178:181], v4, s[4:7], s18 offen sc1
    s_nop 1
    v_mov_b32 v3, v3
    s_nop 0
    v_cvt_pk_bf16_f32 v164, v152, v156
    v_cvt_pk_bf16_f32 v170, v153, v157
    v_cvt_pk_bf16_f32 v176, v154, v158
    v_cvt_pk_bf16_f32 v182, v155, v159
    s_add_u32 s18, s21, 1048576
    buffer_store_dword v164, v5, s[4:7], s18 offen offset:256 sc1
    s_add_u32 s18, s21, 1114112
    buffer_store_dword v170, v5, s[4:7], s18 offen offset:256 sc1
    s_add_u32 s18, s21, 1179648
    buffer_store_dword v176, v5, s[4:7], s18 offen offset:256 sc1
    s_add_u32 s18, s21, 1245184
    buffer_store_dword v182, v5, s[4:7], s18 offen offset:256 sc1
    s_waitcnt vmcnt(0)
    buffer_store_dword v46, off, s[4:7], s52 offset:1024 sc1
    s_branch Lnomlp66
Lnomlp66a:
    buffer_load_dword v40, v2, s[4:7], s20 offen offset:0 sc1
    buffer_load_dword v41, v2, s[4:7], s20 offen offset:256 sc1
    buffer_load_dword v42, v2, s[4:7], s20 offen offset:512 sc1
    buffer_load_dword v43, v2, s[4:7], s20 offen offset:768 sc1
    buffer_load_dword v44, v2, s[4:7], s20 offen offset:1024 sc1
    s_waitcnt vmcnt(0)
    buffer_store_dword v46, off, s[4:7], s52 offset:1536 sc1
Lnomlp66:
    s_mov_b32 exec_lo, 0xffffffff
    s_mov_b32 exec_hi, 0xffffff
    v_mov_b32 v45, 0
Lpf70:
    buffer_load_dword v45, v2, s[4:7], s23 offen offset:1024 sc1
    s_waitcnt vmcnt(1)
    v_cmp_gt_u32 vcc, s17, v45
    s_cbranch_vccz Lpf70d
    s_sub_u32 s15, s15, 1
    s_cbranch_scc0 Lpf70
    s_mov_b32 s15, 0
Lpf70d:
    s_mov_b64 exec, -1
    s_add_u32 s18, s22, 0
    buffer_load_dwordx4 v[48:51], v6, s[4:7], s18 offen offset:0 sc1
    buffer_load_dwordx4 v[52:55], v6, s[4:7], s18 offen offset:256 sc1
    buffer_load_dwordx4 v[56:59], v6, s[4:7], s18 offen offset:512 sc1
    buffer_load_dwordx4 v[60:63], v6, s[4:7], s18 offen offset:768 sc1
    buffer_load_dwordx4 v[64:67], v6, s[4:7], s18 offen offset:1024 sc1
    s_add_u32 s18, s22, 16384
    buffer_load_dwordx4 v[68:71], v7, s[4:7], s18 offen offset:0 sc1
    buffer_load_dwordx4 v[72:75], v7, s[4:7], s18 offen offset:256 sc1
    buffer_load_dwordx4 v[76:79], v7, s[4:7], s18 offen offset:512 sc1
    buffer_load_dwordx4 v[80:83], v7, s[4:7], s18 offen offset:768 sc1
    buffer_load_dwordx4 v[84:87], v7, s[4:7], s18 offen offset:1024 sc1
    s_lshl_b32 s19, s16, 5
    s_add_u32 s19, s19, s51
    s_mul_i32 s19, s19, 1280
    v_and_b32 v109, 0xffff0000, v40
    v_lshlrev_b32 v108, 16, v40
    v_and_b32 v119, 0xffff0000, v20
    v_lshlrev_b32 v118, 16, v20
    v_and_b32 v129, 0xffff0000, v25
    v_lshlrev_b32 v128, 16, v25
    v_and_b32 v111, 0xffff0000, v41
    v_lshlrev_b32 v110, 16, v41
    v_and_b32 v121, 0xffff0000, v21
    v_lshlrev_b32 v120, 16, v21
    v_and_b32 v131, 0xffff0000, v26
    v_lshlrev_b32 v130, 16, v26
    v_and_b32 v113, 0xffff0000, v42
    v_lshlrev_b32 v112, 16, v42
    v_and_b32 v123, 0xffff0000, v22
    v_lshlrev_b32 v122, 16, v22
    v_and_b32 v133, 0xffff0000, v27
    v_lshlrev_b32 v132, 16, v27
    v_and_b32 v115, 0xffff0000, v43
    v_lshlrev_b32 v114, 16, v43
    v_and_b32 v125, 0xffff0000, v23
    v_lshlrev_b32 v124, 16, v23
    v_and_b32 v135, 0xffff0000, v28
    v_lshlrev_b32 v134, 16, v28
    v_and_b32 v117, 0xffff0000, v44
    v_lshlrev_b32 v116, 16, v44
    v_and_b32 v127, 0xffff0000, v24
    v_lshlrev_b32 v126, 16, v24
    v_and_b32 v137, 0xffff0000, v29
    v_lshlrev_b32 v136, 16, v29
    v_fmac_f32 v108, v118, v128
    v_fmac_f32 v109, v119, v129
    v_fmac_f32 v110, v120, v130
    v_fmac_f32 v111, v121, v131
    v_fmac_f32 v112, v122, v132
    v_fmac_f32 v113, v123, v133
    v_fmac_f32 v114, v124, v134
    v_fmac_f32 v115, v125, v135
    v_fmac_f32 v116, v126, v136
    v_fmac_f32 v117, v127, v137
    s_waitcnt vmcnt(9)
    v_mfma_f32_16x16x32_bf16 v[88:91], v[16:19], v[48:51], 0
    s_waitcnt vmcnt(8)
    v_mfma_f32_16x16x32_bf16 v[92:95], v[16:19], v[52:55], 0
    s_waitcnt vmcnt(7)
    v_mfma_f32_16x16x32_bf16 v[96:99], v[16:19], v[56:59], 0
    s_waitcnt vmcnt(6)
    v_mfma_f32_16x16x32_bf16 v[100:103], v[16:19], v[60:63], 0
    s_waitcnt vmcnt(5)
    v_mfma_f32_16x16x32_bf16 v[104:107], v[16:19], v[64:67], 0
    s_waitcnt vmcnt(4)
    v_mfma_f32_16x16x32_bf16 v[88:91], v[16:19], v[68:71], v[88:91]
    s_waitcnt vmcnt(3)
    v_mfma_f32_16x16x32_bf16 v[92:95], v[16:19], v[72:75], v[92:95]
    s_waitcnt vmcnt(2)
    v_mfma_f32_16x16x32_bf16 v[96:99], v[16:19], v[76:79], v[96:99]
    s_nop 0
    s_waitcnt vmcnt(1)
    v_mfma_f32_16x16x32_bf16 v[100:103], v[16:19], v[80:83], v[100:103]
    s_nop 1
    s_waitcnt vmcnt(0)
    v_mfma_f32_16x16x32_bf16 v[104:107], v[16:19], v[84:87], v[104:107]
    s_mov_b32 exec_hi, 0
    ds_write_b128 v8, v[88:91] offset:53248
    ds_write_b128 v8, v[92:95] offset:53760
    ds_write_b128 v8, v[96:99] offset:54272
    ds_write_b128 v8, v[100:103] offset:54784
    s_nop 2
    ds_write_b128 v8, v[104:107] offset:55296
    s_mov_b64 exec, -1
    s_waitcnt lgkmcnt(0)
    s_barrier
    s_cmp_lg_u32 s26, 0
    s_cbranch_scc1 Lp871
    ds_read_b64 v[48:49], v9 offset:53248
    ds_read_b64 v[58:59], v9 offset:55808
    ds_read_b64 v[50:51], v9 offset:53760
    ds_read_b64 v[60:61], v9 offset:56320
    ds_read_b64 v[52:53], v9 offset:54272
    ds_read_b64 v[62:63], v9 offset:56832
    ds_read_b64 v[54:55], v9 offset:54784
    ds_read_b64 v[64:65], v9 offset:57344
    ds_read_b64 v[56:57], v9 offset:55296
    ds_read_b64 v[66:67], v9 offset:57856
    s_waitcnt lgkmcnt(8)
    v_add_f32 v48, v48, v58
    v_add_f32 v49, v49, v59
    s_waitcnt lgkmcnt(6)
    v_add_f32 v50, v50, v60
    v_add_f32 v51, v51, v61
    s_waitcnt lgkmcnt(4)
    v_add_f32 v52, v52, v62
    v_add_f32 v53, v53, v63
    s_waitcnt lgkmcnt(2)
    v_add_f32 v54, v54, v64
    v_add_f32 v55, v55, v65
    s_waitcnt lgkmcnt(0)
    v_add_f32 v56, v56, v66
    v_add_f32 v57, v57, v67
    v_fmac_f32 v108, v118, v48
    v_fmac_f32 v109, v119, v49
    v_cvt_pk_bf16_f32 v68, v108, v109
    buffer_store_dword v68, v2, s[76:79], s19 offen offset:0
    v_fmac_f32 v110, v120, v50
    v_fmac_f32 v111, v121, v51
    v_cvt_pk_bf16_f32 v69, v110, v111
    buffer_store_dword v69, v2, s[76:79], s19 offen offset:256
    v_fmac_f32 v112, v122, v52
    v_fmac_f32 v113, v123, v53
    v_cvt_pk_bf16_f32 v70, v112, v113
    buffer_store_dword v70, v2, s[76:79], s19 offen offset:512
    v_fmac_f32 v114, v124, v54
    v_fmac_f32 v115, v125, v55
    v_cvt_pk_bf16_f32 v71, v114, v115
    buffer_store_dword v71, v2, s[76:79], s19 offen offset:768
    v_fmac_f32 v116, v126, v56
    v_fmac_f32 v117, v127, v57
    v_cvt_pk_bf16_f32 v72, v116, v117
    buffer_store_dword v72, v2, s[76:79], s19 offen offset:1024
Lp871:
    s_add_u32 s17, s17, 1
    s_xor_b32 s28, s28, 0x20000
    s_add_u32 s16, s16, 4
    s_cmp_lt_u32 s16, 64
    s_cbranch_scc1 Lunit58
    s_waitcnt vmcnt(0) lgkmcnt(0)
    s_endpgm
L_chain:
    s_mov_b32 s31, 64
    s_cmp_eq_u32 s13, 1
    s_cbranch_scc1 Lcw1
    s_cmp_eq_u32 s13, 2
    s_cbranch_scc1 Lcw2
    s_cmp_eq_u32 s13, 3
    s_cbranch_scc1 Lcw3
Lcw0:
    v_lshrrev_b32 v16, 4, v0
    v_and_b32 v17, 15, v0
    v_lshlrev_b32 v18, 13, v16
    v_lshl_add_u32 v2, v17, 4, v18
    v_mul_u32_u24 v18, 1280, v16
    v_lshl_add_u32 v3, v17, 4, v18
    v_lshrrev_b32 v18, 3, v0
    v_mul_u32_u24 v18, 1280, v18
    v_and_b32 v19, 7, v0
    v_lshl_add_u32 v4, v19, 4, v18
    v_lshlrev_b32 v10, 4, v0
    v_add_u32 v1, 16384, v10
    v_and_b32 v18, 1, v16
    v_lshlrev_b32 v19, 5, v18
    v_xor_b32 v5, v10, v19
    v_xor_b32 v6, 64, v5
    v_xor_b32 v7, 0x80, v5
    v_xor_b32 v8, 0xc0, v5
    v_lshlrev_b32 v19, 6, v18
    v_xor_b32 v9, v10, v19
    v_xor_b32 v9, 0, v9
    v_lshrrev_b32 v16, 5, v0
    v_bfe_u32 v17, v0, 4, 1
    v_bfe_u32 v18, v0, 3, 1
    v_bfe_u32 v19, v0, 2, 1
    v_and_b32 v20, 3, v0
    v_lshlrev_b32 v20, 3, v20
    v_lshl_add_u32 v11, v16, 12, v20
    v_lshl_add_u32 v11, v17, 10, v11
    v_lshl_add_u32 v11, v18, 11, v11
    v_lshl_add_u32 v11, v19, 8, v11
    v_lshl_add_u32 v11, v19, 5, v11
    v_lshl_add_u32 v11, v17, 6, v11
    v_lshl_add_u32 v11, v18, 7, v11
    v_xor_b32 v11, 0, v11
    v_xor_b32 v12, 32, v11
    v_lshl_add_u32 v20, v18, 5, v20
    v_lshlrev_b32 v18, 4, v17
    v_lshl_add_u32 v18, v16, 2, v18
    v_add_u32 v18, v18, v19
    v_lshl_add_u32 v14, v18, 7, v20
    v_lshl_add_u32 v13, v18, 8, v20
    v_lshl_add_u32 v13, v19, 6, v13
    v_lshl_add_u32 v13, v17, 7, v13
    v_xor_b32 v13, 0, v13
    s_load_dwordx2 s[52:53], s[0:1], 16
    s_load_dwordx2 s[56:57], s[0:1], 24
    s_load_dwordx2 s[60:61], s[0:1], 32
    s_load_dwordx2 s[64:65], s[0:1], 40
    s_waitcnt lgkmcnt(0)
    s_mov_b32 s54, 5242880
    s_mov_b32 s55, 0x20000
    s_mov_b32 s58, 5242880
    s_mov_b32 s59, 0x20000
    s_mov_b32 s62, 5242880
    s_mov_b32 s63, 0x20000
    s_mov_b32 s66, 5242880
    s_mov_b32 s67, 0x20000
    s_lshl_b32 s71, s12, 8
    s_mul_i32 s68, s3, 2621440
    s_sub_u32 s69, 2621440, s68
    s_add_u32 s68, s68, s71
    s_add_u32 s69, s69, s71
    s_mul_i32 s70, s12, 163840
    s_mul_i32 s71, s3, 640
    s_add_u32 s70, s70, s71
    s_add_u32 s71, s68, 0
    buffer_load_dwordx4 v[16:19], v2, s[52:55], s71 offen
    s_add_u32 s71, s68, 32768
    buffer_load_dwordx4 v[20:23], v2, s[52:55], s71 offen
    s_add_u32 s71, s68, 65536
    buffer_load_dwordx4 v[24:27], v2, s[52:55], s71 offen
    s_add_u32 s71, s68, 98304
    buffer_load_dwordx4 v[28:31], v2, s[52:55], s71 offen
    s_add_u32 s71, s68, 0
    buffer_load_dwordx4 v[32:35], v2, s[56:59], s71 offen
    s_add_u32 s71, s68, 32768
    buffer_load_dwordx4 v[36:39], v2, s[56:59], s71 offen
    s_add_u32 s71, s68, 65536
    buffer_load_dwordx4 v[40:43], v2, s[56:59], s71 offen
    s_add_u32 s71, s68, 98304
    buffer_load_dwordx4 v[44:47], v2, s[56:59], s71 offen
    s_add_u32 s71, s68, 0
    buffer_load_dwordx4 v[96:99], v2, s[60:63], s71 offen
    s_add_u32 s71, s68, 32768
    buffer_load_dwordx4 v[100:103], v2, s[60:63], s71 offen
    s_add_u32 s71, s68, 65536
    buffer_load_dwordx4 v[104:107], v2, s[60:63], s71 offen
    s_add_u32 s71, s68, 98304
    buffer_load_dwordx4 v[108:111], v2, s[60:63], s71 offen
    s_add_u32 s71, s69, 0
    buffer_load_dwordx4 v[224:227], v2, s[52:55], s71 offen
    s_add_u32 s71, s69, 32768
    buffer_load_dwordx4 v[228:231], v2, s[52:55], s71 offen
    s_add_u32 s71, s69, 65536
    buffer_load_dwordx4 v[48:51], v2, s[52:55], s71 offen
    s_add_u32 s71, s69, 98304
    buffer_load_dwordx4 v[52:55], v2, s[52:55], s71 offen
    s_add_u32 s71, s69, 0
    buffer_load_dwordx4 v[232:235], v2, s[56:59], s71 offen
    s_add_u32 s71, s69, 32768
    buffer_load_dwordx4 v[236:239], v2, s[56:59], s71 offen
    s_add_u32 s71, s69, 65536
    buffer_load_dwordx4 v[240:243], v2, s[56:59], s71 offen
    s_add_u32 s71, s69, 98304
    buffer_load_dwordx4 v[244:247], v2, s[56:59], s71 offen
    s_add_u32 s71, s69, 0
    buffer_load_dwordx4 v[248:251], v2, s[60:63], s71 offen
    s_add_u32 s71, s69, 32768
    buffer_load_dwordx4 v[252:255], v2, s[60:63], s71 offen
    s_add_u32 s71, s69, 65536
    buffer_load_dwordx4 a[0:3], v2, s[60:63], s71 offen
    s_add_u32 s71, s69, 98304
    buffer_load_dwordx4 a[4:7], v2, s[60:63], s71 offen
    s_waitcnt vmcnt(23)
    ds_write_b128 v5, v[16:19] offset:0
    s_waitcnt vmcnt(22)
    ds_write_b128 v6, v[20:23] offset:1024
    s_waitcnt vmcnt(21)
    ds_write_b128 v7, v[24:27] offset:2048
    s_waitcnt vmcnt(20)
    ds_write_b128 v8, v[28:31] offset:3072
    s_waitcnt lgkmcnt(0)
    s_barrier
    ds_read_b64_tr_b16 v[16:17], v11 offset:0
    ds_read_b64_tr_b16 v[18:19], v11 offset:512
    ds_read_b64_tr_b16 v[20:21], v11 offset:8192
    ds_read_b64_tr_b16 v[22:23], v11 offset:8704
    ds_read_b64_tr_b16 v[24:25], v12 offset:0
    ds_read_b64_tr_b16 v[26:27], v12 offset:512
    ds_read_b64_tr_b16 v[28:29], v12 offset:8192
    ds_read_b64_tr_b16 v[30:31], v12 offset:8704
    s_waitcnt lgkmcnt(0)
    s_barrier
    ds_write_b128 v1, v[16:19] offset:0
    ds_write_b128 v1, v[20:23] offset:1024
    ds_write_b128 v1, v[24:27] offset:2048
    ds_write_b128 v1, v[28:31] offset:3072
    s_add_u32 s71, s68, 524288
    buffer_load_dwordx4 v[112:115], v2, s[52:55], s71 offen
    s_add_u32 s71, s68, 557056
    buffer_load_dwordx4 v[116:119], v2, s[52:55], s71 offen
    s_add_u32 s71, s68, 589824
    buffer_load_dwordx4 v[120:123], v2, s[52:55], s71 offen
    s_add_u32 s71, s68, 622592
    buffer_load_dwordx4 v[124:127], v2, s[52:55], s71 offen
    s_waitcnt vmcnt(23)
    ds_write_b128 v5, v[32:35] offset:0
    s_waitcnt vmcnt(22)
    ds_write_b128 v6, v[36:39] offset:1024
    s_waitcnt vmcnt(21)
    ds_write_b128 v7, v[40:43] offset:2048
    s_waitcnt vmcnt(20)
    ds_write_b128 v8, v[44:47] offset:3072
    s_waitcnt lgkmcnt(0)
    s_barrier
    ds_read_b64_tr_b16 v[32:33], v11 offset:0
    ds_read_b64_tr_b16 v[34:35], v11 offset:512
    ds_read_b64_tr_b16 v[36:37], v11 offset:8192
    ds_read_b64_tr_b16 v[38:39], v11 offset:8704
    ds_read_b64_tr_b16 v[40:41], v12 offset:0
    ds_read_b64_tr_b16 v[42:43], v12 offset:512
    ds_read_b64_tr_b16 v[44:45], v12 offset:8192
    ds_read_b64_tr_b16 v[46:47], v12 offset:8704
    s_waitcnt lgkmcnt(0)
    s_barrier
    ds_write_b128 v1, v[32:35] offset:4096
    ds_write_b128 v1, v[36:39] offset:5120
    ds_write_b128 v1, v[40:43] offset:6144
    ds_write_b128 v1, v[44:47] offset:7168
    s_add_u32 s71, s68, 524288
    buffer_load_dwordx4 v[56:59], v2, s[56:59], s71 offen
    s_add_u32 s71, s68, 557056
    buffer_load_dwordx4 v[60:63], v2, s[56:59], s71 offen
    s_add_u32 s71, s68, 589824
    buffer_load_dwordx4 v[128:131], v2, s[56:59], s71 offen
    s_add_u32 s71, s68, 622592
    buffer_load_dwordx4 v[132:135], v2, s[56:59], s71 offen
    s_waitcnt vmcnt(23)
    ds_write_b128 v5, v[96:99] offset:0
    s_waitcnt vmcnt(22)
    ds_write_b128 v6, v[100:103] offset:1024
    s_waitcnt vmcnt(21)
    ds_write_b128 v7, v[104:107] offset:2048
    s_waitcnt vmcnt(20)
    ds_write_b128 v8, v[108:111] offset:3072
    s_waitcnt lgkmcnt(0)
    s_barrier
    ds_read_b64_tr_b16 v[96:97], v11 offset:0
    ds_read_b64_tr_b16 v[98:99], v11 offset:512
    ds_read_b64_tr_b16 v[100:101], v11 offset:8192
    ds_read_b64_tr_b16 v[102:103], v11 offset:8704
    ds_read_b64_tr_b16 v[104:105], v12 offset:0
    ds_read_b64_tr_b16 v[106:107], v12 offset:512
    ds_read_b64_tr_b16 v[108:109], v12 offset:8192
    ds_read_b64_tr_b16 v[110:111], v12 offset:8704
    s_waitcnt lgkmcnt(0)
    s_barrier
    s_add_u32 s71, s68, 524288
    buffer_load_dwordx4 v[64:67], v2, s[60:63], s71 offen
    s_add_u32 s71, s68, 557056
    buffer_load_dwordx4 v[68:71], v2, s[60:63], s71 offen
    s_add_u32 s71, s68, 589824
    buffer_load_dwordx4 v[136:139], v2, s[60:63], s71 offen
    s_add_u32 s71, s68, 622592
    buffer_load_dwordx4 v[140:143], v2, s[60:63], s71 offen
    s_waitcnt vmcnt(23)
    ds_write_b128 v5, v[224:227] offset:0
    s_waitcnt vmcnt(22)
    ds_write_b128 v6, v[228:231] offset:1024
    s_waitcnt vmcnt(21)
    ds_write_b128 v7, v[48:51] offset:2048
    s_waitcnt vmcnt(20)
    ds_write_b128 v8, v[52:55] offset:3072
    s_waitcnt lgkmcnt(0)
    s_barrier
    ds_read_b64_tr_b16 v[224:225], v11 offset:0
    ds_read_b64_tr_b16 v[226:227], v11 offset:512
    ds_read_b64_tr_b16 v[228:229], v11 offset:8192
    ds_read_b64_tr_b16 v[230:231], v11 offset:8704
    ds_read_b64_tr_b16 v[48:49], v12 offset:0
    ds_read_b64_tr_b16 v[50:51], v12 offset:512
    ds_read_b64_tr_b16 v[52:53], v12 offset:8192
    ds_read_b64_tr_b16 v[54:55], v12 offset:8704
    s_waitcnt lgkmcnt(0)
    s_barrier
    ds_write_b128 v1, v[48:51] offset:28672
    ds_write_b128 v1, v[52:55] offset:29696
    s_add_u32 s71, s69, 524288
    buffer_load_dwordx4 a[8:11], v2, s[52:55], s71 offen
    s_add_u32 s71, s69, 557056
    buffer_load_dwordx4 a[12:15], v2, s[52:55], s71 offen
    s_add_u32 s71, s69, 589824
    buffer_load_dwordx4 a[16:19], v2, s[52:55], s71 offen
    s_add_u32 s71, s69, 622592
    buffer_load_dwordx4 a[20:23], v2, s[52:55], s71 offen
    s_waitcnt vmcnt(23)
    ds_write_b128 v5, v[232:235] offset:0
    s_waitcnt vmcnt(22)
    ds_write_b128 v6, v[236:239] offset:1024
    s_waitcnt vmcnt(21)
    ds_write_b128 v7, v[240:243] offset:2048
    s_waitcnt vmcnt(20)
    ds_write_b128 v8, v[244:247] offset:3072
    s_waitcnt lgkmcnt(0)
    s_barrier
    ds_read_b64_tr_b16 v[232:233], v11 offset:0
    ds_read_b64_tr_b16 v[234:235], v11 offset:512
    ds_read_b64_tr_b16 v[236:237], v11 offset:8192
    ds_read_b64_tr_b16 v[238:239], v11 offset:8704
    ds_read_b64_tr_b16 v[240:241], v12 offset:0
    ds_read_b64_tr_b16 v[242:243], v12 offset:512
    ds_read_b64_tr_b16 v[244:245], v12 offset:8192
    ds_read_b64_tr_b16 v[246:247], v12 offset:8704
    s_waitcnt lgkmcnt(0)
    s_barrier
    s_add_u32 s71, s69, 524288
    buffer_load_dwordx4 a[64:67], v2, s[56:59], s71 offen
    s_add_u32 s71, s69, 557056
    buffer_load_dwordx4 a[68:71], v2, s[56:59], s71 offen
    s_add_u32 s71, s69, 589824
    buffer_load_dwordx4 a[72:75], v2, s[56:59], s71 offen
    s_add_u32 s71, s69, 622592
    buffer_load_dwordx4 a[76:79], v2, s[56:59], s71 offen
    s_waitcnt vmcnt(23)
    ds_write_b128 v5, v[248:251] offset:0
    s_waitcnt vmcnt(22)
    ds_write_b128 v6, v[252:255] offset:1024
    s_waitcnt vmcnt(21)
    ds_write_b128 v7, a[0:3] offset:2048
    s_waitcnt vmcnt(20)
    ds_write_b128 v8, a[4:7] offset:3072
    s_waitcnt lgkmcnt(0)
    s_barrier
    ds_read_b64_tr_b16 v[248:249], v11 offset:0
    ds_read_b64_tr_b16 v[250:251], v11 offset:512
    ds_read_b64_tr_b16 v[252:253], v11 offset:8192
    ds_read_b64_tr_b16 v[254:255], v11 offset:8704
    ds_read_b64_tr_b16 a[0:1], v12 offset:0
    ds_read_b64_tr_b16 a[2:3], v12 offset:512
    ds_read_b64_tr_b16 a[4:5], v12 offset:8192
    ds_read_b64_tr_b16 a[6:7], v12 offset:8704
    s_waitcnt lgkmcnt(0)
    s_barrier
    s_add_u32 s71, s69, 524288
    buffer_load_dwordx4 v[72:75], v2, s[60:63], s71 offen
    s_add_u32 s71, s69, 557056
    buffer_load_dwordx4 v[76:79], v2, s[60:63], s71 offen
    s_add_u32 s71, s69, 589824
    buffer_load_dwordx4 a[128:131], v2, s[60:63], s71 offen
    s_add_u32 s71, s69, 622592
    buffer_load_dwordx4 a[132:135], v2, s[60:63], s71 offen
    s_waitcnt vmcnt(23)
    ds_write_b128 v5, v[112:115] offset:0
    s_waitcnt vmcnt(22)
    ds_write_b128 v6, v[116:119] offset:1024
    s_waitcnt vmcnt(21)
    ds_write_b128 v7, v[120:123] offset:2048
    s_waitcnt vmcnt(20)
    ds_write_b128 v8, v[124:127] offset:3072
    s_waitcnt lgkmcnt(0)
    s_barrier
    ds_read_b64_tr_b16 v[112:113], v11 offset:0
    ds_read_b64_tr_b16 v[114:115], v11 offset:512
    ds_read_b64_tr_b16 v[116:117], v11 offset:8192
    ds_read_b64_tr_b16 v[118:119], v11 offset:8704
    ds_read_b64_tr_b16 v[120:121], v12 offset:0
    ds_read_b64_tr_b16 v[122:123], v12 offset:512
    ds_read_b64_tr_b16 v[124:125], v12 offset:8192
    ds_read_b64_tr_b16 v[126:127], v12 offset:8704
    s_waitcnt lgkmcnt(0)
    s_barrier
    s_add_u32 s71, s68, 1048576
    buffer_load_dwordx4 v[80:83], v2, s[52:55], s71 offen
    s_add_u32 s71, s68, 1081344
    buffer_load_dwordx4 v[84:87], v2, s[52:55], s71 offen
    s_add_u32 s71, s68, 1114112
    buffer_load_dwordx4 v[144:147], v2, s[52:55], s71 offen
    s_add_u32 s71, s68, 1146880
    buffer_load_dwordx4 v[148:151], v2, s[52:55], s71 offen
    s_waitcnt vmcnt(23)
    ds_write_b128 v5, v[56:59] offset:0
    s_waitcnt vmcnt(22)
    ds_write_b128 v6, v[60:63] offset:1024
    s_waitcnt vmcnt(21)
    ds_write_b128 v7, v[128:131] offset:2048
    s_waitcnt vmcnt(20)
    ds_write_b128 v8, v[132:135] offset:3072
    s_waitcnt lgkmcnt(0)
    s_barrier
    ds_read_b64_tr_b16 v[56:57], v11 offset:0
    ds_read_b64_tr_b16 v[58:59], v11 offset:512
    ds_read_b64_tr_b16 v[60:61], v11 offset:8192
    ds_read_b64_tr_b16 v[62:63], v11 offset:8704
    ds_read_b64_tr_b16 v[128:129], v12 offset:0
    ds_read_b64_tr_b16 v[130:131], v12 offset:512
    ds_read_b64_tr_b16 v[132:133], v12 offset:8192
    ds_read_b64_tr_b16 v[134:135], v12 offset:8704
    s_waitcnt lgkmcnt(0)
    s_barrier
    ds_write_b128 v1, v[56:59] offset:8192
    ds_write_b128 v1, v[60:63] offset:9216
    s_add_u32 s71, s68, 1048576
    buffer_load_dwordx4 v[88:91], v2, s[56:59], s71 offen
    s_add_u32 s71, s68, 1081344
    buffer_load_dwordx4 v[92:95], v2, s[56:59], s71 offen
    s_add_u32 s71, s68, 1114112
    buffer_load_dwordx4 v[152:155], v2, s[56:59], s71 offen
    s_add_u32 s71, s68, 1146880
    buffer_load_dwordx4 v[156:159], v2, s[56:59], s71 offen
    s_waitcnt vmcnt(23)
    ds_write_b128 v5, v[64:67] offset:0
    s_waitcnt vmcnt(22)
    ds_write_b128 v6, v[68:71] offset:1024
    s_waitcnt vmcnt(21)
    ds_write_b128 v7, v[136:139] offset:2048
    s_waitcnt vmcnt(20)
    ds_write_b128 v8, v[140:143] offset:3072
    s_waitcnt lgkmcnt(0)
    s_barrier
    ds_read_b64_tr_b16 v[64:65], v11 offset:0
    ds_read_b64_tr_b16 v[66:67], v11 offset:512
    ds_read_b64_tr_b16 v[68:69], v11 offset:8192
    ds_read_b64_tr_b16 v[70:71], v11 offset:8704
    ds_read_b64_tr_b16 v[136:137], v12 offset:0
    ds_read_b64_tr_b16 v[138:139], v12 offset:512
    ds_read_b64_tr_b16 v[140:141], v12 offset:8192
    ds_read_b64_tr_b16 v[142:143], v12 offset:8704
    s_waitcnt lgkmcnt(0)
    s_barrier
    ds_write_b128 v1, v[64:67] offset:10240
    ds_write_b128 v1, v[68:71] offset:11264
    s_add_u32 s71, s68, 1048576
    buffer_load_dwordx4 v[16:19], v2, s[60:63], s71 offen
    s_add_u32 s71, s68, 1081344
    buffer_load_dwordx4 v[20:23], v2, s[60:63], s71 offen
    s_add_u32 s71, s68, 1114112
    buffer_load_dwordx4 v[160:163], v2, s[60:63], s71 offen
    s_add_u32 s71, s68, 1146880
    buffer_load_dwordx4 v[164:167], v2, s[60:63], s71 offen
    s_waitcnt vmcnt(23)
    ds_write_b128 v5, a[8:11] offset:0
    s_waitcnt vmcnt(22)
    ds_write_b128 v6, a[12:15] offset:1024
    s_waitcnt vmcnt(21)
    ds_write_b128 v7, a[16:19] offset:2048
    s_waitcnt vmcnt(20)
    ds_write_b128 v8, a[20:23] offset:3072
    s_waitcnt lgkmcnt(0)
    s_barrier
    ds_read_b64_tr_b16 a[8:9], v11 offset:0
    ds_read_b64_tr_b16 a[10:11], v11 offset:512
    ds_read_b64_tr_b16 a[12:13], v11 offset:8192
    ds_read_b64_tr_b16 a[14:15], v11 offset:8704
    ds_read_b64_tr_b16 a[16:17], v12 offset:0
    ds_read_b64_tr_b16 a[18:19], v12 offset:512
    ds_read_b64_tr_b16 a[20:21], v12 offset:8192
    ds_read_b64_tr_b16 a[22:23], v12 offset:8704
    s_waitcnt lgkmcnt(0)
    s_barrier
    s_add_u32 s71, s69, 1048576
    buffer_load_dwordx4 a[24:27], v2, s[52:55], s71 offen
    s_add_u32 s71, s69, 1081344
    buffer_load_dwordx4 a[28:31], v2, s[52:55], s71 offen
    s_add_u32 s71, s69, 1114112
    buffer_load_dwordx4 a[32:35], v2, s[52:55], s71 offen
    s_add_u32 s71, s69, 1146880
    buffer_load_dwordx4 a[36:39], v2, s[52:55], s71 offen
    s_waitcnt vmcnt(23)
    ds_write_b128 v5, a[64:67] offset:0
    s_waitcnt vmcnt(22)
    ds_write_b128 v6, a[68:71] offset:1024
    s_waitcnt vmcnt(21)
    ds_write_b128 v7, a[72:75] offset:2048
    s_waitcnt vmcnt(20)
    ds_write_b128 v8, a[76:79] offset:3072
    s_waitcnt lgkmcnt(0)
    s_barrier
    ds_read_b64_tr_b16 a[64:65], v11 offset:0
    ds_read_b64_tr_b16 a[66:67], v11 offset:512
    ds_read_b64_tr_b16 a[68:69], v11 offset:8192
    ds_read_b64_tr_b16 a[70:71], v11 offset:8704
    ds_read_b64_tr_b16 a[72:73], v12 offset:0
    ds_read_b64_tr_b16 a[74:75], v12 offset:512
    ds_read_b64_tr_b16 a[76:77], v12 offset:8192
    ds_read_b64_tr_b16 a[78:79], v12 offset:8704
    s_waitcnt lgkmcnt(0)
    s_barrier
    s_add_u32 s71, s69, 1048576
    buffer_load_dwordx4 a[80:83], v2, s[56:59], s71 offen
    s_add_u32 s71, s69, 1081344
    buffer_load_dwordx4 a[84:87], v2, s[56:59], s71 offen
    s_add_u32 s71, s69, 1114112
    buffer_load_dwordx4 a[88:91], v2, s[56:59], s71 offen
    s_add_u32 s71, s69, 1146880
    buffer_load_dwordx4 a[92:95], v2, s[56:59], s71 offen
    s_waitcnt vmcnt(23)
    ds_write_b128 v5, v[72:75] offset:0
    s_waitcnt vmcnt(22)
    ds_write_b128 v6, v[76:79] offset:1024
    s_waitcnt vmcnt(21)
    ds_write_b128 v7, a[128:131] offset:2048
    s_waitcnt vmcnt(20)
    ds_write_b128 v8, a[132:135] offset:3072
    s_waitcnt lgkmcnt(0)
    s_barrier
    ds_read_b64_tr_b16 v[72:73], v11 offset:0
    ds_read_b64_tr_b16 v[74:75], v11 offset:512
    ds_read_b64_tr_b16 v[76:77], v11 offset:8192
    ds_read_b64_tr_b16 v[78:79], v11 offset:8704
    ds_read_b64_tr_b16 a[128:129], v12 offset:0
    ds_read_b64_tr_b16 a[130:131], v12 offset:512
    ds_read_b64_tr_b16 a[132:133], v12 offset:8192
    ds_read_b64_tr_b16 a[134:135], v12 offset:8704
    s_waitcnt lgkmcnt(0)
    s_barrier
    ds_write_b128 v1, v[72:75] offset:32768
    ds_write_b128 v1, v[76:79] offset:33792
    s_add_u32 s71, s69, 1048576
    buffer_load_dwordx4 a[136:139], v2, s[60:63], s71 offen
    s_add_u32 s71, s69, 1081344
    buffer_load_dwordx4 a[140:143], v2, s[60:63], s71 offen
    s_add_u32 s71, s69, 1114112
    buffer_load_dwordx4 a[144:147], v2, s[60:63], s71 offen
    s_add_u32 s71, s69, 1146880
    buffer_load_dwordx4 a[148:151], v2, s[60:63], s71 offen
    s_waitcnt vmcnt(23)
    ds_write_b128 v5, v[80:83] offset:0
    s_waitcnt vmcnt(22)
    ds_write_b128 v6, v[84:87] offset:1024
    s_waitcnt vmcnt(21)
    ds_write_b128 v7, v[144:147] offset:2048
    s_waitcnt vmcnt(20)
    ds_write_b128 v8, v[148:151] offset:3072
    s_waitcnt lgkmcnt(0)
    s_barrier
    ds_read_b64_tr_b16 v[80:81], v11 offset:0
    ds_read_b64_tr_b16 v[82:83], v11 offset:512
    ds_read_b64_tr_b16 v[84:85], v11 offset:8192
    ds_read_b64_tr_b16 v[86:87], v11 offset:8704
    ds_read_b64_tr_b16 v[144:145], v12 offset:0
    ds_read_b64_tr_b16 v[146:147], v12 offset:512
    ds_read_b64_tr_b16 v[148:149], v12 offset:8192
    ds_read_b64_tr_b16 v[150:151], v12 offset:8704
    s_waitcnt lgkmcnt(0)
    s_barrier
    ds_write_b128 v1, v[80:83] offset:12288
    ds_write_b128 v1, v[84:87] offset:13312
    s_add_u32 s71, s68, 1572864
    buffer_load_dwordx4 v[168:171], v2, s[52:55], s71 offen
    s_add_u32 s71, s68, 1605632
    buffer_load_dwordx4 v[172:175], v2, s[52:55], s71 offen
    s_add_u32 s71, s68, 1638400
    buffer_load_dwordx4 v[24:27], v2, s[52:55], s71 offen
    s_add_u32 s71, s68, 1671168
    buffer_load_dwordx4 v[28:31], v2, s[52:55], s71 offen
    s_waitcnt vmcnt(23)
    ds_write_b128 v5, v[88:91] offset:0
    s_waitcnt vmcnt(22)
    ds_write_b128 v6, v[92:95] offset:1024
    s_waitcnt vmcnt(21)
    ds_write_b128 v7, v[152:155] offset:2048
    s_waitcnt vmcnt(20)
    ds_write_b128 v8, v[156:159] offset:3072
    s_waitcnt lgkmcnt(0)
    s_barrier
    ds_read_b64_tr_b16 v[88:89], v11 offset:0
    ds_read_b64_tr_b16 v[90:91], v11 offset:512
    ds_read_b64_tr_b16 v[92:93], v11 offset:8192
    ds_read_b64_tr_b16 v[94:95], v11 offset:8704
    ds_read_b64_tr_b16 v[152:153], v12 offset:0
    ds_read_b64_tr_b16 v[154:155], v12 offset:512
    ds_read_b64_tr_b16 v[156:157], v12 offset:8192
    ds_read_b64_tr_b16 v[158:159], v12 offset:8704
    s_waitcnt lgkmcnt(0)
    s_barrier
    ds_write_b128 v1, v[88:91] offset:14336
    ds_write_b128 v1, v[92:95] offset:15360
    s_add_u32 s71, s68, 1572864
    buffer_load_dwordx4 v[176:179], v2, s[56:59], s71 offen
    s_add_u32 s71, s68, 1605632
    buffer_load_dwordx4 v[180:183], v2, s[56:59], s71 offen
    s_add_u32 s71, s68, 1638400
    buffer_load_dwordx4 v[32:35], v2, s[56:59], s71 offen
    s_add_u32 s71, s68, 1671168
    buffer_load_dwordx4 v[36:39], v2, s[56:59], s71 offen
    s_waitcnt vmcnt(23)
    ds_write_b128 v5, v[16:19] offset:0
    s_waitcnt vmcnt(22)
    ds_write_b128 v6, v[20:23] offset:1024
    s_waitcnt vmcnt(21)
    ds_write_b128 v7, v[160:163] offset:2048
    s_waitcnt vmcnt(20)
    ds_write_b128 v8, v[164:167] offset:3072
    s_waitcnt lgkmcnt(0)
    s_barrier
    ds_read_b64_tr_b16 v[16:17], v11 offset:0
    ds_read_b64_tr_b16 v[18:19], v11 offset:512
    ds_read_b64_tr_b16 v[20:21], v11 offset:8192
    ds_read_b64_tr_b16 v[22:23], v11 offset:8704
    ds_read_b64_tr_b16 v[160:161], v12 offset:0
    ds_read_b64_tr_b16 v[162:163], v12 offset:512
    ds_read_b64_tr_b16 v[164:165], v12 offset:8192
    ds_read_b64_tr_b16 v[166:167], v12 offset:8704
    s_waitcnt lgkmcnt(0)
    s_barrier
    ds_write_b128 v1, v[16:19] offset:16384
    ds_write_b128 v1, v[20:23] offset:17408
    s_add_u32 s71, s68, 1572864
    buffer_load_dwordx4 v[184:187], v2, s[60:63], s71 offen
    s_add_u32 s71, s68, 1605632
    buffer_load_dwordx4 v[188:191], v2, s[60:63], s71 offen
    s_add_u32 s71, s68, 1638400
    buffer_load_dwordx4 v[192:195], v2, s[60:63], s71 offen
    s_add_u32 s71, s68, 1671168
    buffer_load_dwordx4 v[196:199], v2, s[60:63], s71 offen
    s_waitcnt vmcnt(23)
    ds_write_b128 v5, a[24:27] offset:0
    s_waitcnt vmcnt(22)
    ds_write_b128 v6, a[28:31] offset:1024
    s_waitcnt vmcnt(21)
    ds_write_b128 v7, a[32:35] offset:2048
    s_waitcnt vmcnt(20)
    ds_write_b128 v8, a[36:39] offset:3072
    s_waitcnt lgkmcnt(0)
    s_barrier
    ds_read_b64_tr_b16 a[24:25], v11 offset:0
    ds_read_b64_tr_b16 a[26:27], v11 offset:512
    ds_read_b64_tr_b16 a[28:29], v11 offset:8192
    ds_read_b64_tr_b16 a[30:31], v11 offset:8704
    ds_read_b64_tr_b16 a[32:33], v12 offset:0
    ds_read_b64_tr_b16 a[34:35], v12 offset:512
    ds_read_b64_tr_b16 a[36:37], v12 offset:8192
    ds_read_b64_tr_b16 a[38:39], v12 offset:8704
    s_waitcnt lgkmcnt(0)
    s_barrier
    s_add_u32 s71, s69, 1572864
    buffer_load_dwordx4 a[40:43], v2, s[52:55], s71 offen
    s_add_u32 s71, s69, 1605632
    buffer_load_dwordx4 a[44:47], v2, s[52:55], s71 offen
    s_add_u32 s71, s69, 1638400
    buffer_load_dwordx4 v[40:43], v2, s[52:55], s71 offen
    s_add_u32 s71, s69, 1671168
    buffer_load_dwordx4 v[44:47], v2, s[52:55], s71 offen
    s_waitcnt vmcnt(23)
    ds_write_b128 v5, a[80:83] offset:0
    s_waitcnt vmcnt(22)
    ds_write_b128 v6, a[84:87] offset:1024
    s_waitcnt vmcnt(21)
    ds_write_b128 v7, a[88:91] offset:2048
    s_waitcnt vmcnt(20)
    ds_write_b128 v8, a[92:95] offset:3072
    s_waitcnt lgkmcnt(0)
    s_barrier
    ds_read_b64_tr_b16 a[80:81], v11 offset:0
    ds_read_b64_tr_b16 a[82:83], v11 offset:512
    ds_read_b64_tr_b16 a[84:85], v11 offset:8192
    ds_read_b64_tr_b16 a[86:87], v11 offset:8704
    ds_read_b64_tr_b16 a[88:89], v12 offset:0
    ds_read_b64_tr_b16 a[90:91], v12 offset:512
    ds_read_b64_tr_b16 a[92:93], v12 offset:8192
    ds_read_b64_tr_b16 a[94:95], v12 offset:8704
    s_waitcnt lgkmcnt(0)
    s_barrier
    s_add_u32 s71, s69, 1572864
    buffer_load_dwordx4 a[96:99], v2, s[56:59], s71 offen
    s_add_u32 s71, s69, 1605632
    buffer_load_dwordx4 a[100:103], v2, s[56:59], s71 offen
    s_add_u32 s71, s69, 1638400
    buffer_load_dwordx4 a[104:107], v2, s[56:59], s71 offen
    s_add_u32 s71, s69, 1671168
    buffer_load_dwordx4 a[108:111], v2, s[56:59], s71 offen
    s_waitcnt vmcnt(23)
    ds_write_b128 v5, a[136:139] offset:0
    s_waitcnt vmcnt(22)
    ds_write_b128 v6, a[140:143] offset:1024
    s_waitcnt vmcnt(21)
    ds_write_b128 v7, a[144:147] offset:2048
    s_waitcnt vmcnt(20)
    ds_write_b128 v8, a[148:151] offset:3072
    s_waitcnt lgkmcnt(0)
    s_barrier
    ds_read_b64_tr_b16 a[136:137], v11 offset:0
    ds_read_b64_tr_b16 a[138:139], v11 offset:512
    ds_read_b64_tr_b16 a[140:141], v11 offset:8192
    ds_read_b64_tr_b16 a[142:143], v11 offset:8704
    ds_read_b64_tr_b16 a[144:145], v12 offset:0
    ds_read_b64_tr_b16 a[146:147], v12 offset:512
    ds_read_b64_tr_b16 a[148:149], v12 offset:8192
    ds_read_b64_tr_b16 a[150:151], v12 offset:8704
    s_waitcnt lgkmcnt(0)
    s_barrier
    s_add_u32 s71, s69, 1572864
    buffer_load_dwordx4 a[152:155], v2, s[60:63], s71 offen
    s_add_u32 s71, s69, 1605632
    buffer_load_dwordx4 a[156:159], v2, s[60:63], s71 offen
    s_add_u32 s71, s69, 1638400
    buffer_load_dwordx4 a[160:163], v2, s[60:63], s71 offen
    s_add_u32 s71, s69, 1671168
    buffer_load_dwordx4 a[164:167], v2, s[60:63], s71 offen
    s_waitcnt vmcnt(23)
    ds_write_b128 v5, v[168:171] offset:0
    s_waitcnt vmcnt(22)
    ds_write_b128 v6, v[172:175] offset:1024
    s_waitcnt vmcnt(21)
    ds_write_b128 v7, v[24:27] offset:2048
    s_waitcnt vmcnt(20)
    ds_write_b128 v8, v[28:31] offset:3072
    s_waitcnt lgkmcnt(0)
    s_barrier
    ds_read_b64_tr_b16 v[168:169], v11 offset:0
    ds_read_b64_tr_b16 v[170:171], v11 offset:512
    ds_read_b64_tr_b16 v[172:173], v11 offset:8192
    ds_read_b64_tr_b16 v[174:175], v11 offset:8704
    ds_read_b64_tr_b16 v[24:25], v12 offset:0
    ds_read_b64_tr_b16 v[26:27], v12 offset:512
    ds_read_b64_tr_b16 v[28:29], v12 offset:8192
    ds_read_b64_tr_b16 v[30:31], v12 offset:8704
    s_waitcnt lgkmcnt(0)
    s_barrier
    ds_write_b128 v1, v[24:27] offset:18432
    ds_write_b128 v1, v[28:31] offset:19456
    s_add_u32 s71, s68, 2097152
    buffer_load_dwordx4 v[48:51], v2, s[52:55], s71 offen
    s_add_u32 s71, s68, 2129920
    buffer_load_dwordx4 v[52:55], v2, s[52:55], s71 offen
    s_add_u32 s71, s68, 2162688
    buffer_load_dwordx4 v[200:203], v2, s[52:55], s71 offen
    s_add_u32 s71, s68, 2195456
    buffer_load_dwordx4 v[204:207], v2, s[52:55], s71 offen
    s_waitcnt vmcnt(23)
    ds_write_b128 v5, v[176:179] offset:0
    s_waitcnt vmcnt(22)
    ds_write_b128 v6, v[180:183] offset:1024
    s_waitcnt vmcnt(21)
    ds_write_b128 v7, v[32:35] offset:2048
    s_waitcnt vmcnt(20)
    ds_write_b128 v8, v[36:39] offset:3072
    s_waitcnt lgkmcnt(0)
    s_barrier
    ds_read_b64_tr_b16 v[176:177], v11 offset:0
    ds_read_b64_tr_b16 v[178:179], v11 offset:512
    ds_read_b64_tr_b16 v[180:181], v11 offset:8192
    ds_read_b64_tr_b16 v[182:183], v11 offset:8704
    ds_read_b64_tr_b16 v[32:33], v12 offset:0
    ds_read_b64_tr_b16 v[34:35], v12 offset:512
    ds_read_b64_tr_b16 v[36:37], v12 offset:8192
    ds_read_b64_tr_b16 v[38:39], v12 offset:8704
    s_waitcnt lgkmcnt(0)
    s_barrier
    ds_write_b128 v1, v[32:35] offset:20480
    ds_write_b128 v1, v[36:39] offset:21504
    s_add_u32 s71, s68, 2097152
    buffer_load_dwordx4 v[56:59], v2, s[56:59], s71 offen
    s_add_u32 s71, s68, 2129920
    buffer_load_dwordx4 v[60:63], v2, s[56:59], s71 offen
    s_add_u32 s71, s68, 2162688
    buffer_load_dwordx4 v[208:211], v2, s[56:59], s71 offen
    s_add_u32 s71, s68, 2195456
    buffer_load_dwordx4 v[212:215], v2, s[56:59], s71 offen
    s_waitcnt vmcnt(23)
    ds_write_b128 v5, v[184:187] offset:0
    s_waitcnt vmcnt(22)
    ds_write_b128 v6, v[188:191] offset:1024
    s_waitcnt vmcnt(21)
    ds_write_b128 v7, v[192:195] offset:2048
    s_waitcnt vmcnt(20)
    ds_write_b128 v8, v[196:199] offset:3072
    s_waitcnt lgkmcnt(0)
    s_barrier
    ds_read_b64_tr_b16 v[184:185], v11 offset:0
    ds_read_b64_tr_b16 v[186:187], v11 offset:512
    ds_read_b64_tr_b16 v[188:189], v11 offset:8192
    ds_read_b64_tr_b16 v[190:191], v11 offset:8704
    ds_read_b64_tr_b16 v[192:193], v12 offset:0
    ds_read_b64_tr_b16 v[194:195], v12 offset:512
    ds_read_b64_tr_b16 v[196:197], v12 offset:8192
    ds_read_b64_tr_b16 v[198:199], v12 offset:8704
    s_waitcnt lgkmcnt(0)
    s_barrier
    s_add_u32 s71, s68, 2097152
    buffer_load_dwordx4 v[64:67], v2, s[60:63], s71 offen
    s_add_u32 s71, s68, 2129920
    buffer_load_dwordx4 v[68:71], v2, s[60:63], s71 offen
    s_add_u32 s71, s68, 2162688
    buffer_load_dwordx4 v[216:219], v2, s[60:63], s71 offen
    s_add_u32 s71, s68, 2195456
    buffer_load_dwordx4 v[220:223], v2, s[60:63], s71 offen
    s_waitcnt vmcnt(23)
    ds_write_b128 v5, a[40:43] offset:0
    s_waitcnt vmcnt(22)
    ds_write_b128 v6, a[44:47] offset:1024
    s_waitcnt vmcnt(21)
    ds_write_b128 v7, v[40:43] offset:2048
    s_waitcnt vmcnt(20)
    ds_write_b128 v8, v[44:47] offset:3072
    s_waitcnt lgkmcnt(0)
    s_barrier
    ds_read_b64_tr_b16 a[40:41], v11 offset:0
    ds_read_b64_tr_b16 a[42:43], v11 offset:512
    ds_read_b64_tr_b16 a[44:45], v11 offset:8192
    ds_read_b64_tr_b16 a[46:47], v11 offset:8704
    ds_read_b64_tr_b16 v[40:41], v12 offset:0
    ds_read_b64_tr_b16 v[42:43], v12 offset:512
    ds_read_b64_tr_b16 v[44:45], v12 offset:8192
    ds_read_b64_tr_b16 v[46:47], v12 offset:8704
    s_waitcnt lgkmcnt(0)
    s_barrier
    ds_write_b128 v1, v[40:43] offset:30720
    ds_write_b128 v1, v[44:47] offset:31744
    s_add_u32 s71, s69, 2097152
    buffer_load_dwordx4 a[48:51], v2, s[52:55], s71 offen
    s_add_u32 s71, s69, 2129920
    buffer_load_dwordx4 a[52:55], v2, s[52:55], s71 offen
    s_add_u32 s71, s69, 2162688
    buffer_load_dwordx4 a[56:59], v2, s[52:55], s71 offen
    s_add_u32 s71, s69, 2195456
    buffer_load_dwordx4 a[60:63], v2, s[52:55], s71 offen
    s_waitcnt vmcnt(23)
    ds_write_b128 v5, a[96:99] offset:0
    s_waitcnt vmcnt(22)
    ds_write_b128 v6, a[100:103] offset:1024
    s_waitcnt vmcnt(21)
    ds_write_b128 v7, a[104:107] offset:2048
    s_waitcnt vmcnt(20)
    ds_write_b128 v8, a[108:111] offset:3072
    s_waitcnt lgkmcnt(0)
    s_barrier
    ds_read_b64_tr_b16 a[96:97], v11 offset:0
    ds_read_b64_tr_b16 a[98:99], v11 offset:512
    ds_read_b64_tr_b16 a[100:101], v11 offset:8192
    ds_read_b64_tr_b16 a[102:103], v11 offset:8704
    ds_read_b64_tr_b16 a[104:105], v12 offset:0
    ds_read_b64_tr_b16 a[106:107], v12 offset:512
    ds_read_b64_tr_b16 a[108:109], v12 offset:8192
    ds_read_b64_tr_b16 a[110:111], v12 offset:8704
    s_waitcnt lgkmcnt(0)
    s_barrier
    s_add_u32 s71, s69, 2097152
    buffer_load_dwordx4 a[112:115], v2, s[56:59], s71 offen
    s_add_u32 s71, s69, 2129920
    buffer_load_dwordx4 a[116:119], v2, s[56:59], s71 offen
    s_add_u32 s71, s69, 2162688
    buffer_load_dwordx4 a[120:123], v2, s[56:59], s71 offen
    s_add_u32 s71, s69, 2195456
    buffer_load_dwordx4 a[124:127], v2, s[56:59], s71 offen
    s_waitcnt vmcnt(23)
    ds_write_b128 v5, a[152:155] offset:0
    s_waitcnt vmcnt(22)
    ds_write_b128 v6, a[156:159] offset:1024
    s_waitcnt vmcnt(21)
    ds_write_b128 v7, a[160:163] offset:2048
    s_waitcnt vmcnt(20)
    ds_write_b128 v8, a[164:167] offset:3072
    s_waitcnt lgkmcnt(0)
    s_barrier
    ds_read_b64_tr_b16 a[152:153], v11 offset:0
    ds_read_b64_tr_b16 a[154:155], v11 offset:512
    ds_read_b64_tr_b16 a[156:157], v11 offset:8192
    ds_read_b64_tr_b16 a[158:159], v11 offset:8704
    ds_read_b64_tr_b16 a[160:161], v12 offset:0
    ds_read_b64_tr_b16 a[162:163], v12 offset:512
    ds_read_b64_tr_b16 a[164:165], v12 offset:8192
    ds_read_b64_tr_b16 a[166:167], v12 offset:8704
    s_waitcnt lgkmcnt(0)
    s_barrier
    s_add_u32 s71, s69, 2097152
    buffer_load_dwordx4 a[168:171], v2, s[60:63], s71 offen
    s_add_u32 s71, s69, 2129920
    buffer_load_dwordx4 a[172:175], v2, s[60:63], s71 offen
    s_add_u32 s71, s69, 2162688
    buffer_load_dwordx4 a[176:179], v2, s[60:63], s71 offen
    s_add_u32 s71, s69, 2195456
    buffer_load_dwordx4 a[180:183], v2, s[60:63], s71 offen
    s_waitcnt vmcnt(23)
    ds_write_b128 v5, v[48:51] offset:0
    s_waitcnt vmcnt(22)
    ds_write_b128 v6, v[52:55] offset:1024
    s_waitcnt vmcnt(21)
    ds_write_b128 v7, v[200:203] offset:2048
    s_waitcnt vmcnt(20)
    ds_write_b128 v8, v[204:207] offset:3072
    s_waitcnt lgkmcnt(0)
    s_barrier
    ds_read_b64_tr_b16 v[48:49], v11 offset:0
    ds_read_b64_tr_b16 v[50:51], v11 offset:512
    ds_read_b64_tr_b16 v[52:53], v11 offset:8192
    ds_read_b64_tr_b16 v[54:55], v11 offset:8704
    ds_read_b64_tr_b16 v[200:201], v12 offset:0
    ds_read_b64_tr_b16 v[202:203], v12 offset:512
    ds_read_b64_tr_b16 v[204:205], v12 offset:8192
    ds_read_b64_tr_b16 v[206:207], v12 offset:8704
    s_waitcnt lgkmcnt(0)
    s_barrier
    ds_write_b128 v1, v[48:51] offset:22528
    ds_write_b128 v1, v[52:55] offset:23552
    s_add_u32 s71, s70, 0
    buffer_load_dwordx4 v[72:75], v3, s[64:67], s71 offen
    s_add_u32 s71, s70, 5120
    buffer_load_dwordx4 v[76:79], v3, s[64:67], s71 offen
    s_add_u32 s71, s70, 10240
    buffer_load_dwordx4 v[80:83], v3, s[64:67], s71 offen
    s_add_u32 s71, s70, 15360
    buffer_load_dwordx4 v[84:87], v3, s[64:67], s71 offen
    s_waitcnt vmcnt(23)
    ds_write_b128 v5, v[56:59] offset:0
    s_waitcnt vmcnt(22)
    ds_write_b128 v6, v[60:63] offset:1024
    s_waitcnt vmcnt(21)
    ds_write_b128 v7, v[208:211] offset:2048
    s_waitcnt vmcnt(20)
    ds_write_b128 v8, v[212:215] offset:3072
    s_waitcnt lgkmcnt(0)
    s_barrier
    ds_read_b64_tr_b16 v[56:57], v11 offset:0
    ds_read_b64_tr_b16 v[58:59], v11 offset:512
    ds_read_b64_tr_b16 v[60:61], v11 offset:8192
    ds_read_b64_tr_b16 v[62:63], v11 offset:8704
    ds_read_b64_tr_b16 v[208:209], v12 offset:0
    ds_read_b64_tr_b16 v[210:211], v12 offset:512
    ds_read_b64_tr_b16 v[212:213], v12 offset:8192
    ds_read_b64_tr_b16 v[214:215], v12 offset:8704
    s_waitcnt lgkmcnt(0)
    s_barrier
    ds_write_b128 v1, v[56:59] offset:24576
    ds_write_b128 v1, v[60:63] offset:25600
    s_add_u32 s71, s70, 81920
    buffer_load_dwordx4 a[200:203], v3, s[64:67], s71 offen
    s_add_u32 s71, s70, 87040
    buffer_load_dwordx4 a[204:207], v3, s[64:67], s71 offen
    s_add_u32 s71, s70, 92160
    buffer_load_dwordx4 a[208:211], v3, s[64:67], s71 offen
    s_add_u32 s71, s70, 97280
    buffer_load_dwordx4 a[212:215], v3, s[64:67], s71 offen
    s_waitcnt vmcnt(23)
    ds_write_b128 v5, v[64:67] offset:0
    s_waitcnt vmcnt(22)
    ds_write_b128 v6, v[68:71] offset:1024
    s_waitcnt vmcnt(21)
    ds_write_b128 v7, v[216:219] offset:2048
    s_waitcnt vmcnt(20)
    ds_write_b128 v8, v[220:223] offset:3072
    s_waitcnt lgkmcnt(0)
    s_barrier
    ds_read_b64_tr_b16 v[64:65], v11 offset:0
    ds_read_b64_tr_b16 v[66:67], v11 offset:512
    ds_read_b64_tr_b16 v[68:69], v11 offset:8192
    ds_read_b64_tr_b16 v[70:71], v11 offset:8704
    ds_read_b64_tr_b16 v[216:217], v12 offset:0
    ds_read_b64_tr_b16 v[218:219], v12 offset:512
    ds_read_b64_tr_b16 v[220:221], v12 offset:8192
    ds_read_b64_tr_b16 v[222:223], v12 offset:8704
    s_waitcnt lgkmcnt(0)
    s_barrier
    ds_write_b128 v1, v[64:67] offset:26624
    ds_write_b128 v1, v[68:71] offset:27648
    s_add_u32 s71, s70, 256
    buffer_load_dwordx4 a[184:187], v3, s[64:67], s71 offen
    s_add_u32 s71, s70, 5376
    buffer_load_dwordx4 a[188:191], v3, s[64:67], s71 offen
    s_add_u32 s71, s70, 10496
    buffer_load_dwordx4 a[216:219], v3, s[64:67], s71 offen
    s_add_u32 s71, s70, 15616
    buffer_load_dwordx4 a[220:223], v3, s[64:67], s71 offen
    s_waitcnt vmcnt(23)
    ds_write_b128 v5, a[48:51] offset:0
    s_waitcnt vmcnt(22)
    ds_write_b128 v6, a[52:55] offset:1024
    s_waitcnt vmcnt(21)
    ds_write_b128 v7, a[56:59] offset:2048
    s_waitcnt vmcnt(20)
    ds_write_b128 v8, a[60:63] offset:3072
    s_waitcnt lgkmcnt(0)
    s_barrier
    ds_read_b64_tr_b16 a[48:49], v11 offset:0
    ds_read_b64_tr_b16 a[50:51], v11 offset:512
    ds_read_b64_tr_b16 a[52:53], v11 offset:8192
    ds_read_b64_tr_b16 a[54:55], v11 offset:8704
    ds_read_b64_tr_b16 a[56:57], v12 offset:0
    ds_read_b64_tr_b16 a[58:59], v12 offset:512
    ds_read_b64_tr_b16 a[60:61], v12 offset:8192
    ds_read_b64_tr_b16 a[62:63], v12 offset:8704
    s_waitcnt lgkmcnt(0)
    s_barrier
    s_add_u32 s71, s70, 82176
    buffer_load_dwordx4 a[224:227], v3, s[64:67], s71 offen
    s_add_u32 s71, s70, 87296
    buffer_load_dwordx4 a[228:231], v3, s[64:67], s71 offen
    s_add_u32 s71, s70, 92416
    buffer_load_dwordx4 v[88:91], v3, s[64:67], s71 offen
    s_add_u32 s71, s70, 97536
    buffer_load_dwordx4 v[92:95], v3, s[64:67], s71 offen
    s_waitcnt vmcnt(23)
    ds_write_b128 v5, a[112:115] offset:0
    s_waitcnt vmcnt(22)
    ds_write_b128 v6, a[116:119] offset:1024
    s_waitcnt vmcnt(21)
    ds_write_b128 v7, a[120:123] offset:2048
    s_waitcnt vmcnt(20)
    ds_write_b128 v8, a[124:127] offset:3072
    s_waitcnt lgkmcnt(0)
    s_barrier
    ds_read_b64_tr_b16 a[112:113], v11 offset:0
    ds_read_b64_tr_b16 a[114:115], v11 offset:512
    ds_read_b64_tr_b16 a[116:117], v11 offset:8192
    ds_read_b64_tr_b16 a[118:119], v11 offset:8704
    ds_read_b64_tr_b16 a[120:121], v12 offset:0
    ds_read_b64_tr_b16 a[122:123], v12 offset:512
    ds_read_b64_tr_b16 a[124:125], v12 offset:8192
    ds_read_b64_tr_b16 a[126:127], v12 offset:8704
    s_waitcnt lgkmcnt(0)
    s_barrier
    s_add_u32 s71, s70, 512
    buffer_load_dwordx4 a[192:195], v4, s[64:67], s71 offen
    s_add_u32 s71, s70, 10752
    buffer_load_dwordx4 a[196:199], v4, s[64:67], s71 offen
    s_add_u32 s71, s70, 20992
    buffer_load_dwordx4 a[232:235], v4, s[64:67], s71 offen
    s_add_u32 s71, s70, 31232
    buffer_load_dwordx4 a[236:239], v4, s[64:67], s71 offen
    s_waitcnt vmcnt(23)
    ds_write_b128 v5, a[168:171] offset:0
    s_waitcnt vmcnt(22)
    ds_write_b128 v6, a[172:175] offset:1024
    s_waitcnt vmcnt(21)
    ds_write_b128 v7, a[176:179] offset:2048
    s_waitcnt vmcnt(20)
    ds_write_b128 v8, a[180:183] offset:3072
    s_waitcnt lgkmcnt(0)
    s_barrier
    ds_read_b64_tr_b16 a[168:169], v11 offset:0
    ds_read_b64_tr_b16 a[170:171], v11 offset:512
    ds_read_b64_tr_b16 a[172:173], v11 offset:8192
    ds_read_b64_tr_b16 a[174:175], v11 offset:8704
    ds_read_b64_tr_b16 a[176:177], v12 offset:0
    ds_read_b64_tr_b16 a[178:179], v12 offset:512
    ds_read_b64_tr_b16 a[180:181], v12 offset:8192
    ds_read_b64_tr_b16 a[182:183], v12 offset:8704
    s_waitcnt lgkmcnt(0)
    s_barrier
    s_waitcnt vmcnt(19)
    ds_write_b128 v9, v[72:75] offset:0
    s_waitcnt vmcnt(18)
    ds_write_b128 v9, v[76:79] offset:1024
    s_waitcnt vmcnt(17)
    ds_write_b128 v9, v[80:83] offset:2048
    s_waitcnt vmcnt(16)
    ds_write_b128 v9, v[84:87] offset:3072
    s_waitcnt lgkmcnt(0)
    s_barrier
    ds_read_b64_tr_b16 v[72:73], v13 offset:0
    ds_read_b64_tr_b16 v[74:75], v13 offset:512
    ds_read_b64_tr_b16 v[76:77], v13 offset:2048
    ds_read_b64_tr_b16 v[78:79], v13 offset:2560
    ds_read_b64_tr_b16 v[80:81], v13 offset:8192
    ds_read_b64_tr_b16 v[82:83], v13 offset:8704
    ds_read_b64_tr_b16 v[84:85], v13 offset:10240
    ds_read_b64_tr_b16 v[86:87], v13 offset:10752
    s_waitcnt lgkmcnt(0)
    s_barrier
    ds_write_b128 v1, v[72:75] offset:34816
    ds_write_b128 v1, v[76:79] offset:35840
    ds_write_b128 v1, v[80:83] offset:36864
    ds_write_b128 v1, v[84:87] offset:37888
    buffer_load_dword v15, off, s[72:75], 0 offset:48 sc1
    s_waitcnt vmcnt(16)
    ds_write_b128 v9, a[200:203] offset:0
    s_waitcnt vmcnt(15)
    ds_write_b128 v9, a[204:207] offset:1024
    s_waitcnt vmcnt(14)
    ds_write_b128 v9, a[208:211] offset:2048
    s_waitcnt vmcnt(13)
    ds_write_b128 v9, a[212:215] offset:3072
    s_waitcnt lgkmcnt(0)
    s_barrier
    ds_read_b64_tr_b16 a[200:201], v13 offset:0
    ds_read_b64_tr_b16 a[202:203], v13 offset:512
    ds_read_b64_tr_b16 a[204:205], v13 offset:2048
    ds_read_b64_tr_b16 a[206:207], v13 offset:2560
    ds_read_b64_tr_b16 a[208:209], v13 offset:8192
    ds_read_b64_tr_b16 a[210:211], v13 offset:8704
    ds_read_b64_tr_b16 a[212:213], v13 offset:10240
    ds_read_b64_tr_b16 a[214:215], v13 offset:10752
    s_waitcnt lgkmcnt(0)
    s_barrier
    s_waitcnt vmcnt(12)
    ds_write_b128 v9, a[184:187] offset:0
    s_waitcnt vmcnt(11)
    ds_write_b128 v9, a[188:191] offset:1024
    s_waitcnt vmcnt(10)
    ds_write_b128 v9, a[216:219] offset:2048
    s_waitcnt vmcnt(9)
    ds_write_b128 v9, a[220:223] offset:3072
    s_waitcnt lgkmcnt(0)
    s_barrier
    ds_read_b64_tr_b16 a[184:185], v13 offset:0
    ds_read_b64_tr_b16 a[186:187], v13 offset:512
    ds_read_b64_tr_b16 a[188:189], v13 offset:2048
    ds_read_b64_tr_b16 a[190:191], v13 offset:2560
    ds_read_b64_tr_b16 a[216:217], v13 offset:8192
    ds_read_b64_tr_b16 a[218:219], v13 offset:8704
    ds_read_b64_tr_b16 a[220:221], v13 offset:10240
    ds_read_b64_tr_b16 a[222:223], v13 offset:10752
    s_waitcnt lgkmcnt(0)
    s_barrier
    s_waitcnt vmcnt(8)
    ds_write_b128 v9, a[224:227] offset:0
    s_waitcnt vmcnt(7)
    ds_write_b128 v9, a[228:231] offset:1024
    s_waitcnt vmcnt(6)
    ds_write_b128 v9, v[88:91] offset:2048
    s_waitcnt vmcnt(5)
    ds_write_b128 v9, v[92:95] offset:3072
    s_waitcnt lgkmcnt(0)
    s_barrier
    ds_read_b64_tr_b16 a[224:225], v13 offset:0
    ds_read_b64_tr_b16 a[226:227], v13 offset:512
    ds_read_b64_tr_b16 a[228:229], v13 offset:2048
    ds_read_b64_tr_b16 a[230:231], v13 offset:2560
    ds_read_b64_tr_b16 v[88:89], v13 offset:8192
    ds_read_b64_tr_b16 v[90:91], v13 offset:8704
    ds_read_b64_tr_b16 v[92:93], v13 offset:10240
    ds_read_b64_tr_b16 v[94:95], v13 offset:10752
    s_waitcnt lgkmcnt(0)
    s_barrier
    ds_write_b128 v1, v[88:91] offset:38912
    ds_write_b128 v1, v[92:95] offset:39936
    s_waitcnt vmcnt(4)
    ds_write_b128 v10, a[192:195] offset:0
    s_waitcnt vmcnt(3)
    ds_write_b128 v10, a[196:199] offset:1024
    s_waitcnt vmcnt(2)
    ds_write_b128 v10, a[232:235] offset:2048
    s_waitcnt vmcnt(1)
    ds_write_b128 v10, a[236:239] offset:3072
    s_waitcnt lgkmcnt(0)
    s_barrier
    ds_read_b64_tr_b16 a[192:193], v14 offset:0
    ds_read_b64_tr_b16 a[194:195], v14 offset:256
    ds_read_b64_tr_b16 a[196:197], v14 offset:1024
    ds_read_b64_tr_b16 a[198:199], v14 offset:1280
    ds_read_b64_tr_b16 a[232:233], v14 offset:4096
    ds_read_b64_tr_b16 a[234:235], v14 offset:4352
    ds_read_b64_tr_b16 a[236:237], v14 offset:5120
    ds_read_b64_tr_b16 a[238:239], v14 offset:5376
    ds_read_b64_tr_b16 a[240:241], v14 offset:8192
    ds_read_b64_tr_b16 a[242:243], v14 offset:8448
    ds_read_b64_tr_b16 a[244:245], v14 offset:9216
    ds_read_b64_tr_b16 a[246:247], v14 offset:9472
    ds_read_b64_tr_b16 a[248:249], v14 offset:12288
    ds_read_b64_tr_b16 a[250:251], v14 offset:12544
    ds_read_b64_tr_b16 a[252:253], v14 offset:13312
    ds_read_b64_tr_b16 a[254:255], v14 offset:13568
    s_waitcnt lgkmcnt(0)
    s_barrier
    s_waitcnt vmcnt(0)
    v_and_b32 v16, 15, v0
    v_lshrrev_b32 v17, 4, v0
    v_and_b32 v18, 1, v16
    v_bfe_u32 v19, v16, 1, 1
    v_mov_b32 v20, 0xaaaa
    v_mul_u32_u24 v18, v18, v20
    v_mul_u32_u24 v19, v19, v20
    v_lshl_add_u32 v18, v19, 16, v18
    v_add_u32 v2, 0x44444444, v18
    v_lshrrev_b32 v18, 1, v17
    v_lshlrev_b32 v18, 6, v18
    v_lshlrev_b32 v19, 3, v16
    v_xor_b32 v18, v18, v19
    v_lshl_add_u32 v3, v17, 7, v18
    v_and_b32 v18, 3, v0
    v_lshrrev_b32 v19, 2, v0
    v_lshlrev_b32 v19, 3, v19
    v_lshrrev_b32 v20, 1, v18
    v_lshlrev_b32 v20, 6, v20
    v_xor_b32 v19, v19, v20
    v_lshl_add_u32 v4, v18, 7, v19
    v_and_b32 v18, 7, v16
    v_and_b32 v19, 61, v0
    v_lshlrev_b32 v5, 4, v19
    v_lshlrev_b32 v19, 12, v17
    v_lshl_add_u32 v6, v16, 3, v19
    v_and_b32 v19, 1, v17
    v_lshlrev_b32 v19, 5, v19
    v_lshl_add_u32 v19, v18, 2, v19
    v_lshrrev_b32 v20, 1, v17
    v_lshl_add_u32 v7, v20, 8, v19
    v_lshlrev_b32 v8, 2, v0
    v_lshlrev_b32 v0, 4, v0
    v_add_u32 v1, 16384, v0
    v_add_u32 v8, 1024, v8
    s_lshl_b32 s27, s12, 7
    s_lshl_b32 s25, s3, 5
    v_and_b32 v22, 0x30, v0
    buffer_load_dwordx3 v[16:18], off, s[72:75], 0 offset:48 sc1
    buffer_load_dword v20, off, s[72:75], s25 sc1
    buffer_load_dword v21, v22, s[4:7], s27 offen offset:0 sc1
    s_mov_b32 s84, 0
    s_waitcnt vmcnt(2)
    v_lshrrev_b32 v23, 18, v17
    v_add_u32 v18, 4, v18
    v_lshrrev_b32 v18, 3, v18
    s_waitcnt vmcnt(1)
    v_lshrrev_b32 v20, 4, v20
    v_min3_u32 v23, v23, v15, v18
    s_waitcnt vmcnt(0)
    v_min3_u32 v23, v23, v20, v21
    v_cmp_gt_u32 vcc, 2, v23
    s_cbranch_vccz Lrdy72
    v_mov_b32 v17, 0
    s_mov_b32 exec_lo, 0x1
    s_mov_b32 exec_hi, 0x0
Lwf73:
    buffer_load_dword v16, v17, s[72:75], 0 offen offset:48 sc1
    s_waitcnt vmcnt(0)
    v_cmp_gt_u32 vcc, 2, v16
    s_cbranch_vccz Lwf73d
    s_sub_u32 s15, s15, 1
    s_cbranch_scc0 Lwf73
    s_mov_b32 s15, 0
Lwf73d:
    s_mov_b64 exec, -1
    v_mov_b32 v17, 0
    s_mov_b32 exec_lo, 0x1
    s_mov_b32 exec_hi, 0x0
Lwf74:
    buffer_load_dword v16, v17, s[72:75], 0 offen offset:56 sc1
    s_waitcnt vmcnt(0)
    v_cmp_gt_u32 vcc, 12, v16
    s_cbranch_vccz Lwf74d
    s_sub_u32 s15, s15, 1
    s_cbranch_scc0 Lwf74
    s_mov_b32 s15, 0
Lwf74d:
    s_mov_b64 exec, -1
    v_mbcnt_lo_u32_b32 v17, -1, 0
    v_and_b32 v17, 7, v17
    v_lshlrev_b32 v17, 5, v17
Lcen75:
    buffer_load_dword v16, v17, s[72:75], 0 offen sc1
    s_waitcnt vmcnt(0)
    v_readlane_b32 s25, v16, s3
    s_mov_b32 s84, 0
    s_nop 2
    s_cmp_ge_u32 s25, 32
    s_cbranch_scc1 Lcen75d
    s_mov_b32 s84, 1
    v_mov_b32 v18, v16
    s_nop 1
    v_add_u32_dpp v18, v18, v18 row_ror:1 row_mask:0xf bank_mask:0xf
    s_nop 1
    v_add_u32_dpp v18, v18, v18 row_ror:2 row_mask:0xf bank_mask:0xf
    s_nop 1
    v_add_u32_dpp v18, v18, v18 row_ror:4 row_mask:0xf bank_mask:0xf
    s_nop 0
    v_readfirstlane_b32 s25, v18
    s_nop 3
    s_cmp_ge_u32 s25, 256
    s_cbranch_scc1 Lcen75d
    s_sub_u32 s15, s15, 1
    s_cbranch_scc0 Lcen75
    s_mov_b32 s15, 0
Lcen75d:
    v_mov_b32 v18, 0
    s_mov_b32 exec_lo, 0x1
    s_mov_b32 exec_hi, 0x0
Lwf76:
    buffer_load_dword v17, v18, s[72:75], 0 offen offset:52 sc1
    s_waitcnt vmcnt(0)
    v_cmp_gt_u32 vcc, 524288, v17
    s_cbranch_vccz Lwf76d
    s_sub_u32 s15, s15, 1
    s_cbranch_scc0 Lwf76
    s_mov_b32 s15, 0
Lwf76d:
    s_mov_b64 exec, -1
    s_mov_b32 exec_lo, 0xf
    s_mov_b32 exec_hi, 0x0
Lwf77:
    buffer_load_dword v16, v0, s[4:7], s27 offen offset:0 sc1
    s_waitcnt vmcnt(0)
    v_cmp_gt_u32 vcc, 2, v16
    s_cbranch_vccz Lwf77d
    s_sub_u32 s15, s15, 1
    s_cbranch_scc0 Lwf77
    s_mov_b32 s15, 0
Lwf77d:
    s_mov_b64 exec, -1
Lrdy72:
    v_readfirstlane_b32 s35, v17
    s_nop 3
    s_and_b32 s35, s35, 0x60
    s_cselect_b32 s35, 0x2000, 0
    s_mov_b32 s28, 1040356334
    s_mov_b32 s29, 562036736
    s_mov_b32 s30, 1006632960
    s_lshl_b32 s26, s3, 19
    s_add_u32 s26, s26, 1048576
    s_lshl_b32 s25, s12, 7
    s_add_u32 s27, s25, 0
    s_add_u32 s16, s25, s26
    s_add_u32 s16, s16, 0
    s_lshl_b32 s17, s12, 12
    s_add_u32 s17, s17, s26
    s_add_u32 s17, s17, 131072
    s_lshl_b32 s26, s3, 17
    s_and_b32 s19, s25, 384
    s_lshr_b32 s19, s19, 1
    s_sub_u32 s25, s25, s19
    s_add_u32 s25, s25, 4096
    s_add_u32 s19, s26, 132096
    s_add_u32 s33, s26, s25
    s_add_u32 s34, s33, s35
    s_add_u32 s34, s34, 2097152
    s_add_u32 s33, s33, 131072
    s_mov_b32 s20, s33
    s_mov_b32 s24, s34
    s_xor_b32 s21, s26, 0x20000
    s_add_u32 s21, s21, s35
    s_add_u32 s21, s21, 2098176
    s_xor_b32 s26, s35, 0x2000
    s_lshl_b32 s98, s12, 15
    s_add_u32 s98, s98, s26
    s_add_u32 s98, s98, 8388608
    s_lshr_b32 s99, s12, 1
    s_lshl_b32 s99, s99, 14
    s_and_b32 s25, s12, 1
    s_lshl_b32 s25, s25, 12
    s_add_u32 s99, s99, s25
    s_add_u32 s99, s99, s26
    s_add_u32 s99, s99, 75497472
    s_lshr_b32 s23, s99, 8
    s_and_b32 s23, s23, 0x2000
    s_xor_b32 s23, s99, s23
    s_add_u32 s98, s98, 0
    s_lshr_b32 s22, s98, 8
    s_and_b32 s22, s22, 0x2000
    s_xor_b32 s22, s98, s22
    s_add_u32 s32, s22, 16384
    s_lshl_b32 s100, s3, 5
    s_add_u32 s100, s100, s12
    s_lshl_b32 s100, s100, 6
    s_add_u32 s100, s100, 4096
    s_sub_u32 s31, s31, 1
    s_sub_u32 s36, s3, 1
    s_not_b32 s37, s36
    s_mov_b32 s18, 1
    s_mov_b32 s92, 0x00ff00ff
    s_mov_b32 s93, 0x00ff00ff
    s_mov_b32 s14, 0
    s_sub_u32 s19, s19, 1024
    s_sub_u32 s21, s21, 1024
    s_mov_b32 s38, 1114129
    s_mov_b32 s39, 1114129
    s_mov_b32 s40, 285217024
    s_mov_b32 s41, 285217024
    s_mov_b32 s42, 2228258
    s_mov_b32 s43, 2228258
    s_mov_b32 s44, 570434048
    s_mov_b32 s45, 570434048
    s_mov_b32 s46, 4042322160
    s_mov_b32 s47, 4042322160
    buffer_load_dwordx4 v[72:75], v0, s[4:7], s22 offen offset:0 sc1
    buffer_load_dwordx4 v[76:79], v0, s[4:7], s22 offen offset:1024 sc1
    buffer_load_dwordx4 v[80:83], v0, s[4:7], s32 offen offset:0 sc1
    buffer_load_dwordx4 v[84:87], v0, s[4:7], s32 offen offset:1024 sc1
    s_add_u32 s98, s98, 1048576
    s_lshr_b32 s22, s98, 8
    s_and_b32 s22, s22, 0x2000
    s_xor_b32 s22, s98, s22
    s_add_u32 s32, s22, 16384
    v_mov_b64 v[48:49], -1
    v_mov_b64 v[50:51], -1
    v_mov_b32 v9, -1
    s_waitcnt vmcnt(0) lgkmcnt(0)
    s_nop 11
    s_cmp_lg_u32 s84, 0
    s_cbranch_scc1 Ls0_top
Lc0_top:
    v_mov_b64 v[56:57], v[72:73]
    v_mov_b64 v[58:59], v[74:75]
    v_mov_b64 v[60:61], v[76:77]
    v_mov_b64 v[62:63], v[78:79]
    v_mov_b64 v[64:65], v[80:81]
    v_mov_b64 v[66:67], v[82:83]
    v_mov_b64 v[68:69], v[84:85]
    v_mov_b64 v[70:71], v[86:87]
    buffer_load_dwordx4 v[48:51], v0, s[4:7], s19 offen offset:0 sc1
    buffer_load_dword v9, v8, s[4:7], s19 offen offset:3072 sc1
    ds_read_b128 v[40:43], v1 offset:0
    ds_read_b128 v[44:47], v1 offset:1024
    ds_read_b128 v[80:83], v1 offset:2048
    ds_read_b128 v[84:87], v1 offset:3072
    ds_read_b128 v[88:91], v1 offset:4096
    ds_read_b128 v[92:95], v1 offset:5120
    ds_read_b128 v[72:75], v1 offset:6144
    ds_read_b128 v[76:79], v1 offset:7168
    v_mov_b64 v[32:33], 0
    v_mov_b64 v[34:35], 0
    v_mov_b64 v[36:37], 0
    v_mov_b64 v[38:39], 0
    v_mov_b64 v[16:17], 0
    v_mov_b64 v[18:19], 0
    v_mov_b64 v[20:21], 0
    v_mov_b64 v[22:23], 0
    v_mov_b64 v[24:25], 0
    v_mov_b64 v[26:27], 0
    v_mov_b64 v[28:29], 0
    v_mov_b64 v[30:31], 0
    buffer_load_dwordx4 v[48:51], v0, s[4:7], s19 offen offset:0 sc1
    buffer_load_dword v9, v8, s[4:7], s19 offen offset:3072 sc1
    s_waitcnt lgkmcnt(0)
Lc0_pb:
    s_waitcnt vmcnt(3)
    v_max3_u32 v11, v48, v49, v50
    s_waitcnt vmcnt(2)
    v_max3_u32 v11, v11, v51, v9
    v_cmp_eq_u32 vcc, -1, v11
    ds_write_b128 v0, v[48:51] offset:0
    ds_write_b32 v8, v9 offset:3072
    s_cbranch_vccnz Lc0_pc
Lc0_pcd:
    v_smfmac_f32_16x16x64_bf16 v[16:19], v[48:51], v[40:47], v2
    buffer_load_dwordx4 v[12:15], v0, s[4:7], s21 offen offset:0 sc1
    v_smfmac_f32_16x16x64_bf16 v[20:23], v[48:51], v[80:87], v2
    buffer_load_dword v11, v8, s[4:7], s21 offen offset:3072 sc1
    v_smfmac_f32_16x16x64_bf16 v[24:27], v[48:51], v[88:95], v2
    s_waitcnt lgkmcnt(0)
    s_barrier
    ds_read_b128 v[40:43], v0 offset:1024
    v_smfmac_f32_16x16x64_bf16 v[28:31], v[48:51], v[72:79], v2
    ds_read_b128 v[44:47], v0 offset:2048
    ds_read_b128 v[80:83], v1 offset:8192
    v_smfmac_f32_16x16x64_bf16 v[32:35], v[48:51], v[96:103], v2
    ds_read_b128 v[84:87], v1 offset:9216
    ds_read_b128 v[88:91], v1 offset:10240
    v_smfmac_f32_16x16x64_bf16 v[36:39], v[48:51], v[104:111], v2
    ds_read_b128 v[92:95], v1 offset:11264
Lc0_pad:
    s_waitcnt lgkmcnt(5)
    v_smfmac_f32_16x16x64_bf16 v[16:19], v[40:43], v[112:119], v2
    ds_read_b128 v[72:75], v1 offset:12288
    v_smfmac_f32_16x16x64_bf16 v[20:23], v[40:43], v[120:127], v2
    s_waitcnt lgkmcnt(3)
    s_add_u32 s19, s19, 16384
    ds_read_b128 v[76:79], v1 offset:13312
    v_smfmac_f32_16x16x64_bf16 v[24:27], v[40:43], v[80:87], v2
    ds_read_b128 v[80:83], v1 offset:14336
    v_smfmac_f32_16x16x64_bf16 v[28:31], v[40:43], v[128:135], v2
    s_waitcnt lgkmcnt(3)
    s_bitset0_b32 s19, 16
    ds_read_b128 v[84:87], v1 offset:15360
    v_smfmac_f32_16x16x64_bf16 v[32:35], v[40:43], v[88:95], v2
    ds_read_b128 v[88:91], v1 offset:16384
    v_smfmac_f32_16x16x64_bf16 v[36:39], v[40:43], v[136:143], v2
    s_waitcnt lgkmcnt(3)
    s_add_u32 s20, s20, 16384
    ds_read_b128 v[92:95], v1 offset:17408
    v_smfmac_f32_16x16x64_bf16 v[16:19], v[44:47], v[72:79], v2
    ds_read_b128 v[40:43], v0 offset:3072
    v_smfmac_f32_16x16x64_bf16 v[20:23], v[44:47], v[144:151], v2
    s_waitcnt lgkmcnt(3)
    s_bitset0_b32 s20, 16
    ds_read_b128 v[72:75], v1 offset:18432
    v_smfmac_f32_16x16x64_bf16 v[24:27], v[44:47], v[80:87], v2
    ds_read_b128 v[76:79], v1 offset:19456
    v_smfmac_f32_16x16x64_bf16 v[28:31], v[44:47], v[152:159], v2
    s_waitcnt lgkmcnt(3)
    s_add_u32 s24, s24, 16384
    ds_read_b128 v[80:83], v1 offset:20480
    v_smfmac_f32_16x16x64_bf16 v[32:35], v[44:47], v[88:95], v2
    ds_read_b128 v[84:87], v1 offset:21504
    v_smfmac_f32_16x16x64_bf16 v[36:39], v[44:47], v[160:167], v2
    s_waitcnt lgkmcnt(4)
    s_bitset0_b32 s24, 16
    ds_read_b128 v[44:47], v0 offset:4096
    v_smfmac_f32_16x16x64_bf16 v[16:19], v[40:43], v[168:175], v2
    s_waitcnt vmcnt(2)
    ds_read_b128 v[48:51], v1 offset:22528
    s_waitcnt lgkmcnt(4)
    v_smfmac_f32_16x16x64_bf16 v[20:23], v[40:43], v[72:79], v2
    ds_read_b128 v[52:55], v1 offset:23552
    v_smfmac_f32_16x16x64_bf16 v[24:27], v[40:43], v[176:183], v2
    s_waitcnt lgkmcnt(3)
    s_xor_b32 s25, s24, 32768
    ds_read_b128 v[88:91], v1 offset:24576
    v_smfmac_f32_16x16x64_bf16 v[28:31], v[40:43], v[80:87], v2
    ds_read_b128 v[92:95], v1 offset:25600
    v_smfmac_f32_16x16x64_bf16 v[32:35], v[40:43], v[184:191], v2
    s_xor_b32 s26, s20, 32768
    ds_read_b128 v[72:75], v1 offset:26624
    v_smfmac_f32_16x16x64_bf16 v[36:39], v[40:43], v[192:199], v2
    ds_read_b128 v[76:79], v1 offset:27648
    s_waitcnt lgkmcnt(4)
    v_smfmac_f32_16x16x64_bf16 v[16:19], v[44:47], v[48:55], v2
    ds_read_b128 v[48:51], v1 offset:28672
    v_smfmac_f32_16x16x64_bf16 v[20:23], v[44:47], v[200:207], v2
    ds_read_b128 v[52:55], v1 offset:29696
    s_waitcnt lgkmcnt(4)
    v_smfmac_f32_16x16x64_bf16 v[24:27], v[44:47], v[88:95], v2
    v_smfmac_f32_16x16x64_bf16 v[28:31], v[44:47], v[208:215], v2
    s_waitcnt vmcnt(1)
    ds_write_b128 v0, v[12:15] offset:5120
    v_max3_u32 v9, v12, v13, v14
    s_waitcnt vmcnt(0)
    v_max3_u32 v9, v9, v15, v11
    v_cmp_eq_u32 vcc, -1, v9
    s_waitcnt lgkmcnt(3)
    v_smfmac_f32_16x16x64_bf16 v[32:35], v[44:47], v[72:79], v2
    ds_write_b32 v8, v11 offset:8192
    v_smfmac_f32_16x16x64_bf16 v[36:39], v[44:47], v[216:223], v2
    s_cbranch_vccnz Lc0_rr
Lc0_rrd:
    v_smfmac_f32_16x16x64_bf16 v[16:19], v[12:15], v[224:231], v2
    s_waitcnt lgkmcnt(2)
    s_add_u32 s21, s21, 16384
    s_bitset0_b32 s21, 16
    v_smfmac_f32_16x16x64_bf16 v[20:23], v[12:15], v[48:55], v2
    v_mov_b32 v10, -1
    v_smfmac_f32_16x16x64_bf16 v[24:27], v[12:15], v[232:239], v2
    s_waitcnt lgkmcnt(0)
    s_barrier
    ds_read_b128 v[40:43], v0 offset:6144
    v_smfmac_f32_16x16x64_bf16 v[28:31], v[12:15], v[240:247], v2
    ds_read_b128 v[44:47], v0 offset:7168
    v_smfmac_f32_16x16x64_bf16 v[32:35], v[12:15], v[248:255], v2
    ds_read_b128 v[88:91], v0 offset:8192
    v_smfmac_f32_16x16x64_bf16 v[36:39], v[12:15], a[0:7], v2
    s_waitcnt lgkmcnt(2)
    ds_read_b128 v[92:95], v0 offset:9216
    ds_read_b128 v[48:51], v1 offset:30720
    v_smfmac_f32_16x16x64_bf16 v[16:19], v[40:43], a[8:15], v2
    ds_read_b128 v[52:55], v1 offset:31744
    v_mov_b32 v12, 0x3f803f80
    v_smfmac_f32_16x16x64_bf16 v[20:23], v[40:43], a[16:23], v2
    s_waitcnt lgkmcnt(4)
    v_mov_b32 v13, 0x3f803f80
    v_smfmac_f32_16x16x64_bf16 v[16:19], v[44:47], a[24:31], v2
    buffer_load_dwordx4 v[72:75], v0, s[4:7], s22 offen offset:0 sc1
    v_mov_b32 v14, 0x3f803f80
    v_smfmac_f32_16x16x64_bf16 v[20:23], v[44:47], a[32:39], v2
    s_waitcnt lgkmcnt(3)
    buffer_store_dword v10, v7, s[4:7], s26 offen
    v_mov_b32 v15, 0x3f803f80
    v_smfmac_f32_16x16x64_bf16 v[16:19], v[88:91], a[40:47], v2
    buffer_store_dword v10, v7, s[4:7], s25 offen sc1
    s_waitcnt lgkmcnt(0)
    v_smfmac_f32_16x16x64_bf16 v[20:23], v[88:91], v[48:55], v2
    buffer_load_dwordx4 v[76:79], v0, s[4:7], s22 offen offset:1024 sc1
    v_smfmac_f32_16x16x64_bf16 v[16:19], v[92:95], a[48:55], v2
    s_nop 2
    v_smfmac_f32_16x16x64_bf16 v[20:23], v[92:95], a[56:63], v2
    s_nop 0
    ds_read_b128 v[48:51], v1 offset:32768
    v_smfmac_f32_16x16x64_bf16 v[24:27], v[40:43], a[64:71], v2
    ds_read_b128 v[52:55], v1 offset:33792
    v_add_f32 v16, v16, v17
    v_add_f32 v18, v18, v19
    v_smfmac_f32_16x16x64_bf16 v[28:31], v[40:43], a[72:79], v2
    v_cvt_pk_bf16_f32 v16, v16, v18
    v_add_f32 v20, v20, v21
    v_smfmac_f32_16x16x64_bf16 v[24:27], v[44:47], a[80:87], v2
    buffer_load_dwordx4 v[80:83], v0, s[4:7], s32 offen offset:0 sc1
    v_add_f32 v22, v22, v23
    v_cvt_pk_bf16_f32 v17, v20, v22
    v_smfmac_f32_16x16x64_bf16 v[28:31], v[44:47], a[88:95], v2
    ds_write_b64 v3, v[16:17] offset:10240
    v_smfmac_f32_16x16x64_bf16 v[24:27], v[88:91], a[96:103], v2
    buffer_load_dwordx4 v[84:87], v0, s[4:7], s32 offen offset:1024 sc1
    v_smfmac_f32_16x16x64_bf16 v[28:31], v[88:91], a[104:111], v2
    v_smfmac_f32_16x16x64_bf16 v[24:27], v[92:95], a[112:119], v2
    v_smfmac_f32_16x16x64_bf16 v[28:31], v[92:95], a[120:127], v2
    s_waitcnt lgkmcnt(0)
    s_barrier
    ds_read_b64_tr_b16 v[16:17], v4 offset:10240
    v_smfmac_f32_16x16x64_bf16 v[32:35], v[40:43], v[48:55], v2
    ds_read_b64_tr_b16 v[18:19], v4 offset:10752
    ds_read_b64_tr_b16 v[20:21], v4 offset:11264
    ds_read_b64_tr_b16 v[22:23], v4 offset:11776
    v_add_f32 v24, v24, v25
    v_add_f32 v26, v26, v27
    v_cvt_pk_bf16_f32 v24, v24, v26
    v_add_f32 v28, v28, v29
    v_add_f32 v30, v30, v31
    v_cvt_pk_bf16_f32 v25, v28, v30
    v_smfmac_f32_16x16x64_bf16 v[36:39], v[40:43], a[128:135], v2
    ds_write_b64 v3, v[24:25] offset:12288
    s_waitcnt lgkmcnt(3)
    v_mfma_f32_16x16x32_bf16 v[48:51], v[56:59], v[16:19], 0
    s_waitcnt lgkmcnt(1)
    v_mfma_f32_16x16x32_bf16 v[48:51], v[60:63], v[20:23], v[48:51]
    v_smfmac_f32_16x16x64_bf16 v[32:35], v[44:47], a[136:143], v2
    s_waitcnt lgkmcnt(0)
    s_barrier
    ds_read_b64_tr_b16 v[24:25], v4 offset:12288
    v_smfmac_f32_16x16x64_bf16 v[36:39], v[44:47], a[144:151], v2
    ds_read_b64_tr_b16 v[26:27], v4 offset:12800
    ds_read_b64_tr_b16 v[28:29], v4 offset:13312
    ds_read_b64_tr_b16 v[30:31], v4 offset:13824
    v_add_f32_dpp v48, v50, v48 quad_perm:[2,3,0,1] row_mask:0xf bank_mask:0xf
    v_add_f32_dpp v49, v51, v49 quad_perm:[2,3,0,1] row_mask:0xf bank_mask:0xf
    v_exp_f32 v50, v48
    v_exp_f32 v51, v49
    s_nop 0
    v_cvt_pk_bf16_f32 v50, v50, v51
    ds_write_b32 v0, v50 offset:14336
    s_waitcnt lgkmcnt(3)
    v_mfma_f32_16x16x32_bf16 v[52:55], v[24:27], v[16:19], 0
    ds_read_b128 v[56:59], v1 offset:34816
    s_waitcnt lgkmcnt(2)
    v_mfma_f32_16x16x32_bf16 v[52:55], v[28:31], v[20:23], v[52:55]
    ds_read_b128 v[60:63], v1 offset:35840
    v_mov_b64 v[28:29], 0
    v_smfmac_f32_16x16x64_bf16 v[32:35], v[88:91], a[152:159], v2
    v_mov_b64 v[30:31], 0
    s_waitcnt lgkmcnt(2)
    s_barrier
    ds_read_b128 v[16:19], v5 offset:14336
    v_smfmac_f32_16x16x64_bf16 v[36:39], v[88:91], a[160:167], v2
    v_add_f32_dpp v52, v54, v52 quad_perm:[2,3,0,1] row_mask:0xf bank_mask:0xf
    v_add_f32_dpp v53, v55, v53 quad_perm:[2,3,0,1] row_mask:0xf bank_mask:0xf
    v_smfmac_f32_16x16x64_bf16 v[32:35], v[92:95], a[168:175], v2
    v_mul_f32 v50, s28, v52
    v_mul_f32 v51, s28, v53
    v_smfmac_f32_16x16x64_bf16 v[36:39], v[92:95], a[176:183], v2
    v_exp_f32_dpp v52, v50 quad_perm:[0,1,0,1] row_mask:0xf bank_mask:0xf
    v_exp_f32_dpp v53, v51 quad_perm:[0,1,0,1] row_mask:0xf bank_mask:0xf
    s_waitcnt lgkmcnt(0)
    v_mfma_f32_16x16x32_bf16 v[24:27], v[12:15], v[16:19], 0
    v_mov_b32 v21, 0
    v_cvt_pk_bf16_f32 v20, v52, v53
    v_mfma_f32_16x16x32_bf16 v[40:43], v[64:67], v[16:19], 0
    v_add_f32 v32, v32, v33
    v_add_f32 v34, v34, v35
    v_cvt_pk_bf16_f32 v10, v32, v34
    v_mfma_f32_16x16x32_bf16 v[44:47], v[68:71], v[16:19], 0
    v_add_f32 v36, v36, v37
    v_add_f32 v38, v38, v39
    v_cvt_pk_bf16_f32 v11, v36, v38
    v_mfma_f32_16x16x16_bf16 v[24:27], v[12:13], v[20:21], v[24:27]
    v_mov_b32 v22, 0
    v_cvt_pk_bf16_f32 v23, v52, v53
    v_mfma_f32_16x16x16_bf16 v[40:43], v[10:11], v[20:21], v[40:43]
    v_mov_b64 v[32:33], 0
    v_mov_b64 v[34:35], 0
    v_mfma_f32_16x16x16_bf16 v[44:47], v[10:11], v[22:23], v[44:47]
    v_mov_b64 v[36:37], 0
    v_mov_b64 v[38:39], 0
    v_rcp_f32 v25, v24
    v_subrev_u32 v26, s29, v24
    v_cmp_le_u32 vcc, s30, v26
    v_mul_f32 v40, v25, v40
    v_mul_f32 v41, v25, v41
    v_mul_f32 v42, v25, v42
    v_mul_f32 v43, v25, v43
    v_cvt_pk_bf16_f32 v52, v40, v41
    v_cvt_pk_bf16_f32 v53, v42, v43
    v_mul_f32 v44, v25, v44
    v_mul_f32 v45, v25, v45
    v_mul_f32 v46, v25, v46
    v_mul_f32 v47, v25, v47
    v_cvt_pk_bf16_f32 v54, v44, v45
    v_cvt_pk_bf16_f32 v55, v46, v47
    ds_write_b128 v0, v[52:55] offset:10240
    s_cbranch_vccnz Lc0_fb
Lc0_fbd:
    v_smfmac_f32_16x16x64_bf16 v[32:35], v[52:55], v[56:63], v2 abid:1
    s_cmp_eq_u32 s14, s31
    s_mov_b64 exec, s[36:37]
    buffer_store_dwordx2 v[10:11], v3, s[4:7], s23 offen offset:2048 sc1
    s_mov_b64 exec, -1
    v_smfmac_f32_16x16x64_bf16 v[36:39], v[52:55], a[184:191], v2 abid:1
    ds_read_b128 v[88:91], v1 offset:36864
    ds_read_b128 v[92:95], v1 offset:37888
    s_waitcnt lgkmcnt(2)
    s_barrier
    ds_read_b128 v[16:19], v0 offset:11264
    v_smfmac_f32_16x16x64_bf16 v[28:31], v[52:55], a[192:199], v2 abid:1
    ds_read_b128 v[20:23], v0 offset:12288
    ds_read_b128 v[24:27], v0 offset:13312
    v_mov_b32 v1, v1
    s_cbranch_scc1 Lc0_exit
    v_mov_b32 v1, v1
    s_add_u32 s25, s16, 65536
    s_add_u32 s26, s16, 131072
    v_mov_b32 v1, v1
    s_waitcnt lgkmcnt(2)
    v_smfmac_f32_16x16x64_bf16 v[32:35], v[16:19], v[88:95], v2 abid:1
    ds_read_b128 v[64:67], v1 offset:38912
    s_waitcnt lgkmcnt(2)
    v_smfmac_f32_16x16x64_bf16 v[32:35], v[20:23], a[200:207], v2 abid:1
    ds_read_b128 v[68:71], v1 offset:39936
    s_waitcnt lgkmcnt(2)
    v_smfmac_f32_16x16x64_bf16 v[32:35], v[24:27], a[208:215], v2 abid:1
    s_nop 2
    v_smfmac_f32_16x16x64_bf16 v[36:39], v[16:19], a[216:223], v2 abid:1
    s_nop 2
    v_smfmac_f32_16x16x64_bf16 v[36:39], v[20:23], a[224:231], v2 abid:1
    s_waitcnt lgkmcnt(0)
    v_cvt_pk_bf16_f32 v32, v32, v33
    v_smfmac_f32_16x16x64_bf16 v[36:39], v[24:27], v[64:71], v2 abid:1
    s_nop 1
    v_and_or_b32 v32, v32, -2, s18
    v_smfmac_f32_16x16x64_bf16 v[28:31], v[16:19], a[232:239], v2 abid:1
    s_nop 0
    v_cvt_pk_bf16_f32 v33, v34, v35
    v_smfmac_f32_16x16x64_bf16 v[28:31], v[20:23], a[240:247], v2 abid:1
    buffer_store_dwordx2 v[32:33], v6, s[4:7], s16 offen
    v_cvt_pk_bf16_f32 v36, v36, v37
    v_smfmac_f32_16x16x64_bf16 v[28:31], v[24:27], a[248:255], v2 abid:1
    s_nop 1
    v_and_or_b32 v36, v36, -2, s18
    v_cvt_pk_bf16_f32 v37, v38, v39
    buffer_store_dwordx2 v[36:37], v6, s[4:7], s25 offen
    s_nop 2
    v_cvt_pk_bf16_f32 v28, v28, v29
    v_and_or_b32 v28, v28, -2, s18
    v_cvt_pk_bf16_f32 v29, v30, v31
    buffer_store_dwordx2 v[28:29], v6, s[4:7], s26 offen
    s_add_u32 s99, s99, 262144
    s_lshr_b32 s23, s99, 8
    s_and_b32 s23, s23, 0x2000
    s_xor_b32 s23, s99, s23
    s_add_u32 s14, s14, 1
    s_add_u32 s98, s98, 1048576
    s_lshr_b32 s22, s98, 8
    s_and_b32 s22, s22, 0x2000
    s_xor_b32 s22, s98, s22
    s_add_u32 s32, s22, 16384
    s_cmp_ge_u32 s12, 8
    s_cbranch_scc1 Lc0_nored
    v_mov_b32 v52, 0x3f80
    v_cndmask_b32 v52, v52, 1.0, s[46:47]
    v_cndmask_b32 v48, 0, v52, s[38:39]
    v_cndmask_b32 v49, 0, v52, s[40:41]
    v_cndmask_b32 v50, 0, v52, s[42:43]
    v_cndmask_b32 v51, 0, v52, s[44:45]
    s_waitcnt vmcnt(0)
    buffer_load_dwordx4 v[16:19], v0, s[4:7], s17 offen offset:0 sc1
    buffer_load_dwordx4 v[20:23], v0, s[4:7], s17 offen offset:1024 sc1
    buffer_load_dwordx4 v[24:27], v0, s[4:7], s17 offen offset:2048 sc1
    buffer_load_dwordx4 v[28:31], v0, s[4:7], s17 offen offset:3072 sc1
    ds_read_b128 v[12:15], v0
    s_waitcnt lgkmcnt(0)
    buffer_load_dwordx4 v[56:59], v0, s[4:7], s17 offen offset:0 sc1
    buffer_load_dwordx4 v[60:63], v0, s[4:7], s17 offen offset:1024 sc1
    buffer_load_dwordx4 v[64:67], v0, s[4:7], s17 offen offset:2048 sc1
    buffer_load_dwordx4 v[68:71], v0, s[4:7], s17 offen offset:3072 sc1
    s_waitcnt vmcnt(7)
    v_mfma_f32_16x16x32_bf16 v[52:55], v[48:51], v[16:19], 0
    v_bitop3_b32 v17, v16, v18, s18 bitop3:0x7e
    s_waitcnt vmcnt(6)
    v_mfma_f32_16x16x32_bf16 v[52:55], v[48:51], v[20:23], v[52:55]
    v_bitop3_b32 v21, v20, v22, s18 bitop3:0x7e
    s_waitcnt vmcnt(5)
    v_mfma_f32_16x16x32_bf16 v[52:55], v[48:51], v[24:27], v[52:55]
    v_bitop3_b32 v25, v24, v26, s18 bitop3:0x7e
    v_or3_b32 v17, v17, v21, v25
    v_and_b32 v17, 1, v17
    s_waitcnt vmcnt(4)
    v_mfma_f32_16x16x32_bf16 v[52:55], v[48:51], v[28:31], v[52:55]
    s_nop 0
    v_bitop3_b32 v29, v28, v30, s18 bitop3:0x7e
    v_and_or_b32 v17, v29, 1, v17
    v_cmp_ne_u32 vcc, 0, v17
    s_nop 1
    v_mov_b32 v1, v1
    s_nop 0
    v_add_f32_dpp v54, v52, v52 row_ror:8 row_mask:0xf bank_mask:0xf
    v_add_f32_dpp v55, v53, v53 row_ror:8 row_mask:0xf bank_mask:0xf
    v_cvt_pk_bf16_f32 v11, v54, v55
    s_cbranch_vccnz Lc0_r1
Lc0_r1d:
    buffer_store_dword v11, v7, s[4:7], s20 offen
    buffer_store_dword v11, v7, s[4:7], s24 offen sc1
Lc0_redd:
    v_mov_b64 v[48:49], -1
    v_mov_b64 v[50:51], -1
    v_mov_b32 v9, -1
    s_xor_b32 s18, s18, 1
    s_waitcnt vmcnt(2)
    s_barrier
    s_branch Lc0_top
Lc0_exit:
    s_waitcnt vmcnt(0) lgkmcnt(0)
    s_barrier
    s_waitcnt vmcnt(0) lgkmcnt(0)
    s_nop 11
    s_endpgm
Lc0_pc:
    buffer_load_dwordx4 v[48:51], v0, s[4:7], s19 offen offset:0 sc1
    buffer_load_dword v9, v8, s[4:7], s19 offen offset:3072 sc1
    s_sub_u32 s15, s15, 1
    s_cbranch_scc0 Lc0_pb
    s_mov_b32 s15, 0
    s_branch Lc0_pcd
Lc0_rr:
    buffer_load_dwordx4 v[12:15], v0, s[4:7], s21 offen offset:0 sc1
    buffer_load_dword v11, v8, s[4:7], s21 offen offset:3072 sc1
    s_waitcnt vmcnt(1)
    ds_write_b128 v0, v[12:15] offset:5120
    s_waitcnt vmcnt(0)
    ds_write_b32 v8, v11 offset:8192
    v_max3_u32 v9, v12, v13, v14
    v_max3_u32 v9, v9, v15, v11
    v_cmp_eq_u32 vcc, -1, v9
    s_waitcnt lgkmcnt(0)
    s_cbranch_vccz Lc0_rrd
    s_sub_u32 s15, s15, 1
    s_cbranch_scc0 Lc0_rr
    s_mov_b32 s15, 0
    s_branch Lc0_rrd
Lc0_fb:
    s_waitcnt lgkmcnt(0)
    s_nop 11
    s_barrier
    v_max_f32 v16, v48, v49
    v_max3_f32 v16, v16, v50, v51
    ds_write_b32 v0, v16 offset:0
    s_waitcnt lgkmcnt(0)
    s_barrier
    v_and_b32 v40, 0xff, v0
    ds_read_b128 v[16:19], v40 offset:0
    ds_read_b128 v[20:23], v40 offset:256
    ds_read_b128 v[88:91], v40 offset:512
    ds_read_b128 v[92:95], v40 offset:768
    s_waitcnt lgkmcnt(3)
    v_max_f32 v40, v16, v17
    v_max3_f32 v40, v40, v18, v19
    s_waitcnt lgkmcnt(2)
    v_max3_f32 v40, v40, v20, v21
    v_max3_f32 v40, v40, v22, v23
    s_waitcnt lgkmcnt(1)
    v_max3_f32 v40, v40, v88, v89
    v_max3_f32 v40, v40, v90, v91
    s_waitcnt lgkmcnt(0)
    v_max3_f32 v40, v40, v92, v93
    v_max3_f32 v40, v40, v94, v95
    v_sub_f32 v48, v48, v40
    v_sub_f32 v49, v49, v40
    v_sub_f32 v50, v50, v40
    v_sub_f32 v51, v51, v40
    v_exp_f32 v40, v48
    v_exp_f32 v41, v49
    s_nop 0
    v_cvt_pk_bf16_f32 v40, v40, v41
    ds_write_b32 v0, v40 offset:14336
    v_mov_b32 v21, 0
    v_exp_f32_dpp v52, v50 quad_perm:[0,1,0,1] row_mask:0xf bank_mask:0xf
    v_exp_f32_dpp v53, v51 quad_perm:[0,1,0,1] row_mask:0xf bank_mask:0xf
    v_mov_b32 v22, 0
    v_cvt_pk_bf16_f32 v20, v52, v53
    v_cvt_pk_bf16_f32 v23, v52, v53
    s_waitcnt lgkmcnt(0)
    s_barrier
    ds_read_b128 v[16:19], v5 offset:14336
    s_waitcnt lgkmcnt(0)
    v_mfma_f32_16x16x32_bf16 v[24:27], v[12:15], v[16:19], 0
    s_nop 2
    v_mfma_f32_16x16x32_bf16 v[40:43], v[64:67], v[16:19], 0
    s_nop 1
    s_nop 0
    v_mfma_f32_16x16x32_bf16 v[44:47], v[68:71], v[16:19], 0
    s_nop 1
    s_nop 0
    v_mfma_f32_16x16x16_bf16 v[24:27], v[12:13], v[20:21], v[24:27]
    s_nop 1
    s_nop 0
    v_mfma_f32_16x16x16_bf16 v[40:43], v[10:11], v[20:21], v[40:43]
    s_nop 2
    v_mfma_f32_16x16x16_bf16 v[44:47], v[10:11], v[22:23], v[44:47]
    s_nop 0
    v_rcp_f32 v25, v24
    s_nop 1
    v_mul_f32 v40, v25, v40
    v_mul_f32 v41, v25, v41
    v_mul_f32 v42, v25, v42
    v_mul_f32 v43, v25, v43
    v_cvt_pk_bf16_f32 v52, v40, v41
    v_cvt_pk_bf16_f32 v53, v42, v43
    v_mul_f32 v44, v25, v44
    v_mul_f32 v45, v25, v45
    v_mul_f32 v46, v25, v46
    v_mul_f32 v47, v25, v47
    v_cvt_pk_bf16_f32 v54, v44, v45
    v_cvt_pk_bf16_f32 v55, v46, v47
    ds_write_b128 v0, v[52:55] offset:10240
    s_waitcnt lgkmcnt(0)
    s_nop 11
    s_branch Lc0_fbd
Lc0_nored:
    s_waitcnt vmcnt(0)
    s_branch Lc0_redd
Lc0_r1:
    buffer_load_dwordx4 v[16:19], v0, s[4:7], s17 offen offset:0 sc1
    buffer_load_dwordx4 v[20:23], v0, s[4:7], s17 offen offset:1024 sc1
    buffer_load_dwordx4 v[24:27], v0, s[4:7], s17 offen offset:2048 sc1
    buffer_load_dwordx4 v[28:31], v0, s[4:7], s17 offen offset:3072 sc1
    s_waitcnt vmcnt(7)
    v_mfma_f32_16x16x32_bf16 v[52:55], v[48:51], v[56:59], 0
    v_bitop3_b32 v57, v56, v58, s18 bitop3:0x7e
    s_waitcnt vmcnt(6)
    v_mfma_f32_16x16x32_bf16 v[52:55], v[48:51], v[60:63], v[52:55]
    v_bitop3_b32 v61, v60, v62, s18 bitop3:0x7e
    s_waitcnt vmcnt(5)
    v_mfma_f32_16x16x32_bf16 v[52:55], v[48:51], v[64:67], v[52:55]
    v_bitop3_b32 v65, v64, v66, s18 bitop3:0x7e
    v_or3_b32 v57, v57, v61, v65
    v_and_b32 v57, 1, v57
    s_waitcnt vmcnt(4)
    v_mfma_f32_16x16x32_bf16 v[52:55], v[48:51], v[68:71], v[52:55]
    s_nop 0
    v_bitop3_b32 v69, v68, v70, s18 bitop3:0x7e
    v_and_or_b32 v57, v69, 1, v57
    v_cmp_ne_u32 vcc, 0, v57
    s_nop 3
    v_add_f32_dpp v54, v52, v52 row_ror:8 row_mask:0xf bank_mask:0xf
    v_add_f32_dpp v55, v53, v53 row_ror:8 row_mask:0xf bank_mask:0xf
    v_cvt_pk_bf16_f32 v11, v54, v55
    s_cbranch_vccz Lc0_r1d
    buffer_load_dwordx4 v[56:59], v0, s[4:7], s17 offen offset:0 sc1
    buffer_load_dwordx4 v[60:63], v0, s[4:7], s17 offen offset:1024 sc1
    buffer_load_dwordx4 v[64:67], v0, s[4:7], s17 offen offset:2048 sc1
    buffer_load_dwordx4 v[68:71], v0, s[4:7], s17 offen offset:3072 sc1
    s_waitcnt vmcnt(7)
    v_mfma_f32_16x16x32_bf16 v[52:55], v[48:51], v[16:19], 0
    v_bitop3_b32 v17, v16, v18, s18 bitop3:0x7e
    s_waitcnt vmcnt(6)
    v_mfma_f32_16x16x32_bf16 v[52:55], v[48:51], v[20:23], v[52:55]
    v_bitop3_b32 v21, v20, v22, s18 bitop3:0x7e
    s_waitcnt vmcnt(5)
    v_mfma_f32_16x16x32_bf16 v[52:55], v[48:51], v[24:27], v[52:55]
    v_bitop3_b32 v25, v24, v26, s18 bitop3:0x7e
    v_or3_b32 v17, v17, v21, v25
    v_and_b32 v17, 1, v17
    s_waitcnt vmcnt(4)
    v_mfma_f32_16x16x32_bf16 v[52:55], v[48:51], v[28:31], v[52:55]
    s_nop 0
    v_bitop3_b32 v29, v28, v30, s18 bitop3:0x7e
    v_and_or_b32 v17, v29, 1, v17
    v_cmp_ne_u32 vcc, 0, v17
    s_nop 3
    v_add_f32_dpp v54, v52, v52 row_ror:8 row_mask:0xf bank_mask:0xf
    v_add_f32_dpp v55, v53, v53 row_ror:8 row_mask:0xf bank_mask:0xf
    v_cvt_pk_bf16_f32 v11, v54, v55
    s_cbranch_vccz Lc0_r1d
    s_sub_u32 s15, s15, 1
    s_cbranch_scc0 Lc0_r1
    s_mov_b32 s15, 0
    s_branch Lc0_r1d
Lcw1:
    v_lshrrev_b32 v16, 4, v0
    v_and_b32 v17, 15, v0
    v_lshlrev_b32 v18, 13, v16
    v_lshl_add_u32 v2, v17, 4, v18
    v_mul_u32_u24 v18, 1280, v16
    v_lshl_add_u32 v3, v17, 4, v18
    v_lshrrev_b32 v18, 3, v0
    v_mul_u32_u24 v18, 1280, v18
    v_and_b32 v19, 7, v0
    v_lshl_add_u32 v4, v19, 4, v18
    v_lshlrev_b32 v10, 4, v0
    v_add_u32 v1, 57344, v10
    v_and_b32 v18, 1, v16
    v_lshlrev_b32 v19, 5, v18
    v_xor_b32 v5, v10, v19
    v_xor_b32 v6, 64, v5
    v_xor_b32 v7, 0x80, v5
    v_xor_b32 v8, 0xc0, v5
    v_lshlrev_b32 v19, 6, v18
    v_xor_b32 v9, v10, v19
    v_xor_b32 v9, 128, v9
    v_lshrrev_b32 v16, 5, v0
    v_bfe_u32 v17, v0, 4, 1
    v_bfe_u32 v18, v0, 3, 1
    v_bfe_u32 v19, v0, 2, 1
    v_and_b32 v20, 3, v0
    v_lshlrev_b32 v20, 3, v20
    v_lshl_add_u32 v11, v16, 12, v20
    v_lshl_add_u32 v11, v17, 10, v11
    v_lshl_add_u32 v11, v18, 11, v11
    v_lshl_add_u32 v11, v19, 8, v11
    v_lshl_add_u32 v11, v19, 5, v11
    v_lshl_add_u32 v11, v17, 6, v11
    v_lshl_add_u32 v11, v18, 7, v11
    v_xor_b32 v11, 64, v11
    v_xor_b32 v12, 32, v11
    v_lshl_add_u32 v20, v18, 5, v20
    v_lshlrev_b32 v18, 4, v17
    v_lshl_add_u32 v18, v16, 2, v18
    v_add_u32 v18, v18, v19
    v_lshl_add_u32 v14, v18, 7, v20
    v_lshl_add_u32 v13, v18, 8, v20
    v_lshl_add_u32 v13, v19, 6, v13
    v_lshl_add_u32 v13, v17, 7, v13
    v_xor_b32 v13, 64, v13
    s_load_dwordx2 s[52:53], s[0:1], 16
    s_load_dwordx2 s[56:57], s[0:1], 24
    s_load_dwordx2 s[60:61], s[0:1], 32
    s_load_dwordx2 s[64:65], s[0:1], 40
    s_waitcnt lgkmcnt(0)
    s_mov_b32 s54, 5242880
    s_mov_b32 s55, 0x20000
    s_mov_b32 s58, 5242880
    s_mov_b32 s59, 0x20000
    s_mov_b32 s62, 5242880
    s_mov_b32 s63, 0x20000
    s_mov_b32 s66, 5242880
    s_mov_b32 s67, 0x20000
    s_lshl_b32 s71, s12, 8
    s_mul_i32 s68, s3, 2621440
    s_sub_u32 s69, 2621440, s68
    s_add_u32 s68, s68, s71
    s_add_u32 s69, s69, s71
    s_mul_i32 s70, s12, 163840
    s_mul_i32 s71, s3, 640
    s_add_u32 s70, s70, s71
    s_add_u32 s71, s68, 131072
    buffer_load_dwordx4 v[112:115], v2, s[52:55], s71 offen
    s_add_u32 s71, s68, 163840
    buffer_load_dwordx4 v[116:119], v2, s[52:55], s71 offen
    s_add_u32 s71, s68, 196608
    buffer_load_dwordx4 v[120:123], v2, s[52:55], s71 offen
    s_add_u32 s71, s68, 229376
    buffer_load_dwordx4 v[124:127], v2, s[52:55], s71 offen
    s_add_u32 s71, s68, 131072
    buffer_load_dwordx4 v[16:19], v2, s[56:59], s71 offen
    s_add_u32 s71, s68, 163840
    buffer_load_dwordx4 v[20:23], v2, s[56:59], s71 offen
    s_add_u32 s71, s68, 196608
    buffer_load_dwordx4 v[128:131], v2, s[56:59], s71 offen
    s_add_u32 s71, s68, 229376
    buffer_load_dwordx4 v[132:135], v2, s[56:59], s71 offen
    s_add_u32 s71, s68, 131072
    buffer_load_dwordx4 v[24:27], v2, s[60:63], s71 offen
    s_add_u32 s71, s68, 163840
    buffer_load_dwordx4 v[28:31], v2, s[60:63], s71 offen
    s_add_u32 s71, s68, 196608
    buffer_load_dwordx4 v[136:139], v2, s[60:63], s71 offen
    s_add_u32 s71, s68, 229376
    buffer_load_dwordx4 v[140:143], v2, s[60:63], s71 offen
    s_add_u32 s71, s69, 131072
    buffer_load_dwordx4 a[8:11], v2, s[52:55], s71 offen
    s_add_u32 s71, s69, 163840
    buffer_load_dwordx4 a[12:15], v2, s[52:55], s71 offen
    s_add_u32 s71, s69, 196608
    buffer_load_dwordx4 a[16:19], v2, s[52:55], s71 offen
    s_add_u32 s71, s69, 229376
    buffer_load_dwordx4 a[20:23], v2, s[52:55], s71 offen
    s_add_u32 s71, s69, 131072
    buffer_load_dwordx4 a[64:67], v2, s[56:59], s71 offen
    s_add_u32 s71, s69, 163840
    buffer_load_dwordx4 a[68:71], v2, s[56:59], s71 offen
    s_add_u32 s71, s69, 196608
    buffer_load_dwordx4 a[72:75], v2, s[56:59], s71 offen
    s_add_u32 s71, s69, 229376
    buffer_load_dwordx4 a[76:79], v2, s[56:59], s71 offen
    s_add_u32 s71, s69, 131072
    buffer_load_dwordx4 v[32:35], v2, s[60:63], s71 offen
    s_add_u32 s71, s69, 163840
    buffer_load_dwordx4 v[36:39], v2, s[60:63], s71 offen
    s_add_u32 s71, s69, 196608
    buffer_load_dwordx4 a[128:131], v2, s[60:63], s71 offen
    s_add_u32 s71, s69, 229376
    buffer_load_dwordx4 a[132:135], v2, s[60:63], s71 offen
    s_waitcnt vmcnt(23)
    ds_write_b128 v5, v[112:115] offset:4096
    s_waitcnt vmcnt(22)
    ds_write_b128 v6, v[116:119] offset:5120
    s_waitcnt vmcnt(21)
    ds_write_b128 v7, v[120:123] offset:6144
    s_waitcnt vmcnt(20)
    ds_write_b128 v8, v[124:127] offset:7168
    s_waitcnt lgkmcnt(0)
    s_barrier
    ds_read_b64_tr_b16 v[112:113], v11 offset:0
    ds_read_b64_tr_b16 v[114:115], v11 offset:512
    ds_read_b64_tr_b16 v[116:117], v11 offset:8192
    ds_read_b64_tr_b16 v[118:119], v11 offset:8704
    ds_read_b64_tr_b16 v[120:121], v12 offset:0
    ds_read_b64_tr_b16 v[122:123], v12 offset:512
    ds_read_b64_tr_b16 v[124:125], v12 offset:8192
    ds_read_b64_tr_b16 v[126:127], v12 offset:8704
    s_waitcnt lgkmcnt(0)
    s_barrier
    s_add_u32 s71, s68, 655360
    buffer_load_dwordx4 v[40:43], v2, s[52:55], s71 offen
    s_add_u32 s71, s68, 688128
    buffer_load_dwordx4 v[44:47], v2, s[52:55], s71 offen
    s_add_u32 s71, s68, 720896
    buffer_load_dwordx4 v[48:51], v2, s[52:55], s71 offen
    s_add_u32 s71, s68, 753664
    buffer_load_dwordx4 v[52:55], v2, s[52:55], s71 offen
    s_waitcnt vmcnt(23)
    ds_write_b128 v5, v[16:19] offset:4096
    s_waitcnt vmcnt(22)
    ds_write_b128 v6, v[20:23] offset:5120
    s_waitcnt vmcnt(21)
    ds_write_b128 v7, v[128:131] offset:6144
    s_waitcnt vmcnt(20)
    ds_write_b128 v8, v[132:135] offset:7168
    s_waitcnt lgkmcnt(0)
    s_barrier
    ds_read_b64_tr_b16 v[16:17], v11 offset:0
    ds_read_b64_tr_b16 v[18:19], v11 offset:512
    ds_read_b64_tr_b16 v[20:21], v11 offset:8192
    ds_read_b64_tr_b16 v[22:23], v11 offset:8704
    ds_read_b64_tr_b16 v[128:129], v12 offset:0
    ds_read_b64_tr_b16 v[130:131], v12 offset:512
    ds_read_b64_tr_b16 v[132:133], v12 offset:8192
    ds_read_b64_tr_b16 v[134:135], v12 offset:8704
    s_waitcnt lgkmcnt(0)
    s_barrier
    ds_write_b128 v1, v[16:19] offset:8192
    ds_write_b128 v1, v[20:23] offset:9216
    s_add_u32 s71, s68, 655360
    buffer_load_dwordx4 v[56:59], v2, s[56:59], s71 offen
    s_add_u32 s71, s68, 688128
    buffer_load_dwordx4 v[60:63], v2, s[56:59], s71 offen
    s_add_u32 s71, s68, 720896
    buffer_load_dwordx4 v[64:67], v2, s[56:59], s71 offen
    s_add_u32 s71, s68, 753664
    buffer_load_dwordx4 v[68:71], v2, s[56:59], s71 offen
    s_waitcnt vmcnt(23)
    ds_write_b128 v5, v[24:27] offset:4096
    s_waitcnt vmcnt(22)
    ds_write_b128 v6, v[28:31] offset:5120
    s_waitcnt vmcnt(21)
    ds_write_b128 v7, v[136:139] offset:6144
    s_waitcnt vmcnt(20)
    ds_write_b128 v8, v[140:143] offset:7168
    s_waitcnt lgkmcnt(0)
    s_barrier
    ds_read_b64_tr_b16 v[24:25], v11 offset:0
    ds_read_b64_tr_b16 v[26:27], v11 offset:512
    ds_read_b64_tr_b16 v[28:29], v11 offset:8192
    ds_read_b64_tr_b16 v[30:31], v11 offset:8704
    ds_read_b64_tr_b16 v[136:137], v12 offset:0
    ds_read_b64_tr_b16 v[138:139], v12 offset:512
    ds_read_b64_tr_b16 v[140:141], v12 offset:8192
    ds_read_b64_tr_b16 v[142:143], v12 offset:8704
    s_waitcnt lgkmcnt(0)
    s_barrier
    ds_write_b128 v1, v[24:27] offset:10240
    ds_write_b128 v1, v[28:31] offset:11264
    s_add_u32 s71, s68, 655360
    buffer_load_dwordx4 v[96:99], v2, s[60:63], s71 offen
    s_add_u32 s71, s68, 688128
    buffer_load_dwordx4 v[100:103], v2, s[60:63], s71 offen
    s_add_u32 s71, s68, 720896
    buffer_load_dwordx4 v[104:107], v2, s[60:63], s71 offen
    s_add_u32 s71, s68, 753664
    buffer_load_dwordx4 v[108:111], v2, s[60:63], s71 offen
    s_waitcnt vmcnt(23)
    ds_write_b128 v5, a[8:11] offset:4096
    s_waitcnt vmcnt(22)
    ds_write_b128 v6, a[12:15] offset:5120
    s_waitcnt vmcnt(21)
    ds_write_b128 v7, a[16:19] offset:6144
    s_waitcnt vmcnt(20)
    ds_write_b128 v8, a[20:23] offset:7168
    s_waitcnt lgkmcnt(0)
    s_barrier
    ds_read_b64_tr_b16 a[8:9], v11 offset:0
    ds_read_b64_tr_b16 a[10:11], v11 offset:512
    ds_read_b64_tr_b16 a[12:13], v11 offset:8192
    ds_read_b64_tr_b16 a[14:15], v11 offset:8704
    ds_read_b64_tr_b16 a[16:17], v12 offset:0
    ds_read_b64_tr_b16 a[18:19], v12 offset:512
    ds_read_b64_tr_b16 a[20:21], v12 offset:8192
    ds_read_b64_tr_b16 a[22:23], v12 offset:8704
    s_waitcnt lgkmcnt(0)
    s_barrier
    s_add_u32 s71, s69, 655360
    buffer_load_dwordx4 v[224:227], v2, s[52:55], s71 offen
    s_add_u32 s71, s69, 688128
    buffer_load_dwordx4 v[228:231], v2, s[52:55], s71 offen
    s_add_u32 s71, s69, 720896
    buffer_load_dwordx4 v[72:75], v2, s[52:55], s71 offen
    s_add_u32 s71, s69, 753664
    buffer_load_dwordx4 v[76:79], v2, s[52:55], s71 offen
    s_waitcnt vmcnt(23)
    ds_write_b128 v5, a[64:67] offset:4096
    s_waitcnt vmcnt(22)
    ds_write_b128 v6, a[68:71] offset:5120
    s_waitcnt vmcnt(21)
    ds_write_b128 v7, a[72:75] offset:6144
    s_waitcnt vmcnt(20)
    ds_write_b128 v8, a[76:79] offset:7168
    s_waitcnt lgkmcnt(0)
    s_barrier
    ds_read_b64_tr_b16 a[64:65], v11 offset:0
    ds_read_b64_tr_b16 a[66:67], v11 offset:512
    ds_read_b64_tr_b16 a[68:69], v11 offset:8192
    ds_read_b64_tr_b16 a[70:71], v11 offset:8704
    ds_read_b64_tr_b16 a[72:73], v12 offset:0
    ds_read_b64_tr_b16 a[74:75], v12 offset:512
    ds_read_b64_tr_b16 a[76:77], v12 offset:8192
    ds_read_b64_tr_b16 a[78:79], v12 offset:8704
    s_waitcnt lgkmcnt(0)
    s_barrier
    s_add_u32 s71, s69, 655360
    buffer_load_dwordx4 v[232:235], v2, s[56:59], s71 offen
    s_add_u32 s71, s69, 688128
    buffer_load_dwordx4 v[236:239], v2, s[56:59], s71 offen
    s_add_u32 s71, s69, 720896
    buffer_load_dwordx4 v[240:243], v2, s[56:59], s71 offen
    s_add_u32 s71, s69, 753664
    buffer_load_dwordx4 v[244:247], v2, s[56:59], s71 offen
    s_waitcnt vmcnt(23)
    ds_write_b128 v5, v[32:35] offset:4096
    s_waitcnt vmcnt(22)
    ds_write_b128 v6, v[36:39] offset:5120
    s_waitcnt vmcnt(21)
    ds_write_b128 v7, a[128:131] offset:6144
    s_waitcnt vmcnt(20)
    ds_write_b128 v8, a[132:135] offset:7168
    s_waitcnt lgkmcnt(0)
    s_barrier
    ds_read_b64_tr_b16 v[32:33], v11 offset:0
    ds_read_b64_tr_b16 v[34:35], v11 offset:512
    ds_read_b64_tr_b16 v[36:37], v11 offset:8192
    ds_read_b64_tr_b16 v[38:39], v11 offset:8704
    ds_read_b64_tr_b16 a[128:129], v12 offset:0
    ds_read_b64_tr_b16 a[130:131], v12 offset:512
    ds_read_b64_tr_b16 a[132:133], v12 offset:8192
    ds_read_b64_tr_b16 a[134:135], v12 offset:8704
    s_waitcnt lgkmcnt(0)
    s_barrier
    ds_write_b128 v1, v[32:35] offset:32768
    ds_write_b128 v1, v[36:39] offset:33792
    s_add_u32 s71, s69, 655360
    buffer_load_dwordx4 v[248:251], v2, s[60:63], s71 offen
    s_add_u32 s71, s69, 688128
    buffer_load_dwordx4 v[252:255], v2, s[60:63], s71 offen
    s_add_u32 s71, s69, 720896
    buffer_load_dwordx4 a[0:3], v2, s[60:63], s71 offen
    s_add_u32 s71, s69, 753664
    buffer_load_dwordx4 a[4:7], v2, s[60:63], s71 offen
    s_waitcnt vmcnt(23)
    ds_write_b128 v5, v[40:43] offset:4096
    s_waitcnt vmcnt(22)
    ds_write_b128 v6, v[44:47] offset:5120
    s_waitcnt vmcnt(21)
    ds_write_b128 v7, v[48:51] offset:6144
    s_waitcnt vmcnt(20)
    ds_write_b128 v8, v[52:55] offset:7168
    s_waitcnt lgkmcnt(0)
    s_barrier
    ds_read_b64_tr_b16 v[40:41], v11 offset:0
    ds_read_b64_tr_b16 v[42:43], v11 offset:512
    ds_read_b64_tr_b16 v[44:45], v11 offset:8192
    ds_read_b64_tr_b16 v[46:47], v11 offset:8704
    ds_read_b64_tr_b16 v[48:49], v12 offset:0
    ds_read_b64_tr_b16 v[50:51], v12 offset:512
    ds_read_b64_tr_b16 v[52:53], v12 offset:8192
    ds_read_b64_tr_b16 v[54:55], v12 offset:8704
    s_waitcnt lgkmcnt(0)
    s_barrier
    ds_write_b128 v1, v[40:43] offset:0
    ds_write_b128 v1, v[44:47] offset:1024
    ds_write_b128 v1, v[48:51] offset:2048
    ds_write_b128 v1, v[52:55] offset:3072
    s_add_u32 s71, s68, 1179648
    buffer_load_dwordx4 v[168:171], v2, s[52:55], s71 offen
    s_add_u32 s71, s68, 1212416
    buffer_load_dwordx4 v[172:175], v2, s[52:55], s71 offen
    s_add_u32 s71, s68, 1245184
    buffer_load_dwordx4 v[80:83], v2, s[52:55], s71 offen
    s_add_u32 s71, s68, 1277952
    buffer_load_dwordx4 v[84:87], v2, s[52:55], s71 offen
    s_waitcnt vmcnt(23)
    ds_write_b128 v5, v[56:59] offset:4096
    s_waitcnt vmcnt(22)
    ds_write_b128 v6, v[60:63] offset:5120
    s_waitcnt vmcnt(21)
    ds_write_b128 v7, v[64:67] offset:6144
    s_waitcnt vmcnt(20)
    ds_write_b128 v8, v[68:71] offset:7168
    s_waitcnt lgkmcnt(0)
    s_barrier
    ds_read_b64_tr_b16 v[56:57], v11 offset:0
    ds_read_b64_tr_b16 v[58:59], v11 offset:512
    ds_read_b64_tr_b16 v[60:61], v11 offset:8192
    ds_read_b64_tr_b16 v[62:63], v11 offset:8704
    ds_read_b64_tr_b16 v[64:65], v12 offset:0
    ds_read_b64_tr_b16 v[66:67], v12 offset:512
    ds_read_b64_tr_b16 v[68:69], v12 offset:8192
    ds_read_b64_tr_b16 v[70:71], v12 offset:8704
    s_waitcnt lgkmcnt(0)
    s_barrier
    ds_write_b128 v1, v[56:59] offset:4096
    ds_write_b128 v1, v[60:63] offset:5120
    ds_write_b128 v1, v[64:67] offset:6144
    ds_write_b128 v1, v[68:71] offset:7168
    s_add_u32 s71, s68, 1179648
    buffer_load_dwordx4 v[176:179], v2, s[56:59], s71 offen
    s_add_u32 s71, s68, 1212416
    buffer_load_dwordx4 v[180:183], v2, s[56:59], s71 offen
    s_add_u32 s71, s68, 1245184
    buffer_load_dwordx4 v[88:91], v2, s[56:59], s71 offen
    s_add_u32 s71, s68, 1277952
    buffer_load_dwordx4 v[92:95], v2, s[56:59], s71 offen
    s_waitcnt vmcnt(23)
    ds_write_b128 v5, v[96:99] offset:4096
    s_waitcnt vmcnt(22)
    ds_write_b128 v6, v[100:103] offset:5120
    s_waitcnt vmcnt(21)
    ds_write_b128 v7, v[104:107] offset:6144
    s_waitcnt vmcnt(20)
    ds_write_b128 v8, v[108:111] offset:7168
    s_waitcnt lgkmcnt(0)
    s_barrier
    ds_read_b64_tr_b16 v[96:97], v11 offset:0
    ds_read_b64_tr_b16 v[98:99], v11 offset:512
    ds_read_b64_tr_b16 v[100:101], v11 offset:8192
    ds_read_b64_tr_b16 v[102:103], v11 offset:8704
    ds_read_b64_tr_b16 v[104:105], v12 offset:0
    ds_read_b64_tr_b16 v[106:107], v12 offset:512
    ds_read_b64_tr_b16 v[108:109], v12 offset:8192
    ds_read_b64_tr_b16 v[110:111], v12 offset:8704
    s_waitcnt lgkmcnt(0)
    s_barrier
    s_add_u32 s71, s68, 1179648
    buffer_load_dwordx4 v[184:187], v2, s[60:63], s71 offen
    s_add_u32 s71, s68, 1212416
    buffer_load_dwordx4 v[188:191], v2, s[60:63], s71 offen
    s_add_u32 s71, s68, 1245184
    buffer_load_dwordx4 v[192:195], v2, s[60:63], s71 offen
    s_add_u32 s71, s68, 1277952
    buffer_load_dwordx4 v[196:199], v2, s[60:63], s71 offen
    s_waitcnt vmcnt(23)
    ds_write_b128 v5, v[224:227] offset:4096
    s_waitcnt vmcnt(22)
    ds_write_b128 v6, v[228:231] offset:5120
    s_waitcnt vmcnt(21)
    ds_write_b128 v7, v[72:75] offset:6144
    s_waitcnt vmcnt(20)
    ds_write_b128 v8, v[76:79] offset:7168
    s_waitcnt lgkmcnt(0)
    s_barrier
    ds_read_b64_tr_b16 v[224:225], v11 offset:0
    ds_read_b64_tr_b16 v[226:227], v11 offset:512
    ds_read_b64_tr_b16 v[228:229], v11 offset:8192
    ds_read_b64_tr_b16 v[230:231], v11 offset:8704
    ds_read_b64_tr_b16 v[72:73], v12 offset:0
    ds_read_b64_tr_b16 v[74:75], v12 offset:512
    ds_read_b64_tr_b16 v[76:77], v12 offset:8192
    ds_read_b64_tr_b16 v[78:79], v12 offset:8704
    s_waitcnt lgkmcnt(0)
    s_barrier
    ds_write_b128 v1, v[72:75] offset:28672
    ds_write_b128 v1, v[76:79] offset:29696
    s_add_u32 s71, s69, 1179648
    buffer_load_dwordx4 a[40:43], v2, s[52:55], s71 offen
    s_add_u32 s71, s69, 1212416
    buffer_load_dwordx4 a[44:47], v2, s[52:55], s71 offen
    s_add_u32 s71, s69, 1245184
    buffer_load_dwordx4 v[16:19], v2, s[52:55], s71 offen
    s_add_u32 s71, s69, 1277952
    buffer_load_dwordx4 v[20:23], v2, s[52:55], s71 offen
    s_waitcnt vmcnt(23)
    ds_write_b128 v5, v[232:235] offset:4096
    s_waitcnt vmcnt(22)
    ds_write_b128 v6, v[236:239] offset:5120
    s_waitcnt vmcnt(21)
    ds_write_b128 v7, v[240:243] offset:6144
    s_waitcnt vmcnt(20)
    ds_write_b128 v8, v[244:247] offset:7168
    s_waitcnt lgkmcnt(0)
    s_barrier
    ds_read_b64_tr_b16 v[232:233], v11 offset:0
    ds_read_b64_tr_b16 v[234:235], v11 offset:512
    ds_read_b64_tr_b16 v[236:237], v11 offset:8192
    ds_read_b64_tr_b16 v[238:239], v11 offset:8704
    ds_read_b64_tr_b16 v[240:241], v12 offset:0
    ds_read_b64_tr_b16 v[242:243], v12 offset:512
    ds_read_b64_tr_b16 v[244:245], v12 offset:8192
    ds_read_b64_tr_b16 v[246:247], v12 offset:8704
    s_waitcnt lgkmcnt(0)
    s_barrier
    s_add_u32 s71, s69, 1179648
    buffer_load_dwordx4 a[96:99], v2, s[56:59], s71 offen
    s_add_u32 s71, s69, 1212416
    buffer_load_dwordx4 a[100:103], v2, s[56:59], s71 offen
    s_add_u32 s71, s69, 1245184
    buffer_load_dwordx4 a[104:107], v2, s[56:59], s71 offen
    s_add_u32 s71, s69, 1277952
    buffer_load_dwordx4 a[108:111], v2, s[56:59], s71 offen
    s_waitcnt vmcnt(23)
    ds_write_b128 v5, v[248:251] offset:4096
    s_waitcnt vmcnt(22)
    ds_write_b128 v6, v[252:255] offset:5120
    s_waitcnt vmcnt(21)
    ds_write_b128 v7, a[0:3] offset:6144
    s_waitcnt vmcnt(20)
    ds_write_b128 v8, a[4:7] offset:7168
    s_waitcnt lgkmcnt(0)
    s_barrier
    ds_read_b64_tr_b16 v[248:249], v11 offset:0
    ds_read_b64_tr_b16 v[250:251], v11 offset:512
    ds_read_b64_tr_b16 v[252:253], v11 offset:8192
    ds_read_b64_tr_b16 v[254:255], v11 offset:8704
    ds_read_b64_tr_b16 a[0:1], v12 offset:0
    ds_read_b64_tr_b16 a[2:3], v12 offset:512
    ds_read_b64_tr_b16 a[4:5], v12 offset:8192
    ds_read_b64_tr_b16 a[6:7], v12 offset:8704
    s_waitcnt lgkmcnt(0)
    s_barrier
    s_add_u32 s71, s69, 1179648
    buffer_load_dwordx4 a[152:155], v2, s[60:63], s71 offen
    s_add_u32 s71, s69, 1212416
    buffer_load_dwordx4 a[156:159], v2, s[60:63], s71 offen
    s_add_u32 s71, s69, 1245184
    buffer_load_dwordx4 a[160:163], v2, s[60:63], s71 offen
    s_add_u32 s71, s69, 1277952
    buffer_load_dwordx4 a[164:167], v2, s[60:63], s71 offen
    s_waitcnt vmcnt(23)
    ds_write_b128 v5, v[168:171] offset:4096
    s_waitcnt vmcnt(22)
    ds_write_b128 v6, v[172:175] offset:5120
    s_waitcnt vmcnt(21)
    ds_write_b128 v7, v[80:83] offset:6144
    s_waitcnt vmcnt(20)
    ds_write_b128 v8, v[84:87] offset:7168
    s_waitcnt lgkmcnt(0)
    s_barrier
    ds_read_b64_tr_b16 v[168:169], v11 offset:0
    ds_read_b64_tr_b16 v[170:171], v11 offset:512
    ds_read_b64_tr_b16 v[172:173], v11 offset:8192
    ds_read_b64_tr_b16 v[174:175], v11 offset:8704
    ds_read_b64_tr_b16 v[80:81], v12 offset:0
    ds_read_b64_tr_b16 v[82:83], v12 offset:512
    ds_read_b64_tr_b16 v[84:85], v12 offset:8192
    ds_read_b64_tr_b16 v[86:87], v12 offset:8704
    s_waitcnt lgkmcnt(0)
    s_barrier
    ds_write_b128 v1, v[80:83] offset:18432
    ds_write_b128 v1, v[84:87] offset:19456
    s_add_u32 s71, s68, 1703936
    buffer_load_dwordx4 v[24:27], v2, s[52:55], s71 offen
    s_add_u32 s71, s68, 1736704
    buffer_load_dwordx4 v[28:31], v2, s[52:55], s71 offen
    s_add_u32 s71, s68, 1769472
    buffer_load_dwordx4 v[144:147], v2, s[52:55], s71 offen
    s_add_u32 s71, s68, 1802240
    buffer_load_dwordx4 v[148:151], v2, s[52:55], s71 offen
    s_waitcnt vmcnt(23)
    ds_write_b128 v5, v[176:179] offset:4096
    s_waitcnt vmcnt(22)
    ds_write_b128 v6, v[180:183] offset:5120
    s_waitcnt vmcnt(21)
    ds_write_b128 v7, v[88:91] offset:6144
    s_waitcnt vmcnt(20)
    ds_write_b128 v8, v[92:95] offset:7168
    s_waitcnt lgkmcnt(0)
    s_barrier
    ds_read_b64_tr_b16 v[176:177], v11 offset:0
    ds_read_b64_tr_b16 v[178:179], v11 offset:512
    ds_read_b64_tr_b16 v[180:181], v11 offset:8192
    ds_read_b64_tr_b16 v[182:183], v11 offset:8704
    ds_read_b64_tr_b16 v[88:89], v12 offset:0
    ds_read_b64_tr_b16 v[90:91], v12 offset:512
    ds_read_b64_tr_b16 v[92:93], v12 offset:8192
    ds_read_b64_tr_b16 v[94:95], v12 offset:8704
    s_waitcnt lgkmcnt(0)
    s_barrier
    ds_write_b128 v1, v[88:91] offset:20480
    ds_write_b128 v1, v[92:95] offset:21504
    s_add_u32 s71, s68, 1703936
    buffer_load_dwordx4 v[32:35], v2, s[56:59], s71 offen
    s_add_u32 s71, s68, 1736704
    buffer_load_dwordx4 v[36:39], v2, s[56:59], s71 offen
    s_add_u32 s71, s68, 1769472
    buffer_load_dwordx4 v[152:155], v2, s[56:59], s71 offen
    s_add_u32 s71, s68, 1802240
    buffer_load_dwordx4 v[156:159], v2, s[56:59], s71 offen
    s_waitcnt vmcnt(23)
    ds_write_b128 v5, v[184:187] offset:4096
    s_waitcnt vmcnt(22)
    ds_write_b128 v6, v[188:191] offset:5120
    s_waitcnt vmcnt(21)
    ds_write_b128 v7, v[192:195] offset:6144
    s_waitcnt vmcnt(20)
    ds_write_b128 v8, v[196:199] offset:7168
    s_waitcnt lgkmcnt(0)
    s_barrier
    ds_read_b64_tr_b16 v[184:185], v11 offset:0
    ds_read_b64_tr_b16 v[186:187], v11 offset:512
    ds_read_b64_tr_b16 v[188:189], v11 offset:8192
    ds_read_b64_tr_b16 v[190:191], v11 offset:8704
    ds_read_b64_tr_b16 v[192:193], v12 offset:0
    ds_read_b64_tr_b16 v[194:195], v12 offset:512
    ds_read_b64_tr_b16 v[196:197], v12 offset:8192
    ds_read_b64_tr_b16 v[198:199], v12 offset:8704
    s_waitcnt lgkmcnt(0)
    s_barrier
    s_add_u32 s71, s68, 1703936
    buffer_load_dwordx4 v[40:43], v2, s[60:63], s71 offen
    s_add_u32 s71, s68, 1736704
    buffer_load_dwordx4 v[44:47], v2, s[60:63], s71 offen
    s_add_u32 s71, s68, 1769472
    buffer_load_dwordx4 v[160:163], v2, s[60:63], s71 offen
    s_add_u32 s71, s68, 1802240
    buffer_load_dwordx4 v[164:167], v2, s[60:63], s71 offen
    s_waitcnt vmcnt(23)
    ds_write_b128 v5, a[40:43] offset:4096
    s_waitcnt vmcnt(22)
    ds_write_b128 v6, a[44:47] offset:5120
    s_waitcnt vmcnt(21)
    ds_write_b128 v7, v[16:19] offset:6144
    s_waitcnt vmcnt(20)
    ds_write_b128 v8, v[20:23] offset:7168
    s_waitcnt lgkmcnt(0)
    s_barrier
    ds_read_b64_tr_b16 a[40:41], v11 offset:0
    ds_read_b64_tr_b16 a[42:43], v11 offset:512
    ds_read_b64_tr_b16 a[44:45], v11 offset:8192
    ds_read_b64_tr_b16 a[46:47], v11 offset:8704
    ds_read_b64_tr_b16 v[16:17], v12 offset:0
    ds_read_b64_tr_b16 v[18:19], v12 offset:512
    ds_read_b64_tr_b16 v[20:21], v12 offset:8192
    ds_read_b64_tr_b16 v[22:23], v12 offset:8704
    s_waitcnt lgkmcnt(0)
    s_barrier
    ds_write_b128 v1, v[16:19] offset:30720
    ds_write_b128 v1, v[20:23] offset:31744
    s_add_u32 s71, s69, 1703936
    buffer_load_dwordx4 a[24:27], v2, s[52:55], s71 offen
    s_add_u32 s71, s69, 1736704
    buffer_load_dwordx4 a[28:31], v2, s[52:55], s71 offen
    s_add_u32 s71, s69, 1769472
    buffer_load_dwordx4 a[32:35], v2, s[52:55], s71 offen
    s_add_u32 s71, s69, 1802240
    buffer_load_dwordx4 a[36:39], v2, s[52:55], s71 offen
    s_waitcnt vmcnt(23)
    ds_write_b128 v5, a[96:99] offset:4096
    s_waitcnt vmcnt(22)
    ds_write_b128 v6, a[100:103] offset:5120
    s_waitcnt vmcnt(21)
    ds_write_b128 v7, a[104:107] offset:6144
    s_waitcnt vmcnt(20)
    ds_write_b128 v8, a[108:111] offset:7168
    s_waitcnt lgkmcnt(0)
    s_barrier
    ds_read_b64_tr_b16 a[96:97], v11 offset:0
    ds_read_b64_tr_b16 a[98:99], v11 offset:512
    ds_read_b64_tr_b16 a[100:101], v11 offset:8192
    ds_read_b64_tr_b16 a[102:103], v11 offset:8704
    ds_read_b64_tr_b16 a[104:105], v12 offset:0
    ds_read_b64_tr_b16 a[106:107], v12 offset:512
    ds_read_b64_tr_b16 a[108:109], v12 offset:8192
    ds_read_b64_tr_b16 a[110:111], v12 offset:8704
    s_waitcnt lgkmcnt(0)
    s_barrier
    s_add_u32 s71, s69, 1703936
    buffer_load_dwordx4 a[80:83], v2, s[56:59], s71 offen
    s_add_u32 s71, s69, 1736704
    buffer_load_dwordx4 a[84:87], v2, s[56:59], s71 offen
    s_add_u32 s71, s69, 1769472
    buffer_load_dwordx4 a[88:91], v2, s[56:59], s71 offen
    s_add_u32 s71, s69, 1802240
    buffer_load_dwordx4 a[92:95], v2, s[56:59], s71 offen
    s_waitcnt vmcnt(23)
    ds_write_b128 v5, a[152:155] offset:4096
    s_waitcnt vmcnt(22)
    ds_write_b128 v6, a[156:159] offset:5120
    s_waitcnt vmcnt(21)
    ds_write_b128 v7, a[160:163] offset:6144
    s_waitcnt vmcnt(20)
    ds_write_b128 v8, a[164:167] offset:7168
    s_waitcnt lgkmcnt(0)
    s_barrier
    ds_read_b64_tr_b16 a[152:153], v11 offset:0
    ds_read_b64_tr_b16 a[154:155], v11 offset:512
    ds_read_b64_tr_b16 a[156:157], v11 offset:8192
    ds_read_b64_tr_b16 a[158:159], v11 offset:8704
    ds_read_b64_tr_b16 a[160:161], v12 offset:0
    ds_read_b64_tr_b16 a[162:163], v12 offset:512
    ds_read_b64_tr_b16 a[164:165], v12 offset:8192
    ds_read_b64_tr_b16 a[166:167], v12 offset:8704
    s_waitcnt lgkmcnt(0)
    s_barrier
    s_add_u32 s71, s69, 1703936
    buffer_load_dwordx4 a[136:139], v2, s[60:63], s71 offen
    s_add_u32 s71, s69, 1736704
    buffer_load_dwordx4 a[140:143], v2, s[60:63], s71 offen
    s_add_u32 s71, s69, 1769472
    buffer_load_dwordx4 a[144:147], v2, s[60:63], s71 offen
    s_add_u32 s71, s69, 1802240
    buffer_load_dwordx4 a[148:151], v2, s[60:63], s71 offen
    s_waitcnt vmcnt(23)
    ds_write_b128 v5, v[24:27] offset:4096
    s_waitcnt vmcnt(22)
    ds_write_b128 v6, v[28:31] offset:5120
    s_waitcnt vmcnt(21)
    ds_write_b128 v7, v[144:147] offset:6144
    s_waitcnt vmcnt(20)
    ds_write_b128 v8, v[148:151] offset:7168
    s_waitcnt lgkmcnt(0)
    s_barrier
    ds_read_b64_tr_b16 v[24:25], v11 offset:0
    ds_read_b64_tr_b16 v[26:27], v11 offset:512
    ds_read_b64_tr_b16 v[28:29], v11 offset:8192
    ds_read_b64_tr_b16 v[30:31], v11 offset:8704
    ds_read_b64_tr_b16 v[144:145], v12 offset:0
    ds_read_b64_tr_b16 v[146:147], v12 offset:512
    ds_read_b64_tr_b16 v[148:149], v12 offset:8192
    ds_read_b64_tr_b16 v[150:151], v12 offset:8704
    s_waitcnt lgkmcnt(0)
    s_barrier
    ds_write_b128 v1, v[24:27] offset:12288
    ds_write_b128 v1, v[28:31] offset:13312
    s_add_u32 s71, s68, 2228224
    buffer_load_dwordx4 v[48:51], v2, s[52:55], s71 offen
    s_add_u32 s71, s68, 2260992
    buffer_load_dwordx4 v[52:55], v2, s[52:55], s71 offen
    s_add_u32 s71, s68, 2293760
    buffer_load_dwordx4 v[200:203], v2, s[52:55], s71 offen
    s_add_u32 s71, s68, 2326528
    buffer_load_dwordx4 v[204:207], v2, s[52:55], s71 offen
    s_waitcnt vmcnt(23)
    ds_write_b128 v5, v[32:35] offset:4096
    s_waitcnt vmcnt(22)
    ds_write_b128 v6, v[36:39] offset:5120
    s_waitcnt vmcnt(21)
    ds_write_b128 v7, v[152:155] offset:6144
    s_waitcnt vmcnt(20)
    ds_write_b128 v8, v[156:159] offset:7168
    s_waitcnt lgkmcnt(0)
    s_barrier
    ds_read_b64_tr_b16 v[32:33], v11 offset:0
    ds_read_b64_tr_b16 v[34:35], v11 offset:512
    ds_read_b64_tr_b16 v[36:37], v11 offset:8192
    ds_read_b64_tr_b16 v[38:39], v11 offset:8704
    ds_read_b64_tr_b16 v[152:153], v12 offset:0
    ds_read_b64_tr_b16 v[154:155], v12 offset:512
    ds_read_b64_tr_b16 v[156:157], v12 offset:8192
    ds_read_b64_tr_b16 v[158:159], v12 offset:8704
    s_waitcnt lgkmcnt(0)
    s_barrier
    ds_write_b128 v1, v[32:35] offset:14336
    ds_write_b128 v1, v[36:39] offset:15360
    s_add_u32 s71, s68, 2228224
    buffer_load_dwordx4 v[56:59], v2, s[56:59], s71 offen
    s_add_u32 s71, s68, 2260992
    buffer_load_dwordx4 v[60:63], v2, s[56:59], s71 offen
    s_add_u32 s71, s68, 2293760
    buffer_load_dwordx4 v[208:211], v2, s[56:59], s71 offen
    s_add_u32 s71, s68, 2326528
    buffer_load_dwordx4 v[212:215], v2, s[56:59], s71 offen
    s_waitcnt vmcnt(23)
    ds_write_b128 v5, v[40:43] offset:4096
    s_waitcnt vmcnt(22)
    ds_write_b128 v6, v[44:47] offset:5120
    s_waitcnt vmcnt(21)
    ds_write_b128 v7, v[160:163] offset:6144
    s_waitcnt vmcnt(20)
    ds_write_b128 v8, v[164:167] offset:7168
    s_waitcnt lgkmcnt(0)
    s_barrier
    ds_read_b64_tr_b16 v[40:41], v11 offset:0
    ds_read_b64_tr_b16 v[42:43], v11 offset:512
    ds_read_b64_tr_b16 v[44:45], v11 offset:8192
    ds_read_b64_tr_b16 v[46:47], v11 offset:8704
    ds_read_b64_tr_b16 v[160:161], v12 offset:0
    ds_read_b64_tr_b16 v[162:163], v12 offset:512
    ds_read_b64_tr_b16 v[164:165], v12 offset:8192
    ds_read_b64_tr_b16 v[166:167], v12 offset:8704
    s_waitcnt lgkmcnt(0)
    s_barrier
    ds_write_b128 v1, v[40:43] offset:16384
    ds_write_b128 v1, v[44:47] offset:17408
    s_add_u32 s71, s68, 2228224
    buffer_load_dwordx4 v[64:67], v2, s[60:63], s71 offen
    s_add_u32 s71, s68, 2260992
    buffer_load_dwordx4 v[68:71], v2, s[60:63], s71 offen
    s_add_u32 s71, s68, 2293760
    buffer_load_dwordx4 v[216:219], v2, s[60:63], s71 offen
    s_add_u32 s71, s68, 2326528
    buffer_load_dwordx4 v[220:223], v2, s[60:63], s71 offen
    s_waitcnt vmcnt(23)
    ds_write_b128 v5, a[24:27] offset:4096
    s_waitcnt vmcnt(22)
    ds_write_b128 v6, a[28:31] offset:5120
    s_waitcnt vmcnt(21)
    ds_write_b128 v7, a[32:35] offset:6144
    s_waitcnt vmcnt(20)
    ds_write_b128 v8, a[36:39] offset:7168
    s_waitcnt lgkmcnt(0)
    s_barrier
    ds_read_b64_tr_b16 a[24:25], v11 offset:0
    ds_read_b64_tr_b16 a[26:27], v11 offset:512
    ds_read_b64_tr_b16 a[28:29], v11 offset:8192
    ds_read_b64_tr_b16 a[30:31], v11 offset:8704
    ds_read_b64_tr_b16 a[32:33], v12 offset:0
    ds_read_b64_tr_b16 a[34:35], v12 offset:512
    ds_read_b64_tr_b16 a[36:37], v12 offset:8192
    ds_read_b64_tr_b16 a[38:39], v12 offset:8704
    s_waitcnt lgkmcnt(0)
    s_barrier
    s_add_u32 s71, s69, 2228224
    buffer_load_dwordx4 a[48:51], v2, s[52:55], s71 offen
    s_add_u32 s71, s69, 2260992
    buffer_load_dwordx4 a[52:55], v2, s[52:55], s71 offen
    s_add_u32 s71, s69, 2293760
    buffer_load_dwordx4 a[56:59], v2, s[52:55], s71 offen
    s_add_u32 s71, s69, 2326528
    buffer_load_dwordx4 a[60:63], v2, s[52:55], s71 offen
    s_waitcnt vmcnt(23)
    ds_write_b128 v5, a[80:83] offset:4096
    s_waitcnt vmcnt(22)
    ds_write_b128 v6, a[84:87] offset:5120
    s_waitcnt vmcnt(21)
    ds_write_b128 v7, a[88:91] offset:6144
    s_waitcnt vmcnt(20)
    ds_write_b128 v8, a[92:95] offset:7168
    s_waitcnt lgkmcnt(0)
    s_barrier
    ds_read_b64_tr_b16 a[80:81], v11 offset:0
    ds_read_b64_tr_b16 a[82:83], v11 offset:512
    ds_read_b64_tr_b16 a[84:85], v11 offset:8192
    ds_read_b64_tr_b16 a[86:87], v11 offset:8704
    ds_read_b64_tr_b16 a[88:89], v12 offset:0
    ds_read_b64_tr_b16 a[90:91], v12 offset:512
    ds_read_b64_tr_b16 a[92:93], v12 offset:8192
    ds_read_b64_tr_b16 a[94:95], v12 offset:8704
    s_waitcnt lgkmcnt(0)
    s_barrier
    s_add_u32 s71, s69, 2228224
    buffer_load_dwordx4 a[112:115], v2, s[56:59], s71 offen
    s_add_u32 s71, s69, 2260992
    buffer_load_dwordx4 a[116:119], v2, s[56:59], s71 offen
    s_add_u32 s71, s69, 2293760
    buffer_load_dwordx4 a[120:123], v2, s[56:59], s71 offen
    s_add_u32 s71, s69, 2326528
    buffer_load_dwordx4 a[124:127], v2, s[56:59], s71 offen
    s_waitcnt vmcnt(23)
    ds_write_b128 v5, a[136:139] offset:4096
    s_waitcnt vmcnt(22)
    ds_write_b128 v6, a[140:143] offset:5120
    s_waitcnt vmcnt(21)
    ds_write_b128 v7, a[144:147] offset:6144
    s_waitcnt vmcnt(20)
    ds_write_b128 v8, a[148:151] offset:7168
    s_waitcnt lgkmcnt(0)
    s_barrier
    ds_read_b64_tr_b16 a[136:137], v11 offset:0
    ds_read_b64_tr_b16 a[138:139], v11 offset:512
    ds_read_b64_tr_b16 a[140:141], v11 offset:8192
    ds_read_b64_tr_b16 a[142:143], v11 offset:8704
    ds_read_b64_tr_b16 a[144:145], v12 offset:0
    ds_read_b64_tr_b16 a[146:147], v12 offset:512
    ds_read_b64_tr_b16 a[148:149], v12 offset:8192
    ds_read_b64_tr_b16 a[150:151], v12 offset:8704
    s_waitcnt lgkmcnt(0)
    s_barrier
    s_add_u32 s71, s69, 2228224
    buffer_load_dwordx4 a[168:171], v2, s[60:63], s71 offen
    s_add_u32 s71, s69, 2260992
    buffer_load_dwordx4 a[172:175], v2, s[60:63], s71 offen
    s_add_u32 s71, s69, 2293760
    buffer_load_dwordx4 a[176:179], v2, s[60:63], s71 offen
    s_add_u32 s71, s69, 2326528
    buffer_load_dwordx4 a[180:183], v2, s[60:63], s71 offen
    s_waitcnt vmcnt(23)
    ds_write_b128 v5, v[48:51] offset:4096
    s_waitcnt vmcnt(22)
    ds_write_b128 v6, v[52:55] offset:5120
    s_waitcnt vmcnt(21)
    ds_write_b128 v7, v[200:203] offset:6144
    s_waitcnt vmcnt(20)
    ds_write_b128 v8, v[204:207] offset:7168
    s_waitcnt lgkmcnt(0)
    s_barrier
    ds_read_b64_tr_b16 v[48:49], v11 offset:0
    ds_read_b64_tr_b16 v[50:51], v11 offset:512
    ds_read_b64_tr_b16 v[52:53], v11 offset:8192
    ds_read_b64_tr_b16 v[54:55], v11 offset:8704
    ds_read_b64_tr_b16 v[200:201], v12 offset:0
    ds_read_b64_tr_b16 v[202:203], v12 offset:512
    ds_read_b64_tr_b16 v[204:205], v12 offset:8192
    ds_read_b64_tr_b16 v[206:207], v12 offset:8704
    s_waitcnt lgkmcnt(0)
    s_barrier
    ds_write_b128 v1, v[48:51] offset:22528
    ds_write_b128 v1, v[52:55] offset:23552
    s_add_u32 s71, s70, 20480
    buffer_load_dwordx4 v[72:75], v3, s[64:67], s71 offen
    s_add_u32 s71, s70, 25600
    buffer_load_dwordx4 v[76:79], v3, s[64:67], s71 offen
    s_add_u32 s71, s70, 30720
    buffer_load_dwordx4 v[80:83], v3, s[64:67], s71 offen
    s_add_u32 s71, s70, 35840
    buffer_load_dwordx4 v[84:87], v3, s[64:67], s71 offen
    s_waitcnt vmcnt(23)
    ds_write_b128 v5, v[56:59] offset:4096
    s_waitcnt vmcnt(22)
    ds_write_b128 v6, v[60:63] offset:5120
    s_waitcnt vmcnt(21)
    ds_write_b128 v7, v[208:211] offset:6144
    s_waitcnt vmcnt(20)
    ds_write_b128 v8, v[212:215] offset:7168
    s_waitcnt lgkmcnt(0)
    s_barrier
    ds_read_b64_tr_b16 v[56:57], v11 offset:0
    ds_read_b64_tr_b16 v[58:59], v11 offset:512
    ds_read_b64_tr_b16 v[60:61], v11 offset:8192
    ds_read_b64_tr_b16 v[62:63], v11 offset:8704
    ds_read_b64_tr_b16 v[208:209], v12 offset:0
    ds_read_b64_tr_b16 v[210:211], v12 offset:512
    ds_read_b64_tr_b16 v[212:213], v12 offset:8192
    ds_read_b64_tr_b16 v[214:215], v12 offset:8704
    s_waitcnt lgkmcnt(0)
    s_barrier
    ds_write_b128 v1, v[56:59] offset:24576
    ds_write_b128 v1, v[60:63] offset:25600
    s_add_u32 s71, s70, 102400
    buffer_load_dwordx4 a[208:211], v3, s[64:67], s71 offen
    s_add_u32 s71, s70, 107520
    buffer_load_dwordx4 a[212:215], v3, s[64:67], s71 offen
    s_add_u32 s71, s70, 112640
    buffer_load_dwordx4 a[200:203], v3, s[64:67], s71 offen
    s_add_u32 s71, s70, 117760
    buffer_load_dwordx4 a[204:207], v3, s[64:67], s71 offen
    s_waitcnt vmcnt(23)
    ds_write_b128 v5, v[64:67] offset:4096
    s_waitcnt vmcnt(22)
    ds_write_b128 v6, v[68:71] offset:5120
    s_waitcnt vmcnt(21)
    ds_write_b128 v7, v[216:219] offset:6144
    s_waitcnt vmcnt(20)
    ds_write_b128 v8, v[220:223] offset:7168
    s_waitcnt lgkmcnt(0)
    s_barrier
    ds_read_b64_tr_b16 v[64:65], v11 offset:0
    ds_read_b64_tr_b16 v[66:67], v11 offset:512
    ds_read_b64_tr_b16 v[68:69], v11 offset:8192
    ds_read_b64_tr_b16 v[70:71], v11 offset:8704
    ds_read_b64_tr_b16 v[216:217], v12 offset:0
    ds_read_b64_tr_b16 v[218:219], v12 offset:512
    ds_read_b64_tr_b16 v[220:221], v12 offset:8192
    ds_read_b64_tr_b16 v[222:223], v12 offset:8704
    s_waitcnt lgkmcnt(0)
    s_barrier
    ds_write_b128 v1, v[64:67] offset:26624
    ds_write_b128 v1, v[68:71] offset:27648
    s_add_u32 s71, s70, 20736
    buffer_load_dwordx4 a[216:219], v3, s[64:67], s71 offen
    s_add_u32 s71, s70, 25856
    buffer_load_dwordx4 a[220:223], v3, s[64:67], s71 offen
    s_add_u32 s71, s70, 30976
    buffer_load_dwordx4 a[184:187], v3, s[64:67], s71 offen
    s_add_u32 s71, s70, 36096
    buffer_load_dwordx4 a[188:191], v3, s[64:67], s71 offen
    s_waitcnt vmcnt(23)
    ds_write_b128 v5, a[48:51] offset:4096
    s_waitcnt vmcnt(22)
    ds_write_b128 v6, a[52:55] offset:5120
    s_waitcnt vmcnt(21)
    ds_write_b128 v7, a[56:59] offset:6144
    s_waitcnt vmcnt(20)
    ds_write_b128 v8, a[60:63] offset:7168
    s_waitcnt lgkmcnt(0)
    s_barrier
    ds_read_b64_tr_b16 a[48:49], v11 offset:0
    ds_read_b64_tr_b16 a[50:51], v11 offset:512
    ds_read_b64_tr_b16 a[52:53], v11 offset:8192
    ds_read_b64_tr_b16 a[54:55], v11 offset:8704
    ds_read_b64_tr_b16 a[56:57], v12 offset:0
    ds_read_b64_tr_b16 a[58:59], v12 offset:512
    ds_read_b64_tr_b16 a[60:61], v12 offset:8192
    ds_read_b64_tr_b16 a[62:63], v12 offset:8704
    s_waitcnt lgkmcnt(0)
    s_barrier
    s_add_u32 s71, s70, 102656
    buffer_load_dwordx4 v[88:91], v3, s[64:67], s71 offen
    s_add_u32 s71, s70, 107776
    buffer_load_dwordx4 v[92:95], v3, s[64:67], s71 offen
    s_add_u32 s71, s70, 112896
    buffer_load_dwordx4 a[224:227], v3, s[64:67], s71 offen
    s_add_u32 s71, s70, 118016
    buffer_load_dwordx4 a[228:231], v3, s[64:67], s71 offen
    s_waitcnt vmcnt(23)
    ds_write_b128 v5, a[112:115] offset:4096
    s_waitcnt vmcnt(22)
    ds_write_b128 v6, a[116:119] offset:5120
    s_waitcnt vmcnt(21)
    ds_write_b128 v7, a[120:123] offset:6144
    s_waitcnt vmcnt(20)
    ds_write_b128 v8, a[124:127] offset:7168
    s_waitcnt lgkmcnt(0)
    s_barrier
    ds_read_b64_tr_b16 a[112:113], v11 offset:0
    ds_read_b64_tr_b16 a[114:115], v11 offset:512
    ds_read_b64_tr_b16 a[116:117], v11 offset:8192
    ds_read_b64_tr_b16 a[118:119], v11 offset:8704
    ds_read_b64_tr_b16 a[120:121], v12 offset:0
    ds_read_b64_tr_b16 a[122:123], v12 offset:512
    ds_read_b64_tr_b16 a[124:125], v12 offset:8192
    ds_read_b64_tr_b16 a[126:127], v12 offset:8704
    s_waitcnt lgkmcnt(0)
    s_barrier
    s_add_u32 s71, s70, 41472
    buffer_load_dwordx4 a[232:235], v4, s[64:67], s71 offen
    s_add_u32 s71, s70, 51712
    buffer_load_dwordx4 a[236:239], v4, s[64:67], s71 offen
    s_add_u32 s71, s70, 61952
    buffer_load_dwordx4 a[192:195], v4, s[64:67], s71 offen
    s_add_u32 s71, s70, 72192
    buffer_load_dwordx4 a[196:199], v4, s[64:67], s71 offen
    s_waitcnt vmcnt(23)
    ds_write_b128 v5, a[168:171] offset:4096
    s_waitcnt vmcnt(22)
    ds_write_b128 v6, a[172:175] offset:5120
    s_waitcnt vmcnt(21)
    ds_write_b128 v7, a[176:179] offset:6144
    s_waitcnt vmcnt(20)
    ds_write_b128 v8, a[180:183] offset:7168
    s_waitcnt lgkmcnt(0)
    s_barrier
    ds_read_b64_tr_b16 a[168:169], v11 offset:0
    ds_read_b64_tr_b16 a[170:171], v11 offset:512
    ds_read_b64_tr_b16 a[172:173], v11 offset:8192
    ds_read_b64_tr_b16 a[174:175], v11 offset:8704
    ds_read_b64_tr_b16 a[176:177], v12 offset:0
    ds_read_b64_tr_b16 a[178:179], v12 offset:512
    ds_read_b64_tr_b16 a[180:181], v12 offset:8192
    ds_read_b64_tr_b16 a[182:183], v12 offset:8704
    s_waitcnt lgkmcnt(0)
    s_barrier
    s_waitcnt vmcnt(19)
    ds_write_b128 v9, v[72:75] offset:4096
    s_waitcnt vmcnt(18)
    ds_write_b128 v9, v[76:79] offset:5120
    s_waitcnt vmcnt(17)
    ds_write_b128 v9, v[80:83] offset:6144
    s_waitcnt vmcnt(16)
    ds_write_b128 v9, v[84:87] offset:7168
    s_waitcnt lgkmcnt(0)
    s_barrier
    ds_read_b64_tr_b16 v[72:73], v13 offset:0
    ds_read_b64_tr_b16 v[74:75], v13 offset:512
    ds_read_b64_tr_b16 v[76:77], v13 offset:2048
    ds_read_b64_tr_b16 v[78:79], v13 offset:2560
    ds_read_b64_tr_b16 v[80:81], v13 offset:8192
    ds_read_b64_tr_b16 v[82:83], v13 offset:8704
    ds_read_b64_tr_b16 v[84:85], v13 offset:10240
    ds_read_b64_tr_b16 v[86:87], v13 offset:10752
    s_waitcnt lgkmcnt(0)
    s_barrier
    ds_write_b128 v1, v[72:75] offset:36864
    ds_write_b128 v1, v[76:79] offset:37888
    ds_write_b128 v1, v[80:83] offset:34816
    ds_write_b128 v1, v[84:87] offset:35840
    buffer_load_dword v15, off, s[72:75], 0 offset:48 sc1
    s_waitcnt vmcnt(16)
    ds_write_b128 v9, a[208:211] offset:4096
    s_waitcnt vmcnt(15)
    ds_write_b128 v9, a[212:215] offset:5120
    s_waitcnt vmcnt(14)
    ds_write_b128 v9, a[200:203] offset:6144
    s_waitcnt vmcnt(13)
    ds_write_b128 v9, a[204:207] offset:7168
    s_waitcnt lgkmcnt(0)
    s_barrier
    ds_read_b64_tr_b16 a[208:209], v13 offset:0
    ds_read_b64_tr_b16 a[210:211], v13 offset:512
    ds_read_b64_tr_b16 a[212:213], v13 offset:2048
    ds_read_b64_tr_b16 a[214:215], v13 offset:2560
    ds_read_b64_tr_b16 a[200:201], v13 offset:8192
    ds_read_b64_tr_b16 a[202:203], v13 offset:8704
    ds_read_b64_tr_b16 a[204:205], v13 offset:10240
    ds_read_b64_tr_b16 a[206:207], v13 offset:10752
    s_waitcnt lgkmcnt(0)
    s_barrier
    s_waitcnt vmcnt(12)
    ds_write_b128 v9, a[216:219] offset:4096
    s_waitcnt vmcnt(11)
    ds_write_b128 v9, a[220:223] offset:5120
    s_waitcnt vmcnt(10)
    ds_write_b128 v9, a[184:187] offset:6144
    s_waitcnt vmcnt(9)
    ds_write_b128 v9, a[188:191] offset:7168
    s_waitcnt lgkmcnt(0)
    s_barrier
    ds_read_b64_tr_b16 a[216:217], v13 offset:0
    ds_read_b64_tr_b16 a[218:219], v13 offset:512
    ds_read_b64_tr_b16 a[220:221], v13 offset:2048
    ds_read_b64_tr_b16 a[222:223], v13 offset:2560
    ds_read_b64_tr_b16 a[184:185], v13 offset:8192
    ds_read_b64_tr_b16 a[186:187], v13 offset:8704
    ds_read_b64_tr_b16 a[188:189], v13 offset:10240
    ds_read_b64_tr_b16 a[190:191], v13 offset:10752
    s_waitcnt lgkmcnt(0)
    s_barrier
    s_waitcnt vmcnt(8)
    ds_write_b128 v9, v[88:91] offset:4096
    s_waitcnt vmcnt(7)
    ds_write_b128 v9, v[92:95] offset:5120
    s_waitcnt vmcnt(6)
    ds_write_b128 v9, a[224:227] offset:6144
    s_waitcnt vmcnt(5)
    ds_write_b128 v9, a[228:231] offset:7168
    s_waitcnt lgkmcnt(0)
    s_barrier
    ds_read_b64_tr_b16 v[88:89], v13 offset:0
    ds_read_b64_tr_b16 v[90:91], v13 offset:512
    ds_read_b64_tr_b16 v[92:93], v13 offset:2048
    ds_read_b64_tr_b16 v[94:95], v13 offset:2560
    ds_read_b64_tr_b16 a[224:225], v13 offset:8192
    ds_read_b64_tr_b16 a[226:227], v13 offset:8704
    ds_read_b64_tr_b16 a[228:229], v13 offset:10240
    ds_read_b64_tr_b16 a[230:231], v13 offset:10752
    s_waitcnt lgkmcnt(0)
    s_barrier
    ds_write_b128 v1, v[88:91] offset:38912
    ds_write_b128 v1, v[92:95] offset:39936
    s_waitcnt vmcnt(4)
    ds_write_b128 v10, a[232:235] offset:4096
    s_waitcnt vmcnt(3)
    ds_write_b128 v10, a[236:239] offset:5120
    s_waitcnt vmcnt(2)
    ds_write_b128 v10, a[192:195] offset:6144
    s_waitcnt vmcnt(1)
    ds_write_b128 v10, a[196:199] offset:7168
    s_waitcnt lgkmcnt(0)
    s_barrier
    ds_read_b64_tr_b16 a[232:233], v14 offset:64
    ds_read_b64_tr_b16 a[234:235], v14 offset:320
    ds_read_b64_tr_b16 a[236:237], v14 offset:1088
    ds_read_b64_tr_b16 a[238:239], v14 offset:1344
    ds_read_b64_tr_b16 a[192:193], v14 offset:4160
    ds_read_b64_tr_b16 a[194:195], v14 offset:4416
    ds_read_b64_tr_b16 a[196:197], v14 offset:5184
    ds_read_b64_tr_b16 a[198:199], v14 offset:5440
    ds_read_b64_tr_b16 a[248:249], v14 offset:8256
    ds_read_b64_tr_b16 a[250:251], v14 offset:8512
    ds_read_b64_tr_b16 a[252:253], v14 offset:9280
    ds_read_b64_tr_b16 a[254:255], v14 offset:9536
    ds_read_b64_tr_b16 a[240:241], v14 offset:12352
    ds_read_b64_tr_b16 a[242:243], v14 offset:12608
    ds_read_b64_tr_b16 a[244:245], v14 offset:13376
    ds_read_b64_tr_b16 a[246:247], v14 offset:13632
    s_waitcnt lgkmcnt(0)
    s_barrier
    s_waitcnt vmcnt(0)
    v_and_b32 v16, 15, v0
    v_lshrrev_b32 v17, 4, v0
    v_and_b32 v18, 1, v16
    v_bfe_u32 v19, v16, 1, 1
    v_mov_b32 v20, 0xaaaa
    v_mul_u32_u24 v18, v18, v20
    v_mul_u32_u24 v19, v19, v20
    v_lshl_add_u32 v18, v19, 16, v18
    v_add_u32 v2, 0x44444444, v18
    v_lshrrev_b32 v18, 1, v17
    v_lshlrev_b32 v18, 6, v18
    v_lshlrev_b32 v19, 3, v16
    v_xor_b32 v18, v18, v19
    v_lshl_add_u32 v3, v17, 7, v18
    v_and_b32 v18, 3, v0
    v_lshrrev_b32 v19, 2, v0
    v_lshlrev_b32 v19, 3, v19
    v_lshrrev_b32 v20, 1, v18
    v_lshlrev_b32 v20, 6, v20
    v_xor_b32 v19, v19, v20
    v_lshl_add_u32 v4, v18, 7, v19
    v_and_b32 v18, 7, v16
    v_and_b32 v19, 61, v0
    v_lshlrev_b32 v5, 4, v19
    v_lshlrev_b32 v19, 12, v17
    v_lshl_add_u32 v6, v16, 3, v19
    v_and_b32 v19, 1, v17
    v_lshlrev_b32 v19, 5, v19
    v_lshl_add_u32 v19, v18, 2, v19
    v_lshrrev_b32 v20, 1, v17
    v_lshl_add_u32 v7, v20, 8, v19
    v_lshlrev_b32 v8, 2, v0
    v_lshlrev_b32 v0, 4, v0
    v_add_u32 v1, 57344, v0
    v_mov_b32 v7, 0
    s_lshl_b32 s27, s12, 7
    s_lshl_b32 s25, s3, 5
    v_and_b32 v22, 0x30, v0
    buffer_load_dwordx3 v[16:18], off, s[72:75], 0 offset:48 sc1
    buffer_load_dword v20, off, s[72:75], s25 sc1
    buffer_load_dword v21, v22, s[4:7], s27 offen offset:0 sc1
    s_mov_b32 s84, 0
    s_waitcnt vmcnt(2)
    v_lshrrev_b32 v23, 18, v17
    v_add_u32 v18, 4, v18
    v_lshrrev_b32 v18, 3, v18
    s_waitcnt vmcnt(1)
    v_lshrrev_b32 v20, 4, v20
    v_min3_u32 v23, v23, v15, v18
    s_waitcnt vmcnt(0)
    v_min3_u32 v23, v23, v20, v21
    v_cmp_gt_u32 vcc, 2, v23
    s_cbranch_vccz Lrdy78
    v_mov_b32 v17, 0
    s_mov_b32 exec_lo, 0x1
    s_mov_b32 exec_hi, 0x0
Lwf79:
    buffer_load_dword v16, v17, s[72:75], 0 offen offset:48 sc1
    s_waitcnt vmcnt(0)
    v_cmp_gt_u32 vcc, 2, v16
    s_cbranch_vccz Lwf79d
    s_sub_u32 s15, s15, 1
    s_cbranch_scc0 Lwf79
    s_mov_b32 s15, 0
Lwf79d:
    s_mov_b64 exec, -1
    v_mov_b32 v17, 0
    s_mov_b32 exec_lo, 0x1
    s_mov_b32 exec_hi, 0x0
Lwf80:
    buffer_load_dword v16, v17, s[72:75], 0 offen offset:56 sc1
    s_waitcnt vmcnt(0)
    v_cmp_gt_u32 vcc, 12, v16
    s_cbranch_vccz Lwf80d
    s_sub_u32 s15, s15, 1
    s_cbranch_scc0 Lwf80
    s_mov_b32 s15, 0
Lwf80d:
    s_mov_b64 exec, -1
    v_mbcnt_lo_u32_b32 v17, -1, 0
    v_and_b32 v17, 7, v17
    v_lshlrev_b32 v17, 5, v17
Lcen81:
    buffer_load_dword v16, v17, s[72:75], 0 offen sc1
    s_waitcnt vmcnt(0)
    v_readlane_b32 s25, v16, s3
    s_mov_b32 s84, 0
    s_nop 2
    s_cmp_ge_u32 s25, 32
    s_cbranch_scc1 Lcen81d
    s_mov_b32 s84, 1
    v_mov_b32 v18, v16
    s_nop 1
    v_add_u32_dpp v18, v18, v18 row_ror:1 row_mask:0xf bank_mask:0xf
    s_nop 1
    v_add_u32_dpp v18, v18, v18 row_ror:2 row_mask:0xf bank_mask:0xf
    s_nop 1
    v_add_u32_dpp v18, v18, v18 row_ror:4 row_mask:0xf bank_mask:0xf
    s_nop 0
    v_readfirstlane_b32 s25, v18
    s_nop 3
    s_cmp_ge_u32 s25, 256
    s_cbranch_scc1 Lcen81d
    s_sub_u32 s15, s15, 1
    s_cbranch_scc0 Lcen81
    s_mov_b32 s15, 0
Lcen81d:
    v_mov_b32 v18, 0
    s_mov_b32 exec_lo, 0x1
    s_mov_b32 exec_hi, 0x0
Lwf82:
    buffer_load_dword v17, v18, s[72:75], 0 offen offset:52 sc1
    s_waitcnt vmcnt(0)
    v_cmp_gt_u32 vcc, 524288, v17
    s_cbranch_vccz Lwf82d
    s_sub_u32 s15, s15, 1
    s_cbranch_scc0 Lwf82
    s_mov_b32 s15, 0
Lwf82d:
    s_mov_b64 exec, -1
    s_mov_b32 exec_lo, 0xf
    s_mov_b32 exec_hi, 0x0
Lwf83:
    buffer_load_dword v16, v0, s[4:7], s27 offen offset:0 sc1
    s_waitcnt vmcnt(0)
    v_cmp_gt_u32 vcc, 2, v16
    s_cbranch_vccz Lwf83d
    s_sub_u32 s15, s15, 1
    s_cbranch_scc0 Lwf83
    s_mov_b32 s15, 0
Lwf83d:
    s_mov_b64 exec, -1
Lrdy78:
    v_readfirstlane_b32 s35, v17
    s_nop 3
    s_and_b32 s35, s35, 0x60
    s_cselect_b32 s35, 0x2000, 0
    s_mov_b32 s28, 1040356334
    s_mov_b32 s29, 562036736
    s_mov_b32 s30, 1006632960
    s_lshl_b32 s26, s3, 19
    s_add_u32 s26, s26, 1048576
    s_lshl_b32 s25, s12, 7
    s_add_u32 s27, s25, 0
    s_add_u32 s16, s25, s26
    s_add_u32 s16, s16, 16384
    s_lshl_b32 s17, s12, 12
    s_add_u32 s17, s17, s26
    s_add_u32 s17, s17, 0
    s_lshl_b32 s26, s3, 17
    s_and_b32 s19, s25, 384
    s_lshr_b32 s19, s19, 1
    s_sub_u32 s25, s25, s19
    s_add_u32 s25, s25, 0
    s_add_u32 s19, s26, 132096
    s_add_u32 s33, s26, s25
    s_add_u32 s34, s33, s35
    s_add_u32 s34, s34, 2097152
    s_add_u32 s33, s33, 131072
    s_mov_b32 s20, s33
    s_mov_b32 s24, s34
    s_xor_b32 s21, s26, 0x20000
    s_add_u32 s21, s21, s35
    s_add_u32 s21, s21, 2098176
    s_xor_b32 s26, s35, 0x2000
    s_lshl_b32 s98, s12, 15
    s_add_u32 s98, s98, s26
    s_add_u32 s98, s98, 8390656
    s_lshr_b32 s99, s12, 1
    s_lshl_b32 s99, s99, 14
    s_and_b32 s25, s12, 1
    s_lshl_b32 s25, s25, 12
    s_add_u32 s99, s99, s25
    s_add_u32 s99, s99, s26
    s_add_u32 s99, s99, 75497472
    s_lshr_b32 s23, s99, 8
    s_and_b32 s23, s23, 0x2000
    s_xor_b32 s23, s99, s23
    s_add_u32 s98, s98, 0
    s_lshr_b32 s22, s98, 8
    s_and_b32 s22, s22, 0x2000
    s_xor_b32 s22, s98, s22
    s_add_u32 s32, s22, 16384
    s_lshl_b32 s100, s3, 5
    s_add_u32 s100, s100, s12
    s_lshl_b32 s100, s100, 6
    s_add_u32 s100, s100, 4096
    s_sub_u32 s31, s31, 1
    s_sub_u32 s36, s3, 1
    s_not_b32 s37, s36
    s_mov_b32 s18, 1
    s_mov_b32 s92, 0x00ff00ff
    s_mov_b32 s93, 0x00ff00ff
    s_mov_b32 s14, 0
    s_mov_b32 s38, 1114129
    s_mov_b32 s39, 1114129
    s_mov_b32 s40, 285217024
    s_mov_b32 s41, 285217024
    s_mov_b32 s42, 2228258
    s_mov_b32 s43, 2228258
    s_mov_b32 s44, 570434048
    s_mov_b32 s45, 570434048
    s_mov_b32 s46, 4042322160
    s_mov_b32 s47, 4042322160
    buffer_load_dwordx4 v[72:75], v0, s[4:7], s22 offen offset:0 sc1
    buffer_load_dwordx4 v[76:79], v0, s[4:7], s22 offen offset:1024 sc1
    buffer_load_dwordx4 v[80:83], v0, s[4:7], s32 offen offset:0 sc1
    buffer_load_dwordx4 v[84:87], v0, s[4:7], s32 offen offset:1024 sc1
    s_add_u32 s98, s98, 1048576
    s_lshr_b32 s22, s98, 8
    s_and_b32 s22, s22, 0x2000
    s_xor_b32 s22, s98, s22
    s_add_u32 s32, s22, 16384
    v_mov_b64 v[48:49], -1
    v_mov_b64 v[50:51], -1
    v_mov_b32 v9, -1
    s_waitcnt vmcnt(0) lgkmcnt(0)
    s_nop 11
    s_cmp_lg_u32 s84, 0
    s_cbranch_scc1 Ls1_top
Lc1_top:
    v_mov_b64 v[56:57], v[72:73]
    v_mov_b64 v[58:59], v[74:75]
    v_mov_b64 v[60:61], v[76:77]
    v_mov_b64 v[62:63], v[78:79]
    v_mov_b64 v[64:65], v[80:81]
    v_mov_b64 v[66:67], v[82:83]
    v_mov_b64 v[68:69], v[84:85]
    v_mov_b64 v[70:71], v[86:87]
    buffer_load_dwordx4 v[48:51], v0, s[4:7], s19 offen offset:0 sc1
    buffer_load_dword v9, v8, s[4:7], s19 offen offset:3328 sc1
    ds_read_b128 v[40:43], v1 offset:0
    ds_read_b128 v[44:47], v1 offset:1024
    ds_read_b128 v[80:83], v1 offset:2048
    ds_read_b128 v[84:87], v1 offset:3072
    ds_read_b128 v[88:91], v1 offset:4096
    ds_read_b128 v[92:95], v1 offset:5120
    ds_read_b128 v[72:75], v1 offset:6144
    ds_read_b128 v[76:79], v1 offset:7168
    v_mov_b64 v[32:33], 0
    v_mov_b64 v[34:35], 0
    v_mov_b64 v[36:37], 0
    v_mov_b64 v[38:39], 0
    v_mov_b64 v[16:17], 0
    v_mov_b64 v[18:19], 0
    v_mov_b64 v[20:21], 0
    v_mov_b64 v[22:23], 0
    v_mov_b64 v[24:25], 0
    v_mov_b64 v[26:27], 0
    v_mov_b64 v[28:29], 0
    v_mov_b64 v[30:31], 0
    buffer_load_dwordx4 v[48:51], v0, s[4:7], s19 offen offset:0 sc1
    buffer_load_dword v9, v8, s[4:7], s19 offen offset:3328 sc1
    s_waitcnt lgkmcnt(0)
Lc1_pb:
    s_waitcnt vmcnt(3)
    v_max3_u32 v11, v48, v49, v50
    s_waitcnt vmcnt(2)
    v_max3_u32 v11, v11, v51, v9
    v_cmp_eq_u32 vcc, -1, v11
    ds_write_b128 v0, v[48:51] offset:1024
    ds_write_b32 v8, v9 offset:4352
    s_cbranch_vccnz Lc1_pc
Lc1_pcd:
    v_smfmac_f32_16x16x64_bf16 v[16:19], v[48:51], v[40:47], v2
    buffer_load_dwordx4 v[12:15], v0, s[4:7], s21 offen offset:0 sc1
    v_smfmac_f32_16x16x64_bf16 v[20:23], v[48:51], v[80:87], v2
    buffer_load_dword v11, v8, s[4:7], s21 offen offset:3328 sc1
    v_smfmac_f32_16x16x64_bf16 v[24:27], v[48:51], v[88:95], v2
    s_waitcnt lgkmcnt(0)
    s_barrier
    ds_read_b128 v[40:43], v0 offset:0
    v_smfmac_f32_16x16x64_bf16 v[28:31], v[48:51], v[72:79], v2
    ds_read_b128 v[44:47], v0 offset:3072
    ds_read_b128 v[80:83], v1 offset:8192
    v_smfmac_f32_16x16x64_bf16 v[32:35], v[48:51], v[96:103], v2
    ds_read_b128 v[84:87], v1 offset:9216
    ds_read_b128 v[88:91], v1 offset:10240
    v_smfmac_f32_16x16x64_bf16 v[36:39], v[48:51], v[104:111], v2
    ds_read_b128 v[92:95], v1 offset:11264
Lc1_pad:
    s_waitcnt lgkmcnt(5)
    v_smfmac_f32_16x16x64_bf16 v[16:19], v[40:43], v[112:119], v2
    ds_read_b128 v[72:75], v1 offset:12288
    v_smfmac_f32_16x16x64_bf16 v[20:23], v[40:43], v[120:127], v2
    s_waitcnt lgkmcnt(3)
    s_add_u32 s19, s19, 16384
    ds_read_b128 v[76:79], v1 offset:13312
    v_smfmac_f32_16x16x64_bf16 v[24:27], v[40:43], v[80:87], v2
    ds_read_b128 v[80:83], v1 offset:14336
    v_smfmac_f32_16x16x64_bf16 v[28:31], v[40:43], v[128:135], v2
    s_waitcnt lgkmcnt(3)
    s_bitset0_b32 s19, 16
    ds_read_b128 v[84:87], v1 offset:15360
    v_smfmac_f32_16x16x64_bf16 v[32:35], v[40:43], v[88:95], v2
    ds_read_b128 v[88:91], v1 offset:16384
    v_smfmac_f32_16x16x64_bf16 v[36:39], v[40:43], v[136:143], v2
    s_waitcnt lgkmcnt(3)
    s_add_u32 s20, s20, 16384
    ds_read_b128 v[92:95], v1 offset:17408
    v_smfmac_f32_16x16x64_bf16 v[16:19], v[44:47], v[72:79], v2
    ds_read_b128 v[40:43], v0 offset:2048
    v_smfmac_f32_16x16x64_bf16 v[20:23], v[44:47], v[144:151], v2
    s_waitcnt lgkmcnt(3)
    s_bitset0_b32 s20, 16
    ds_read_b128 v[72:75], v1 offset:18432
    v_smfmac_f32_16x16x64_bf16 v[24:27], v[44:47], v[80:87], v2
    ds_read_b128 v[76:79], v1 offset:19456
    v_smfmac_f32_16x16x64_bf16 v[28:31], v[44:47], v[152:159], v2
    s_waitcnt lgkmcnt(3)
    s_add_u32 s24, s24, 16384
    ds_read_b128 v[80:83], v1 offset:20480
    v_smfmac_f32_16x16x64_bf16 v[32:35], v[44:47], v[88:95], v2
    ds_read_b128 v[84:87], v1 offset:21504
    v_smfmac_f32_16x16x64_bf16 v[36:39], v[44:47], v[160:167], v2
    s_waitcnt lgkmcnt(4)
    s_bitset0_b32 s24, 16
    ds_read_b128 v[44:47], v0 offset:4096
    v_smfmac_f32_16x16x64_bf16 v[16:19], v[40:43], v[168:175], v2
    s_waitcnt vmcnt(2)
    ds_read_b128 v[48:51], v1 offset:22528
    s_waitcnt lgkmcnt(4)
    v_smfmac_f32_16x16x64_bf16 v[20:23], v[40:43], v[72:79], v2
    ds_read_b128 v[52:55], v1 offset:23552
    v_smfmac_f32_16x16x64_bf16 v[24:27], v[40:43], v[176:183], v2
    ds_read_b128 v[88:91], v1 offset:24576
    s_waitcnt lgkmcnt(4)
    v_smfmac_f32_16x16x64_bf16 v[28:31], v[40:43], v[80:87], v2
    ds_read_b128 v[92:95], v1 offset:25600
    v_smfmac_f32_16x16x64_bf16 v[32:35], v[40:43], v[184:191], v2
    ds_read_b128 v[72:75], v1 offset:26624
    v_smfmac_f32_16x16x64_bf16 v[36:39], v[40:43], v[192:199], v2
    ds_read_b128 v[76:79], v1 offset:27648
    s_waitcnt lgkmcnt(4)
    v_smfmac_f32_16x16x64_bf16 v[16:19], v[44:47], v[48:55], v2
    ds_read_b128 v[48:51], v1 offset:28672
    v_smfmac_f32_16x16x64_bf16 v[20:23], v[44:47], v[200:207], v2
    ds_read_b128 v[52:55], v1 offset:29696
    s_waitcnt lgkmcnt(4)
    v_smfmac_f32_16x16x64_bf16 v[24:27], v[44:47], v[88:95], v2
    v_smfmac_f32_16x16x64_bf16 v[28:31], v[44:47], v[208:215], v2
    s_waitcnt vmcnt(1)
    ds_write_b128 v0, v[12:15] offset:6144
    v_max3_u32 v9, v12, v13, v14
    s_waitcnt vmcnt(0)
    v_max3_u32 v9, v9, v15, v11
    v_cmp_eq_u32 vcc, -1, v9
    s_waitcnt lgkmcnt(3)
    v_smfmac_f32_16x16x64_bf16 v[32:35], v[44:47], v[72:79], v2
    ds_write_b32 v8, v11 offset:9472
    v_smfmac_f32_16x16x64_bf16 v[36:39], v[44:47], v[216:223], v2
    s_cbranch_vccnz Lc1_rr
Lc1_rrd:
    v_smfmac_f32_16x16x64_bf16 v[16:19], v[12:15], v[224:231], v2
    s_waitcnt lgkmcnt(2)
    s_add_u32 s21, s21, 16384
    s_bitset0_b32 s21, 16
    v_smfmac_f32_16x16x64_bf16 v[20:23], v[12:15], v[48:55], v2
    v_and_b32 v9, 0x30, v0
    v_smfmac_f32_16x16x64_bf16 v[24:27], v[12:15], v[232:239], v2
    s_waitcnt lgkmcnt(0)
    s_barrier
    ds_read_b128 v[40:43], v0 offset:5120
    v_smfmac_f32_16x16x64_bf16 v[28:31], v[12:15], v[240:247], v2
    ds_read_b128 v[44:47], v0 offset:8192
    v_smfmac_f32_16x16x64_bf16 v[32:35], v[12:15], v[248:255], v2
    ds_read_b128 v[88:91], v0 offset:7168
    v_smfmac_f32_16x16x64_bf16 v[36:39], v[12:15], a[0:7], v2
    s_waitcnt lgkmcnt(2)
    ds_read_b128 v[92:95], v0 offset:9216
    ds_read_b128 v[48:51], v1 offset:30720
    v_smfmac_f32_16x16x64_bf16 v[16:19], v[40:43], a[8:15], v2
    ds_read_b128 v[52:55], v1 offset:31744
    v_mov_b32 v12, 0x3f803f80
    v_smfmac_f32_16x16x64_bf16 v[20:23], v[40:43], a[16:23], v2
    s_waitcnt lgkmcnt(4)
    buffer_load_dwordx4 v[72:75], v0, s[4:7], s22 offen offset:0 sc1
    v_mov_b32 v13, 0x3f803f80
    v_smfmac_f32_16x16x64_bf16 v[16:19], v[44:47], a[24:31], v2
    v_mov_b32 v14, 0x3f803f80
    v_smfmac_f32_16x16x64_bf16 v[20:23], v[44:47], a[32:39], v2
    s_waitcnt lgkmcnt(3)
    v_mov_b32 v15, 0x3f803f80
    v_smfmac_f32_16x16x64_bf16 v[16:19], v[88:91], a[40:47], v2
    buffer_load_dword v7, v9, s[4:7], s27 offen sc1
    s_waitcnt lgkmcnt(0)
    v_smfmac_f32_16x16x64_bf16 v[20:23], v[88:91], v[48:55], v2
    v_smfmac_f32_16x16x64_bf16 v[16:19], v[92:95], a[48:55], v2
    s_nop 1
    buffer_load_dwordx4 v[76:79], v0, s[4:7], s22 offen offset:1024 sc1
    v_smfmac_f32_16x16x64_bf16 v[20:23], v[92:95], a[56:63], v2
    s_nop 0
    ds_read_b128 v[48:51], v1 offset:32768
    v_smfmac_f32_16x16x64_bf16 v[24:27], v[40:43], a[64:71], v2
    ds_read_b128 v[52:55], v1 offset:33792
    v_add_f32 v16, v16, v17
    v_add_f32 v18, v18, v19
    v_smfmac_f32_16x16x64_bf16 v[28:31], v[40:43], a[72:79], v2
    v_cvt_pk_bf16_f32 v16, v16, v18
    v_add_f32 v20, v20, v21
    v_smfmac_f32_16x16x64_bf16 v[24:27], v[44:47], a[80:87], v2
    buffer_load_dwordx4 v[80:83], v0, s[4:7], s32 offen offset:0 sc1
    v_add_f32 v22, v22, v23
    v_cvt_pk_bf16_f32 v17, v20, v22
    v_smfmac_f32_16x16x64_bf16 v[28:31], v[44:47], a[88:95], v2
    ds_write_b64 v3, v[16:17] offset:10752
    v_smfmac_f32_16x16x64_bf16 v[24:27], v[88:91], a[96:103], v2
    buffer_load_dwordx4 v[84:87], v0, s[4:7], s32 offen offset:1024 sc1
    v_smfmac_f32_16x16x64_bf16 v[28:31], v[88:91], a[104:111], v2
    v_smfmac_f32_16x16x64_bf16 v[24:27], v[92:95], a[112:119], v2
    v_smfmac_f32_16x16x64_bf16 v[28:31], v[92:95], a[120:127], v2
    s_waitcnt lgkmcnt(0)
    s_barrier
    ds_read_b64_tr_b16 v[16:17], v4 offset:10240
    v_smfmac_f32_16x16x64_bf16 v[32:35], v[40:43], v[48:55], v2
    ds_read_b64_tr_b16 v[18:19], v4 offset:10752
    ds_read_b64_tr_b16 v[20:21], v4 offset:11264
    ds_read_b64_tr_b16 v[22:23], v4 offset:11776
    v_add_f32 v24, v24, v25
    v_add_f32 v26, v26, v27
    v_cvt_pk_bf16_f32 v24, v24, v26
    v_add_f32 v28, v28, v29
    v_add_f32 v30, v30, v31
    v_cvt_pk_bf16_f32 v25, v28, v30
    v_smfmac_f32_16x16x64_bf16 v[36:39], v[40:43], a[128:135], v2
    ds_write_b64 v3, v[24:25] offset:12800
    s_waitcnt lgkmcnt(3)
    v_mfma_f32_16x16x32_bf16 v[48:51], v[56:59], v[16:19], 0
    s_waitcnt lgkmcnt(1)
    v_mfma_f32_16x16x32_bf16 v[48:51], v[60:63], v[20:23], v[48:51]
    v_smfmac_f32_16x16x64_bf16 v[32:35], v[44:47], a[136:143], v2
    s_waitcnt lgkmcnt(0)
    s_barrier
    ds_read_b64_tr_b16 v[24:25], v4 offset:12288
    v_smfmac_f32_16x16x64_bf16 v[36:39], v[44:47], a[144:151], v2
    ds_read_b64_tr_b16 v[26:27], v4 offset:12800
    ds_read_b64_tr_b16 v[28:29], v4 offset:13312
    ds_read_b64_tr_b16 v[30:31], v4 offset:13824
    v_add_f32_dpp v48, v50, v48 quad_perm:[2,3,0,1] row_mask:0xf bank_mask:0xf
    v_add_f32_dpp v49, v51, v49 quad_perm:[2,3,0,1] row_mask:0xf bank_mask:0xf
    v_exp_f32 v50, v48
    v_exp_f32 v51, v49
    s_nop 0
    v_cvt_pk_bf16_f32 v50, v50, v51
    ds_write_b32 v0, v50 offset:14340
    s_waitcnt lgkmcnt(3)
    v_mfma_f32_16x16x32_bf16 v[52:55], v[24:27], v[16:19], 0
    ds_read_b128 v[56:59], v1 offset:34816
    s_waitcnt lgkmcnt(2)
    v_mfma_f32_16x16x32_bf16 v[52:55], v[28:31], v[20:23], v[52:55]
    ds_read_b128 v[60:63], v1 offset:35840
    v_mov_b64 v[28:29], 0
    v_smfmac_f32_16x16x64_bf16 v[32:35], v[88:91], a[152:159], v2
    v_mov_b64 v[30:31], 0
    s_waitcnt lgkmcnt(2)
    s_barrier
    ds_read_b128 v[16:19], v5 offset:14336
    v_smfmac_f32_16x16x64_bf16 v[36:39], v[88:91], a[160:167], v2
    v_add_f32_dpp v52, v54, v52 quad_perm:[2,3,0,1] row_mask:0xf bank_mask:0xf
    v_add_f32_dpp v53, v55, v53 quad_perm:[2,3,0,1] row_mask:0xf bank_mask:0xf
    v_smfmac_f32_16x16x64_bf16 v[32:35], v[92:95], a[168:175], v2
    v_mul_f32 v50, s28, v52
    v_mul_f32 v51, s28, v53
    v_smfmac_f32_16x16x64_bf16 v[36:39], v[92:95], a[176:183], v2
    v_exp_f32_dpp v52, v50 quad_perm:[0,1,0,1] row_mask:0xf bank_mask:0xf
    v_exp_f32_dpp v53, v51 quad_perm:[0,1,0,1] row_mask:0xf bank_mask:0xf
    s_waitcnt lgkmcnt(0)
    v_mfma_f32_16x16x32_bf16 v[24:27], v[12:15], v[16:19], 0
    v_mov_b32 v21, 0
    v_cvt_pk_bf16_f32 v20, v52, v53
    v_mfma_f32_16x16x32_bf16 v[40:43], v[64:67], v[16:19], 0
    v_add_f32 v32, v32, v33
    v_add_f32 v34, v34, v35
    v_cvt_pk_bf16_f32 v10, v32, v34
    v_mfma_f32_16x16x32_bf16 v[44:47], v[68:71], v[16:19], 0
    v_add_f32 v36, v36, v37
    v_add_f32 v38, v38, v39
    v_cvt_pk_bf16_f32 v11, v36, v38
    v_mfma_f32_16x16x16_bf16 v[24:27], v[12:13], v[20:21], v[24:27]
    v_mov_b32 v22, 0
    v_cvt_pk_bf16_f32 v23, v52, v53
    v_mfma_f32_16x16x16_bf16 v[40:43], v[10:11], v[20:21], v[40:43]
    v_mov_b64 v[32:33], 0
    v_mov_b64 v[34:35], 0
    v_mfma_f32_16x16x16_bf16 v[44:47], v[10:11], v[22:23], v[44:47]
    v_mov_b64 v[36:37], 0
    v_mov_b64 v[38:39], 0
    v_rcp_f32 v25, v24
    v_subrev_u32 v26, s29, v24
    v_cmp_le_u32 vcc, s30, v26
    v_mul_f32 v40, v25, v40
    v_mul_f32 v41, v25, v41
    v_mul_f32 v42, v25, v42
    v_mul_f32 v43, v25, v43
    v_cvt_pk_bf16_f32 v52, v40, v41
    v_cvt_pk_bf16_f32 v53, v42, v43
    v_mul_f32 v44, v25, v44
    v_mul_f32 v45, v25, v45
    v_mul_f32 v46, v25, v46
    v_mul_f32 v47, v25, v47
    v_cvt_pk_bf16_f32 v54, v44, v45
    v_cvt_pk_bf16_f32 v55, v46, v47
    ds_write_b128 v0, v[52:55] offset:11264
    s_cbranch_vccnz Lc1_fb
Lc1_fbd:
    v_smfmac_f32_16x16x64_bf16 v[32:35], v[52:55], v[56:63], v2 abid:1
    s_cmp_eq_u32 s14, s31
    s_mov_b64 exec, s[36:37]
    buffer_store_dwordx2 v[10:11], v3, s[4:7], s23 offen offset:2560 sc1
    s_mov_b64 exec, -1
    v_smfmac_f32_16x16x64_bf16 v[36:39], v[52:55], a[184:191], v2 abid:1
    ds_read_b128 v[88:91], v1 offset:36864
    ds_read_b128 v[92:95], v1 offset:37888
    s_waitcnt lgkmcnt(2)
    s_barrier
    ds_read_b128 v[16:19], v0 offset:10240
    v_smfmac_f32_16x16x64_bf16 v[28:31], v[52:55], a[192:199], v2 abid:1
    ds_read_b128 v[20:23], v0 offset:13312
    ds_read_b128 v[24:27], v0 offset:12288
    v_mov_b32 v1, v1
    s_cbranch_scc1 Lc1_exit
    v_mov_b32 v1, v1
    s_add_u32 s25, s16, 65536
    s_add_u32 s26, s16, 131072
    v_mov_b32 v1, v1
    s_waitcnt lgkmcnt(2)
    v_smfmac_f32_16x16x64_bf16 v[32:35], v[16:19], v[88:95], v2 abid:1
    ds_read_b128 v[64:67], v1 offset:38912
    s_waitcnt lgkmcnt(2)
    v_smfmac_f32_16x16x64_bf16 v[32:35], v[20:23], a[200:207], v2 abid:1
    ds_read_b128 v[68:71], v1 offset:39936
    s_waitcnt lgkmcnt(2)
    v_smfmac_f32_16x16x64_bf16 v[32:35], v[24:27], a[208:215], v2 abid:1
    s_nop 2
    v_smfmac_f32_16x16x64_bf16 v[36:39], v[16:19], a[216:223], v2 abid:1
    s_nop 2
    v_smfmac_f32_16x16x64_bf16 v[36:39], v[20:23], a[224:231], v2 abid:1
    s_waitcnt lgkmcnt(0)
    v_cvt_pk_bf16_f32 v32, v32, v33
    v_smfmac_f32_16x16x64_bf16 v[36:39], v[24:27], v[64:71], v2 abid:1
    s_nop 1
    v_and_or_b32 v32, v32, -2, s18
    v_smfmac_f32_16x16x64_bf16 v[28:31], v[16:19], a[232:239], v2 abid:1
    s_nop 0
    v_cvt_pk_bf16_f32 v33, v34, v35
    v_smfmac_f32_16x16x64_bf16 v[28:31], v[20:23], a[240:247], v2 abid:1
    buffer_store_dwordx2 v[32:33], v6, s[4:7], s16 offen
    v_cvt_pk_bf16_f32 v36, v36, v37
    v_smfmac_f32_16x16x64_bf16 v[28:31], v[24:27], a[248:255], v2 abid:1
    s_nop 1
    v_and_or_b32 v36, v36, -2, s18
    v_cvt_pk_bf16_f32 v37, v38, v39
    buffer_store_dwordx2 v[36:37], v6, s[4:7], s25 offen
    s_nop 2
    v_cvt_pk_bf16_f32 v28, v28, v29
    v_and_or_b32 v28, v28, -2, s18
    v_cvt_pk_bf16_f32 v29, v30, v31
    buffer_store_dwordx2 v[28:29], v6, s[4:7], s26 offen
    s_add_u32 s99, s99, 262144
    s_lshr_b32 s23, s99, 8
    s_and_b32 s23, s23, 0x2000
    s_xor_b32 s23, s99, s23
    s_add_u32 s14, s14, 1
    s_add_u32 s98, s98, 1048576
    s_lshr_b32 s22, s98, 8
    s_and_b32 s22, s22, 0x2000
    s_xor_b32 s22, s98, s22
    s_add_u32 s32, s22, 16384
    s_waitcnt vmcnt(0)
    s_add_u32 s25, s14, 2
    s_min_u32 s25, s25, 64
    v_cmp_gt_u32 vcc, s25, v7
    s_cbranch_vccnz Lc1_kv
Lc1_kvd:
    s_xor_b32 s18, s18, 1
    s_barrier
    s_branch Lc1_top
Lc1_exit:
    s_waitcnt vmcnt(0) lgkmcnt(0)
    s_barrier
    s_waitcnt vmcnt(0) lgkmcnt(0)
    s_nop 11
    s_endpgm
Lc1_pc:
    buffer_load_dwordx4 v[48:51], v0, s[4:7], s19 offen offset:0 sc1
    buffer_load_dword v9, v8, s[4:7], s19 offen offset:3328 sc1
    s_sub_u32 s15, s15, 1
    s_cbranch_scc0 Lc1_pb
    s_mov_b32 s15, 0
    s_branch Lc1_pcd
Lc1_rr:
    buffer_load_dwordx4 v[12:15], v0, s[4:7], s21 offen offset:0 sc1
    buffer_load_dword v11, v8, s[4:7], s21 offen offset:3328 sc1
    s_waitcnt vmcnt(1)
    ds_write_b128 v0, v[12:15] offset:6144
    s_waitcnt vmcnt(0)
    ds_write_b32 v8, v11 offset:9472
    v_max3_u32 v9, v12, v13, v14
    v_max3_u32 v9, v9, v15, v11
    v_cmp_eq_u32 vcc, -1, v9
    s_waitcnt lgkmcnt(0)
    s_cbranch_vccz Lc1_rrd
    s_sub_u32 s15, s15, 1
    s_cbranch_scc0 Lc1_rr
    s_mov_b32 s15, 0
    s_branch Lc1_rrd
Lc1_fb:
    s_waitcnt lgkmcnt(0)
    s_nop 11
    s_barrier
    v_max_f32 v16, v48, v49
    v_max3_f32 v16, v16, v50, v51
    ds_write_b32 v0, v16 offset:4
    s_waitcnt lgkmcnt(0)
    s_barrier
    v_and_b32 v40, 0xff, v0
    ds_read_b128 v[16:19], v40 offset:0
    ds_read_b128 v[20:23], v40 offset:256
    ds_read_b128 v[88:91], v40 offset:512
    ds_read_b128 v[92:95], v40 offset:768
    s_waitcnt lgkmcnt(3)
    v_max_f32 v40, v16, v17
    v_max3_f32 v40, v40, v18, v19
    s_waitcnt lgkmcnt(2)
    v_max3_f32 v40, v40, v20, v21
    v_max3_f32 v40, v40, v22, v23
    s_waitcnt lgkmcnt(1)
    v_max3_f32 v40, v40, v88, v89
    v_max3_f32 v40, v40, v90, v91
    s_waitcnt lgkmcnt(0)
    v_max3_f32 v40, v40, v92, v93
    v_max3_f32 v40, v40, v94, v95
    v_sub_f32 v48, v48, v40
    v_sub_f32 v49, v49, v40
    v_sub_f32 v50, v50, v40
    v_sub_f32 v51, v51, v40
    v_exp_f32 v40, v48
    v_exp_f32 v41, v49
    s_nop 0
    v_cvt_pk_bf16_f32 v40, v40, v41
    ds_write_b32 v0, v40 offset:14340
    v_mov_b32 v21, 0
    v_exp_f32_dpp v52, v50 quad_perm:[0,1,0,1] row_mask:0xf bank_mask:0xf
    v_exp_f32_dpp v53, v51 quad_perm:[0,1,0,1] row_mask:0xf bank_mask:0xf
    v_mov_b32 v22, 0
    v_cvt_pk_bf16_f32 v20, v52, v53
    v_cvt_pk_bf16_f32 v23, v52, v53
    s_waitcnt lgkmcnt(0)
    s_barrier
    ds_read_b128 v[16:19], v5 offset:14336
    s_waitcnt lgkmcnt(0)
    v_mfma_f32_16x16x32_bf16 v[24:27], v[12:15], v[16:19], 0
    s_nop 2
    v_mfma_f32_16x16x32_bf16 v[40:43], v[64:67], v[16:19], 0
    s_nop 1
    s_nop 0
    v_mfma_f32_16x16x32_bf16 v[44:47], v[68:71], v[16:19], 0
    s_nop 1
    s_nop 0
    v_mfma_f32_16x16x16_bf16 v[24:27], v[12:13], v[20:21], v[24:27]
    s_nop 1
    s_nop 0
    v_mfma_f32_16x16x16_bf16 v[40:43], v[10:11], v[20:21], v[40:43]
    s_nop 2
    v_mfma_f32_16x16x16_bf16 v[44:47], v[10:11], v[22:23], v[44:47]
    s_nop 0
    v_rcp_f32 v25, v24
    s_nop 1
    v_mul_f32 v40, v25, v40
    v_mul_f32 v41, v25, v41
    v_mul_f32 v42, v25, v42
    v_mul_f32 v43, v25, v43
    v_cvt_pk_bf16_f32 v52, v40, v41
    v_cvt_pk_bf16_f32 v53, v42, v43
    v_mul_f32 v44, v25, v44
    v_mul_f32 v45, v25, v45
    v_mul_f32 v46, v25, v46
    v_mul_f32 v47, v25, v47
    v_cvt_pk_bf16_f32 v54, v44, v45
    v_cvt_pk_bf16_f32 v55, v46, v47
    ds_write_b128 v0, v[52:55] offset:11264
    s_waitcnt lgkmcnt(0)
    s_nop 11
    s_branch Lc1_fbd
Lc1_kv:
    v_and_b32 v9, 0x30, v0
    buffer_load_dword v7, v9, s[4:7], s27 offen sc1
    s_waitcnt vmcnt(0)
    v_cmp_gt_u32 vcc, s25, v7
    s_cbranch_vccz Lc1_kvd
    s_sub_u32 s15, s15, 1
    s_cbranch_scc0 Lc1_kv
    s_mov_b32 s15, 0
    s_branch Lc1_kvd
Lcw2:
    v_lshrrev_b32 v16, 4, v0
    v_and_b32 v17, 15, v0
    v_lshlrev_b32 v18, 13, v16
    v_lshl_add_u32 v2, v17, 4, v18
    v_mul_u32_u24 v18, 1280, v16
    v_lshl_add_u32 v3, v17, 4, v18
    v_lshrrev_b32 v18, 3, v0
    v_mul_u32_u24 v18, 1280, v18
    v_and_b32 v19, 7, v0
    v_lshl_add_u32 v4, v19, 4, v18
    v_lshlrev_b32 v10, 4, v0
    v_add_u32 v1, 98304, v10
    v_and_b32 v18, 1, v16
    v_lshlrev_b32 v19, 5, v18
    v_xor_b32 v5, v10, v19
    v_xor_b32 v6, 64, v5
    v_xor_b32 v7, 0x80, v5
    v_xor_b32 v8, 0xc0, v5
    v_lshlrev_b32 v19, 6, v18
    v_xor_b32 v9, v10, v19
    v_xor_b32 v9, 0, v9
    v_lshrrev_b32 v16, 5, v0
    v_bfe_u32 v17, v0, 4, 1
    v_bfe_u32 v18, v0, 3, 1
    v_bfe_u32 v19, v0, 2, 1
    v_and_b32 v20, 3, v0
    v_lshlrev_b32 v20, 3, v20
    v_lshl_add_u32 v11, v16, 12, v20
    v_lshl_add_u32 v11, v17, 10, v11
    v_lshl_add_u32 v11, v18, 11, v11
    v_lshl_add_u32 v11, v19, 8, v11
    v_lshl_add_u32 v11, v19, 5, v11
    v_lshl_add_u32 v11, v17, 6, v11
    v_lshl_add_u32 v11, v18, 7, v11
    v_xor_b32 v11, 128, v11
    v_xor_b32 v12, 32, v11
    v_lshl_add_u32 v20, v18, 5, v20
    v_lshlrev_b32 v18, 4, v17
    v_lshl_add_u32 v18, v16, 2, v18
    v_add_u32 v18, v18, v19
    v_lshl_add_u32 v14, v18, 7, v20
    v_lshl_add_u32 v13, v18, 8, v20
    v_lshl_add_u32 v13, v19, 6, v13
    v_lshl_add_u32 v13, v17, 7, v13
    v_xor_b32 v13, 128, v13
    s_load_dwordx2 s[52:53], s[0:1], 16
    s_load_dwordx2 s[56:57], s[0:1], 24
    s_load_dwordx2 s[60:61], s[0:1], 32
    s_load_dwordx2 s[64:65], s[0:1], 40
    s_waitcnt lgkmcnt(0)
    s_mov_b32 s54, 5242880
    s_mov_b32 s55, 0x20000
    s_mov_b32 s58, 5242880
    s_mov_b32 s59, 0x20000
    s_mov_b32 s62, 5242880
    s_mov_b32 s63, 0x20000
    s_mov_b32 s66, 5242880
    s_mov_b32 s67, 0x20000
    s_lshl_b32 s71, s12, 8
    s_mul_i32 s68, s3, 2621440
    s_sub_u32 s69, 2621440, s68
    s_add_u32 s68, s68, s71
    s_add_u32 s69, s69, s71
    s_mul_i32 s70, s12, 163840
    s_mul_i32 s71, s3, 640
    s_add_u32 s70, s70, s71
    s_add_u32 s71, s68, 262144
    buffer_load_dwordx4 v[16:19], v2, s[52:55], s71 offen
    s_add_u32 s71, s68, 294912
    buffer_load_dwordx4 v[20:23], v2, s[52:55], s71 offen
    s_add_u32 s71, s68, 327680
    buffer_load_dwordx4 v[144:147], v2, s[52:55], s71 offen
    s_add_u32 s71, s68, 360448
    buffer_load_dwordx4 v[148:151], v2, s[52:55], s71 offen
    s_add_u32 s71, s68, 262144
    buffer_load_dwordx4 v[24:27], v2, s[56:59], s71 offen
    s_add_u32 s71, s68, 294912
    buffer_load_dwordx4 v[28:31], v2, s[56:59], s71 offen
    s_add_u32 s71, s68, 327680
    buffer_load_dwordx4 v[152:155], v2, s[56:59], s71 offen
    s_add_u32 s71, s68, 360448
    buffer_load_dwordx4 v[156:159], v2, s[56:59], s71 offen
    s_add_u32 s71, s68, 262144
    buffer_load_dwordx4 v[32:35], v2, s[60:63], s71 offen
    s_add_u32 s71, s68, 294912
    buffer_load_dwordx4 v[36:39], v2, s[60:63], s71 offen
    s_add_u32 s71, s68, 327680
    buffer_load_dwordx4 v[160:163], v2, s[60:63], s71 offen
    s_add_u32 s71, s68, 360448
    buffer_load_dwordx4 v[164:167], v2, s[60:63], s71 offen
    s_add_u32 s71, s69, 262144
    buffer_load_dwordx4 a[48:51], v2, s[52:55], s71 offen
    s_add_u32 s71, s69, 294912
    buffer_load_dwordx4 a[52:55], v2, s[52:55], s71 offen
    s_add_u32 s71, s69, 327680
    buffer_load_dwordx4 a[56:59], v2, s[52:55], s71 offen
    s_add_u32 s71, s69, 360448
    buffer_load_dwordx4 a[60:63], v2, s[52:55], s71 offen
    s_add_u32 s71, s69, 262144
    buffer_load_dwordx4 a[112:115], v2, s[56:59], s71 offen
    s_add_u32 s71, s69, 294912
    buffer_load_dwordx4 a[116:119], v2, s[56:59], s71 offen
    s_add_u32 s71, s69, 327680
    buffer_load_dwordx4 a[120:123], v2, s[56:59], s71 offen
    s_add_u32 s71, s69, 360448
    buffer_load_dwordx4 a[124:127], v2, s[56:59], s71 offen
    s_add_u32 s71, s69, 262144
    buffer_load_dwordx4 a[168:171], v2, s[60:63], s71 offen
    s_add_u32 s71, s69, 294912
    buffer_load_dwordx4 a[172:175], v2, s[60:63], s71 offen
    s_add_u32 s71, s69, 327680
    buffer_load_dwordx4 a[176:179], v2, s[60:63], s71 offen
    s_add_u32 s71, s69, 360448
    buffer_load_dwordx4 a[180:183], v2, s[60:63], s71 offen
    s_waitcnt vmcnt(23)
    ds_write_b128 v5, v[16:19] offset:8192
    s_waitcnt vmcnt(22)
    ds_write_b128 v6, v[20:23] offset:9216
    s_waitcnt vmcnt(21)
    ds_write_b128 v7, v[144:147] offset:10240
    s_waitcnt vmcnt(20)
    ds_write_b128 v8, v[148:151] offset:11264
    s_waitcnt lgkmcnt(0)
    s_barrier
    ds_read_b64_tr_b16 v[16:17], v11 offset:0
    ds_read_b64_tr_b16 v[18:19], v11 offset:512
    ds_read_b64_tr_b16 v[20:21], v11 offset:8192
    ds_read_b64_tr_b16 v[22:23], v11 offset:8704
    ds_read_b64_tr_b16 v[144:145], v12 offset:0
    ds_read_b64_tr_b16 v[146:147], v12 offset:512
    ds_read_b64_tr_b16 v[148:149], v12 offset:8192
    ds_read_b64_tr_b16 v[150:151], v12 offset:8704
    s_waitcnt lgkmcnt(0)
    s_barrier
    ds_write_b128 v1, v[16:19] offset:12288
    ds_write_b128 v1, v[20:23] offset:13312
    s_add_u32 s71, s68, 786432
    buffer_load_dwordx4 v[168:171], v2, s[52:55], s71 offen
    s_add_u32 s71, s68, 819200
    buffer_load_dwordx4 v[172:175], v2, s[52:55], s71 offen
    s_add_u32 s71, s68, 851968
    buffer_load_dwordx4 v[40:43], v2, s[52:55], s71 offen
    s_add_u32 s71, s68, 884736
    buffer_load_dwordx4 v[44:47], v2, s[52:55], s71 offen
    s_waitcnt vmcnt(23)
    ds_write_b128 v5, v[24:27] offset:8192
    s_waitcnt vmcnt(22)
    ds_write_b128 v6, v[28:31] offset:9216
    s_waitcnt vmcnt(21)
    ds_write_b128 v7, v[152:155] offset:10240
    s_waitcnt vmcnt(20)
    ds_write_b128 v8, v[156:159] offset:11264
    s_waitcnt lgkmcnt(0)
    s_barrier
    ds_read_b64_tr_b16 v[24:25], v11 offset:0
    ds_read_b64_tr_b16 v[26:27], v11 offset:512
    ds_read_b64_tr_b16 v[28:29], v11 offset:8192
    ds_read_b64_tr_b16 v[30:31], v11 offset:8704
    ds_read_b64_tr_b16 v[152:153], v12 offset:0
    ds_read_b64_tr_b16 v[154:155], v12 offset:512
    ds_read_b64_tr_b16 v[156:157], v12 offset:8192
    ds_read_b64_tr_b16 v[158:159], v12 offset:8704
    s_waitcnt lgkmcnt(0)
    s_barrier
    ds_write_b128 v1, v[24:27] offset:14336
    ds_write_b128 v1, v[28:31] offset:15360
    s_add_u32 s71, s68, 786432
    buffer_load_dwordx4 v[176:179], v2, s[56:59], s71 offen
    s_add_u32 s71, s68, 819200
    buffer_load_dwordx4 v[180:183], v2, s[56:59], s71 offen
    s_add_u32 s71, s68, 851968
    buffer_load_dwordx4 v[48:51], v2, s[56:59], s71 offen
    s_add_u32 s71, s68, 884736
    buffer_load_dwordx4 v[52:55], v2, s[56:59], s71 offen
    s_waitcnt vmcnt(23)
    ds_write_b128 v5, v[32:35] offset:8192
    s_waitcnt vmcnt(22)
    ds_write_b128 v6, v[36:39] offset:9216
    s_waitcnt vmcnt(21)
    ds_write_b128 v7, v[160:163] offset:10240
    s_waitcnt vmcnt(20)
    ds_write_b128 v8, v[164:167] offset:11264
    s_waitcnt lgkmcnt(0)
    s_barrier
    ds_read_b64_tr_b16 v[32:33], v11 offset:0
    ds_read_b64_tr_b16 v[34:35], v11 offset:512
    ds_read_b64_tr_b16 v[36:37], v11 offset:8192
    ds_read_b64_tr_b16 v[38:39], v11 offset:8704
    ds_read_b64_tr_b16 v[160:161], v12 offset:0
    ds_read_b64_tr_b16 v[162:163], v12 offset:512
    ds_read_b64_tr_b16 v[164:165], v12 offset:8192
    ds_read_b64_tr_b16 v[166:167], v12 offset:8704
    s_waitcnt lgkmcnt(0)
    s_barrier
    ds_write_b128 v1, v[32:35] offset:16384
    ds_write_b128 v1, v[36:39] offset:17408
    s_add_u32 s71, s68, 786432
    buffer_load_dwordx4 v[184:187], v2, s[60:63], s71 offen
    s_add_u32 s71, s68, 819200
    buffer_load_dwordx4 v[188:191], v2, s[60:63], s71 offen
    s_add_u32 s71, s68, 851968
    buffer_load_dwordx4 v[192:195], v2, s[60:63], s71 offen
    s_add_u32 s71, s68, 884736
    buffer_load_dwordx4 v[196:199], v2, s[60:63], s71 offen
    s_waitcnt vmcnt(23)
    ds_write_b128 v5, a[48:51] offset:8192
    s_waitcnt vmcnt(22)
    ds_write_b128 v6, a[52:55] offset:9216
    s_waitcnt vmcnt(21)
    ds_write_b128 v7, a[56:59] offset:10240
    s_waitcnt vmcnt(20)
    ds_write_b128 v8, a[60:63] offset:11264
    s_waitcnt lgkmcnt(0)
    s_barrier
    ds_read_b64_tr_b16 a[48:49], v11 offset:0
    ds_read_b64_tr_b16 a[50:51], v11 offset:512
    ds_read_b64_tr_b16 a[52:53], v11 offset:8192
    ds_read_b64_tr_b16 a[54:55], v11 offset:8704
    ds_read_b64_tr_b16 a[56:57], v12 offset:0
    ds_read_b64_tr_b16 a[58:59], v12 offset:512
    ds_read_b64_tr_b16 a[60:61], v12 offset:8192
    ds_read_b64_tr_b16 a[62:63], v12 offset:8704
    s_waitcnt lgkmcnt(0)
    s_barrier
    s_add_u32 s71, s69, 786432
    buffer_load_dwordx4 a[64:67], v2, s[52:55], s71 offen
    s_add_u32 s71, s69, 819200
    buffer_load_dwordx4 a[68:71], v2, s[52:55], s71 offen
    s_add_u32 s71, s69, 851968
    buffer_load_dwordx4 a[72:75], v2, s[52:55], s71 offen
    s_add_u32 s71, s69, 884736
    buffer_load_dwordx4 a[76:79], v2, s[52:55], s71 offen
    s_waitcnt vmcnt(23)
    ds_write_b128 v5, a[112:115] offset:8192
    s_waitcnt vmcnt(22)
    ds_write_b128 v6, a[116:119] offset:9216
    s_waitcnt vmcnt(21)
    ds_write_b128 v7, a[120:123] offset:10240
    s_waitcnt vmcnt(20)
    ds_write_b128 v8, a[124:127] offset:11264
    s_waitcnt lgkmcnt(0)
    s_barrier
    ds_read_b64_tr_b16 a[112:113], v11 offset:0
    ds_read_b64_tr_b16 a[114:115], v11 offset:512
    ds_read_b64_tr_b16 a[116:117], v11 offset:8192
    ds_read_b64_tr_b16 a[118:119], v11 offset:8704
    ds_read_b64_tr_b16 a[120:121], v12 offset:0
    ds_read_b64_tr_b16 a[122:123], v12 offset:512
    ds_read_b64_tr_b16 a[124:125], v12 offset:8192
    ds_read_b64_tr_b16 a[126:127], v12 offset:8704
    s_waitcnt lgkmcnt(0)
    s_barrier
    s_add_u32 s71, s69, 786432
    buffer_load_dwordx4 a[128:131], v2, s[56:59], s71 offen
    s_add_u32 s71, s69, 819200
    buffer_load_dwordx4 a[132:135], v2, s[56:59], s71 offen
    s_add_u32 s71, s69, 851968
    buffer_load_dwordx4 a[136:139], v2, s[56:59], s71 offen
    s_add_u32 s71, s69, 884736
    buffer_load_dwordx4 a[140:143], v2, s[56:59], s71 offen
    s_waitcnt vmcnt(23)
    ds_write_b128 v5, a[168:171] offset:8192
    s_waitcnt vmcnt(22)
    ds_write_b128 v6, a[172:175] offset:9216
    s_waitcnt vmcnt(21)
    ds_write_b128 v7, a[176:179] offset:10240
    s_waitcnt vmcnt(20)
    ds_write_b128 v8, a[180:183] offset:11264
    s_waitcnt lgkmcnt(0)
    s_barrier
    ds_read_b64_tr_b16 a[168:169], v11 offset:0
    ds_read_b64_tr_b16 a[170:171], v11 offset:512
    ds_read_b64_tr_b16 a[172:173], v11 offset:8192
    ds_read_b64_tr_b16 a[174:175], v11 offset:8704
    ds_read_b64_tr_b16 a[176:177], v12 offset:0
    ds_read_b64_tr_b16 a[178:179], v12 offset:512
    ds_read_b64_tr_b16 a[180:181], v12 offset:8192
    ds_read_b64_tr_b16 a[182:183], v12 offset:8704
    s_waitcnt lgkmcnt(0)
    s_barrier
    s_add_u32 s71, s69, 786432
    buffer_load_dwordx4 a[184:187], v2, s[60:63], s71 offen
    s_add_u32 s71, s69, 819200
    buffer_load_dwordx4 a[188:191], v2, s[60:63], s71 offen
    s_add_u32 s71, s69, 851968
    buffer_load_dwordx4 a[192:195], v2, s[60:63], s71 offen
    s_add_u32 s71, s69, 884736
    buffer_load_dwordx4 a[196:199], v2, s[60:63], s71 offen
    s_waitcnt vmcnt(23)
    ds_write_b128 v5, v[168:171] offset:8192
    s_waitcnt vmcnt(22)
    ds_write_b128 v6, v[172:175] offset:9216
    s_waitcnt vmcnt(21)
    ds_write_b128 v7, v[40:43] offset:10240
    s_waitcnt vmcnt(20)
    ds_write_b128 v8, v[44:47] offset:11264
    s_waitcnt lgkmcnt(0)
    s_barrier
    ds_read_b64_tr_b16 v[168:169], v11 offset:0
    ds_read_b64_tr_b16 v[170:171], v11 offset:512
    ds_read_b64_tr_b16 v[172:173], v11 offset:8192
    ds_read_b64_tr_b16 v[174:175], v11 offset:8704
    ds_read_b64_tr_b16 v[40:41], v12 offset:0
    ds_read_b64_tr_b16 v[42:43], v12 offset:512
    ds_read_b64_tr_b16 v[44:45], v12 offset:8192
    ds_read_b64_tr_b16 v[46:47], v12 offset:8704
    s_waitcnt lgkmcnt(0)
    s_barrier
    ds_write_b128 v1, v[40:43] offset:18432
    ds_write_b128 v1, v[44:47] offset:19456
    s_add_u32 s71, s68, 1310720
    buffer_load_dwordx4 v[56:59], v2, s[52:55], s71 offen
    s_add_u32 s71, s68, 1343488
    buffer_load_dwordx4 v[60:63], v2, s[52:55], s71 offen
    s_add_u32 s71, s68, 1376256
    buffer_load_dwordx4 v[64:67], v2, s[52:55], s71 offen
    s_add_u32 s71, s68, 1409024
    buffer_load_dwordx4 v[68:71], v2, s[52:55], s71 offen
    s_waitcnt vmcnt(23)
    ds_write_b128 v5, v[176:179] offset:8192
    s_waitcnt vmcnt(22)
    ds_write_b128 v6, v[180:183] offset:9216
    s_waitcnt vmcnt(21)
    ds_write_b128 v7, v[48:51] offset:10240
    s_waitcnt vmcnt(20)
    ds_write_b128 v8, v[52:55] offset:11264
    s_waitcnt lgkmcnt(0)
    s_barrier
    ds_read_b64_tr_b16 v[176:177], v11 offset:0
    ds_read_b64_tr_b16 v[178:179], v11 offset:512
    ds_read_b64_tr_b16 v[180:181], v11 offset:8192
    ds_read_b64_tr_b16 v[182:183], v11 offset:8704
    ds_read_b64_tr_b16 v[48:49], v12 offset:0
    ds_read_b64_tr_b16 v[50:51], v12 offset:512
    ds_read_b64_tr_b16 v[52:53], v12 offset:8192
    ds_read_b64_tr_b16 v[54:55], v12 offset:8704
    s_waitcnt lgkmcnt(0)
    s_barrier
    ds_write_b128 v1, v[48:51] offset:20480
    ds_write_b128 v1, v[52:55] offset:21504
    s_add_u32 s71, s68, 1310720
    buffer_load_dwordx4 v[72:75], v2, s[56:59], s71 offen
    s_add_u32 s71, s68, 1343488
    buffer_load_dwordx4 v[76:79], v2, s[56:59], s71 offen
    s_add_u32 s71, s68, 1376256
    buffer_load_dwordx4 v[80:83], v2, s[56:59], s71 offen
    s_add_u32 s71, s68, 1409024
    buffer_load_dwordx4 v[84:87], v2, s[56:59], s71 offen
    s_waitcnt vmcnt(23)
    ds_write_b128 v5, v[184:187] offset:8192
    s_waitcnt vmcnt(22)
    ds_write_b128 v6, v[188:191] offset:9216
    s_waitcnt vmcnt(21)
    ds_write_b128 v7, v[192:195] offset:10240
    s_waitcnt vmcnt(20)
    ds_write_b128 v8, v[196:199] offset:11264
    s_waitcnt lgkmcnt(0)
    s_barrier
    ds_read_b64_tr_b16 v[184:185], v11 offset:0
    ds_read_b64_tr_b16 v[186:187], v11 offset:512
    ds_read_b64_tr_b16 v[188:189], v11 offset:8192
    ds_read_b64_tr_b16 v[190:191], v11 offset:8704
    ds_read_b64_tr_b16 v[192:193], v12 offset:0
    ds_read_b64_tr_b16 v[194:195], v12 offset:512
    ds_read_b64_tr_b16 v[196:197], v12 offset:8192
    ds_read_b64_tr_b16 v[198:199], v12 offset:8704
    s_waitcnt lgkmcnt(0)
    s_barrier
    s_add_u32 s71, s68, 1310720
    buffer_load_dwordx4 v[96:99], v2, s[60:63], s71 offen
    s_add_u32 s71, s68, 1343488
    buffer_load_dwordx4 v[100:103], v2, s[60:63], s71 offen
    s_add_u32 s71, s68, 1376256
    buffer_load_dwordx4 v[104:107], v2, s[60:63], s71 offen
    s_add_u32 s71, s68, 1409024
    buffer_load_dwordx4 v[108:111], v2, s[60:63], s71 offen
    s_waitcnt vmcnt(23)
    ds_write_b128 v5, a[64:67] offset:8192
    s_waitcnt vmcnt(22)
    ds_write_b128 v6, a[68:71] offset:9216
    s_waitcnt vmcnt(21)
    ds_write_b128 v7, a[72:75] offset:10240
    s_waitcnt vmcnt(20)
    ds_write_b128 v8, a[76:79] offset:11264
    s_waitcnt lgkmcnt(0)
    s_barrier
    ds_read_b64_tr_b16 a[64:65], v11 offset:0
    ds_read_b64_tr_b16 a[66:67], v11 offset:512
    ds_read_b64_tr_b16 a[68:69], v11 offset:8192
    ds_read_b64_tr_b16 a[70:71], v11 offset:8704
    ds_read_b64_tr_b16 a[72:73], v12 offset:0
    ds_read_b64_tr_b16 a[74:75], v12 offset:512
    ds_read_b64_tr_b16 a[76:77], v12 offset:8192
    ds_read_b64_tr_b16 a[78:79], v12 offset:8704
    s_waitcnt lgkmcnt(0)
    s_barrier
    s_add_u32 s71, s69, 1310720
    buffer_load_dwordx4 v[240:243], v2, s[52:55], s71 offen
    s_add_u32 s71, s69, 1343488
    buffer_load_dwordx4 v[244:247], v2, s[52:55], s71 offen
    s_add_u32 s71, s69, 1376256
    buffer_load_dwordx4 v[248:251], v2, s[52:55], s71 offen
    s_add_u32 s71, s69, 1409024
    buffer_load_dwordx4 v[252:255], v2, s[52:55], s71 offen
    s_waitcnt vmcnt(23)
    ds_write_b128 v5, a[128:131] offset:8192
    s_waitcnt vmcnt(22)
    ds_write_b128 v6, a[132:135] offset:9216
    s_waitcnt vmcnt(21)
    ds_write_b128 v7, a[136:139] offset:10240
    s_waitcnt vmcnt(20)
    ds_write_b128 v8, a[140:143] offset:11264
    s_waitcnt lgkmcnt(0)
    s_barrier
    ds_read_b64_tr_b16 a[128:129], v11 offset:0
    ds_read_b64_tr_b16 a[130:131], v11 offset:512
    ds_read_b64_tr_b16 a[132:133], v11 offset:8192
    ds_read_b64_tr_b16 a[134:135], v11 offset:8704
    ds_read_b64_tr_b16 a[136:137], v12 offset:0
    ds_read_b64_tr_b16 a[138:139], v12 offset:512
    ds_read_b64_tr_b16 a[140:141], v12 offset:8192
    ds_read_b64_tr_b16 a[142:143], v12 offset:8704
    s_waitcnt lgkmcnt(0)
    s_barrier
    s_add_u32 s71, s69, 1310720
    buffer_load_dwordx4 a[0:3], v2, s[56:59], s71 offen
    s_add_u32 s71, s69, 1343488
    buffer_load_dwordx4 a[4:7], v2, s[56:59], s71 offen
    s_add_u32 s71, s69, 1376256
    buffer_load_dwordx4 a[8:11], v2, s[56:59], s71 offen
    s_add_u32 s71, s69, 1409024
    buffer_load_dwordx4 a[12:15], v2, s[56:59], s71 offen
    s_waitcnt vmcnt(23)
    ds_write_b128 v5, a[184:187] offset:8192
    s_waitcnt vmcnt(22)
    ds_write_b128 v6, a[188:191] offset:9216
    s_waitcnt vmcnt(21)
    ds_write_b128 v7, a[192:195] offset:10240
    s_waitcnt vmcnt(20)
    ds_write_b128 v8, a[196:199] offset:11264
    s_waitcnt lgkmcnt(0)
    s_barrier
    ds_read_b64_tr_b16 a[184:185], v11 offset:0
    ds_read_b64_tr_b16 a[186:187], v11 offset:512
    ds_read_b64_tr_b16 a[188:189], v11 offset:8192
    ds_read_b64_tr_b16 a[190:191], v11 offset:8704
    ds_read_b64_tr_b16 a[192:193], v12 offset:0
    ds_read_b64_tr_b16 a[194:195], v12 offset:512
    ds_read_b64_tr_b16 a[196:197], v12 offset:8192
    ds_read_b64_tr_b16 a[198:199], v12 offset:8704
    s_waitcnt lgkmcnt(0)
    s_barrier
    s_add_u32 s71, s69, 1310720
    buffer_load_dwordx4 a[16:19], v2, s[60:63], s71 offen
    s_add_u32 s71, s69, 1343488
    buffer_load_dwordx4 a[20:23], v2, s[60:63], s71 offen
    s_add_u32 s71, s69, 1376256
    buffer_load_dwordx4 a[24:27], v2, s[60:63], s71 offen
    s_add_u32 s71, s69, 1409024
    buffer_load_dwordx4 a[28:31], v2, s[60:63], s71 offen
    s_waitcnt vmcnt(23)
    ds_write_b128 v5, v[56:59] offset:8192
    s_waitcnt vmcnt(22)
    ds_write_b128 v6, v[60:63] offset:9216
    s_waitcnt vmcnt(21)
    ds_write_b128 v7, v[64:67] offset:10240
    s_waitcnt vmcnt(20)
    ds_write_b128 v8, v[68:71] offset:11264
    s_waitcnt lgkmcnt(0)
    s_barrier
    ds_read_b64_tr_b16 v[56:57], v11 offset:0
    ds_read_b64_tr_b16 v[58:59], v11 offset:512
    ds_read_b64_tr_b16 v[60:61], v11 offset:8192
    ds_read_b64_tr_b16 v[62:63], v11 offset:8704
    ds_read_b64_tr_b16 v[64:65], v12 offset:0
    ds_read_b64_tr_b16 v[66:67], v12 offset:512
    ds_read_b64_tr_b16 v[68:69], v12 offset:8192
    ds_read_b64_tr_b16 v[70:71], v12 offset:8704
    s_waitcnt lgkmcnt(0)
    s_barrier
    ds_write_b128 v1, v[56:59] offset:0
    ds_write_b128 v1, v[60:63] offset:1024
    ds_write_b128 v1, v[64:67] offset:2048
    ds_write_b128 v1, v[68:71] offset:3072
    s_add_u32 s71, s68, 1835008
    buffer_load_dwordx4 v[112:115], v2, s[52:55], s71 offen
    s_add_u32 s71, s68, 1867776
    buffer_load_dwordx4 v[116:119], v2, s[52:55], s71 offen
    s_add_u32 s71, s68, 1900544
    buffer_load_dwordx4 v[120:123], v2, s[52:55], s71 offen
    s_add_u32 s71, s68, 1933312
    buffer_load_dwordx4 v[124:127], v2, s[52:55], s71 offen
    s_waitcnt vmcnt(23)
    ds_write_b128 v5, v[72:75] offset:8192
    s_waitcnt vmcnt(22)
    ds_write_b128 v6, v[76:79] offset:9216
    s_waitcnt vmcnt(21)
    ds_write_b128 v7, v[80:83] offset:10240
    s_waitcnt vmcnt(20)
    ds_write_b128 v8, v[84:87] offset:11264
    s_waitcnt lgkmcnt(0)
    s_barrier
    ds_read_b64_tr_b16 v[72:73], v11 offset:0
    ds_read_b64_tr_b16 v[74:75], v11 offset:512
    ds_read_b64_tr_b16 v[76:77], v11 offset:8192
    ds_read_b64_tr_b16 v[78:79], v11 offset:8704
    ds_read_b64_tr_b16 v[80:81], v12 offset:0
    ds_read_b64_tr_b16 v[82:83], v12 offset:512
    ds_read_b64_tr_b16 v[84:85], v12 offset:8192
    ds_read_b64_tr_b16 v[86:87], v12 offset:8704
    s_waitcnt lgkmcnt(0)
    s_barrier
    ds_write_b128 v1, v[72:75] offset:4096
    ds_write_b128 v1, v[76:79] offset:5120
    ds_write_b128 v1, v[80:83] offset:6144
    ds_write_b128 v1, v[84:87] offset:7168
    s_add_u32 s71, s68, 1835008
    buffer_load_dwordx4 v[88:91], v2, s[56:59], s71 offen
    s_add_u32 s71, s68, 1867776
    buffer_load_dwordx4 v[92:95], v2, s[56:59], s71 offen
    s_add_u32 s71, s68, 1900544
    buffer_load_dwordx4 v[128:131], v2, s[56:59], s71 offen
    s_add_u32 s71, s68, 1933312
    buffer_load_dwordx4 v[132:135], v2, s[56:59], s71 offen
    s_waitcnt vmcnt(23)
    ds_write_b128 v5, v[96:99] offset:8192
    s_waitcnt vmcnt(22)
    ds_write_b128 v6, v[100:103] offset:9216
    s_waitcnt vmcnt(21)
    ds_write_b128 v7, v[104:107] offset:10240
    s_waitcnt vmcnt(20)
    ds_write_b128 v8, v[108:111] offset:11264
    s_waitcnt lgkmcnt(0)
    s_barrier
    ds_read_b64_tr_b16 v[96:97], v11 offset:0
    ds_read_b64_tr_b16 v[98:99], v11 offset:512
    ds_read_b64_tr_b16 v[100:101], v11 offset:8192
    ds_read_b64_tr_b16 v[102:103], v11 offset:8704
    ds_read_b64_tr_b16 v[104:105], v12 offset:0
    ds_read_b64_tr_b16 v[106:107], v12 offset:512
    ds_read_b64_tr_b16 v[108:109], v12 offset:8192
    ds_read_b64_tr_b16 v[110:111], v12 offset:8704
    s_waitcnt lgkmcnt(0)
    s_barrier
    s_add_u32 s71, s68, 1835008
    buffer_load_dwordx4 v[16:19], v2, s[60:63], s71 offen
    s_add_u32 s71, s68, 1867776
    buffer_load_dwordx4 v[20:23], v2, s[60:63], s71 offen
    s_add_u32 s71, s68, 1900544
    buffer_load_dwordx4 v[136:139], v2, s[60:63], s71 offen
    s_add_u32 s71, s68, 1933312
    buffer_load_dwordx4 v[140:143], v2, s[60:63], s71 offen
    s_waitcnt vmcnt(23)
    ds_write_b128 v5, v[240:243] offset:8192
    s_waitcnt vmcnt(22)
    ds_write_b128 v6, v[244:247] offset:9216
    s_waitcnt vmcnt(21)
    ds_write_b128 v7, v[248:251] offset:10240
    s_waitcnt vmcnt(20)
    ds_write_b128 v8, v[252:255] offset:11264
    s_waitcnt lgkmcnt(0)
    s_barrier
    ds_read_b64_tr_b16 v[240:241], v11 offset:0
    ds_read_b64_tr_b16 v[242:243], v11 offset:512
    ds_read_b64_tr_b16 v[244:245], v11 offset:8192
    ds_read_b64_tr_b16 v[246:247], v11 offset:8704
    ds_read_b64_tr_b16 v[248:249], v12 offset:0
    ds_read_b64_tr_b16 v[250:251], v12 offset:512
    ds_read_b64_tr_b16 v[252:253], v12 offset:8192
    ds_read_b64_tr_b16 v[254:255], v12 offset:8704
    s_waitcnt lgkmcnt(0)
    s_barrier
    s_add_u32 s71, s69, 1835008
    buffer_load_dwordx4 a[32:35], v2, s[52:55], s71 offen
    s_add_u32 s71, s69, 1867776
    buffer_load_dwordx4 a[36:39], v2, s[52:55], s71 offen
    s_add_u32 s71, s69, 1900544
    buffer_load_dwordx4 a[40:43], v2, s[52:55], s71 offen
    s_add_u32 s71, s69, 1933312
    buffer_load_dwordx4 a[44:47], v2, s[52:55], s71 offen
    s_waitcnt vmcnt(23)
    ds_write_b128 v5, a[0:3] offset:8192
    s_waitcnt vmcnt(22)
    ds_write_b128 v6, a[4:7] offset:9216
    s_waitcnt vmcnt(21)
    ds_write_b128 v7, a[8:11] offset:10240
    s_waitcnt vmcnt(20)
    ds_write_b128 v8, a[12:15] offset:11264
    s_waitcnt lgkmcnt(0)
    s_barrier
    ds_read_b64_tr_b16 a[0:1], v11 offset:0
    ds_read_b64_tr_b16 a[2:3], v11 offset:512
    ds_read_b64_tr_b16 a[4:5], v11 offset:8192
    ds_read_b64_tr_b16 a[6:7], v11 offset:8704
    ds_read_b64_tr_b16 a[8:9], v12 offset:0
    ds_read_b64_tr_b16 a[10:11], v12 offset:512
    ds_read_b64_tr_b16 a[12:13], v12 offset:8192
    ds_read_b64_tr_b16 a[14:15], v12 offset:8704
    s_waitcnt lgkmcnt(0)
    s_barrier
    s_add_u32 s71, s69, 1835008
    buffer_load_dwordx4 a[96:99], v2, s[56:59], s71 offen
    s_add_u32 s71, s69, 1867776
    buffer_load_dwordx4 a[100:103], v2, s[56:59], s71 offen
    s_add_u32 s71, s69, 1900544
    buffer_load_dwordx4 a[104:107], v2, s[56:59], s71 offen
    s_add_u32 s71, s69, 1933312
    buffer_load_dwordx4 a[108:111], v2, s[56:59], s71 offen
    s_waitcnt vmcnt(23)
    ds_write_b128 v5, a[16:19] offset:8192
    s_waitcnt vmcnt(22)
    ds_write_b128 v6, a[20:23] offset:9216
    s_waitcnt vmcnt(21)
    ds_write_b128 v7, a[24:27] offset:10240
    s_waitcnt vmcnt(20)
    ds_write_b128 v8, a[28:31] offset:11264
    s_waitcnt lgkmcnt(0)
    s_barrier
    ds_read_b64_tr_b16 a[16:17], v11 offset:0
    ds_read_b64_tr_b16 a[18:19], v11 offset:512
    ds_read_b64_tr_b16 a[20:21], v11 offset:8192
    ds_read_b64_tr_b16 a[22:23], v11 offset:8704
    ds_read_b64_tr_b16 a[24:25], v12 offset:0
    ds_read_b64_tr_b16 a[26:27], v12 offset:512
    ds_read_b64_tr_b16 a[28:29], v12 offset:8192
    ds_read_b64_tr_b16 a[30:31], v12 offset:8704
    s_waitcnt lgkmcnt(0)
    s_barrier
    s_add_u32 s71, s69, 1835008
    buffer_load_dwordx4 v[24:27], v2, s[60:63], s71 offen
    s_add_u32 s71, s69, 1867776
    buffer_load_dwordx4 v[28:31], v2, s[60:63], s71 offen
    s_add_u32 s71, s69, 1900544
    buffer_load_dwordx4 a[160:163], v2, s[60:63], s71 offen
    s_add_u32 s71, s69, 1933312
    buffer_load_dwordx4 a[164:167], v2, s[60:63], s71 offen
    s_waitcnt vmcnt(23)
    ds_write_b128 v5, v[112:115] offset:8192
    s_waitcnt vmcnt(22)
    ds_write_b128 v6, v[116:119] offset:9216
    s_waitcnt vmcnt(21)
    ds_write_b128 v7, v[120:123] offset:10240
    s_waitcnt vmcnt(20)
    ds_write_b128 v8, v[124:127] offset:11264
    s_waitcnt lgkmcnt(0)
    s_barrier
    ds_read_b64_tr_b16 v[112:113], v11 offset:0
    ds_read_b64_tr_b16 v[114:115], v11 offset:512
    ds_read_b64_tr_b16 v[116:117], v11 offset:8192
    ds_read_b64_tr_b16 v[118:119], v11 offset:8704
    ds_read_b64_tr_b16 v[120:121], v12 offset:0
    ds_read_b64_tr_b16 v[122:123], v12 offset:512
    ds_read_b64_tr_b16 v[124:125], v12 offset:8192
    ds_read_b64_tr_b16 v[126:127], v12 offset:8704
    s_waitcnt lgkmcnt(0)
    s_barrier
    s_add_u32 s71, s68, 2359296
    buffer_load_dwordx4 v[32:35], v2, s[52:55], s71 offen
    s_add_u32 s71, s68, 2392064
    buffer_load_dwordx4 v[36:39], v2, s[52:55], s71 offen
    s_add_u32 s71, s68, 2424832
    buffer_load_dwordx4 v[200:203], v2, s[52:55], s71 offen
    s_add_u32 s71, s68, 2457600
    buffer_load_dwordx4 v[204:207], v2, s[52:55], s71 offen
    s_waitcnt vmcnt(23)
    ds_write_b128 v5, v[88:91] offset:8192
    s_waitcnt vmcnt(22)
    ds_write_b128 v6, v[92:95] offset:9216
    s_waitcnt vmcnt(21)
    ds_write_b128 v7, v[128:131] offset:10240
    s_waitcnt vmcnt(20)
    ds_write_b128 v8, v[132:135] offset:11264
    s_waitcnt lgkmcnt(0)
    s_barrier
    ds_read_b64_tr_b16 v[88:89], v11 offset:0
    ds_read_b64_tr_b16 v[90:91], v11 offset:512
    ds_read_b64_tr_b16 v[92:93], v11 offset:8192
    ds_read_b64_tr_b16 v[94:95], v11 offset:8704
    ds_read_b64_tr_b16 v[128:129], v12 offset:0
    ds_read_b64_tr_b16 v[130:131], v12 offset:512
    ds_read_b64_tr_b16 v[132:133], v12 offset:8192
    ds_read_b64_tr_b16 v[134:135], v12 offset:8704
    s_waitcnt lgkmcnt(0)
    s_barrier
    ds_write_b128 v1, v[88:91] offset:8192
    ds_write_b128 v1, v[92:95] offset:9216
    s_add_u32 s71, s68, 2359296
    buffer_load_dwordx4 v[208:211], v2, s[56:59], s71 offen
    s_add_u32 s71, s68, 2392064
    buffer_load_dwordx4 v[212:215], v2, s[56:59], s71 offen
    s_add_u32 s71, s68, 2424832
    buffer_load_dwordx4 v[216:219], v2, s[56:59], s71 offen
    s_add_u32 s71, s68, 2457600
    buffer_load_dwordx4 v[220:223], v2, s[56:59], s71 offen
    s_waitcnt vmcnt(23)
    ds_write_b128 v5, v[16:19] offset:8192
    s_waitcnt vmcnt(22)
    ds_write_b128 v6, v[20:23] offset:9216
    s_waitcnt vmcnt(21)
    ds_write_b128 v7, v[136:139] offset:10240
    s_waitcnt vmcnt(20)
    ds_write_b128 v8, v[140:143] offset:11264
    s_waitcnt lgkmcnt(0)
    s_barrier
    ds_read_b64_tr_b16 v[16:17], v11 offset:0
    ds_read_b64_tr_b16 v[18:19], v11 offset:512
    ds_read_b64_tr_b16 v[20:21], v11 offset:8192
    ds_read_b64_tr_b16 v[22:23], v11 offset:8704
    ds_read_b64_tr_b16 v[136:137], v12 offset:0
    ds_read_b64_tr_b16 v[138:139], v12 offset:512
    ds_read_b64_tr_b16 v[140:141], v12 offset:8192
    ds_read_b64_tr_b16 v[142:143], v12 offset:8704
    s_waitcnt lgkmcnt(0)
    s_barrier
    ds_write_b128 v1, v[16:19] offset:10240
    ds_write_b128 v1, v[20:23] offset:11264
    s_add_u32 s71, s68, 2359296
    buffer_load_dwordx4 v[224:227], v2, s[60:63], s71 offen
    s_add_u32 s71, s68, 2392064
    buffer_load_dwordx4 v[228:231], v2, s[60:63], s71 offen
    s_add_u32 s71, s68, 2424832
    buffer_load_dwordx4 v[232:235], v2, s[60:63], s71 offen
    s_add_u32 s71, s68, 2457600
    buffer_load_dwordx4 v[236:239], v2, s[60:63], s71 offen
    s_waitcnt vmcnt(23)
    ds_write_b128 v5, a[32:35] offset:8192
    s_waitcnt vmcnt(22)
    ds_write_b128 v6, a[36:39] offset:9216
    s_waitcnt vmcnt(21)
    ds_write_b128 v7, a[40:43] offset:10240
    s_waitcnt vmcnt(20)
    ds_write_b128 v8, a[44:47] offset:11264
    s_waitcnt lgkmcnt(0)
    s_barrier
    ds_read_b64_tr_b16 a[32:33], v11 offset:0
    ds_read_b64_tr_b16 a[34:35], v11 offset:512
    ds_read_b64_tr_b16 a[36:37], v11 offset:8192
    ds_read_b64_tr_b16 a[38:39], v11 offset:8704
    ds_read_b64_tr_b16 a[40:41], v12 offset:0
    ds_read_b64_tr_b16 a[42:43], v12 offset:512
    ds_read_b64_tr_b16 a[44:45], v12 offset:8192
    ds_read_b64_tr_b16 a[46:47], v12 offset:8704
    s_waitcnt lgkmcnt(0)
    s_barrier
    s_add_u32 s71, s69, 2359296
    buffer_load_dwordx4 a[80:83], v2, s[52:55], s71 offen
    s_add_u32 s71, s69, 2392064
    buffer_load_dwordx4 a[84:87], v2, s[52:55], s71 offen
    s_add_u32 s71, s69, 2424832
    buffer_load_dwordx4 a[88:91], v2, s[52:55], s71 offen
    s_add_u32 s71, s69, 2457600
    buffer_load_dwordx4 a[92:95], v2, s[52:55], s71 offen
    s_waitcnt vmcnt(23)
    ds_write_b128 v5, a[96:99] offset:8192
    s_waitcnt vmcnt(22)
    ds_write_b128 v6, a[100:103] offset:9216
    s_waitcnt vmcnt(21)
    ds_write_b128 v7, a[104:107] offset:10240
    s_waitcnt vmcnt(20)
    ds_write_b128 v8, a[108:111] offset:11264
    s_waitcnt lgkmcnt(0)
    s_barrier
    ds_read_b64_tr_b16 a[96:97], v11 offset:0
    ds_read_b64_tr_b16 a[98:99], v11 offset:512
    ds_read_b64_tr_b16 a[100:101], v11 offset:8192
    ds_read_b64_tr_b16 a[102:103], v11 offset:8704
    ds_read_b64_tr_b16 a[104:105], v12 offset:0
    ds_read_b64_tr_b16 a[106:107], v12 offset:512
    ds_read_b64_tr_b16 a[108:109], v12 offset:8192
    ds_read_b64_tr_b16 a[110:111], v12 offset:8704
    s_waitcnt lgkmcnt(0)
    s_barrier
    s_add_u32 s71, s69, 2359296
    buffer_load_dwordx4 a[144:147], v2, s[56:59], s71 offen
    s_add_u32 s71, s69, 2392064
    buffer_load_dwordx4 a[148:151], v2, s[56:59], s71 offen
    s_add_u32 s71, s69, 2424832
    buffer_load_dwordx4 a[152:155], v2, s[56:59], s71 offen
    s_add_u32 s71, s69, 2457600
    buffer_load_dwordx4 a[156:159], v2, s[56:59], s71 offen
    s_waitcnt vmcnt(23)
    ds_write_b128 v5, v[24:27] offset:8192
    s_waitcnt vmcnt(22)
    ds_write_b128 v6, v[28:31] offset:9216
    s_waitcnt vmcnt(21)
    ds_write_b128 v7, a[160:163] offset:10240
    s_waitcnt vmcnt(20)
    ds_write_b128 v8, a[164:167] offset:11264
    s_waitcnt lgkmcnt(0)
    s_barrier
    ds_read_b64_tr_b16 v[24:25], v11 offset:0
    ds_read_b64_tr_b16 v[26:27], v11 offset:512
    ds_read_b64_tr_b16 v[28:29], v11 offset:8192
    ds_read_b64_tr_b16 v[30:31], v11 offset:8704
    ds_read_b64_tr_b16 a[160:161], v12 offset:0
    ds_read_b64_tr_b16 a[162:163], v12 offset:512
    ds_read_b64_tr_b16 a[164:165], v12 offset:8192
    ds_read_b64_tr_b16 a[166:167], v12 offset:8704
    s_waitcnt lgkmcnt(0)
    s_barrier
    ds_write_b128 v1, v[24:27] offset:24576
    ds_write_b128 v1, v[28:31] offset:25600
    s_add_u32 s71, s69, 2359296
    buffer_load_dwordx4 a[200:203], v2, s[60:63], s71 offen
    s_add_u32 s71, s69, 2392064
    buffer_load_dwordx4 a[204:207], v2, s[60:63], s71 offen
    s_add_u32 s71, s69, 2424832
    buffer_load_dwordx4 a[208:211], v2, s[60:63], s71 offen
    s_add_u32 s71, s69, 2457600
    buffer_load_dwordx4 a[212:215], v2, s[60:63], s71 offen
    s_waitcnt vmcnt(23)
    ds_write_b128 v5, v[32:35] offset:8192
    s_waitcnt vmcnt(22)
    ds_write_b128 v6, v[36:39] offset:9216
    s_waitcnt vmcnt(21)
    ds_write_b128 v7, v[200:203] offset:10240
    s_waitcnt vmcnt(20)
    ds_write_b128 v8, v[204:207] offset:11264
    s_waitcnt lgkmcnt(0)
    s_barrier
    ds_read_b64_tr_b16 v[32:33], v11 offset:0
    ds_read_b64_tr_b16 v[34:35], v11 offset:512
    ds_read_b64_tr_b16 v[36:37], v11 offset:8192
    ds_read_b64_tr_b16 v[38:39], v11 offset:8704
    ds_read_b64_tr_b16 v[200:201], v12 offset:0
    ds_read_b64_tr_b16 v[202:203], v12 offset:512
    ds_read_b64_tr_b16 v[204:205], v12 offset:8192
    ds_read_b64_tr_b16 v[206:207], v12 offset:8704
    s_waitcnt lgkmcnt(0)
    s_barrier
    ds_write_b128 v1, v[32:35] offset:22528
    ds_write_b128 v1, v[36:39] offset:23552
    s_add_u32 s71, s70, 40960
    buffer_load_dwordx4 a[224:227], v3, s[64:67], s71 offen
    s_add_u32 s71, s70, 46080
    buffer_load_dwordx4 a[228:231], v3, s[64:67], s71 offen
    s_add_u32 s71, s70, 51200
    buffer_load_dwordx4 a[232:235], v3, s[64:67], s71 offen
    s_add_u32 s71, s70, 56320
    buffer_load_dwordx4 a[236:239], v3, s[64:67], s71 offen
    s_waitcnt vmcnt(23)
    ds_write_b128 v5, v[208:211] offset:8192
    s_waitcnt vmcnt(22)
    ds_write_b128 v6, v[212:215] offset:9216
    s_waitcnt vmcnt(21)
    ds_write_b128 v7, v[216:219] offset:10240
    s_waitcnt vmcnt(20)
    ds_write_b128 v8, v[220:223] offset:11264
    s_waitcnt lgkmcnt(0)
    s_barrier
    ds_read_b64_tr_b16 v[208:209], v11 offset:0
    ds_read_b64_tr_b16 v[210:211], v11 offset:512
    ds_read_b64_tr_b16 v[212:213], v11 offset:8192
    ds_read_b64_tr_b16 v[214:215], v11 offset:8704
    ds_read_b64_tr_b16 v[216:217], v12 offset:0
    ds_read_b64_tr_b16 v[218:219], v12 offset:512
    ds_read_b64_tr_b16 v[220:221], v12 offset:8192
    ds_read_b64_tr_b16 v[222:223], v12 offset:8704
    s_waitcnt lgkmcnt(0)
    s_barrier
    s_add_u32 s71, s70, 122880
    buffer_load_dwordx4 v[40:43], v3, s[64:67], s71 offen
    s_add_u32 s71, s70, 128000
    buffer_load_dwordx4 v[44:47], v3, s[64:67], s71 offen
    s_add_u32 s71, s70, 133120
    buffer_load_dwordx4 v[48:51], v3, s[64:67], s71 offen
    s_add_u32 s71, s70, 138240
    buffer_load_dwordx4 v[52:55], v3, s[64:67], s71 offen
    s_waitcnt vmcnt(23)
    ds_write_b128 v5, v[224:227] offset:8192
    s_waitcnt vmcnt(22)
    ds_write_b128 v6, v[228:231] offset:9216
    s_waitcnt vmcnt(21)
    ds_write_b128 v7, v[232:235] offset:10240
    s_waitcnt vmcnt(20)
    ds_write_b128 v8, v[236:239] offset:11264
    s_waitcnt lgkmcnt(0)
    s_barrier
    ds_read_b64_tr_b16 v[224:225], v11 offset:0
    ds_read_b64_tr_b16 v[226:227], v11 offset:512
    ds_read_b64_tr_b16 v[228:229], v11 offset:8192
    ds_read_b64_tr_b16 v[230:231], v11 offset:8704
    ds_read_b64_tr_b16 v[232:233], v12 offset:0
    ds_read_b64_tr_b16 v[234:235], v12 offset:512
    ds_read_b64_tr_b16 v[236:237], v12 offset:8192
    ds_read_b64_tr_b16 v[238:239], v12 offset:8704
    s_waitcnt lgkmcnt(0)
    s_barrier
    s_add_u32 s71, s70, 41216
    buffer_load_dwordx4 a[248:251], v3, s[64:67], s71 offen
    s_add_u32 s71, s70, 46336
    buffer_load_dwordx4 a[252:255], v3, s[64:67], s71 offen
    s_add_u32 s71, s70, 51456
    buffer_load_dwordx4 v[56:59], v3, s[64:67], s71 offen
    s_add_u32 s71, s70, 56576
    buffer_load_dwordx4 v[60:63], v3, s[64:67], s71 offen
    s_waitcnt vmcnt(23)
    ds_write_b128 v5, a[80:83] offset:8192
    s_waitcnt vmcnt(22)
    ds_write_b128 v6, a[84:87] offset:9216
    s_waitcnt vmcnt(21)
    ds_write_b128 v7, a[88:91] offset:10240
    s_waitcnt vmcnt(20)
    ds_write_b128 v8, a[92:95] offset:11264
    s_waitcnt lgkmcnt(0)
    s_barrier
    ds_read_b64_tr_b16 a[80:81], v11 offset:0
    ds_read_b64_tr_b16 a[82:83], v11 offset:512
    ds_read_b64_tr_b16 a[84:85], v11 offset:8192
    ds_read_b64_tr_b16 a[86:87], v11 offset:8704
    ds_read_b64_tr_b16 a[88:89], v12 offset:0
    ds_read_b64_tr_b16 a[90:91], v12 offset:512
    ds_read_b64_tr_b16 a[92:93], v12 offset:8192
    ds_read_b64_tr_b16 a[94:95], v12 offset:8704
    s_waitcnt lgkmcnt(0)
    s_barrier
    s_add_u32 s71, s70, 123136
    buffer_load_dwordx4 a[216:219], v3, s[64:67], s71 offen
    s_add_u32 s71, s70, 128256
    buffer_load_dwordx4 a[220:223], v3, s[64:67], s71 offen
    s_add_u32 s71, s70, 133376
    buffer_load_dwordx4 a[240:243], v3, s[64:67], s71 offen
    s_add_u32 s71, s70, 138496
    buffer_load_dwordx4 a[244:247], v3, s[64:67], s71 offen
    s_waitcnt vmcnt(23)
    ds_write_b128 v5, a[144:147] offset:8192
    s_waitcnt vmcnt(22)
    ds_write_b128 v6, a[148:151] offset:9216
    s_waitcnt vmcnt(21)
    ds_write_b128 v7, a[152:155] offset:10240
    s_waitcnt vmcnt(20)
    ds_write_b128 v8, a[156:159] offset:11264
    s_waitcnt lgkmcnt(0)
    s_barrier
    ds_read_b64_tr_b16 a[144:145], v11 offset:0
    ds_read_b64_tr_b16 a[146:147], v11 offset:512
    ds_read_b64_tr_b16 a[148:149], v11 offset:8192
    ds_read_b64_tr_b16 a[150:151], v11 offset:8704
    ds_read_b64_tr_b16 a[152:153], v12 offset:0
    ds_read_b64_tr_b16 a[154:155], v12 offset:512
    ds_read_b64_tr_b16 a[156:157], v12 offset:8192
    ds_read_b64_tr_b16 a[158:159], v12 offset:8704
    s_waitcnt lgkmcnt(0)
    s_barrier
    s_add_u32 s71, s70, 82432
    buffer_load_dwordx4 v[64:67], v4, s[64:67], s71 offen
    s_add_u32 s71, s70, 92672
    buffer_load_dwordx4 v[68:71], v4, s[64:67], s71 offen
    s_add_u32 s71, s70, 102912
    buffer_load_dwordx4 v[72:75], v4, s[64:67], s71 offen
    s_add_u32 s71, s70, 113152
    buffer_load_dwordx4 v[76:79], v4, s[64:67], s71 offen
    s_waitcnt vmcnt(23)
    ds_write_b128 v5, a[200:203] offset:8192
    s_waitcnt vmcnt(22)
    ds_write_b128 v6, a[204:207] offset:9216
    s_waitcnt vmcnt(21)
    ds_write_b128 v7, a[208:211] offset:10240
    s_waitcnt vmcnt(20)
    ds_write_b128 v8, a[212:215] offset:11264
    s_waitcnt lgkmcnt(0)
    s_barrier
    ds_read_b64_tr_b16 a[200:201], v11 offset:0
    ds_read_b64_tr_b16 a[202:203], v11 offset:512
    ds_read_b64_tr_b16 a[204:205], v11 offset:8192
    ds_read_b64_tr_b16 a[206:207], v11 offset:8704
    ds_read_b64_tr_b16 a[208:209], v12 offset:0
    ds_read_b64_tr_b16 a[210:211], v12 offset:512
    ds_read_b64_tr_b16 a[212:213], v12 offset:8192
    ds_read_b64_tr_b16 a[214:215], v12 offset:8704
    s_waitcnt lgkmcnt(0)
    s_barrier
    s_waitcnt vmcnt(19)
    ds_write_b128 v9, a[224:227] offset:8192
    s_waitcnt vmcnt(18)
    ds_write_b128 v9, a[228:231] offset:9216
    s_waitcnt vmcnt(17)
    ds_write_b128 v9, a[232:235] offset:10240
    s_waitcnt vmcnt(16)
    ds_write_b128 v9, a[236:239] offset:11264
    s_waitcnt lgkmcnt(0)
    s_barrier
    ds_read_b64_tr_b16 a[224:225], v13 offset:0
    ds_read_b64_tr_b16 a[226:227], v13 offset:512
    ds_read_b64_tr_b16 a[228:229], v13 offset:2048
    ds_read_b64_tr_b16 a[230:231], v13 offset:2560
    ds_read_b64_tr_b16 a[232:233], v13 offset:8192
    ds_read_b64_tr_b16 a[234:235], v13 offset:8704
    ds_read_b64_tr_b16 a[236:237], v13 offset:10240
    ds_read_b64_tr_b16 a[238:239], v13 offset:10752
    s_waitcnt lgkmcnt(0)
    s_barrier
    buffer_load_dword v15, off, s[72:75], 0 offset:48 sc1
    s_waitcnt vmcnt(16)
    ds_write_b128 v9, v[40:43] offset:8192
    s_waitcnt vmcnt(15)
    ds_write_b128 v9, v[44:47] offset:9216
    s_waitcnt vmcnt(14)
    ds_write_b128 v9, v[48:51] offset:10240
    s_waitcnt vmcnt(13)
    ds_write_b128 v9, v[52:55] offset:11264
    s_waitcnt lgkmcnt(0)
    s_barrier
    ds_read_b64_tr_b16 v[40:41], v13 offset:0
    ds_read_b64_tr_b16 v[42:43], v13 offset:512
    ds_read_b64_tr_b16 v[44:45], v13 offset:2048
    ds_read_b64_tr_b16 v[46:47], v13 offset:2560
    ds_read_b64_tr_b16 v[48:49], v13 offset:8192
    ds_read_b64_tr_b16 v[50:51], v13 offset:8704
    ds_read_b64_tr_b16 v[52:53], v13 offset:10240
    ds_read_b64_tr_b16 v[54:55], v13 offset:10752
    s_waitcnt lgkmcnt(0)
    s_barrier
    ds_write_b128 v1, v[40:43] offset:26624
    ds_write_b128 v1, v[44:47] offset:27648
    ds_write_b128 v1, v[48:51] offset:28672
    ds_write_b128 v1, v[52:55] offset:29696
    s_waitcnt vmcnt(12)
    ds_write_b128 v9, a[248:251] offset:8192
    s_waitcnt vmcnt(11)
    ds_write_b128 v9, a[252:255] offset:9216
    s_waitcnt vmcnt(10)
    ds_write_b128 v9, v[56:59] offset:10240
    s_waitcnt vmcnt(9)
    ds_write_b128 v9, v[60:63] offset:11264
    s_waitcnt lgkmcnt(0)
    s_barrier
    ds_read_b64_tr_b16 a[248:249], v13 offset:0
    ds_read_b64_tr_b16 a[250:251], v13 offset:512
    ds_read_b64_tr_b16 a[252:253], v13 offset:2048
    ds_read_b64_tr_b16 a[254:255], v13 offset:2560
    ds_read_b64_tr_b16 v[56:57], v13 offset:8192
    ds_read_b64_tr_b16 v[58:59], v13 offset:8704
    ds_read_b64_tr_b16 v[60:61], v13 offset:10240
    ds_read_b64_tr_b16 v[62:63], v13 offset:10752
    s_waitcnt lgkmcnt(0)
    s_barrier
    ds_write_b128 v1, v[56:59] offset:30720
    ds_write_b128 v1, v[60:63] offset:31744
    s_waitcnt vmcnt(8)
    ds_write_b128 v9, a[216:219] offset:8192
    s_waitcnt vmcnt(7)
    ds_write_b128 v9, a[220:223] offset:9216
    s_waitcnt vmcnt(6)
    ds_write_b128 v9, a[240:243] offset:10240
    s_waitcnt vmcnt(5)
    ds_write_b128 v9, a[244:247] offset:11264
    s_waitcnt lgkmcnt(0)
    s_barrier
    ds_read_b64_tr_b16 a[216:217], v13 offset:0
    ds_read_b64_tr_b16 a[218:219], v13 offset:512
    ds_read_b64_tr_b16 a[220:221], v13 offset:2048
    ds_read_b64_tr_b16 a[222:223], v13 offset:2560
    ds_read_b64_tr_b16 a[240:241], v13 offset:8192
    ds_read_b64_tr_b16 a[242:243], v13 offset:8704
    ds_read_b64_tr_b16 a[244:245], v13 offset:10240
    ds_read_b64_tr_b16 a[246:247], v13 offset:10752
    s_waitcnt lgkmcnt(0)
    s_barrier
    s_waitcnt vmcnt(4)
    ds_write_b128 v10, v[64:67] offset:8192
    s_waitcnt vmcnt(3)
    ds_write_b128 v10, v[68:71] offset:9216
    s_waitcnt vmcnt(2)
    ds_write_b128 v10, v[72:75] offset:10240
    s_waitcnt vmcnt(1)
    ds_write_b128 v10, v[76:79] offset:11264
    s_waitcnt lgkmcnt(0)
    s_barrier
    s_barrier
    s_waitcnt vmcnt(0)
    v_and_b32 v16, 15, v0
    v_lshrrev_b32 v17, 4, v0
    v_and_b32 v18, 1, v16
    v_bfe_u32 v19, v16, 1, 1
    v_mov_b32 v20, 0xaaaa
    v_mul_u32_u24 v18, v18, v20
    v_mul_u32_u24 v19, v19, v20
    v_lshl_add_u32 v18, v19, 16, v18
    v_add_u32 v2, 0x44444444, v18
    v_lshrrev_b32 v18, 1, v17
    v_lshlrev_b32 v18, 6, v18
    v_lshlrev_b32 v19, 3, v16
    v_xor_b32 v18, v18, v19
    v_lshl_add_u32 v3, v17, 7, v18
    v_and_b32 v18, 3, v0
    v_lshrrev_b32 v19, 2, v0
    v_lshlrev_b32 v19, 3, v19
    v_lshrrev_b32 v20, 1, v18
    v_lshlrev_b32 v20, 6, v20
    v_xor_b32 v19, v19, v20
    v_lshl_add_u32 v4, v18, 7, v19
    v_and_b32 v18, 7, v16
    v_and_b32 v19, 61, v0
    v_lshlrev_b32 v5, 4, v19
    v_lshlrev_b32 v19, 12, v17
    v_lshl_add_u32 v6, v16, 3, v19
    v_and_b32 v19, 1, v17
    v_lshlrev_b32 v19, 5, v19
    v_lshl_add_u32 v19, v18, 2, v19
    v_lshrrev_b32 v20, 1, v17
    v_lshl_add_u32 v7, v20, 8, v19
    v_lshlrev_b32 v8, 2, v0
    v_lshlrev_b32 v0, 4, v0
    v_add_u32 v1, 98304, v0
    s_lshl_b32 s27, s12, 7
    s_lshl_b32 s25, s3, 5
    v_and_b32 v22, 0x30, v0
    buffer_load_dwordx3 v[16:18], off, s[72:75], 0 offset:48 sc1
    buffer_load_dword v20, off, s[72:75], s25 sc1
    buffer_load_dword v21, v22, s[4:7], s27 offen offset:0 sc1
    s_mov_b32 s84, 0
    s_waitcnt vmcnt(2)
    v_lshrrev_b32 v23, 18, v17
    v_add_u32 v18, 4, v18
    v_lshrrev_b32 v18, 3, v18
    s_waitcnt vmcnt(1)
    v_lshrrev_b32 v20, 4, v20
    v_min3_u32 v23, v23, v15, v18
    s_waitcnt vmcnt(0)
    v_min3_u32 v23, v23, v20, v21
    v_cmp_gt_u32 vcc, 2, v23
    s_cbranch_vccz Lrdy84
    v_mov_b32 v17, 0
    s_mov_b32 exec_lo, 0x1
    s_mov_b32 exec_hi, 0x0
Lwf85:
    buffer_load_dword v16, v17, s[72:75], 0 offen offset:48 sc1
    s_waitcnt vmcnt(0)
    v_cmp_gt_u32 vcc, 2, v16
    s_cbranch_vccz Lwf85d
    s_sub_u32 s15, s15, 1
    s_cbranch_scc0 Lwf85
    s_mov_b32 s15, 0
Lwf85d:
    s_mov_b64 exec, -1
    v_mov_b32 v17, 0
    s_mov_b32 exec_lo, 0x1
    s_mov_b32 exec_hi, 0x0
Lwf86:
    buffer_load_dword v16, v17, s[72:75], 0 offen offset:56 sc1
    s_waitcnt vmcnt(0)
    v_cmp_gt_u32 vcc, 12, v16
    s_cbranch_vccz Lwf86d
    s_sub_u32 s15, s15, 1
    s_cbranch_scc0 Lwf86
    s_mov_b32 s15, 0
Lwf86d:
    s_mov_b64 exec, -1
    v_mbcnt_lo_u32_b32 v17, -1, 0
    v_and_b32 v17, 7, v17
    v_lshlrev_b32 v17, 5, v17
Lcen87:
    buffer_load_dword v16, v17, s[72:75], 0 offen sc1
    s_waitcnt vmcnt(0)
    v_readlane_b32 s25, v16, s3
    s_mov_b32 s84, 0
    s_nop 2
    s_cmp_ge_u32 s25, 32
    s_cbranch_scc1 Lcen87d
    s_mov_b32 s84, 1
    v_mov_b32 v18, v16
    s_nop 1
    v_add_u32_dpp v18, v18, v18 row_ror:1 row_mask:0xf bank_mask:0xf
    s_nop 1
    v_add_u32_dpp v18, v18, v18 row_ror:2 row_mask:0xf bank_mask:0xf
    s_nop 1
    v_add_u32_dpp v18, v18, v18 row_ror:4 row_mask:0xf bank_mask:0xf
    s_nop 0
    v_readfirstlane_b32 s25, v18
    s_nop 3
    s_cmp_ge_u32 s25, 256
    s_cbranch_scc1 Lcen87d
    s_sub_u32 s15, s15, 1
    s_cbranch_scc0 Lcen87
    s_mov_b32 s15, 0
Lcen87d:
    v_mov_b32 v18, 0
    s_mov_b32 exec_lo, 0x1
    s_mov_b32 exec_hi, 0x0
Lwf88:
    buffer_load_dword v17, v18, s[72:75], 0 offen offset:52 sc1
    s_waitcnt vmcnt(0)
    v_cmp_gt_u32 vcc, 524288, v17
    s_cbranch_vccz Lwf88d
    s_sub_u32 s15, s15, 1
    s_cbranch_scc0 Lwf88
    s_mov_b32 s15, 0
Lwf88d:
    s_mov_b64 exec, -1
    s_mov_b32 exec_lo, 0xf
    s_mov_b32 exec_hi, 0x0
Lwf89:
    buffer_load_dword v16, v0, s[4:7], s27 offen offset:0 sc1
    s_waitcnt vmcnt(0)
    v_cmp_gt_u32 vcc, 2, v16
    s_cbranch_vccz Lwf89d
    s_sub_u32 s15, s15, 1
    s_cbranch_scc0 Lwf89
    s_mov_b32 s15, 0
Lwf89d:
    s_mov_b64 exec, -1
Lrdy84:
    v_readfirstlane_b32 s35, v17
    s_nop 3
    s_and_b32 s35, s35, 0x60
    s_cselect_b32 s35, 0x2000, 0
    s_mov_b32 s28, 1040356334
    s_mov_b32 s29, 562036736
    s_mov_b32 s30, 1006632960
    s_lshl_b32 s26, s3, 19
    s_add_u32 s26, s26, 1048576
    s_lshl_b32 s25, s12, 7
    s_add_u32 s27, s25, 0
    s_add_u32 s16, s25, s26
    s_add_u32 s16, s16, 32768
    s_lshl_b32 s17, s12, 12
    s_add_u32 s17, s17, s26
    s_add_u32 s17, s17, 0
    s_lshl_b32 s26, s3, 17
    s_and_b32 s19, s25, 384
    s_lshr_b32 s19, s19, 1
    s_sub_u32 s25, s25, s19
    s_add_u32 s25, s25, 0
    s_add_u32 s19, s26, 132096
    s_add_u32 s33, s26, s25
    s_add_u32 s34, s33, s35
    s_add_u32 s34, s34, 2097152
    s_add_u32 s33, s33, 131072
    s_mov_b32 s20, s33
    s_mov_b32 s24, s34
    s_xor_b32 s21, s26, 0x20000
    s_add_u32 s21, s21, s35
    s_add_u32 s21, s21, 2098176
    s_xor_b32 s26, s35, 0x2000
    s_lshl_b32 s98, s12, 15
    s_add_u32 s98, s98, s26
    s_add_u32 s98, s98, 8392704
    s_lshr_b32 s99, s12, 1
    s_lshl_b32 s99, s99, 14
    s_and_b32 s25, s12, 1
    s_lshl_b32 s25, s25, 12
    s_add_u32 s99, s99, s25
    s_add_u32 s99, s99, s26
    s_add_u32 s99, s99, 75497472
    s_lshr_b32 s23, s99, 8
    s_and_b32 s23, s23, 0x2000
    s_xor_b32 s23, s99, s23
    s_add_u32 s98, s98, 0
    s_lshr_b32 s22, s98, 8
    s_and_b32 s22, s22, 0x2000
    s_xor_b32 s22, s98, s22
    s_add_u32 s32, s22, 16384
    s_lshl_b32 s100, s3, 5
    s_add_u32 s100, s100, s12
    s_lshl_b32 s100, s100, 6
    s_add_u32 s100, s100, 4096
    s_sub_u32 s31, s31, 1
    s_sub_u32 s36, s3, 1
    s_not_b32 s37, s36
    s_mov_b32 s18, 1
    s_mov_b32 s92, 0x00ff00ff
    s_mov_b32 s93, 0x00ff00ff
    s_mov_b32 s14, 0
    s_mov_b32 s38, 1114129
    s_mov_b32 s39, 1114129
    s_mov_b32 s40, 285217024
    s_mov_b32 s41, 285217024
    s_mov_b32 s42, 2228258
    s_mov_b32 s43, 2228258
    s_mov_b32 s44, 570434048
    s_mov_b32 s45, 570434048
    s_mov_b32 s46, 4042322160
    s_mov_b32 s47, 4042322160
    buffer_load_dwordx4 v[72:75], v0, s[4:7], s22 offen offset:0 sc1
    buffer_load_dwordx4 v[76:79], v0, s[4:7], s22 offen offset:1024 sc1
    buffer_load_dwordx4 v[80:83], v0, s[4:7], s32 offen offset:0 sc1
    buffer_load_dwordx4 v[84:87], v0, s[4:7], s32 offen offset:1024 sc1
    s_add_u32 s98, s98, 1048576
    s_lshr_b32 s22, s98, 8
    s_and_b32 s22, s22, 0x2000
    s_xor_b32 s22, s98, s22
    s_add_u32 s32, s22, 16384
    v_mov_b64 v[48:49], -1
    v_mov_b64 v[50:51], -1
    v_mov_b32 v9, -1
    s_waitcnt vmcnt(0) lgkmcnt(0)
    s_nop 11
    s_cmp_lg_u32 s84, 0
    s_cbranch_scc1 Ls2_top
Lc2_top:
    v_mov_b64 v[56:57], v[72:73]
    v_mov_b64 v[58:59], v[74:75]
    v_mov_b64 v[60:61], v[76:77]
    v_mov_b64 v[62:63], v[78:79]
    v_mov_b64 v[64:65], v[80:81]
    v_mov_b64 v[66:67], v[82:83]
    v_mov_b64 v[68:69], v[84:85]
    v_mov_b64 v[70:71], v[86:87]
    buffer_load_dwordx4 v[48:51], v0, s[4:7], s19 offen offset:1024 sc1
    buffer_load_dword v9, v8, s[4:7], s19 offen offset:3584 sc1
    ds_read_b128 v[40:43], v1 offset:0
    ds_read_b128 v[44:47], v1 offset:1024
    ds_read_b128 v[80:83], v1 offset:2048
    ds_read_b128 v[84:87], v1 offset:3072
    ds_read_b128 v[88:91], v1 offset:4096
    ds_read_b128 v[92:95], v1 offset:5120
    ds_read_b128 v[72:75], v1 offset:6144
    ds_read_b128 v[76:79], v1 offset:7168
    v_mov_b64 v[32:33], 0
    v_mov_b64 v[34:35], 0
    v_mov_b64 v[36:37], 0
    v_mov_b64 v[38:39], 0
    v_mov_b64 v[16:17], 0
    v_mov_b64 v[18:19], 0
    v_mov_b64 v[20:21], 0
    v_mov_b64 v[22:23], 0
    v_mov_b64 v[24:25], 0
    v_mov_b64 v[26:27], 0
    v_mov_b64 v[28:29], 0
    v_mov_b64 v[30:31], 0
    buffer_load_dwordx4 v[48:51], v0, s[4:7], s19 offen offset:1024 sc1
    buffer_load_dword v9, v8, s[4:7], s19 offen offset:3584 sc1
    s_waitcnt lgkmcnt(0)
Lc2_pb:
    s_waitcnt vmcnt(3)
    v_max3_u32 v11, v48, v49, v50
    s_waitcnt vmcnt(2)
    v_max3_u32 v11, v11, v51, v9
    v_cmp_eq_u32 vcc, -1, v11
    ds_write_b128 v0, v[48:51] offset:2048
    ds_write_b32 v8, v9 offset:4608
    s_cbranch_vccnz Lc2_pc
Lc2_pcd:
    v_smfmac_f32_16x16x64_bf16 v[16:19], v[48:51], v[40:47], v2
    buffer_load_dwordx4 v[12:15], v0, s[4:7], s21 offen offset:1024 sc1
    v_smfmac_f32_16x16x64_bf16 v[20:23], v[48:51], v[80:87], v2
    buffer_load_dword v11, v8, s[4:7], s21 offen offset:3584 sc1
    v_smfmac_f32_16x16x64_bf16 v[24:27], v[48:51], v[88:95], v2
    s_waitcnt lgkmcnt(0)
    s_barrier
    ds_read_b128 v[40:43], v0 offset:3072
    v_smfmac_f32_16x16x64_bf16 v[28:31], v[48:51], v[72:79], v2
    ds_read_b128 v[44:47], v0 offset:0
    ds_read_b128 v[80:83], v1 offset:8192
    v_smfmac_f32_16x16x64_bf16 v[32:35], v[48:51], v[96:103], v2
    ds_read_b128 v[84:87], v1 offset:9216
    ds_read_b128 v[88:91], v1 offset:10240
    v_smfmac_f32_16x16x64_bf16 v[36:39], v[48:51], v[104:111], v2
    ds_read_b128 v[92:95], v1 offset:11264
Lc2_pad:
    s_waitcnt lgkmcnt(5)
    v_smfmac_f32_16x16x64_bf16 v[16:19], v[40:43], v[112:119], v2
    ds_read_b128 v[72:75], v1 offset:12288
    v_smfmac_f32_16x16x64_bf16 v[20:23], v[40:43], v[120:127], v2
    s_waitcnt lgkmcnt(3)
    s_add_u32 s19, s19, 16384
    ds_read_b128 v[76:79], v1 offset:13312
    v_smfmac_f32_16x16x64_bf16 v[24:27], v[40:43], v[80:87], v2
    ds_read_b128 v[80:83], v1 offset:14336
    v_smfmac_f32_16x16x64_bf16 v[28:31], v[40:43], v[128:135], v2
    s_waitcnt lgkmcnt(3)
    s_bitset0_b32 s19, 16
    ds_read_b128 v[84:87], v1 offset:15360
    v_smfmac_f32_16x16x64_bf16 v[32:35], v[40:43], v[88:95], v2
    ds_read_b128 v[88:91], v1 offset:16384
    v_smfmac_f32_16x16x64_bf16 v[36:39], v[40:43], v[136:143], v2
    s_waitcnt lgkmcnt(3)
    s_add_u32 s20, s20, 16384
    ds_read_b128 v[92:95], v1 offset:17408
    v_smfmac_f32_16x16x64_bf16 v[16:19], v[44:47], v[72:79], v2
    ds_read_b128 v[40:43], v0 offset:1024
    v_smfmac_f32_16x16x64_bf16 v[20:23], v[44:47], v[144:151], v2
    s_waitcnt lgkmcnt(3)
    s_bitset0_b32 s20, 16
    ds_read_b128 v[72:75], v1 offset:18432
    v_smfmac_f32_16x16x64_bf16 v[24:27], v[44:47], v[80:87], v2
    ds_read_b128 v[76:79], v1 offset:19456
    v_smfmac_f32_16x16x64_bf16 v[28:31], v[44:47], v[152:159], v2
    s_waitcnt lgkmcnt(3)
    s_add_u32 s24, s24, 16384
    ds_read_b128 v[80:83], v1 offset:20480
    v_smfmac_f32_16x16x64_bf16 v[32:35], v[44:47], v[88:95], v2
    ds_read_b128 v[84:87], v1 offset:21504
    v_smfmac_f32_16x16x64_bf16 v[36:39], v[44:47], v[160:167], v2
    s_waitcnt lgkmcnt(4)
    s_bitset0_b32 s24, 16
    ds_read_b128 v[44:47], v0 offset:4096
    v_smfmac_f32_16x16x64_bf16 v[16:19], v[40:43], v[168:175], v2
    s_waitcnt vmcnt(2)
    ds_read_b128 v[48:51], v1 offset:22528
    s_waitcnt lgkmcnt(4)
    v_smfmac_f32_16x16x64_bf16 v[20:23], v[40:43], v[72:79], v2
    ds_read_b128 v[52:55], v1 offset:23552
    v_smfmac_f32_16x16x64_bf16 v[24:27], v[40:43], v[176:183], v2
    s_xor_b32 s25, s24, 32768
    s_waitcnt lgkmcnt(3)
    v_smfmac_f32_16x16x64_bf16 v[28:31], v[40:43], v[80:87], v2
    v_smfmac_f32_16x16x64_bf16 v[32:35], v[40:43], v[184:191], v2
    s_xor_b32 s26, s20, 32768
    v_smfmac_f32_16x16x64_bf16 v[36:39], v[40:43], v[192:199], v2
    s_waitcnt lgkmcnt(0)
    v_smfmac_f32_16x16x64_bf16 v[16:19], v[44:47], v[48:55], v2
    v_smfmac_f32_16x16x64_bf16 v[20:23], v[44:47], v[200:207], v2
    v_smfmac_f32_16x16x64_bf16 v[24:27], v[44:47], v[208:215], v2
    v_smfmac_f32_16x16x64_bf16 v[28:31], v[44:47], v[216:223], v2
    s_waitcnt vmcnt(1)
    ds_write_b128 v0, v[12:15] offset:7168
    v_max3_u32 v9, v12, v13, v14
    s_waitcnt vmcnt(0)
    v_max3_u32 v9, v9, v15, v11
    v_cmp_eq_u32 vcc, -1, v9
    v_smfmac_f32_16x16x64_bf16 v[32:35], v[44:47], v[224:231], v2
    ds_write_b32 v8, v11 offset:9728
    v_smfmac_f32_16x16x64_bf16 v[36:39], v[44:47], v[232:239], v2
    s_cbranch_vccnz Lc2_rr
Lc2_rrd:
    v_smfmac_f32_16x16x64_bf16 v[16:19], v[12:15], v[240:247], v2
    s_add_u32 s21, s21, 16384
    s_bitset0_b32 s21, 16
    v_smfmac_f32_16x16x64_bf16 v[20:23], v[12:15], v[248:255], v2
    v_mov_b32 v10, -1
    v_smfmac_f32_16x16x64_bf16 v[24:27], v[12:15], a[0:7], v2
    s_waitcnt lgkmcnt(0)
    s_barrier
    ds_read_b128 v[40:43], v0 offset:8192
    v_smfmac_f32_16x16x64_bf16 v[28:31], v[12:15], a[8:15], v2
    ds_read_b128 v[44:47], v0 offset:5120
    v_smfmac_f32_16x16x64_bf16 v[32:35], v[12:15], a[16:23], v2
    ds_read_b128 v[88:91], v0 offset:6144
    v_smfmac_f32_16x16x64_bf16 v[36:39], v[12:15], a[24:31], v2
    ds_read_b128 v[92:95], v0 offset:9216
    s_waitcnt lgkmcnt(3)
    v_smfmac_f32_16x16x64_bf16 v[16:19], v[40:43], a[32:39], v2
    buffer_load_dwordx4 v[72:75], v0, s[4:7], s22 offen offset:0 sc1
    v_mov_b32 v12, 0x3f803f80
    v_smfmac_f32_16x16x64_bf16 v[20:23], v[40:43], a[40:47], v2
    s_waitcnt lgkmcnt(2)
    v_mov_b32 v13, 0x3f803f80
    v_smfmac_f32_16x16x64_bf16 v[16:19], v[44:47], a[48:55], v2
    buffer_store_dword v10, v7, s[4:7], s26 offen
    v_mov_b32 v14, 0x3f803f80
    v_smfmac_f32_16x16x64_bf16 v[20:23], v[44:47], a[56:63], v2
    s_waitcnt lgkmcnt(1)
    v_mov_b32 v15, 0x3f803f80
    v_smfmac_f32_16x16x64_bf16 v[16:19], v[88:91], a[64:71], v2
    buffer_load_dwordx4 v[76:79], v0, s[4:7], s22 offen offset:1024 sc1
    v_smfmac_f32_16x16x64_bf16 v[20:23], v[88:91], a[72:79], v2
    s_waitcnt lgkmcnt(0)
    v_smfmac_f32_16x16x64_bf16 v[16:19], v[92:95], a[80:87], v2
    s_nop 1
    buffer_store_dword v10, v7, s[4:7], s25 offen sc1
    v_smfmac_f32_16x16x64_bf16 v[20:23], v[92:95], a[88:95], v2
    s_nop 0
    ds_read_b128 v[48:51], v1 offset:24576
    v_smfmac_f32_16x16x64_bf16 v[24:27], v[40:43], a[96:103], v2
    ds_read_b128 v[52:55], v1 offset:25600
    v_add_f32 v16, v16, v17
    v_add_f32 v18, v18, v19
    v_smfmac_f32_16x16x64_bf16 v[28:31], v[40:43], a[104:111], v2
    buffer_load_dwordx4 v[80:83], v0, s[4:7], s32 offen offset:0 sc1
    v_cvt_pk_bf16_f32 v16, v16, v18
    v_add_f32 v20, v20, v21
    v_smfmac_f32_16x16x64_bf16 v[24:27], v[44:47], a[112:119], v2
    v_add_f32 v22, v22, v23
    v_cvt_pk_bf16_f32 v17, v20, v22
    v_smfmac_f32_16x16x64_bf16 v[28:31], v[44:47], a[120:127], v2
    ds_write_b64 v3, v[16:17] offset:11264
    v_smfmac_f32_16x16x64_bf16 v[24:27], v[88:91], a[128:135], v2
    buffer_load_dwordx4 v[84:87], v0, s[4:7], s32 offen offset:1024 sc1
    v_smfmac_f32_16x16x64_bf16 v[28:31], v[88:91], a[136:143], v2
    v_smfmac_f32_16x16x64_bf16 v[24:27], v[92:95], a[144:151], v2
    v_smfmac_f32_16x16x64_bf16 v[28:31], v[92:95], a[152:159], v2
    s_waitcnt lgkmcnt(0)
    s_barrier
    ds_read_b64_tr_b16 v[16:17], v4 offset:10240
    v_smfmac_f32_16x16x64_bf16 v[32:35], v[40:43], v[48:55], v2
    ds_read_b64_tr_b16 v[18:19], v4 offset:10752
    ds_read_b64_tr_b16 v[20:21], v4 offset:11264
    ds_read_b64_tr_b16 v[22:23], v4 offset:11776
    v_add_f32 v24, v24, v25
    v_add_f32 v26, v26, v27
    v_cvt_pk_bf16_f32 v24, v24, v26
    v_add_f32 v28, v28, v29
    v_add_f32 v30, v30, v31
    v_cvt_pk_bf16_f32 v25, v28, v30
    v_smfmac_f32_16x16x64_bf16 v[36:39], v[40:43], a[160:167], v2
    ds_write_b64 v3, v[24:25] offset:13312
    s_waitcnt lgkmcnt(3)
    v_mfma_f32_16x16x32_bf16 v[48:51], v[56:59], v[16:19], 0
    s_waitcnt lgkmcnt(1)
    v_mfma_f32_16x16x32_bf16 v[48:51], v[60:63], v[20:23], v[48:51]
    v_smfmac_f32_16x16x64_bf16 v[32:35], v[44:47], a[168:175], v2
    s_waitcnt lgkmcnt(0)
    s_barrier
    ds_read_b64_tr_b16 v[24:25], v4 offset:12288
    v_smfmac_f32_16x16x64_bf16 v[36:39], v[44:47], a[176:183], v2
    ds_read_b64_tr_b16 v[26:27], v4 offset:12800
    ds_read_b64_tr_b16 v[28:29], v4 offset:13312
    ds_read_b64_tr_b16 v[30:31], v4 offset:13824
    v_add_f32_dpp v48, v50, v48 quad_perm:[2,3,0,1] row_mask:0xf bank_mask:0xf
    v_add_f32_dpp v49, v51, v49 quad_perm:[2,3,0,1] row_mask:0xf bank_mask:0xf
    v_exp_f32 v50, v48
    v_exp_f32 v51, v49
    s_nop 0
    v_cvt_pk_bf16_f32 v50, v50, v51
    ds_write_b32 v0, v50 offset:14344
    s_waitcnt lgkmcnt(3)
    v_mfma_f32_16x16x32_bf16 v[52:55], v[24:27], v[16:19], 0
    ds_read_b128 v[56:59], v1 offset:26624
    s_waitcnt lgkmcnt(2)
    v_mfma_f32_16x16x32_bf16 v[52:55], v[28:31], v[20:23], v[52:55]
    s_nop 1
    ds_read_b128 v[60:63], v1 offset:27648
    v_smfmac_f32_16x16x64_bf16 v[32:35], v[88:91], a[184:191], v2
    s_waitcnt lgkmcnt(2)
    s_barrier
    ds_read_b128 v[16:19], v5 offset:14336
    v_smfmac_f32_16x16x64_bf16 v[36:39], v[88:91], a[192:199], v2
    v_add_f32_dpp v52, v54, v52 quad_perm:[2,3,0,1] row_mask:0xf bank_mask:0xf
    v_add_f32_dpp v53, v55, v53 quad_perm:[2,3,0,1] row_mask:0xf bank_mask:0xf
    v_smfmac_f32_16x16x64_bf16 v[32:35], v[92:95], a[200:207], v2
    v_mul_f32 v50, s28, v52
    v_mul_f32 v51, s28, v53
    v_smfmac_f32_16x16x64_bf16 v[36:39], v[92:95], a[208:215], v2
    v_exp_f32_dpp v52, v50 quad_perm:[0,1,0,1] row_mask:0xf bank_mask:0xf
    v_exp_f32_dpp v53, v51 quad_perm:[0,1,0,1] row_mask:0xf bank_mask:0xf
    s_waitcnt lgkmcnt(0)
    v_mfma_f32_16x16x32_bf16 v[28:31], v[12:15], v[16:19], 0
    v_mov_b32 v21, 0
    v_cvt_pk_bf16_f32 v20, v52, v53
    v_mfma_f32_16x16x32_bf16 v[40:43], v[64:67], v[16:19], 0
    v_add_f32 v32, v32, v33
    v_add_f32 v34, v34, v35
    v_cvt_pk_bf16_f32 v10, v32, v34
    v_mfma_f32_16x16x32_bf16 v[44:47], v[68:71], v[16:19], 0
    v_add_f32 v36, v36, v37
    v_add_f32 v38, v38, v39
    v_cvt_pk_bf16_f32 v11, v36, v38
    v_mfma_f32_16x16x16_bf16 v[28:31], v[12:13], v[20:21], v[28:31]
    v_mov_b32 v22, 0
    v_cvt_pk_bf16_f32 v23, v52, v53
    v_mfma_f32_16x16x16_bf16 v[40:43], v[10:11], v[20:21], v[40:43]
    v_mov_b64 v[32:33], 0
    v_mov_b64 v[34:35], 0
    v_mfma_f32_16x16x16_bf16 v[44:47], v[10:11], v[22:23], v[44:47]
    v_mov_b64 v[36:37], 0
    v_mov_b64 v[38:39], 0
    v_rcp_f32 v29, v28
    v_subrev_u32 v30, s29, v28
    v_cmp_le_u32 vcc, s30, v30
    v_mul_f32 v40, v29, v40
    v_mul_f32 v41, v29, v41
    v_mul_f32 v42, v29, v42
    v_mul_f32 v43, v29, v43
    v_cvt_pk_bf16_f32 v52, v40, v41
    v_cvt_pk_bf16_f32 v53, v42, v43
    v_mul_f32 v44, v29, v44
    v_mul_f32 v45, v29, v45
    v_mul_f32 v46, v29, v46
    v_mul_f32 v47, v29, v47
    v_cvt_pk_bf16_f32 v54, v44, v45
    v_cvt_pk_bf16_f32 v55, v46, v47
    ds_write_b128 v0, v[52:55] offset:12288
    s_cbranch_vccnz Lc2_fb
Lc2_fbd:
    v_smfmac_f32_16x16x64_bf16 v[32:35], v[52:55], v[56:63], v2 abid:1
    s_cmp_eq_u32 s14, s31
    s_mov_b64 exec, s[36:37]
    buffer_store_dwordx2 v[10:11], v3, s[4:7], s23 offen offset:3072 sc1
    s_mov_b64 exec, -1
    s_mov_b64 exec, s[36:37]
    buffer_store_dwordx4 v[24:27], v0, s[4:7], s23 offen offset:0 sc1
    s_mov_b64 exec, -1
    ds_read_b128 v[88:91], v1 offset:28672
    ds_read_b128 v[92:95], v1 offset:29696
    s_waitcnt lgkmcnt(2)
    s_barrier
    ds_read_b128 v[16:19], v0 offset:13312
    v_smfmac_f32_16x16x64_bf16 v[36:39], v[52:55], a[216:223], v2 abid:1
    ds_read_b128 v[20:23], v0 offset:10240
    ds_read_b128 v[24:27], v0 offset:11264
    v_mov_b32 v1, v1
    s_cbranch_scc1 Lc2_exit
    v_mov_b32 v1, v1
    s_add_u32 s25, s16, 65536
    s_add_u32 s26, s16, 131072
    v_mov_b32 v1, v1
    s_waitcnt lgkmcnt(2)
    v_smfmac_f32_16x16x64_bf16 v[32:35], v[16:19], v[88:95], v2 abid:1
    ds_read_b128 v[64:67], v1 offset:30720
    s_waitcnt lgkmcnt(2)
    v_smfmac_f32_16x16x64_bf16 v[32:35], v[20:23], a[224:231], v2 abid:1
    ds_read_b128 v[68:71], v1 offset:31744
    s_waitcnt lgkmcnt(2)
    v_smfmac_f32_16x16x64_bf16 v[32:35], v[24:27], a[232:239], v2 abid:1
    s_nop 2
    v_smfmac_f32_16x16x64_bf16 v[36:39], v[16:19], a[240:247], v2 abid:1
    s_nop 2
    v_smfmac_f32_16x16x64_bf16 v[36:39], v[20:23], a[248:255], v2 abid:1
    s_waitcnt lgkmcnt(0)
    v_cvt_pk_bf16_f32 v32, v32, v33
    v_smfmac_f32_16x16x64_bf16 v[36:39], v[24:27], v[64:71], v2 abid:1
    s_nop 1
    v_and_or_b32 v32, v32, -2, s18
    v_cvt_pk_bf16_f32 v33, v34, v35
    buffer_store_dwordx2 v[32:33], v6, s[4:7], s16 offen
    s_nop 2
    v_cvt_pk_bf16_f32 v36, v36, v37
    v_and_or_b32 v36, v36, -2, s18
    v_cvt_pk_bf16_f32 v37, v38, v39
    buffer_store_dwordx2 v[36:37], v6, s[4:7], s25 offen
    s_add_u32 s99, s99, 262144
    s_lshr_b32 s23, s99, 8
    s_and_b32 s23, s23, 0x2000
    s_xor_b32 s23, s99, s23
    s_add_u32 s14, s14, 1
    s_add_u32 s98, s98, 1048576
    s_lshr_b32 s22, s98, 8
    s_and_b32 s22, s22, 0x2000
    s_xor_b32 s22, s98, s22
    s_add_u32 s32, s22, 16384
    v_mov_b32 v52, 0x3f80
    v_cndmask_b32 v52, v52, 1.0, s[46:47]
    v_cndmask_b32 v48, 0, v52, s[38:39]
    v_cndmask_b32 v49, 0, v52, s[40:41]
    v_cndmask_b32 v50, 0, v52, s[42:43]
    v_cndmask_b32 v51, 0, v52, s[44:45]
    s_waitcnt vmcnt(0)
    buffer_load_dwordx4 v[16:19], v0, s[4:7], s17 offen offset:0 sc1
    buffer_load_dwordx4 v[20:23], v0, s[4:7], s17 offen offset:1024 sc1
    buffer_load_dwordx4 v[24:27], v0, s[4:7], s17 offen offset:2048 sc1
    buffer_load_dwordx4 v[28:31], v0, s[4:7], s17 offen offset:3072 sc1
    ds_read_b128 v[12:15], v0
    s_waitcnt lgkmcnt(0)
    buffer_load_dwordx4 v[56:59], v0, s[4:7], s17 offen offset:0 sc1
    buffer_load_dwordx4 v[60:63], v0, s[4:7], s17 offen offset:1024 sc1
    buffer_load_dwordx4 v[64:67], v0, s[4:7], s17 offen offset:2048 sc1
    buffer_load_dwordx4 v[68:71], v0, s[4:7], s17 offen offset:3072 sc1
    s_waitcnt vmcnt(7)
    v_mfma_f32_16x16x32_bf16 v[52:55], v[48:51], v[16:19], 0
    v_bitop3_b32 v17, v16, v18, s18 bitop3:0x7e
    s_waitcnt vmcnt(6)
    v_mfma_f32_16x16x32_bf16 v[52:55], v[48:51], v[20:23], v[52:55]
    v_bitop3_b32 v21, v20, v22, s18 bitop3:0x7e
    s_waitcnt vmcnt(5)
    v_mfma_f32_16x16x32_bf16 v[52:55], v[48:51], v[24:27], v[52:55]
    v_bitop3_b32 v25, v24, v26, s18 bitop3:0x7e
    v_or3_b32 v17, v17, v21, v25
    v_and_b32 v17, 1, v17
    s_waitcnt vmcnt(4)
    v_mfma_f32_16x16x32_bf16 v[52:55], v[48:51], v[28:31], v[52:55]
    s_nop 0
    v_bitop3_b32 v29, v28, v30, s18 bitop3:0x7e
    v_and_or_b32 v17, v29, 1, v17
    v_cmp_ne_u32 vcc, 0, v17
    s_nop 1
    v_mov_b32 v1, v1
    s_nop 0
    v_add_f32_dpp v54, v52, v52 row_ror:8 row_mask:0xf bank_mask:0xf
    v_add_f32_dpp v55, v53, v53 row_ror:8 row_mask:0xf bank_mask:0xf
    v_cvt_pk_bf16_f32 v11, v54, v55
    s_cbranch_vccnz Lc2_r1
Lc2_r1d:
    buffer_store_dword v11, v7, s[4:7], s20 offen
    buffer_store_dword v11, v7, s[4:7], s24 offen sc1
    v_mov_b64 v[48:49], -1
    v_mov_b64 v[50:51], -1
    v_mov_b32 v9, -1
    s_xor_b32 s18, s18, 1
    s_waitcnt vmcnt(2)
    s_barrier
    s_branch Lc2_top
Lc2_exit:
    s_waitcnt vmcnt(0) lgkmcnt(0)
    s_barrier
    s_waitcnt vmcnt(0) lgkmcnt(0)
    s_nop 11
    s_endpgm
Lc2_pc:
    buffer_load_dwordx4 v[48:51], v0, s[4:7], s19 offen offset:1024 sc1
    buffer_load_dword v9, v8, s[4:7], s19 offen offset:3584 sc1
    s_sub_u32 s15, s15, 1
    s_cbranch_scc0 Lc2_pb
    s_mov_b32 s15, 0
    s_branch Lc2_pcd
Lc2_rr:
    buffer_load_dwordx4 v[12:15], v0, s[4:7], s21 offen offset:1024 sc1
    buffer_load_dword v11, v8, s[4:7], s21 offen offset:3584 sc1
    s_waitcnt vmcnt(1)
    ds_write_b128 v0, v[12:15] offset:7168
    s_waitcnt vmcnt(0)
    ds_write_b32 v8, v11 offset:9728
    v_max3_u32 v9, v12, v13, v14
    v_max3_u32 v9, v9, v15, v11
    v_cmp_eq_u32 vcc, -1, v9
    s_waitcnt lgkmcnt(0)
    s_cbranch_vccz Lc2_rrd
    s_sub_u32 s15, s15, 1
    s_cbranch_scc0 Lc2_rr
    s_mov_b32 s15, 0
    s_branch Lc2_rrd
Lc2_fb:
    s_waitcnt lgkmcnt(0)
    s_nop 11
    s_barrier
    v_max_f32 v16, v48, v49
    v_max3_f32 v16, v16, v50, v51
    ds_write_b32 v0, v16 offset:8
    s_waitcnt lgkmcnt(0)
    s_barrier
    v_and_b32 v40, 0xff, v0
    ds_read_b128 v[16:19], v40 offset:0
    ds_read_b128 v[20:23], v40 offset:256
    ds_read_b128 v[88:91], v40 offset:512
    ds_read_b128 v[92:95], v40 offset:768
    s_waitcnt lgkmcnt(3)
    v_max_f32 v40, v16, v17
    v_max3_f32 v40, v40, v18, v19
    s_waitcnt lgkmcnt(2)
    v_max3_f32 v40, v40, v20, v21
    v_max3_f32 v40, v40, v22, v23
    s_waitcnt lgkmcnt(1)
    v_max3_f32 v40, v40, v88, v89
    v_max3_f32 v40, v40, v90, v91
    s_waitcnt lgkmcnt(0)
    v_max3_f32 v40, v40, v92, v93
    v_max3_f32 v40, v40, v94, v95
    v_sub_f32 v48, v48, v40
    v_sub_f32 v49, v49, v40
    v_sub_f32 v50, v50, v40
    v_sub_f32 v51, v51, v40
    v_exp_f32 v40, v48
    v_exp_f32 v41, v49
    s_nop 0
    v_cvt_pk_bf16_f32 v40, v40, v41
    ds_write_b32 v0, v40 offset:14344
    v_mov_b32 v21, 0
    v_exp_f32_dpp v52, v50 quad_perm:[0,1,0,1] row_mask:0xf bank_mask:0xf
    v_exp_f32_dpp v53, v51 quad_perm:[0,1,0,1] row_mask:0xf bank_mask:0xf
    v_mov_b32 v22, 0
    v_cvt_pk_bf16_f32 v20, v52, v53
    v_cvt_pk_bf16_f32 v23, v52, v53
    s_waitcnt lgkmcnt(0)
    s_barrier
    ds_read_b128 v[16:19], v5 offset:14336
    s_waitcnt lgkmcnt(0)
    v_mfma_f32_16x16x32_bf16 v[28:31], v[12:15], v[16:19], 0
    s_nop 2
    v_mfma_f32_16x16x32_bf16 v[40:43], v[64:67], v[16:19], 0
    s_nop 1
    s_nop 0
    v_mfma_f32_16x16x32_bf16 v[44:47], v[68:71], v[16:19], 0
    s_nop 1
    s_nop 0
    v_mfma_f32_16x16x16_bf16 v[28:31], v[12:13], v[20:21], v[28:31]
    s_nop 1
    s_nop 0
    v_mfma_f32_16x16x16_bf16 v[40:43], v[10:11], v[20:21], v[40:43]
    s_nop 2
    v_mfma_f32_16x16x16_bf16 v[44:47], v[10:11], v[22:23], v[44:47]
    s_nop 0
    v_rcp_f32 v29, v28
    s_nop 1
    v_mul_f32 v40, v29, v40
    v_mul_f32 v41, v29, v41
    v_mul_f32 v42, v29, v42
    v_mul_f32 v43, v29, v43
    v_cvt_pk_bf16_f32 v52, v40, v41
    v_cvt_pk_bf16_f32 v53, v42, v43
    v_mul_f32 v44, v29, v44
    v_mul_f32 v45, v29, v45
    v_mul_f32 v46, v29, v46
    v_mul_f32 v47, v29, v47
    v_cvt_pk_bf16_f32 v54, v44, v45
    v_cvt_pk_bf16_f32 v55, v46, v47
    ds_write_b128 v0, v[52:55] offset:12288
    s_waitcnt lgkmcnt(0)
    s_nop 11
    s_branch Lc2_fbd
Lc2_r1:
    buffer_load_dwordx4 v[16:19], v0, s[4:7], s17 offen offset:0 sc1
    buffer_load_dwordx4 v[20:23], v0, s[4:7], s17 offen offset:1024 sc1
    buffer_load_dwordx4 v[24:27], v0, s[4:7], s17 offen offset:2048 sc1
    buffer_load_dwordx4 v[28:31], v0, s[4:7], s17 offen offset:3072 sc1
    s_waitcnt vmcnt(7)
    v_mfma_f32_16x16x32_bf16 v[52:55], v[48:51], v[56:59], 0
    v_bitop3_b32 v57, v56, v58, s18 bitop3:0x7e
    s_waitcnt vmcnt(6)
    v_mfma_f32_16x16x32_bf16 v[52:55], v[48:51], v[60:63], v[52:55]
    v_bitop3_b32 v61, v60, v62, s18 bitop3:0x7e
    s_waitcnt vmcnt(5)
    v_mfma_f32_16x16x32_bf16 v[52:55], v[48:51], v[64:67], v[52:55]
    v_bitop3_b32 v65, v64, v66, s18 bitop3:0x7e
    v_or3_b32 v57, v57, v61, v65
    v_and_b32 v57, 1, v57
    s_waitcnt vmcnt(4)
    v_mfma_f32_16x16x32_bf16 v[52:55], v[48:51], v[68:71], v[52:55]
    s_nop 0
    v_bitop3_b32 v69, v68, v70, s18 bitop3:0x7e
    v_and_or_b32 v57, v69, 1, v57
    v_cmp_ne_u32 vcc, 0, v57
    s_nop 3
    v_add_f32_dpp v54, v52, v52 row_ror:8 row_mask:0xf bank_mask:0xf
    v_add_f32_dpp v55, v53, v53 row_ror:8 row_mask:0xf bank_mask:0xf
    v_cvt_pk_bf16_f32 v11, v54, v55
    s_cbranch_vccz Lc2_r1d
    buffer_load_dwordx4 v[56:59], v0, s[4:7], s17 offen offset:0 sc1
    buffer_load_dwordx4 v[60:63], v0, s[4:7], s17 offen offset:1024 sc1
    buffer_load_dwordx4 v[64:67], v0, s[4:7], s17 offen offset:2048 sc1
    buffer_load_dwordx4 v[68:71], v0, s[4:7], s17 offen offset:3072 sc1
    s_waitcnt vmcnt(7)
    v_mfma_f32_16x16x32_bf16 v[52:55], v[48:51], v[16:19], 0
    v_bitop3_b32 v17, v16, v18, s18 bitop3:0x7e
    s_waitcnt vmcnt(6)
    v_mfma_f32_16x16x32_bf16 v[52:55], v[48:51], v[20:23], v[52:55]
    v_bitop3_b32 v21, v20, v22, s18 bitop3:0x7e
    s_waitcnt vmcnt(5)
    v_mfma_f32_16x16x32_bf16 v[52:55], v[48:51], v[24:27], v[52:55]
    v_bitop3_b32 v25, v24, v26, s18 bitop3:0x7e
    v_or3_b32 v17, v17, v21, v25
    v_and_b32 v17, 1, v17
    s_waitcnt vmcnt(4)
    v_mfma_f32_16x16x32_bf16 v[52:55], v[48:51], v[28:31], v[52:55]
    s_nop 0
    v_bitop3_b32 v29, v28, v30, s18 bitop3:0x7e
    v_and_or_b32 v17, v29, 1, v17
    v_cmp_ne_u32 vcc, 0, v17
    s_nop 3
    v_add_f32_dpp v54, v52, v52 row_ror:8 row_mask:0xf bank_mask:0xf
    v_add_f32_dpp v55, v53, v53 row_ror:8 row_mask:0xf bank_mask:0xf
    v_cvt_pk_bf16_f32 v11, v54, v55
    s_cbranch_vccz Lc2_r1d
    s_sub_u32 s15, s15, 1
    s_cbranch_scc0 Lc2_r1
    s_mov_b32 s15, 0
    s_branch Lc2_r1d
Lcw3:
    v_lshrrev_b32 v16, 4, v0
    v_and_b32 v17, 15, v0
    v_lshlrev_b32 v18, 13, v16
    v_lshl_add_u32 v2, v17, 4, v18
    v_mul_u32_u24 v18, 1280, v16
    v_lshl_add_u32 v3, v17, 4, v18
    v_lshrrev_b32 v18, 3, v0
    v_mul_u32_u24 v18, 1280, v18
    v_and_b32 v19, 7, v0
    v_lshl_add_u32 v4, v19, 4, v18
    v_lshlrev_b32 v10, 4, v0
    v_add_u32 v1, 131072, v10
    v_and_b32 v18, 1, v16
    v_lshlrev_b32 v19, 5, v18
    v_xor_b32 v5, v10, v19
    v_xor_b32 v6, 64, v5
    v_xor_b32 v7, 0x80, v5
    v_xor_b32 v8, 0xc0, v5
    v_lshlrev_b32 v19, 6, v18
    v_xor_b32 v9, v10, v19
    v_xor_b32 v9, 128, v9
    v_lshrrev_b32 v16, 5, v0
    v_bfe_u32 v17, v0, 4, 1
    v_bfe_u32 v18, v0, 3, 1
    v_bfe_u32 v19, v0, 2, 1
    v_and_b32 v20, 3, v0
    v_lshlrev_b32 v20, 3, v20
    v_lshl_add_u32 v11, v16, 12, v20
    v_lshl_add_u32 v11, v17, 10, v11
    v_lshl_add_u32 v11, v18, 11, v11
    v_lshl_add_u32 v11, v19, 8, v11
    v_lshl_add_u32 v11, v19, 5, v11
    v_lshl_add_u32 v11, v17, 6, v11
    v_lshl_add_u32 v11, v18, 7, v11
    v_xor_b32 v11, 192, v11
    v_xor_b32 v12, 32, v11
    v_lshl_add_u32 v20, v18, 5, v20
    v_lshlrev_b32 v18, 4, v17
    v_lshl_add_u32 v18, v16, 2, v18
    v_add_u32 v18, v18, v19
    v_lshl_add_u32 v14, v18, 7, v20
    v_lshl_add_u32 v13, v18, 8, v20
    v_lshl_add_u32 v13, v19, 6, v13
    v_lshl_add_u32 v13, v17, 7, v13
    v_xor_b32 v13, 192, v13
    s_load_dwordx2 s[52:53], s[0:1], 16
    s_load_dwordx2 s[56:57], s[0:1], 24
    s_load_dwordx2 s[60:61], s[0:1], 32
    s_load_dwordx2 s[64:65], s[0:1], 40
    s_waitcnt lgkmcnt(0)
    s_mov_b32 s54, 5242880
    s_mov_b32 s55, 0x20000
    s_mov_b32 s58, 5242880
    s_mov_b32 s59, 0x20000
    s_mov_b32 s62, 5242880
    s_mov_b32 s63, 0x20000
    s_mov_b32 s66, 5242880
    s_mov_b32 s67, 0x20000
    s_lshl_b32 s71, s12, 8
    s_mul_i32 s68, s3, 2621440
    s_sub_u32 s69, 2621440, s68
    s_add_u32 s68, s68, s71
    s_add_u32 s69, s69, s71
    s_mul_i32 s70, s12, 163840
    s_mul_i32 s71, s3, 640
    s_add_u32 s70, s70, s71
    s_add_u32 s71, s68, 393216
    buffer_load_dwordx4 v[168:171], v2, s[52:55], s71 offen
    s_add_u32 s71, s68, 425984
    buffer_load_dwordx4 v[172:175], v2, s[52:55], s71 offen
    s_add_u32 s71, s68, 458752
    buffer_load_dwordx4 v[16:19], v2, s[52:55], s71 offen
    s_add_u32 s71, s68, 491520
    buffer_load_dwordx4 v[20:23], v2, s[52:55], s71 offen
    s_add_u32 s71, s68, 393216
    buffer_load_dwordx4 v[176:179], v2, s[56:59], s71 offen
    s_add_u32 s71, s68, 425984
    buffer_load_dwordx4 v[180:183], v2, s[56:59], s71 offen
    s_add_u32 s71, s68, 458752
    buffer_load_dwordx4 v[24:27], v2, s[56:59], s71 offen
    s_add_u32 s71, s68, 491520
    buffer_load_dwordx4 v[28:31], v2, s[56:59], s71 offen
    s_add_u32 s71, s68, 393216
    buffer_load_dwordx4 v[184:187], v2, s[60:63], s71 offen
    s_add_u32 s71, s68, 425984
    buffer_load_dwordx4 v[188:191], v2, s[60:63], s71 offen
    s_add_u32 s71, s68, 458752
    buffer_load_dwordx4 v[192:195], v2, s[60:63], s71 offen
    s_add_u32 s71, s68, 491520
    buffer_load_dwordx4 v[196:199], v2, s[60:63], s71 offen
    s_add_u32 s71, s69, 393216
    buffer_load_dwordx4 a[64:67], v2, s[52:55], s71 offen
    s_add_u32 s71, s69, 425984
    buffer_load_dwordx4 a[68:71], v2, s[52:55], s71 offen
    s_add_u32 s71, s69, 458752
    buffer_load_dwordx4 a[72:75], v2, s[52:55], s71 offen
    s_add_u32 s71, s69, 491520
    buffer_load_dwordx4 a[76:79], v2, s[52:55], s71 offen
    s_add_u32 s71, s69, 393216
    buffer_load_dwordx4 a[128:131], v2, s[56:59], s71 offen
    s_add_u32 s71, s69, 425984
    buffer_load_dwordx4 a[132:135], v2, s[56:59], s71 offen
    s_add_u32 s71, s69, 458752
    buffer_load_dwordx4 a[136:139], v2, s[56:59], s71 offen
    s_add_u32 s71, s69, 491520
    buffer_load_dwordx4 a[140:143], v2, s[56:59], s71 offen
    s_add_u32 s71, s69, 393216
    buffer_load_dwordx4 a[184:187], v2, s[60:63], s71 offen
    s_add_u32 s71, s69, 425984
    buffer_load_dwordx4 a[188:191], v2, s[60:63], s71 offen
    s_add_u32 s71, s69, 458752
    buffer_load_dwordx4 a[192:195], v2, s[60:63], s71 offen
    s_add_u32 s71, s69, 491520
    buffer_load_dwordx4 a[196:199], v2, s[60:63], s71 offen
    s_waitcnt vmcnt(23)
    ds_write_b128 v5, v[168:171] offset:12288
    s_waitcnt vmcnt(22)
    ds_write_b128 v6, v[172:175] offset:13312
    s_waitcnt vmcnt(21)
    ds_write_b128 v7, v[16:19] offset:14336
    s_waitcnt vmcnt(20)
    ds_write_b128 v8, v[20:23] offset:15360
    s_waitcnt lgkmcnt(0)
    s_barrier
    ds_read_b64_tr_b16 v[168:169], v11 offset:0
    ds_read_b64_tr_b16 v[170:171], v11 offset:512
    ds_read_b64_tr_b16 v[172:173], v11 offset:8192
    ds_read_b64_tr_b16 v[174:175], v11 offset:8704
    ds_read_b64_tr_b16 v[16:17], v12 offset:0
    ds_read_b64_tr_b16 v[18:19], v12 offset:512
    ds_read_b64_tr_b16 v[20:21], v12 offset:8192
    ds_read_b64_tr_b16 v[22:23], v12 offset:8704
    s_waitcnt lgkmcnt(0)
    s_barrier
    ds_write_b128 v1, v[16:19] offset:18432
    ds_write_b128 v1, v[20:23] offset:19456
    s_add_u32 s71, s68, 917504
    buffer_load_dwordx4 v[32:35], v2, s[52:55], s71 offen
    s_add_u32 s71, s68, 950272
    buffer_load_dwordx4 v[36:39], v2, s[52:55], s71 offen
    s_add_u32 s71, s68, 983040
    buffer_load_dwordx4 v[144:147], v2, s[52:55], s71 offen
    s_add_u32 s71, s68, 1015808
    buffer_load_dwordx4 v[148:151], v2, s[52:55], s71 offen
    s_waitcnt vmcnt(23)
    ds_write_b128 v5, v[176:179] offset:12288
    s_waitcnt vmcnt(22)
    ds_write_b128 v6, v[180:183] offset:13312
    s_waitcnt vmcnt(21)
    ds_write_b128 v7, v[24:27] offset:14336
    s_waitcnt vmcnt(20)
    ds_write_b128 v8, v[28:31] offset:15360
    s_waitcnt lgkmcnt(0)
    s_barrier
    ds_read_b64_tr_b16 v[176:177], v11 offset:0
    ds_read_b64_tr_b16 v[178:179], v11 offset:512
    ds_read_b64_tr_b16 v[180:181], v11 offset:8192
    ds_read_b64_tr_b16 v[182:183], v11 offset:8704
    ds_read_b64_tr_b16 v[24:25], v12 offset:0
    ds_read_b64_tr_b16 v[26:27], v12 offset:512
    ds_read_b64_tr_b16 v[28:29], v12 offset:8192
    ds_read_b64_tr_b16 v[30:31], v12 offset:8704
    s_waitcnt lgkmcnt(0)
    s_barrier
    ds_write_b128 v1, v[24:27] offset:20480
    ds_write_b128 v1, v[28:31] offset:21504
    s_add_u32 s71, s68, 917504
    buffer_load_dwordx4 v[40:43], v2, s[56:59], s71 offen
    s_add_u32 s71, s68, 950272
    buffer_load_dwordx4 v[44:47], v2, s[56:59], s71 offen
    s_add_u32 s71, s68, 983040
    buffer_load_dwordx4 v[152:155], v2, s[56:59], s71 offen
    s_add_u32 s71, s68, 1015808
    buffer_load_dwordx4 v[156:159], v2, s[56:59], s71 offen
    s_waitcnt vmcnt(23)
    ds_write_b128 v5, v[184:187] offset:12288
    s_waitcnt vmcnt(22)
    ds_write_b128 v6, v[188:191] offset:13312
    s_waitcnt vmcnt(21)
    ds_write_b128 v7, v[192:195] offset:14336
    s_waitcnt vmcnt(20)
    ds_write_b128 v8, v[196:199] offset:15360
    s_waitcnt lgkmcnt(0)
    s_barrier
    ds_read_b64_tr_b16 v[184:185], v11 offset:0
    ds_read_b64_tr_b16 v[186:187], v11 offset:512
    ds_read_b64_tr_b16 v[188:189], v11 offset:8192
    ds_read_b64_tr_b16 v[190:191], v11 offset:8704
    ds_read_b64_tr_b16 v[192:193], v12 offset:0
    ds_read_b64_tr_b16 v[194:195], v12 offset:512
    ds_read_b64_tr_b16 v[196:197], v12 offset:8192
    ds_read_b64_tr_b16 v[198:199], v12 offset:8704
    s_waitcnt lgkmcnt(0)
    s_barrier
    s_add_u32 s71, s68, 917504
    buffer_load_dwordx4 v[48:51], v2, s[60:63], s71 offen
    s_add_u32 s71, s68, 950272
    buffer_load_dwordx4 v[52:55], v2, s[60:63], s71 offen
    s_add_u32 s71, s68, 983040
    buffer_load_dwordx4 v[160:163], v2, s[60:63], s71 offen
    s_add_u32 s71, s68, 1015808
    buffer_load_dwordx4 v[164:167], v2, s[60:63], s71 offen
    s_waitcnt vmcnt(23)
    ds_write_b128 v5, a[64:67] offset:12288
    s_waitcnt vmcnt(22)
    ds_write_b128 v6, a[68:71] offset:13312
    s_waitcnt vmcnt(21)
    ds_write_b128 v7, a[72:75] offset:14336
    s_waitcnt vmcnt(20)
    ds_write_b128 v8, a[76:79] offset:15360
    s_waitcnt lgkmcnt(0)
    s_barrier
    ds_read_b64_tr_b16 a[64:65], v11 offset:0
    ds_read_b64_tr_b16 a[66:67], v11 offset:512
    ds_read_b64_tr_b16 a[68:69], v11 offset:8192
    ds_read_b64_tr_b16 a[70:71], v11 offset:8704
    ds_read_b64_tr_b16 a[72:73], v12 offset:0
    ds_read_b64_tr_b16 a[74:75], v12 offset:512
    ds_read_b64_tr_b16 a[76:77], v12 offset:8192
    ds_read_b64_tr_b16 a[78:79], v12 offset:8704
    s_waitcnt lgkmcnt(0)
    s_barrier
    s_add_u32 s71, s69, 917504
    buffer_load_dwordx4 a[48:51], v2, s[52:55], s71 offen
    s_add_u32 s71, s69, 950272
    buffer_load_dwordx4 a[52:55], v2, s[52:55], s71 offen
    s_add_u32 s71, s69, 983040
    buffer_load_dwordx4 a[56:59], v2, s[52:55], s71 offen
    s_add_u32 s71, s69, 1015808
    buffer_load_dwordx4 a[60:63], v2, s[52:55], s71 offen
    s_waitcnt vmcnt(23)
    ds_write_b128 v5, a[128:131] offset:12288
    s_waitcnt vmcnt(22)
    ds_write_b128 v6, a[132:135] offset:13312
    s_waitcnt vmcnt(21)
    ds_write_b128 v7, a[136:139] offset:14336
    s_waitcnt vmcnt(20)
    ds_write_b128 v8, a[140:143] offset:15360
    s_waitcnt lgkmcnt(0)
    s_barrier
    ds_read_b64_tr_b16 a[128:129], v11 offset:0
    ds_read_b64_tr_b16 a[130:131], v11 offset:512
    ds_read_b64_tr_b16 a[132:133], v11 offset:8192
    ds_read_b64_tr_b16 a[134:135], v11 offset:8704
    ds_read_b64_tr_b16 a[136:137], v12 offset:0
    ds_read_b64_tr_b16 a[138:139], v12 offset:512
    ds_read_b64_tr_b16 a[140:141], v12 offset:8192
    ds_read_b64_tr_b16 a[142:143], v12 offset:8704
    s_waitcnt lgkmcnt(0)
    s_barrier
    s_add_u32 s71, s69, 917504
    buffer_load_dwordx4 a[112:115], v2, s[56:59], s71 offen
    s_add_u32 s71, s69, 950272
    buffer_load_dwordx4 a[116:119], v2, s[56:59], s71 offen
    s_add_u32 s71, s69, 983040
    buffer_load_dwordx4 a[120:123], v2, s[56:59], s71 offen
    s_add_u32 s71, s69, 1015808
    buffer_load_dwordx4 a[124:127], v2, s[56:59], s71 offen
    s_waitcnt vmcnt(23)
    ds_write_b128 v5, a[184:187] offset:12288
    s_waitcnt vmcnt(22)
    ds_write_b128 v6, a[188:191] offset:13312
    s_waitcnt vmcnt(21)
    ds_write_b128 v7, a[192:195] offset:14336
    s_waitcnt vmcnt(20)
    ds_write_b128 v8, a[196:199] offset:15360
    s_waitcnt lgkmcnt(0)
    s_barrier
    ds_read_b64_tr_b16 a[184:185], v11 offset:0
    ds_read_b64_tr_b16 a[186:187], v11 offset:512
    ds_read_b64_tr_b16 a[188:189], v11 offset:8192
    ds_read_b64_tr_b16 a[190:191], v11 offset:8704
    ds_read_b64_tr_b16 a[192:193], v12 offset:0
    ds_read_b64_tr_b16 a[194:195], v12 offset:512
    ds_read_b64_tr_b16 a[196:197], v12 offset:8192
    ds_read_b64_tr_b16 a[198:199], v12 offset:8704
    s_waitcnt lgkmcnt(0)
    s_barrier
    s_add_u32 s71, s69, 917504
    buffer_load_dwordx4 a[168:171], v2, s[60:63], s71 offen
    s_add_u32 s71, s69, 950272
    buffer_load_dwordx4 a[172:175], v2, s[60:63], s71 offen
    s_add_u32 s71, s69, 983040
    buffer_load_dwordx4 a[176:179], v2, s[60:63], s71 offen
    s_add_u32 s71, s69, 1015808
    buffer_load_dwordx4 a[180:183], v2, s[60:63], s71 offen
    s_waitcnt vmcnt(23)
    ds_write_b128 v5, v[32:35] offset:12288
    s_waitcnt vmcnt(22)
    ds_write_b128 v6, v[36:39] offset:13312
    s_waitcnt vmcnt(21)
    ds_write_b128 v7, v[144:147] offset:14336
    s_waitcnt vmcnt(20)
    ds_write_b128 v8, v[148:151] offset:15360
    s_waitcnt lgkmcnt(0)
    s_barrier
    ds_read_b64_tr_b16 v[32:33], v11 offset:0
    ds_read_b64_tr_b16 v[34:35], v11 offset:512
    ds_read_b64_tr_b16 v[36:37], v11 offset:8192
    ds_read_b64_tr_b16 v[38:39], v11 offset:8704
    ds_read_b64_tr_b16 v[144:145], v12 offset:0
    ds_read_b64_tr_b16 v[146:147], v12 offset:512
    ds_read_b64_tr_b16 v[148:149], v12 offset:8192
    ds_read_b64_tr_b16 v[150:151], v12 offset:8704
    s_waitcnt lgkmcnt(0)
    s_barrier
    ds_write_b128 v1, v[32:35] offset:12288
    ds_write_b128 v1, v[36:39] offset:13312
    s_add_u32 s71, s68, 1441792
    buffer_load_dwordx4 v[112:115], v2, s[52:55], s71 offen
    s_add_u32 s71, s68, 1474560
    buffer_load_dwordx4 v[116:119], v2, s[52:55], s71 offen
    s_add_u32 s71, s68, 1507328
    buffer_load_dwordx4 v[120:123], v2, s[52:55], s71 offen
    s_add_u32 s71, s68, 1540096
    buffer_load_dwordx4 v[124:127], v2, s[52:55], s71 offen
    s_waitcnt vmcnt(23)
    ds_write_b128 v5, v[40:43] offset:12288
    s_waitcnt vmcnt(22)
    ds_write_b128 v6, v[44:47] offset:13312
    s_waitcnt vmcnt(21)
    ds_write_b128 v7, v[152:155] offset:14336
    s_waitcnt vmcnt(20)
    ds_write_b128 v8, v[156:159] offset:15360
    s_waitcnt lgkmcnt(0)
    s_barrier
    ds_read_b64_tr_b16 v[40:41], v11 offset:0
    ds_read_b64_tr_b16 v[42:43], v11 offset:512
    ds_read_b64_tr_b16 v[44:45], v11 offset:8192
    ds_read_b64_tr_b16 v[46:47], v11 offset:8704
    ds_read_b64_tr_b16 v[152:153], v12 offset:0
    ds_read_b64_tr_b16 v[154:155], v12 offset:512
    ds_read_b64_tr_b16 v[156:157], v12 offset:8192
    ds_read_b64_tr_b16 v[158:159], v12 offset:8704
    s_waitcnt lgkmcnt(0)
    s_barrier
    ds_write_b128 v1, v[40:43] offset:14336
    ds_write_b128 v1, v[44:47] offset:15360
    s_add_u32 s71, s68, 1441792
    buffer_load_dwordx4 v[56:59], v2, s[56:59], s71 offen
    s_add_u32 s71, s68, 1474560
    buffer_load_dwordx4 v[60:63], v2, s[56:59], s71 offen
    s_add_u32 s71, s68, 1507328
    buffer_load_dwordx4 v[128:131], v2, s[56:59], s71 offen
    s_add_u32 s71, s68, 1540096
    buffer_load_dwordx4 v[132:135], v2, s[56:59], s71 offen
    s_waitcnt vmcnt(23)
    ds_write_b128 v5, v[48:51] offset:12288
    s_waitcnt vmcnt(22)
    ds_write_b128 v6, v[52:55] offset:13312
    s_waitcnt vmcnt(21)
    ds_write_b128 v7, v[160:163] offset:14336
    s_waitcnt vmcnt(20)
    ds_write_b128 v8, v[164:167] offset:15360
    s_waitcnt lgkmcnt(0)
    s_barrier
    ds_read_b64_tr_b16 v[48:49], v11 offset:0
    ds_read_b64_tr_b16 v[50:51], v11 offset:512
    ds_read_b64_tr_b16 v[52:53], v11 offset:8192
    ds_read_b64_tr_b16 v[54:55], v11 offset:8704
    ds_read_b64_tr_b16 v[160:161], v12 offset:0
    ds_read_b64_tr_b16 v[162:163], v12 offset:512
    ds_read_b64_tr_b16 v[164:165], v12 offset:8192
    ds_read_b64_tr_b16 v[166:167], v12 offset:8704
    s_waitcnt lgkmcnt(0)
    s_barrier
    ds_write_b128 v1, v[48:51] offset:16384
    ds_write_b128 v1, v[52:55] offset:17408
    s_add_u32 s71, s68, 1441792
    buffer_load_dwordx4 v[64:67], v2, s[60:63], s71 offen
    s_add_u32 s71, s68, 1474560
    buffer_load_dwordx4 v[68:71], v2, s[60:63], s71 offen
    s_add_u32 s71, s68, 1507328
    buffer_load_dwordx4 v[136:139], v2, s[60:63], s71 offen
    s_add_u32 s71, s68, 1540096
    buffer_load_dwordx4 v[140:143], v2, s[60:63], s71 offen
    s_waitcnt vmcnt(23)
    ds_write_b128 v5, a[48:51] offset:12288
    s_waitcnt vmcnt(22)
    ds_write_b128 v6, a[52:55] offset:13312
    s_waitcnt vmcnt(21)
    ds_write_b128 v7, a[56:59] offset:14336
    s_waitcnt vmcnt(20)
    ds_write_b128 v8, a[60:63] offset:15360
    s_waitcnt lgkmcnt(0)
    s_barrier
    ds_read_b64_tr_b16 a[48:49], v11 offset:0
    ds_read_b64_tr_b16 a[50:51], v11 offset:512
    ds_read_b64_tr_b16 a[52:53], v11 offset:8192
    ds_read_b64_tr_b16 a[54:55], v11 offset:8704
    ds_read_b64_tr_b16 a[56:57], v12 offset:0
    ds_read_b64_tr_b16 a[58:59], v12 offset:512
    ds_read_b64_tr_b16 a[60:61], v12 offset:8192
    ds_read_b64_tr_b16 a[62:63], v12 offset:8704
    s_waitcnt lgkmcnt(0)
    s_barrier
    s_add_u32 s71, s69, 1441792
    buffer_load_dwordx4 a[32:35], v2, s[52:55], s71 offen
    s_add_u32 s71, s69, 1474560
    buffer_load_dwordx4 a[36:39], v2, s[52:55], s71 offen
    s_add_u32 s71, s69, 1507328
    buffer_load_dwordx4 a[40:43], v2, s[52:55], s71 offen
    s_add_u32 s71, s69, 1540096
    buffer_load_dwordx4 a[44:47], v2, s[52:55], s71 offen
    s_waitcnt vmcnt(23)
    ds_write_b128 v5, a[112:115] offset:12288
    s_waitcnt vmcnt(22)
    ds_write_b128 v6, a[116:119] offset:13312
    s_waitcnt vmcnt(21)
    ds_write_b128 v7, a[120:123] offset:14336
    s_waitcnt vmcnt(20)
    ds_write_b128 v8, a[124:127] offset:15360
    s_waitcnt lgkmcnt(0)
    s_barrier
    ds_read_b64_tr_b16 a[112:113], v11 offset:0
    ds_read_b64_tr_b16 a[114:115], v11 offset:512
    ds_read_b64_tr_b16 a[116:117], v11 offset:8192
    ds_read_b64_tr_b16 a[118:119], v11 offset:8704
    ds_read_b64_tr_b16 a[120:121], v12 offset:0
    ds_read_b64_tr_b16 a[122:123], v12 offset:512
    ds_read_b64_tr_b16 a[124:125], v12 offset:8192
    ds_read_b64_tr_b16 a[126:127], v12 offset:8704
    s_waitcnt lgkmcnt(0)
    s_barrier
    s_add_u32 s71, s69, 1441792
    buffer_load_dwordx4 a[96:99], v2, s[56:59], s71 offen
    s_add_u32 s71, s69, 1474560
    buffer_load_dwordx4 a[100:103], v2, s[56:59], s71 offen
    s_add_u32 s71, s69, 1507328
    buffer_load_dwordx4 a[104:107], v2, s[56:59], s71 offen
    s_add_u32 s71, s69, 1540096
    buffer_load_dwordx4 a[108:111], v2, s[56:59], s71 offen
    s_waitcnt vmcnt(23)
    ds_write_b128 v5, a[168:171] offset:12288
    s_waitcnt vmcnt(22)
    ds_write_b128 v6, a[172:175] offset:13312
    s_waitcnt vmcnt(21)
    ds_write_b128 v7, a[176:179] offset:14336
    s_waitcnt vmcnt(20)
    ds_write_b128 v8, a[180:183] offset:15360
    s_waitcnt lgkmcnt(0)
    s_barrier
    ds_read_b64_tr_b16 a[168:169], v11 offset:0
    ds_read_b64_tr_b16 a[170:171], v11 offset:512
    ds_read_b64_tr_b16 a[172:173], v11 offset:8192
    ds_read_b64_tr_b16 a[174:175], v11 offset:8704
    ds_read_b64_tr_b16 a[176:177], v12 offset:0
    ds_read_b64_tr_b16 a[178:179], v12 offset:512
    ds_read_b64_tr_b16 a[180:181], v12 offset:8192
    ds_read_b64_tr_b16 a[182:183], v12 offset:8704
    s_waitcnt lgkmcnt(0)
    s_barrier
    s_add_u32 s71, s69, 1441792
    buffer_load_dwordx4 v[72:75], v2, s[60:63], s71 offen
    s_add_u32 s71, s69, 1474560
    buffer_load_dwordx4 v[76:79], v2, s[60:63], s71 offen
    s_add_u32 s71, s69, 1507328
    buffer_load_dwordx4 a[160:163], v2, s[60:63], s71 offen
    s_add_u32 s71, s69, 1540096
    buffer_load_dwordx4 a[164:167], v2, s[60:63], s71 offen
    s_waitcnt vmcnt(23)
    ds_write_b128 v5, v[112:115] offset:12288
    s_waitcnt vmcnt(22)
    ds_write_b128 v6, v[116:119] offset:13312
    s_waitcnt vmcnt(21)
    ds_write_b128 v7, v[120:123] offset:14336
    s_waitcnt vmcnt(20)
    ds_write_b128 v8, v[124:127] offset:15360
    s_waitcnt lgkmcnt(0)
    s_barrier
    ds_read_b64_tr_b16 v[112:113], v11 offset:0
    ds_read_b64_tr_b16 v[114:115], v11 offset:512
    ds_read_b64_tr_b16 v[116:117], v11 offset:8192
    ds_read_b64_tr_b16 v[118:119], v11 offset:8704
    ds_read_b64_tr_b16 v[120:121], v12 offset:0
    ds_read_b64_tr_b16 v[122:123], v12 offset:512
    ds_read_b64_tr_b16 v[124:125], v12 offset:8192
    ds_read_b64_tr_b16 v[126:127], v12 offset:8704
    s_waitcnt lgkmcnt(0)
    s_barrier
    s_add_u32 s71, s68, 1966080
    buffer_load_dwordx4 v[80:83], v2, s[52:55], s71 offen
    s_add_u32 s71, s68, 1998848
    buffer_load_dwordx4 v[84:87], v2, s[52:55], s71 offen
    s_add_u32 s71, s68, 2031616
    buffer_load_dwordx4 v[88:91], v2, s[52:55], s71 offen
    s_add_u32 s71, s68, 2064384
    buffer_load_dwordx4 v[92:95], v2, s[52:55], s71 offen
    s_waitcnt vmcnt(23)
    ds_write_b128 v5, v[56:59] offset:12288
    s_waitcnt vmcnt(22)
    ds_write_b128 v6, v[60:63] offset:13312
    s_waitcnt vmcnt(21)
    ds_write_b128 v7, v[128:131] offset:14336
    s_waitcnt vmcnt(20)
    ds_write_b128 v8, v[132:135] offset:15360
    s_waitcnt lgkmcnt(0)
    s_barrier
    ds_read_b64_tr_b16 v[56:57], v11 offset:0
    ds_read_b64_tr_b16 v[58:59], v11 offset:512
    ds_read_b64_tr_b16 v[60:61], v11 offset:8192
    ds_read_b64_tr_b16 v[62:63], v11 offset:8704
    ds_read_b64_tr_b16 v[128:129], v12 offset:0
    ds_read_b64_tr_b16 v[130:131], v12 offset:512
    ds_read_b64_tr_b16 v[132:133], v12 offset:8192
    ds_read_b64_tr_b16 v[134:135], v12 offset:8704
    s_waitcnt lgkmcnt(0)
    s_barrier
    ds_write_b128 v1, v[56:59] offset:8192
    ds_write_b128 v1, v[60:63] offset:9216
    s_add_u32 s71, s68, 1966080
    buffer_load_dwordx4 v[16:19], v2, s[56:59], s71 offen
    s_add_u32 s71, s68, 1998848
    buffer_load_dwordx4 v[20:23], v2, s[56:59], s71 offen
    s_add_u32 s71, s68, 2031616
    buffer_load_dwordx4 v[24:27], v2, s[56:59], s71 offen
    s_add_u32 s71, s68, 2064384
    buffer_load_dwordx4 v[28:31], v2, s[56:59], s71 offen
    s_waitcnt vmcnt(23)
    ds_write_b128 v5, v[64:67] offset:12288
    s_waitcnt vmcnt(22)
    ds_write_b128 v6, v[68:71] offset:13312
    s_waitcnt vmcnt(21)
    ds_write_b128 v7, v[136:139] offset:14336
    s_waitcnt vmcnt(20)
    ds_write_b128 v8, v[140:143] offset:15360
    s_waitcnt lgkmcnt(0)
    s_barrier
    ds_read_b64_tr_b16 v[64:65], v11 offset:0
    ds_read_b64_tr_b16 v[66:67], v11 offset:512
    ds_read_b64_tr_b16 v[68:69], v11 offset:8192
    ds_read_b64_tr_b16 v[70:71], v11 offset:8704
    ds_read_b64_tr_b16 v[136:137], v12 offset:0
    ds_read_b64_tr_b16 v[138:139], v12 offset:512
    ds_read_b64_tr_b16 v[140:141], v12 offset:8192
    ds_read_b64_tr_b16 v[142:143], v12 offset:8704
    s_waitcnt lgkmcnt(0)
    s_barrier
    ds_write_b128 v1, v[64:67] offset:10240
    ds_write_b128 v1, v[68:71] offset:11264
    s_add_u32 s71, s68, 1966080
    buffer_load_dwordx4 v[96:99], v2, s[60:63], s71 offen
    s_add_u32 s71, s68, 1998848
    buffer_load_dwordx4 v[100:103], v2, s[60:63], s71 offen
    s_add_u32 s71, s68, 2031616
    buffer_load_dwordx4 v[104:107], v2, s[60:63], s71 offen
    s_add_u32 s71, s68, 2064384
    buffer_load_dwordx4 v[108:111], v2, s[60:63], s71 offen
    s_waitcnt vmcnt(23)
    ds_write_b128 v5, a[32:35] offset:12288
    s_waitcnt vmcnt(22)
    ds_write_b128 v6, a[36:39] offset:13312
    s_waitcnt vmcnt(21)
    ds_write_b128 v7, a[40:43] offset:14336
    s_waitcnt vmcnt(20)
    ds_write_b128 v8, a[44:47] offset:15360
    s_waitcnt lgkmcnt(0)
    s_barrier
    ds_read_b64_tr_b16 a[32:33], v11 offset:0
    ds_read_b64_tr_b16 a[34:35], v11 offset:512
    ds_read_b64_tr_b16 a[36:37], v11 offset:8192
    ds_read_b64_tr_b16 a[38:39], v11 offset:8704
    ds_read_b64_tr_b16 a[40:41], v12 offset:0
    ds_read_b64_tr_b16 a[42:43], v12 offset:512
    ds_read_b64_tr_b16 a[44:45], v12 offset:8192
    ds_read_b64_tr_b16 a[46:47], v12 offset:8704
    s_waitcnt lgkmcnt(0)
    s_barrier
    s_add_u32 s71, s69, 1966080
    buffer_load_dwordx4 v[240:243], v2, s[52:55], s71 offen
    s_add_u32 s71, s69, 1998848
    buffer_load_dwordx4 v[244:247], v2, s[52:55], s71 offen
    s_add_u32 s71, s69, 2031616
    buffer_load_dwordx4 v[248:251], v2, s[52:55], s71 offen
    s_add_u32 s71, s69, 2064384
    buffer_load_dwordx4 v[252:255], v2, s[52:55], s71 offen
    s_waitcnt vmcnt(23)
    ds_write_b128 v5, a[96:99] offset:12288
    s_waitcnt vmcnt(22)
    ds_write_b128 v6, a[100:103] offset:13312
    s_waitcnt vmcnt(21)
    ds_write_b128 v7, a[104:107] offset:14336
    s_waitcnt vmcnt(20)
    ds_write_b128 v8, a[108:111] offset:15360
    s_waitcnt lgkmcnt(0)
    s_barrier
    ds_read_b64_tr_b16 a[96:97], v11 offset:0
    ds_read_b64_tr_b16 a[98:99], v11 offset:512
    ds_read_b64_tr_b16 a[100:101], v11 offset:8192
    ds_read_b64_tr_b16 a[102:103], v11 offset:8704
    ds_read_b64_tr_b16 a[104:105], v12 offset:0
    ds_read_b64_tr_b16 a[106:107], v12 offset:512
    ds_read_b64_tr_b16 a[108:109], v12 offset:8192
    ds_read_b64_tr_b16 a[110:111], v12 offset:8704
    s_waitcnt lgkmcnt(0)
    s_barrier
    s_add_u32 s71, s69, 1966080
    buffer_load_dwordx4 a[0:3], v2, s[56:59], s71 offen
    s_add_u32 s71, s69, 1998848
    buffer_load_dwordx4 a[4:7], v2, s[56:59], s71 offen
    s_add_u32 s71, s69, 2031616
    buffer_load_dwordx4 a[8:11], v2, s[56:59], s71 offen
    s_add_u32 s71, s69, 2064384
    buffer_load_dwordx4 a[12:15], v2, s[56:59], s71 offen
    s_waitcnt vmcnt(23)
    ds_write_b128 v5, v[72:75] offset:12288
    s_waitcnt vmcnt(22)
    ds_write_b128 v6, v[76:79] offset:13312
    s_waitcnt vmcnt(21)
    ds_write_b128 v7, a[160:163] offset:14336
    s_waitcnt vmcnt(20)
    ds_write_b128 v8, a[164:167] offset:15360
    s_waitcnt lgkmcnt(0)
    s_barrier
    ds_read_b64_tr_b16 v[72:73], v11 offset:0
    ds_read_b64_tr_b16 v[74:75], v11 offset:512
    ds_read_b64_tr_b16 v[76:77], v11 offset:8192
    ds_read_b64_tr_b16 v[78:79], v11 offset:8704
    ds_read_b64_tr_b16 a[160:161], v12 offset:0
    ds_read_b64_tr_b16 a[162:163], v12 offset:512
    ds_read_b64_tr_b16 a[164:165], v12 offset:8192
    ds_read_b64_tr_b16 a[166:167], v12 offset:8704
    s_waitcnt lgkmcnt(0)
    s_barrier
    ds_write_b128 v1, v[72:75] offset:24576
    ds_write_b128 v1, v[76:79] offset:25600
    s_add_u32 s71, s69, 1966080
    buffer_load_dwordx4 a[16:19], v2, s[60:63], s71 offen
    s_add_u32 s71, s69, 1998848
    buffer_load_dwordx4 a[20:23], v2, s[60:63], s71 offen
    s_add_u32 s71, s69, 2031616
    buffer_load_dwordx4 a[24:27], v2, s[60:63], s71 offen
    s_add_u32 s71, s69, 2064384
    buffer_load_dwordx4 a[28:31], v2, s[60:63], s71 offen
    s_waitcnt vmcnt(23)
    ds_write_b128 v5, v[80:83] offset:12288
    s_waitcnt vmcnt(22)
    ds_write_b128 v6, v[84:87] offset:13312
    s_waitcnt vmcnt(21)
    ds_write_b128 v7, v[88:91] offset:14336
    s_waitcnt vmcnt(20)
    ds_write_b128 v8, v[92:95] offset:15360
    s_waitcnt lgkmcnt(0)
    s_barrier
    ds_read_b64_tr_b16 v[80:81], v11 offset:0
    ds_read_b64_tr_b16 v[82:83], v11 offset:512
    ds_read_b64_tr_b16 v[84:85], v11 offset:8192
    ds_read_b64_tr_b16 v[86:87], v11 offset:8704
    ds_read_b64_tr_b16 v[88:89], v12 offset:0
    ds_read_b64_tr_b16 v[90:91], v12 offset:512
    ds_read_b64_tr_b16 v[92:93], v12 offset:8192
    ds_read_b64_tr_b16 v[94:95], v12 offset:8704
    s_waitcnt lgkmcnt(0)
    s_barrier
    ds_write_b128 v1, v[80:83] offset:0
    ds_write_b128 v1, v[84:87] offset:1024
    ds_write_b128 v1, v[88:91] offset:2048
    ds_write_b128 v1, v[92:95] offset:3072
    s_add_u32 s71, s68, 2490368
    buffer_load_dwordx4 v[32:35], v2, s[52:55], s71 offen
    s_add_u32 s71, s68, 2523136
    buffer_load_dwordx4 v[36:39], v2, s[52:55], s71 offen
    s_add_u32 s71, s68, 2555904
    buffer_load_dwordx4 v[200:203], v2, s[52:55], s71 offen
    s_add_u32 s71, s68, 2588672
    buffer_load_dwordx4 v[204:207], v2, s[52:55], s71 offen
    s_waitcnt vmcnt(23)
    ds_write_b128 v5, v[16:19] offset:12288
    s_waitcnt vmcnt(22)
    ds_write_b128 v6, v[20:23] offset:13312
    s_waitcnt vmcnt(21)
    ds_write_b128 v7, v[24:27] offset:14336
    s_waitcnt vmcnt(20)
    ds_write_b128 v8, v[28:31] offset:15360
    s_waitcnt lgkmcnt(0)
    s_barrier
    ds_read_b64_tr_b16 v[16:17], v11 offset:0
    ds_read_b64_tr_b16 v[18:19], v11 offset:512
    ds_read_b64_tr_b16 v[20:21], v11 offset:8192
    ds_read_b64_tr_b16 v[22:23], v11 offset:8704
    ds_read_b64_tr_b16 v[24:25], v12 offset:0
    ds_read_b64_tr_b16 v[26:27], v12 offset:512
    ds_read_b64_tr_b16 v[28:29], v12 offset:8192
    ds_read_b64_tr_b16 v[30:31], v12 offset:8704
    s_waitcnt lgkmcnt(0)
    s_barrier
    ds_write_b128 v1, v[16:19] offset:4096
    ds_write_b128 v1, v[20:23] offset:5120
    ds_write_b128 v1, v[24:27] offset:6144
    ds_write_b128 v1, v[28:31] offset:7168
    s_add_u32 s71, s68, 2490368
    buffer_load_dwordx4 v[208:211], v2, s[56:59], s71 offen
    s_add_u32 s71, s68, 2523136
    buffer_load_dwordx4 v[212:215], v2, s[56:59], s71 offen
    s_add_u32 s71, s68, 2555904
    buffer_load_dwordx4 v[216:219], v2, s[56:59], s71 offen
    s_add_u32 s71, s68, 2588672
    buffer_load_dwordx4 v[220:223], v2, s[56:59], s71 offen
    s_waitcnt vmcnt(23)
    ds_write_b128 v5, v[96:99] offset:12288
    s_waitcnt vmcnt(22)
    ds_write_b128 v6, v[100:103] offset:13312
    s_waitcnt vmcnt(21)
    ds_write_b128 v7, v[104:107] offset:14336
    s_waitcnt vmcnt(20)
    ds_write_b128 v8, v[108:111] offset:15360
    s_waitcnt lgkmcnt(0)
    s_barrier
    ds_read_b64_tr_b16 v[96:97], v11 offset:0
    ds_read_b64_tr_b16 v[98:99], v11 offset:512
    ds_read_b64_tr_b16 v[100:101], v11 offset:8192
    ds_read_b64_tr_b16 v[102:103], v11 offset:8704
    ds_read_b64_tr_b16 v[104:105], v12 offset:0
    ds_read_b64_tr_b16 v[106:107], v12 offset:512
    ds_read_b64_tr_b16 v[108:109], v12 offset:8192
    ds_read_b64_tr_b16 v[110:111], v12 offset:8704
    s_waitcnt lgkmcnt(0)
    s_barrier
    s_add_u32 s71, s68, 2490368
    buffer_load_dwordx4 v[224:227], v2, s[60:63], s71 offen
    s_add_u32 s71, s68, 2523136
    buffer_load_dwordx4 v[228:231], v2, s[60:63], s71 offen
    s_add_u32 s71, s68, 2555904
    buffer_load_dwordx4 v[232:235], v2, s[60:63], s71 offen
    s_add_u32 s71, s68, 2588672
    buffer_load_dwordx4 v[236:239], v2, s[60:63], s71 offen
    s_waitcnt vmcnt(23)
    ds_write_b128 v5, v[240:243] offset:12288
    s_waitcnt vmcnt(22)
    ds_write_b128 v6, v[244:247] offset:13312
    s_waitcnt vmcnt(21)
    ds_write_b128 v7, v[248:251] offset:14336
    s_waitcnt vmcnt(20)
    ds_write_b128 v8, v[252:255] offset:15360
    s_waitcnt lgkmcnt(0)
    s_barrier
    ds_read_b64_tr_b16 v[240:241], v11 offset:0
    ds_read_b64_tr_b16 v[242:243], v11 offset:512
    ds_read_b64_tr_b16 v[244:245], v11 offset:8192
    ds_read_b64_tr_b16 v[246:247], v11 offset:8704
    ds_read_b64_tr_b16 v[248:249], v12 offset:0
    ds_read_b64_tr_b16 v[250:251], v12 offset:512
    ds_read_b64_tr_b16 v[252:253], v12 offset:8192
    ds_read_b64_tr_b16 v[254:255], v12 offset:8704
    s_waitcnt lgkmcnt(0)
    s_barrier
    s_add_u32 s71, s69, 2490368
    buffer_load_dwordx4 a[80:83], v2, s[52:55], s71 offen
    s_add_u32 s71, s69, 2523136
    buffer_load_dwordx4 a[84:87], v2, s[52:55], s71 offen
    s_add_u32 s71, s69, 2555904
    buffer_load_dwordx4 a[88:91], v2, s[52:55], s71 offen
    s_add_u32 s71, s69, 2588672
    buffer_load_dwordx4 a[92:95], v2, s[52:55], s71 offen
    s_waitcnt vmcnt(23)
    ds_write_b128 v5, a[0:3] offset:12288
    s_waitcnt vmcnt(22)
    ds_write_b128 v6, a[4:7] offset:13312
    s_waitcnt vmcnt(21)
    ds_write_b128 v7, a[8:11] offset:14336
    s_waitcnt vmcnt(20)
    ds_write_b128 v8, a[12:15] offset:15360
    s_waitcnt lgkmcnt(0)
    s_barrier
    ds_read_b64_tr_b16 a[0:1], v11 offset:0
    ds_read_b64_tr_b16 a[2:3], v11 offset:512
    ds_read_b64_tr_b16 a[4:5], v11 offset:8192
    ds_read_b64_tr_b16 a[6:7], v11 offset:8704
    ds_read_b64_tr_b16 a[8:9], v12 offset:0
    ds_read_b64_tr_b16 a[10:11], v12 offset:512
    ds_read_b64_tr_b16 a[12:13], v12 offset:8192
    ds_read_b64_tr_b16 a[14:15], v12 offset:8704
    s_waitcnt lgkmcnt(0)
    s_barrier
    s_add_u32 s71, s69, 2490368
    buffer_load_dwordx4 a[144:147], v2, s[56:59], s71 offen
    s_add_u32 s71, s69, 2523136
    buffer_load_dwordx4 a[148:151], v2, s[56:59], s71 offen
    s_add_u32 s71, s69, 2555904
    buffer_load_dwordx4 a[152:155], v2, s[56:59], s71 offen
    s_add_u32 s71, s69, 2588672
    buffer_load_dwordx4 a[156:159], v2, s[56:59], s71 offen
    s_waitcnt vmcnt(23)
    ds_write_b128 v5, a[16:19] offset:12288
    s_waitcnt vmcnt(22)
    ds_write_b128 v6, a[20:23] offset:13312
    s_waitcnt vmcnt(21)
    ds_write_b128 v7, a[24:27] offset:14336
    s_waitcnt vmcnt(20)
    ds_write_b128 v8, a[28:31] offset:15360
    s_waitcnt lgkmcnt(0)
    s_barrier
    ds_read_b64_tr_b16 a[16:17], v11 offset:0
    ds_read_b64_tr_b16 a[18:19], v11 offset:512
    ds_read_b64_tr_b16 a[20:21], v11 offset:8192
    ds_read_b64_tr_b16 a[22:23], v11 offset:8704
    ds_read_b64_tr_b16 a[24:25], v12 offset:0
    ds_read_b64_tr_b16 a[26:27], v12 offset:512
    ds_read_b64_tr_b16 a[28:29], v12 offset:8192
    ds_read_b64_tr_b16 a[30:31], v12 offset:8704
    s_waitcnt lgkmcnt(0)
    s_barrier
    s_add_u32 s71, s69, 2490368
    buffer_load_dwordx4 a[200:203], v2, s[60:63], s71 offen
    s_add_u32 s71, s69, 2523136
    buffer_load_dwordx4 a[204:207], v2, s[60:63], s71 offen
    s_add_u32 s71, s69, 2555904
    buffer_load_dwordx4 a[208:211], v2, s[60:63], s71 offen
    s_add_u32 s71, s69, 2588672
    buffer_load_dwordx4 a[212:215], v2, s[60:63], s71 offen
    s_waitcnt vmcnt(23)
    ds_write_b128 v5, v[32:35] offset:12288
    s_waitcnt vmcnt(22)
    ds_write_b128 v6, v[36:39] offset:13312
    s_waitcnt vmcnt(21)
    ds_write_b128 v7, v[200:203] offset:14336
    s_waitcnt vmcnt(20)
    ds_write_b128 v8, v[204:207] offset:15360
    s_waitcnt lgkmcnt(0)
    s_barrier
    ds_read_b64_tr_b16 v[32:33], v11 offset:0
    ds_read_b64_tr_b16 v[34:35], v11 offset:512
    ds_read_b64_tr_b16 v[36:37], v11 offset:8192
    ds_read_b64_tr_b16 v[38:39], v11 offset:8704
    ds_read_b64_tr_b16 v[200:201], v12 offset:0
    ds_read_b64_tr_b16 v[202:203], v12 offset:512
    ds_read_b64_tr_b16 v[204:205], v12 offset:8192
    ds_read_b64_tr_b16 v[206:207], v12 offset:8704
    s_waitcnt lgkmcnt(0)
    s_barrier
    ds_write_b128 v1, v[32:35] offset:22528
    ds_write_b128 v1, v[36:39] offset:23552
    s_add_u32 s71, s70, 61440
    buffer_load_dwordx4 a[232:235], v3, s[64:67], s71 offen
    s_add_u32 s71, s70, 66560
    buffer_load_dwordx4 a[236:239], v3, s[64:67], s71 offen
    s_add_u32 s71, s70, 71680
    buffer_load_dwordx4 a[224:227], v3, s[64:67], s71 offen
    s_add_u32 s71, s70, 76800
    buffer_load_dwordx4 a[228:231], v3, s[64:67], s71 offen
    s_waitcnt vmcnt(23)
    ds_write_b128 v5, v[208:211] offset:12288
    s_waitcnt vmcnt(22)
    ds_write_b128 v6, v[212:215] offset:13312
    s_waitcnt vmcnt(21)
    ds_write_b128 v7, v[216:219] offset:14336
    s_waitcnt vmcnt(20)
    ds_write_b128 v8, v[220:223] offset:15360
    s_waitcnt lgkmcnt(0)
    s_barrier
    ds_read_b64_tr_b16 v[208:209], v11 offset:0
    ds_read_b64_tr_b16 v[210:211], v11 offset:512
    ds_read_b64_tr_b16 v[212:213], v11 offset:8192
    ds_read_b64_tr_b16 v[214:215], v11 offset:8704
    ds_read_b64_tr_b16 v[216:217], v12 offset:0
    ds_read_b64_tr_b16 v[218:219], v12 offset:512
    ds_read_b64_tr_b16 v[220:221], v12 offset:8192
    ds_read_b64_tr_b16 v[222:223], v12 offset:8704
    s_waitcnt lgkmcnt(0)
    s_barrier
    s_add_u32 s71, s70, 143360
    buffer_load_dwordx4 v[40:43], v3, s[64:67], s71 offen
    s_add_u32 s71, s70, 148480
    buffer_load_dwordx4 v[44:47], v3, s[64:67], s71 offen
    s_add_u32 s71, s70, 153600
    buffer_load_dwordx4 v[48:51], v3, s[64:67], s71 offen
    s_add_u32 s71, s70, 158720
    buffer_load_dwordx4 v[52:55], v3, s[64:67], s71 offen
    s_waitcnt vmcnt(23)
    ds_write_b128 v5, v[224:227] offset:12288
    s_waitcnt vmcnt(22)
    ds_write_b128 v6, v[228:231] offset:13312
    s_waitcnt vmcnt(21)
    ds_write_b128 v7, v[232:235] offset:14336
    s_waitcnt vmcnt(20)
    ds_write_b128 v8, v[236:239] offset:15360
    s_waitcnt lgkmcnt(0)
    s_barrier
    ds_read_b64_tr_b16 v[224:225], v11 offset:0
    ds_read_b64_tr_b16 v[226:227], v11 offset:512
    ds_read_b64_tr_b16 v[228:229], v11 offset:8192
    ds_read_b64_tr_b16 v[230:231], v11 offset:8704
    ds_read_b64_tr_b16 v[232:233], v12 offset:0
    ds_read_b64_tr_b16 v[234:235], v12 offset:512
    ds_read_b64_tr_b16 v[236:237], v12 offset:8192
    ds_read_b64_tr_b16 v[238:239], v12 offset:8704
    s_waitcnt lgkmcnt(0)
    s_barrier
    s_add_u32 s71, s70, 61696
    buffer_load_dwordx4 v[56:59], v3, s[64:67], s71 offen
    s_add_u32 s71, s70, 66816
    buffer_load_dwordx4 v[60:63], v3, s[64:67], s71 offen
    s_add_u32 s71, s70, 71936
    buffer_load_dwordx4 a[248:251], v3, s[64:67], s71 offen
    s_add_u32 s71, s70, 77056
    buffer_load_dwordx4 a[252:255], v3, s[64:67], s71 offen
    s_waitcnt vmcnt(23)
    ds_write_b128 v5, a[80:83] offset:12288
    s_waitcnt vmcnt(22)
    ds_write_b128 v6, a[84:87] offset:13312
    s_waitcnt vmcnt(21)
    ds_write_b128 v7, a[88:91] offset:14336
    s_waitcnt vmcnt(20)
    ds_write_b128 v8, a[92:95] offset:15360
    s_waitcnt lgkmcnt(0)
    s_barrier
    ds_read_b64_tr_b16 a[80:81], v11 offset:0
    ds_read_b64_tr_b16 a[82:83], v11 offset:512
    ds_read_b64_tr_b16 a[84:85], v11 offset:8192
    ds_read_b64_tr_b16 a[86:87], v11 offset:8704
    ds_read_b64_tr_b16 a[88:89], v12 offset:0
    ds_read_b64_tr_b16 a[90:91], v12 offset:512
    ds_read_b64_tr_b16 a[92:93], v12 offset:8192
    ds_read_b64_tr_b16 a[94:95], v12 offset:8704
    s_waitcnt lgkmcnt(0)
    s_barrier
    s_add_u32 s71, s70, 143616
    buffer_load_dwordx4 a[240:243], v3, s[64:67], s71 offen
    s_add_u32 s71, s70, 148736
    buffer_load_dwordx4 a[244:247], v3, s[64:67], s71 offen
    s_add_u32 s71, s70, 153856
    buffer_load_dwordx4 a[216:219], v3, s[64:67], s71 offen
    s_add_u32 s71, s70, 158976
    buffer_load_dwordx4 a[220:223], v3, s[64:67], s71 offen
    s_waitcnt vmcnt(23)
    ds_write_b128 v5, a[144:147] offset:12288
    s_waitcnt vmcnt(22)
    ds_write_b128 v6, a[148:151] offset:13312
    s_waitcnt vmcnt(21)
    ds_write_b128 v7, a[152:155] offset:14336
    s_waitcnt vmcnt(20)
    ds_write_b128 v8, a[156:159] offset:15360
    s_waitcnt lgkmcnt(0)
    s_barrier
    ds_read_b64_tr_b16 a[144:145], v11 offset:0
    ds_read_b64_tr_b16 a[146:147], v11 offset:512
    ds_read_b64_tr_b16 a[148:149], v11 offset:8192
    ds_read_b64_tr_b16 a[150:151], v11 offset:8704
    ds_read_b64_tr_b16 a[152:153], v12 offset:0
    ds_read_b64_tr_b16 a[154:155], v12 offset:512
    ds_read_b64_tr_b16 a[156:157], v12 offset:8192
    ds_read_b64_tr_b16 a[158:159], v12 offset:8704
    s_waitcnt lgkmcnt(0)
    s_barrier
    s_add_u32 s71, s70, 123392
    buffer_load_dwordx4 v[64:67], v4, s[64:67], s71 offen
    s_add_u32 s71, s70, 133632
    buffer_load_dwordx4 v[68:71], v4, s[64:67], s71 offen
    s_add_u32 s71, s70, 143872
    buffer_load_dwordx4 v[72:75], v4, s[64:67], s71 offen
    s_add_u32 s71, s70, 154112
    buffer_load_dwordx4 v[76:79], v4, s[64:67], s71 offen
    s_waitcnt vmcnt(23)
    ds_write_b128 v5, a[200:203] offset:12288
    s_waitcnt vmcnt(22)
    ds_write_b128 v6, a[204:207] offset:13312
    s_waitcnt vmcnt(21)
    ds_write_b128 v7, a[208:211] offset:14336
    s_waitcnt vmcnt(20)
    ds_write_b128 v8, a[212:215] offset:15360
    s_waitcnt lgkmcnt(0)
    s_barrier
    ds_read_b64_tr_b16 a[200:201], v11 offset:0
    ds_read_b64_tr_b16 a[202:203], v11 offset:512
    ds_read_b64_tr_b16 a[204:205], v11 offset:8192
    ds_read_b64_tr_b16 a[206:207], v11 offset:8704
    ds_read_b64_tr_b16 a[208:209], v12 offset:0
    ds_read_b64_tr_b16 a[210:211], v12 offset:512
    ds_read_b64_tr_b16 a[212:213], v12 offset:8192
    ds_read_b64_tr_b16 a[214:215], v12 offset:8704
    s_waitcnt lgkmcnt(0)
    s_barrier
    s_waitcnt vmcnt(19)
    ds_write_b128 v9, a[232:235] offset:12288
    s_waitcnt vmcnt(18)
    ds_write_b128 v9, a[236:239] offset:13312
    s_waitcnt vmcnt(17)
    ds_write_b128 v9, a[224:227] offset:14336
    s_waitcnt vmcnt(16)
    ds_write_b128 v9, a[228:231] offset:15360
    s_waitcnt lgkmcnt(0)
    s_barrier
    ds_read_b64_tr_b16 a[232:233], v13 offset:0
    ds_read_b64_tr_b16 a[234:235], v13 offset:512
    ds_read_b64_tr_b16 a[236:237], v13 offset:2048
    ds_read_b64_tr_b16 a[238:239], v13 offset:2560
    ds_read_b64_tr_b16 a[224:225], v13 offset:8192
    ds_read_b64_tr_b16 a[226:227], v13 offset:8704
    ds_read_b64_tr_b16 a[228:229], v13 offset:10240
    ds_read_b64_tr_b16 a[230:231], v13 offset:10752
    s_waitcnt lgkmcnt(0)
    s_barrier
    buffer_load_dword v15, off, s[72:75], 0 offset:48 sc1
    s_waitcnt vmcnt(16)
    ds_write_b128 v9, v[40:43] offset:12288
    s_waitcnt vmcnt(15)
    ds_write_b128 v9, v[44:47] offset:13312
    s_waitcnt vmcnt(14)
    ds_write_b128 v9, v[48:51] offset:14336
    s_waitcnt vmcnt(13)
    ds_write_b128 v9, v[52:55] offset:15360
    s_waitcnt lgkmcnt(0)
    s_barrier
    ds_read_b64_tr_b16 v[40:41], v13 offset:0
    ds_read_b64_tr_b16 v[42:43], v13 offset:512
    ds_read_b64_tr_b16 v[44:45], v13 offset:2048
    ds_read_b64_tr_b16 v[46:47], v13 offset:2560
    ds_read_b64_tr_b16 v[48:49], v13 offset:8192
    ds_read_b64_tr_b16 v[50:51], v13 offset:8704
    ds_read_b64_tr_b16 v[52:53], v13 offset:10240
    ds_read_b64_tr_b16 v[54:55], v13 offset:10752
    s_waitcnt lgkmcnt(0)
    s_barrier
    ds_write_b128 v1, v[40:43] offset:28672
    ds_write_b128 v1, v[44:47] offset:29696
    ds_write_b128 v1, v[48:51] offset:26624
    ds_write_b128 v1, v[52:55] offset:27648
    s_waitcnt vmcnt(12)
    ds_write_b128 v9, v[56:59] offset:12288
    s_waitcnt vmcnt(11)
    ds_write_b128 v9, v[60:63] offset:13312
    s_waitcnt vmcnt(10)
    ds_write_b128 v9, a[248:251] offset:14336
    s_waitcnt vmcnt(9)
    ds_write_b128 v9, a[252:255] offset:15360
    s_waitcnt lgkmcnt(0)
    s_barrier
    ds_read_b64_tr_b16 v[56:57], v13 offset:0
    ds_read_b64_tr_b16 v[58:59], v13 offset:512
    ds_read_b64_tr_b16 v[60:61], v13 offset:2048
    ds_read_b64_tr_b16 v[62:63], v13 offset:2560
    ds_read_b64_tr_b16 a[248:249], v13 offset:8192
    ds_read_b64_tr_b16 a[250:251], v13 offset:8704
    ds_read_b64_tr_b16 a[252:253], v13 offset:10240
    ds_read_b64_tr_b16 a[254:255], v13 offset:10752
    s_waitcnt lgkmcnt(0)
    s_barrier
    ds_write_b128 v1, v[56:59] offset:30720
    ds_write_b128 v1, v[60:63] offset:31744
    s_waitcnt vmcnt(8)
    ds_write_b128 v9, a[240:243] offset:12288
    s_waitcnt vmcnt(7)
    ds_write_b128 v9, a[244:247] offset:13312
    s_waitcnt vmcnt(6)
    ds_write_b128 v9, a[216:219] offset:14336
    s_waitcnt vmcnt(5)
    ds_write_b128 v9, a[220:223] offset:15360
    s_waitcnt lgkmcnt(0)
    s_barrier
    ds_read_b64_tr_b16 a[240:241], v13 offset:0
    ds_read_b64_tr_b16 a[242:243], v13 offset:512
    ds_read_b64_tr_b16 a[244:245], v13 offset:2048
    ds_read_b64_tr_b16 a[246:247], v13 offset:2560
    ds_read_b64_tr_b16 a[216:217], v13 offset:8192
    ds_read_b64_tr_b16 a[218:219], v13 offset:8704
    ds_read_b64_tr_b16 a[220:221], v13 offset:10240
    ds_read_b64_tr_b16 a[222:223], v13 offset:10752
    s_waitcnt lgkmcnt(0)
    s_barrier
    s_waitcnt vmcnt(4)
    ds_write_b128 v10, v[64:67] offset:12288
    s_waitcnt vmcnt(3)
    ds_write_b128 v10, v[68:71] offset:13312
    s_waitcnt vmcnt(2)
    ds_write_b128 v10, v[72:75] offset:14336
    s_waitcnt vmcnt(1)
    ds_write_b128 v10, v[76:79] offset:15360
    s_waitcnt lgkmcnt(0)
    s_barrier
    s_barrier
    s_waitcnt vmcnt(0)
    v_and_b32 v16, 15, v0
    v_lshrrev_b32 v17, 4, v0
    v_and_b32 v18, 1, v16
    v_bfe_u32 v19, v16, 1, 1
    v_mov_b32 v20, 0xaaaa
    v_mul_u32_u24 v18, v18, v20
    v_mul_u32_u24 v19, v19, v20
    v_lshl_add_u32 v18, v19, 16, v18
    v_add_u32 v2, 0x44444444, v18
    v_lshrrev_b32 v18, 1, v17
    v_lshlrev_b32 v18, 6, v18
    v_lshlrev_b32 v19, 3, v16
    v_xor_b32 v18, v18, v19
    v_lshl_add_u32 v3, v17, 7, v18
    v_and_b32 v18, 3, v0
    v_lshrrev_b32 v19, 2, v0
    v_lshlrev_b32 v19, 3, v19
    v_lshrrev_b32 v20, 1, v18
    v_lshlrev_b32 v20, 6, v20
    v_xor_b32 v19, v19, v20
    v_lshl_add_u32 v4, v18, 7, v19
    v_and_b32 v18, 7, v16
    v_and_b32 v19, 61, v0
    v_lshlrev_b32 v5, 4, v19
    v_lshlrev_b32 v19, 12, v17
    v_lshl_add_u32 v6, v16, 3, v19
    v_and_b32 v19, 1, v17
    v_lshlrev_b32 v19, 5, v19
    v_lshl_add_u32 v19, v18, 2, v19
    v_lshrrev_b32 v20, 1, v17
    v_lshl_add_u32 v7, v20, 8, v19
    v_lshlrev_b32 v8, 2, v0
    v_lshlrev_b32 v0, 4, v0
    v_add_u32 v1, 131072, v0
    v_mov_b32 v7, 0
    s_lshl_b32 s27, s12, 7
    s_lshl_b32 s25, s3, 5
    v_and_b32 v22, 0x30, v0
    buffer_load_dwordx3 v[16:18], off, s[72:75], 0 offset:48 sc1
    buffer_load_dword v20, off, s[72:75], s25 sc1
    buffer_load_dword v21, v22, s[4:7], s27 offen offset:0 sc1
    s_mov_b32 s84, 0
    s_waitcnt vmcnt(2)
    v_lshrrev_b32 v23, 18, v17
    v_add_u32 v18, 4, v18
    v_lshrrev_b32 v18, 3, v18
    s_waitcnt vmcnt(1)
    v_lshrrev_b32 v20, 4, v20
    v_min3_u32 v23, v23, v15, v18
    s_waitcnt vmcnt(0)
    v_min3_u32 v23, v23, v20, v21
    v_cmp_gt_u32 vcc, 2, v23
    s_cbranch_vccz Lrdy90
    v_mov_b32 v17, 0
    s_mov_b32 exec_lo, 0x1
    s_mov_b32 exec_hi, 0x0
Lwf91:
    buffer_load_dword v16, v17, s[72:75], 0 offen offset:48 sc1
    s_waitcnt vmcnt(0)
    v_cmp_gt_u32 vcc, 2, v16
    s_cbranch_vccz Lwf91d
    s_sub_u32 s15, s15, 1
    s_cbranch_scc0 Lwf91
    s_mov_b32 s15, 0
Lwf91d:
    s_mov_b64 exec, -1
    v_mov_b32 v17, 0
    s_mov_b32 exec_lo, 0x1
    s_mov_b32 exec_hi, 0x0
Lwf92:
    buffer_load_dword v16, v17, s[72:75], 0 offen offset:56 sc1
    s_waitcnt vmcnt(0)
    v_cmp_gt_u32 vcc, 12, v16
    s_cbranch_vccz Lwf92d
    s_sub_u32 s15, s15, 1
    s_cbranch_scc0 Lwf92
    s_mov_b32 s15, 0
Lwf92d:
    s_mov_b64 exec, -1
    v_mbcnt_lo_u32_b32 v17, -1, 0
    v_and_b32 v17, 7, v17
    v_lshlrev_b32 v17, 5, v17
Lcen93:
    buffer_load_dword v16, v17, s[72:75], 0 offen sc1
    s_waitcnt vmcnt(0)
    v_readlane_b32 s25, v16, s3
    s_mov_b32 s84, 0
    s_nop 2
    s_cmp_ge_u32 s25, 32
    s_cbranch_scc1 Lcen93d
    s_mov_b32 s84, 1
    v_mov_b32 v18, v16
    s_nop 1
    v_add_u32_dpp v18, v18, v18 row_ror:1 row_mask:0xf bank_mask:0xf
    s_nop 1
    v_add_u32_dpp v18, v18, v18 row_ror:2 row_mask:0xf bank_mask:0xf
    s_nop 1
    v_add_u32_dpp v18, v18, v18 row_ror:4 row_mask:0xf bank_mask:0xf
    s_nop 0
    v_readfirstlane_b32 s25, v18
    s_nop 3
    s_cmp_ge_u32 s25, 256
    s_cbranch_scc1 Lcen93d
    s_sub_u32 s15, s15, 1
    s_cbranch_scc0 Lcen93
    s_mov_b32 s15, 0
Lcen93d:
    v_mov_b32 v18, 0
    s_mov_b32 exec_lo, 0x1
    s_mov_b32 exec_hi, 0x0
Lwf94:
    buffer_load_dword v17, v18, s[72:75], 0 offen offset:52 sc1
    s_waitcnt vmcnt(0)
    v_cmp_gt_u32 vcc, 524288, v17
    s_cbranch_vccz Lwf94d
    s_sub_u32 s15, s15, 1
    s_cbranch_scc0 Lwf94
    s_mov_b32 s15, 0
Lwf94d:
    s_mov_b64 exec, -1
    s_mov_b32 exec_lo, 0xf
    s_mov_b32 exec_hi, 0x0
Lwf95:
    buffer_load_dword v16, v0, s[4:7], s27 offen offset:0 sc1
    s_waitcnt vmcnt(0)
    v_cmp_gt_u32 vcc, 2, v16
    s_cbranch_vccz Lwf95d
    s_sub_u32 s15, s15, 1
    s_cbranch_scc0 Lwf95
    s_mov_b32 s15, 0
Lwf95d:
    s_mov_b64 exec, -1
Lrdy90:
    v_readfirstlane_b32 s35, v17
    s_nop 3
    s_and_b32 s35, s35, 0x60
    s_cselect_b32 s35, 0x2000, 0
    s_mov_b32 s28, 1040356334
    s_mov_b32 s29, 562036736
    s_mov_b32 s30, 1006632960
    s_lshl_b32 s26, s3, 19
    s_add_u32 s26, s26, 1048576
    s_lshl_b32 s25, s12, 7
    s_add_u32 s27, s25, 0
    s_add_u32 s16, s25, s26
    s_add_u32 s16, s16, 49152
    s_lshl_b32 s17, s12, 12
    s_add_u32 s17, s17, s26
    s_add_u32 s17, s17, 0
    s_lshl_b32 s26, s3, 17
    s_and_b32 s19, s25, 384
    s_lshr_b32 s19, s19, 1
    s_sub_u32 s25, s25, s19
    s_add_u32 s25, s25, 0
    s_add_u32 s19, s26, 132096
    s_add_u32 s33, s26, s25
    s_add_u32 s34, s33, s35
    s_add_u32 s34, s34, 2097152
    s_add_u32 s33, s33, 131072
    s_mov_b32 s20, s33
    s_mov_b32 s24, s34
    s_xor_b32 s21, s26, 0x20000
    s_add_u32 s21, s21, s35
    s_add_u32 s21, s21, 2098176
    s_xor_b32 s26, s35, 0x2000
    s_lshl_b32 s98, s12, 15
    s_add_u32 s98, s98, s26
    s_add_u32 s98, s98, 8394752
    s_lshr_b32 s99, s12, 1
    s_lshl_b32 s99, s99, 14
    s_and_b32 s25, s12, 1
    s_lshl_b32 s25, s25, 12
    s_add_u32 s99, s99, s25
    s_add_u32 s99, s99, s26
    s_add_u32 s99, s99, 75497472
    s_lshr_b32 s23, s99, 8
    s_and_b32 s23, s23, 0x2000
    s_xor_b32 s23, s99, s23
    s_add_u32 s98, s98, 0
    s_lshr_b32 s22, s98, 8
    s_and_b32 s22, s22, 0x2000
    s_xor_b32 s22, s98, s22
    s_add_u32 s32, s22, 16384
    s_lshl_b32 s100, s3, 5
    s_add_u32 s100, s100, s12
    s_lshl_b32 s100, s100, 6
    s_add_u32 s100, s100, 4096
    s_sub_u32 s31, s31, 1
    s_sub_u32 s36, s3, 1
    s_not_b32 s37, s36
    s_mov_b32 s18, 1
    s_mov_b32 s92, 0x00ff00ff
    s_mov_b32 s93, 0x00ff00ff
    s_mov_b32 s14, 0
    s_mov_b32 s38, 1114129
    s_mov_b32 s39, 1114129
    s_mov_b32 s40, 285217024
    s_mov_b32 s41, 285217024
    s_mov_b32 s42, 2228258
    s_mov_b32 s43, 2228258
    s_mov_b32 s44, 570434048
    s_mov_b32 s45, 570434048
    s_mov_b32 s46, 4042322160
    s_mov_b32 s47, 4042322160
    buffer_load_dwordx4 v[72:75], v0, s[4:7], s22 offen offset:0 sc1
    buffer_load_dwordx4 v[76:79], v0, s[4:7], s22 offen offset:1024 sc1
    buffer_load_dwordx4 v[80:83], v0, s[4:7], s32 offen offset:0 sc1
    buffer_load_dwordx4 v[84:87], v0, s[4:7], s32 offen offset:1024 sc1
    s_add_u32 s98, s98, 1048576
    s_lshr_b32 s22, s98, 8
    s_and_b32 s22, s22, 0x2000
    s_xor_b32 s22, s98, s22
    s_add_u32 s32, s22, 16384
    v_mov_b64 v[48:49], -1
    v_mov_b64 v[50:51], -1
    v_mov_b32 v9, -1
    s_waitcnt vmcnt(0) lgkmcnt(0)
    s_nop 11
    s_cmp_lg_u32 s84, 0
    s_cbranch_scc1 Ls3_top
Lc3_top:
    v_mov_b64 v[56:57], v[72:73]
    v_mov_b64 v[58:59], v[74:75]
    v_mov_b64 v[60:61], v[76:77]
    v_mov_b64 v[62:63], v[78:79]
    v_mov_b64 v[64:65], v[80:81]
    v_mov_b64 v[66:67], v[82:83]
    v_mov_b64 v[68:69], v[84:85]
    v_mov_b64 v[70:71], v[86:87]
    buffer_load_dwordx4 v[48:51], v0, s[4:7], s19 offen offset:2048 sc1
    buffer_load_dword v9, v8, s[4:7], s19 offen offset:3840 sc1
    ds_read_b128 v[40:43], v1 offset:0
    ds_read_b128 v[44:47], v1 offset:1024
    ds_read_b128 v[80:83], v1 offset:2048
    ds_read_b128 v[84:87], v1 offset:3072
    ds_read_b128 v[88:91], v1 offset:4096
    ds_read_b128 v[92:95], v1 offset:5120
    ds_read_b128 v[72:75], v1 offset:6144
    ds_read_b128 v[76:79], v1 offset:7168
    v_mov_b64 v[32:33], 0
    v_mov_b64 v[34:35], 0
    v_mov_b64 v[36:37], 0
    v_mov_b64 v[38:39], 0
    v_mov_b64 v[16:17], 0
    v_mov_b64 v[18:19], 0
    v_mov_b64 v[20:21], 0
    v_mov_b64 v[22:23], 0
    v_mov_b64 v[24:25], 0
    v_mov_b64 v[26:27], 0
    v_mov_b64 v[28:29], 0
    v_mov_b64 v[30:31], 0
    buffer_load_dwordx4 v[48:51], v0, s[4:7], s19 offen offset:2048 sc1
    buffer_load_dword v9, v8, s[4:7], s19 offen offset:3840 sc1
    s_waitcnt lgkmcnt(0)
Lc3_pb:
    s_waitcnt vmcnt(3)
    v_max3_u32 v11, v48, v49, v50
    s_waitcnt vmcnt(2)
    v_max3_u32 v11, v11, v51, v9
    v_cmp_eq_u32 vcc, -1, v11
    ds_write_b128 v0, v[48:51] offset:3072
    ds_write_b32 v8, v9 offset:4864
    s_cbranch_vccnz Lc3_pc
Lc3_pcd:
    v_smfmac_f32_16x16x64_bf16 v[16:19], v[48:51], v[40:47], v2
    buffer_load_dwordx4 v[12:15], v0, s[4:7], s21 offen offset:2048 sc1
    v_smfmac_f32_16x16x64_bf16 v[20:23], v[48:51], v[80:87], v2
    buffer_load_dword v11, v8, s[4:7], s21 offen offset:3840 sc1
    v_smfmac_f32_16x16x64_bf16 v[24:27], v[48:51], v[88:95], v2
    s_waitcnt lgkmcnt(0)
    s_barrier
    ds_read_b128 v[40:43], v0 offset:2048
    v_smfmac_f32_16x16x64_bf16 v[28:31], v[48:51], v[72:79], v2
    ds_read_b128 v[44:47], v0 offset:1024
    ds_read_b128 v[80:83], v1 offset:8192
    v_smfmac_f32_16x16x64_bf16 v[32:35], v[48:51], v[96:103], v2
    ds_read_b128 v[84:87], v1 offset:9216
    ds_read_b128 v[88:91], v1 offset:10240
    v_smfmac_f32_16x16x64_bf16 v[36:39], v[48:51], v[104:111], v2
    ds_read_b128 v[92:95], v1 offset:11264
Lc3_pad:
    s_waitcnt lgkmcnt(5)
    v_smfmac_f32_16x16x64_bf16 v[16:19], v[40:43], v[112:119], v2
    ds_read_b128 v[72:75], v1 offset:12288
    v_mov_b32 v10, s14
    v_smfmac_f32_16x16x64_bf16 v[20:23], v[40:43], v[120:127], v2
    s_waitcnt lgkmcnt(3)
    s_add_u32 s19, s19, 16384
    ds_read_b128 v[76:79], v1 offset:13312
    v_smfmac_f32_16x16x64_bf16 v[24:27], v[40:43], v[80:87], v2
    ds_read_b128 v[80:83], v1 offset:14336
    buffer_store_dword v10, off, s[4:7], s100 sc1
    v_smfmac_f32_16x16x64_bf16 v[28:31], v[40:43], v[128:135], v2
    s_waitcnt lgkmcnt(3)
    s_bitset0_b32 s19, 16
    ds_read_b128 v[84:87], v1 offset:15360
    v_smfmac_f32_16x16x64_bf16 v[32:35], v[40:43], v[88:95], v2
    ds_read_b128 v[88:91], v1 offset:16384
    v_smfmac_f32_16x16x64_bf16 v[36:39], v[40:43], v[136:143], v2
    s_waitcnt lgkmcnt(3)
    s_add_u32 s20, s20, 16384
    ds_read_b128 v[92:95], v1 offset:17408
    v_smfmac_f32_16x16x64_bf16 v[16:19], v[44:47], v[72:79], v2
    ds_read_b128 v[40:43], v0 offset:0
    v_smfmac_f32_16x16x64_bf16 v[20:23], v[44:47], v[144:151], v2
    s_waitcnt lgkmcnt(3)
    s_bitset0_b32 s20, 16
    ds_read_b128 v[72:75], v1 offset:18432
    v_smfmac_f32_16x16x64_bf16 v[24:27], v[44:47], v[80:87], v2
    ds_read_b128 v[76:79], v1 offset:19456
    v_smfmac_f32_16x16x64_bf16 v[28:31], v[44:47], v[152:159], v2
    s_waitcnt lgkmcnt(3)
    s_add_u32 s24, s24, 16384
    ds_read_b128 v[80:83], v1 offset:20480
    v_smfmac_f32_16x16x64_bf16 v[32:35], v[44:47], v[88:95], v2
    ds_read_b128 v[84:87], v1 offset:21504
    v_smfmac_f32_16x16x64_bf16 v[36:39], v[44:47], v[160:167], v2
    s_waitcnt lgkmcnt(4)
    s_bitset0_b32 s24, 16
    ds_read_b128 v[44:47], v0 offset:4096
    v_smfmac_f32_16x16x64_bf16 v[16:19], v[40:43], v[168:175], v2
    s_waitcnt vmcnt(3)
    ds_read_b128 v[48:51], v1 offset:22528
    s_waitcnt lgkmcnt(4)
    v_smfmac_f32_16x16x64_bf16 v[20:23], v[40:43], v[72:79], v2
    ds_read_b128 v[52:55], v1 offset:23552
    v_smfmac_f32_16x16x64_bf16 v[24:27], v[40:43], v[176:183], v2
    s_waitcnt lgkmcnt(3)
    v_smfmac_f32_16x16x64_bf16 v[28:31], v[40:43], v[80:87], v2
    v_smfmac_f32_16x16x64_bf16 v[32:35], v[40:43], v[184:191], v2
    v_smfmac_f32_16x16x64_bf16 v[36:39], v[40:43], v[192:199], v2
    s_waitcnt lgkmcnt(0)
    v_smfmac_f32_16x16x64_bf16 v[16:19], v[44:47], v[48:55], v2
    v_smfmac_f32_16x16x64_bf16 v[20:23], v[44:47], v[200:207], v2
    v_smfmac_f32_16x16x64_bf16 v[24:27], v[44:47], v[208:215], v2
    v_smfmac_f32_16x16x64_bf16 v[28:31], v[44:47], v[216:223], v2
    s_waitcnt vmcnt(2)
    ds_write_b128 v0, v[12:15] offset:8192
    v_max3_u32 v9, v12, v13, v14
    s_waitcnt vmcnt(1)
    v_max3_u32 v9, v9, v15, v11
    v_cmp_eq_u32 vcc, -1, v9
    v_smfmac_f32_16x16x64_bf16 v[32:35], v[44:47], v[224:231], v2
    ds_write_b32 v8, v11 offset:9984
    v_smfmac_f32_16x16x64_bf16 v[36:39], v[44:47], v[232:239], v2
    s_cbranch_vccnz Lc3_rr
Lc3_rrd:
    v_smfmac_f32_16x16x64_bf16 v[16:19], v[12:15], v[240:247], v2
    s_add_u32 s21, s21, 16384
    s_bitset0_b32 s21, 16
    v_smfmac_f32_16x16x64_bf16 v[20:23], v[12:15], v[248:255], v2
    v_smfmac_f32_16x16x64_bf16 v[24:27], v[12:15], a[0:7], v2
    s_waitcnt lgkmcnt(0)
    s_barrier
    ds_read_b128 v[40:43], v0 offset:7168
    v_smfmac_f32_16x16x64_bf16 v[28:31], v[12:15], a[8:15], v2
    ds_read_b128 v[44:47], v0 offset:6144
    v_smfmac_f32_16x16x64_bf16 v[32:35], v[12:15], a[16:23], v2
    ds_read_b128 v[88:91], v0 offset:5120
    v_smfmac_f32_16x16x64_bf16 v[36:39], v[12:15], a[24:31], v2
    ds_read_b128 v[92:95], v0 offset:9216
    s_waitcnt lgkmcnt(3)
    v_smfmac_f32_16x16x64_bf16 v[16:19], v[40:43], a[32:39], v2
    v_mov_b32 v12, 0x3f803f80
    v_smfmac_f32_16x16x64_bf16 v[20:23], v[40:43], a[40:47], v2
    s_waitcnt lgkmcnt(2)
    buffer_load_dwordx4 v[72:75], v0, s[4:7], s22 offen offset:0 sc1
    v_mov_b32 v13, 0x3f803f80
    v_smfmac_f32_16x16x64_bf16 v[16:19], v[44:47], a[48:55], v2
    v_mov_b32 v14, 0x3f803f80
    v_smfmac_f32_16x16x64_bf16 v[20:23], v[44:47], a[56:63], v2
    s_waitcnt lgkmcnt(1)
    v_mov_b32 v15, 0x3f803f80
    v_smfmac_f32_16x16x64_bf16 v[16:19], v[88:91], a[64:71], v2
    v_smfmac_f32_16x16x64_bf16 v[20:23], v[88:91], a[72:79], v2
    buffer_load_dwordx4 v[76:79], v0, s[4:7], s22 offen offset:1024 sc1
    s_waitcnt lgkmcnt(0)
    v_smfmac_f32_16x16x64_bf16 v[16:19], v[92:95], a[80:87], v2
    s_nop 2
    v_smfmac_f32_16x16x64_bf16 v[20:23], v[92:95], a[88:95], v2
    s_nop 0
    ds_read_b128 v[48:51], v1 offset:24576
    v_smfmac_f32_16x16x64_bf16 v[24:27], v[40:43], a[96:103], v2
    ds_read_b128 v[52:55], v1 offset:25600
    v_add_f32 v16, v16, v17
    v_add_f32 v18, v18, v19
    v_smfmac_f32_16x16x64_bf16 v[28:31], v[40:43], a[104:111], v2
    v_cvt_pk_bf16_f32 v16, v16, v18
    v_add_f32 v20, v20, v21
    v_smfmac_f32_16x16x64_bf16 v[24:27], v[44:47], a[112:119], v2
    buffer_load_dwordx4 v[80:83], v0, s[4:7], s32 offen offset:0 sc1
    v_add_f32 v22, v22, v23
    v_cvt_pk_bf16_f32 v17, v20, v22
    v_smfmac_f32_16x16x64_bf16 v[28:31], v[44:47], a[120:127], v2
    ds_write_b64 v3, v[16:17] offset:11776
    v_smfmac_f32_16x16x64_bf16 v[24:27], v[88:91], a[128:135], v2
    buffer_load_dwordx4 v[84:87], v0, s[4:7], s32 offen offset:1024 sc1
    v_smfmac_f32_16x16x64_bf16 v[28:31], v[88:91], a[136:143], v2
    v_smfmac_f32_16x16x64_bf16 v[24:27], v[92:95], a[144:151], v2
    v_smfmac_f32_16x16x64_bf16 v[28:31], v[92:95], a[152:159], v2
    s_waitcnt lgkmcnt(0)
    s_barrier
    ds_read_b64_tr_b16 v[16:17], v4 offset:10240
    v_smfmac_f32_16x16x64_bf16 v[32:35], v[40:43], v[48:55], v2
    ds_read_b64_tr_b16 v[18:19], v4 offset:10752
    ds_read_b64_tr_b16 v[20:21], v4 offset:11264
    ds_read_b64_tr_b16 v[22:23], v4 offset:11776
    v_add_f32 v24, v24, v25
    v_add_f32 v26, v26, v27
    v_cvt_pk_bf16_f32 v24, v24, v26
    v_add_f32 v28, v28, v29
    v_add_f32 v30, v30, v31
    v_cvt_pk_bf16_f32 v25, v28, v30
    v_smfmac_f32_16x16x64_bf16 v[36:39], v[40:43], a[160:167], v2
    ds_write_b64 v3, v[24:25] offset:13824
    s_waitcnt lgkmcnt(3)
    v_mfma_f32_16x16x32_bf16 v[48:51], v[56:59], v[16:19], 0
    s_waitcnt lgkmcnt(1)
    v_mfma_f32_16x16x32_bf16 v[48:51], v[60:63], v[20:23], v[48:51]
    v_smfmac_f32_16x16x64_bf16 v[32:35], v[44:47], a[168:175], v2
    s_waitcnt lgkmcnt(0)
    s_barrier
    ds_read_b64_tr_b16 v[24:25], v4 offset:12288
    v_smfmac_f32_16x16x64_bf16 v[36:39], v[44:47], a[176:183], v2
    ds_read_b64_tr_b16 v[26:27], v4 offset:12800
    ds_read_b64_tr_b16 v[28:29], v4 offset:13312
    ds_read_b64_tr_b16 v[30:31], v4 offset:13824
    v_add_f32_dpp v48, v50, v48 quad_perm:[2,3,0,1] row_mask:0xf bank_mask:0xf
    v_add_f32_dpp v49, v51, v49 quad_perm:[2,3,0,1] row_mask:0xf bank_mask:0xf
    v_exp_f32 v50, v48
    v_exp_f32 v51, v49
    s_nop 0
    v_cvt_pk_bf16_f32 v50, v50, v51
    ds_write_b32 v0, v50 offset:14348
    s_waitcnt lgkmcnt(3)
    v_mfma_f32_16x16x32_bf16 v[52:55], v[24:27], v[16:19], 0
    ds_read_b128 v[56:59], v1 offset:26624
    s_waitcnt lgkmcnt(2)
    v_mfma_f32_16x16x32_bf16 v[52:55], v[28:31], v[20:23], v[52:55]
    s_nop 1
    ds_read_b128 v[60:63], v1 offset:27648
    v_smfmac_f32_16x16x64_bf16 v[32:35], v[88:91], a[184:191], v2
    s_waitcnt lgkmcnt(2)
    s_barrier
    ds_read_b128 v[16:19], v5 offset:14336
    v_smfmac_f32_16x16x64_bf16 v[36:39], v[88:91], a[192:199], v2
    v_add_f32_dpp v52, v54, v52 quad_perm:[2,3,0,1] row_mask:0xf bank_mask:0xf
    v_add_f32_dpp v53, v55, v53 quad_perm:[2,3,0,1] row_mask:0xf bank_mask:0xf
    v_smfmac_f32_16x16x64_bf16 v[32:35], v[92:95], a[200:207], v2
    v_mul_f32 v50, s28, v52
    v_mul_f32 v51, s28, v53
    v_smfmac_f32_16x16x64_bf16 v[36:39], v[92:95], a[208:215], v2
    v_exp_f32_dpp v52, v50 quad_perm:[0,1,0,1] row_mask:0xf bank_mask:0xf
    v_exp_f32_dpp v53, v51 quad_perm:[0,1,0,1] row_mask:0xf bank_mask:0xf
    s_waitcnt lgkmcnt(0)
    v_mfma_f32_16x16x32_bf16 v[24:27], v[12:15], v[16:19], 0
    v_mov_b32 v21, 0
    v_cvt_pk_bf16_f32 v20, v52, v53
    v_mfma_f32_16x16x32_bf16 v[40:43], v[64:67], v[16:19], 0
    v_add_f32 v32, v32, v33
    v_add_f32 v34, v34, v35
    v_cvt_pk_bf16_f32 v10, v32, v34
    v_mfma_f32_16x16x32_bf16 v[44:47], v[68:71], v[16:19], 0
    v_add_f32 v36, v36, v37
    v_add_f32 v38, v38, v39
    v_cvt_pk_bf16_f32 v11, v36, v38
    v_mfma_f32_16x16x16_bf16 v[24:27], v[12:13], v[20:21], v[24:27]
    v_mov_b32 v22, 0
    v_cvt_pk_bf16_f32 v23, v52, v53
    v_mfma_f32_16x16x16_bf16 v[40:43], v[10:11], v[20:21], v[40:43]
    v_mov_b64 v[32:33], 0
    v_mov_b64 v[34:35], 0
    v_mfma_f32_16x16x16_bf16 v[44:47], v[10:11], v[22:23], v[44:47]
    v_mov_b64 v[36:37], 0
    v_mov_b64 v[38:39], 0
    v_rcp_f32 v25, v24
    v_subrev_u32 v26, s29, v24
    v_cmp_le_u32 vcc, s30, v26
    v_mul_f32 v40, v25, v40
    v_mul_f32 v41, v25, v41
    v_mul_f32 v42, v25, v42
    v_mul_f32 v43, v25, v43
    v_cvt_pk_bf16_f32 v52, v40, v41
    v_cvt_pk_bf16_f32 v53, v42, v43
    v_mul_f32 v44, v25, v44
    v_mul_f32 v45, v25, v45
    v_mul_f32 v46, v25, v46
    v_mul_f32 v47, v25, v47
    v_cvt_pk_bf16_f32 v54, v44, v45
    v_cvt_pk_bf16_f32 v55, v46, v47
    ds_write_b128 v0, v[52:55] offset:13312
    s_cbranch_vccnz Lc3_fb
Lc3_fbd:
    v_smfmac_f32_16x16x64_bf16 v[32:35], v[52:55], v[56:63], v2 abid:1
    s_cmp_eq_u32 s14, s31
    s_mov_b64 exec, s[36:37]
    buffer_store_dwordx2 v[10:11], v3, s[4:7], s23 offen offset:3584 sc1
    s_mov_b64 exec, -1
    s_mov_b64 exec, s[36:37]
    buffer_store_dwordx4 v[28:31], v0, s[4:7], s23 offen offset:1024 sc1
    s_mov_b64 exec, -1
    ds_read_b128 v[88:91], v1 offset:28672
    ds_read_b128 v[92:95], v1 offset:29696
    s_waitcnt lgkmcnt(2)
    s_barrier
    ds_read_b128 v[16:19], v0 offset:12288
    v_smfmac_f32_16x16x64_bf16 v[36:39], v[52:55], a[216:223], v2 abid:1
    ds_read_b128 v[20:23], v0 offset:11264
    ds_read_b128 v[24:27], v0 offset:10240
    v_mov_b32 v1, v1
    s_cbranch_scc1 Lc3_exit
    v_mov_b32 v1, v1
    s_add_u32 s25, s16, 65536
    s_add_u32 s26, s16, 131072
    v_mov_b32 v1, v1
    s_waitcnt lgkmcnt(2)
    v_smfmac_f32_16x16x64_bf16 v[32:35], v[16:19], v[88:95], v2 abid:1
    ds_read_b128 v[64:67], v1 offset:30720
    s_waitcnt lgkmcnt(2)
    v_smfmac_f32_16x16x64_bf16 v[32:35], v[20:23], a[224:231], v2 abid:1
    ds_read_b128 v[68:71], v1 offset:31744
    s_waitcnt lgkmcnt(2)
    v_smfmac_f32_16x16x64_bf16 v[32:35], v[24:27], a[232:239], v2 abid:1
    s_nop 2
    v_smfmac_f32_16x16x64_bf16 v[36:39], v[16:19], a[240:247], v2 abid:1
    s_nop 2
    v_smfmac_f32_16x16x64_bf16 v[36:39], v[20:23], a[248:255], v2 abid:1
    s_waitcnt lgkmcnt(0)
    v_cvt_pk_bf16_f32 v32, v32, v33
    v_smfmac_f32_16x16x64_bf16 v[36:39], v[24:27], v[64:71], v2 abid:1
    s_nop 1
    v_and_or_b32 v32, v32, -2, s18
    v_cvt_pk_bf16_f32 v33, v34, v35
    buffer_store_dwordx2 v[32:33], v6, s[4:7], s16 offen
    s_nop 2
    v_cvt_pk_bf16_f32 v36, v36, v37
    v_and_or_b32 v36, v36, -2, s18
    v_cvt_pk_bf16_f32 v37, v38, v39
    buffer_store_dwordx2 v[36:37], v6, s[4:7], s25 offen
    s_add_u32 s99, s99, 262144
    s_lshr_b32 s23, s99, 8
    s_and_b32 s23, s23, 0x2000
    s_xor_b32 s23, s99, s23
    s_add_u32 s14, s14, 1
    s_add_u32 s98, s98, 1048576
    s_lshr_b32 s22, s98, 8
    s_and_b32 s22, s22, 0x2000
    s_xor_b32 s22, s98, s22
    s_add_u32 s32, s22, 16384
    s_waitcnt vmcnt(0)
    s_xor_b32 s18, s18, 1
    s_barrier
    s_branch Lc3_top
Lc3_exit:
    s_waitcnt vmcnt(0) lgkmcnt(0)
    s_barrier
    s_add_u32 s14, s14, 1
    v_mov_b32 v10, s14
    buffer_store_dword v10, off, s[4:7], s100 sc1
    s_waitcnt vmcnt(0) lgkmcnt(0)
    s_nop 11
    s_endpgm
Lc3_pc:
    buffer_load_dwordx4 v[48:51], v0, s[4:7], s19 offen offset:2048 sc1
    buffer_load_dword v9, v8, s[4:7], s19 offen offset:3840 sc1
    s_sub_u32 s15, s15, 1
    s_cbranch_scc0 Lc3_pb
    s_mov_b32 s15, 0
    s_branch Lc3_pcd
Lc3_rr:
    buffer_load_dwordx4 v[12:15], v0, s[4:7], s21 offen offset:2048 sc1
    buffer_load_dword v11, v8, s[4:7], s21 offen offset:3840 sc1
    s_waitcnt vmcnt(1)
    ds_write_b128 v0, v[12:15] offset:8192
    s_waitcnt vmcnt(0)
    ds_write_b32 v8, v11 offset:9984
    v_max3_u32 v9, v12, v13, v14
    v_max3_u32 v9, v9, v15, v11
    v_cmp_eq_u32 vcc, -1, v9
    s_waitcnt lgkmcnt(0)
    s_cbranch_vccz Lc3_rrd
    s_sub_u32 s15, s15, 1
    s_cbranch_scc0 Lc3_rr
    s_mov_b32 s15, 0
    s_branch Lc3_rrd
Lc3_fb:
    s_waitcnt lgkmcnt(0)
    s_nop 11
    s_barrier
    v_max_f32 v16, v48, v49
    v_max3_f32 v16, v16, v50, v51
    ds_write_b32 v0, v16 offset:12
    s_waitcnt lgkmcnt(0)
    s_barrier
    v_and_b32 v40, 0xff, v0
    ds_read_b128 v[16:19], v40 offset:0
    ds_read_b128 v[20:23], v40 offset:256
    ds_read_b128 v[88:91], v40 offset:512
    ds_read_b128 v[92:95], v40 offset:768
    s_waitcnt lgkmcnt(3)
    v_max_f32 v40, v16, v17
    v_max3_f32 v40, v40, v18, v19
    s_waitcnt lgkmcnt(2)
    v_max3_f32 v40, v40, v20, v21
    v_max3_f32 v40, v40, v22, v23
    s_waitcnt lgkmcnt(1)
    v_max3_f32 v40, v40, v88, v89
    v_max3_f32 v40, v40, v90, v91
    s_waitcnt lgkmcnt(0)
    v_max3_f32 v40, v40, v92, v93
    v_max3_f32 v40, v40, v94, v95
    v_sub_f32 v48, v48, v40
    v_sub_f32 v49, v49, v40
    v_sub_f32 v50, v50, v40
    v_sub_f32 v51, v51, v40
    v_exp_f32 v40, v48
    v_exp_f32 v41, v49
    s_nop 0
    v_cvt_pk_bf16_f32 v40, v40, v41
    ds_write_b32 v0, v40 offset:14348
    v_mov_b32 v21, 0
    v_exp_f32_dpp v52, v50 quad_perm:[0,1,0,1] row_mask:0xf bank_mask:0xf
    v_exp_f32_dpp v53, v51 quad_perm:[0,1,0,1] row_mask:0xf bank_mask:0xf
    v_mov_b32 v22, 0
    v_cvt_pk_bf16_f32 v20, v52, v53
    v_cvt_pk_bf16_f32 v23, v52, v53
    s_waitcnt lgkmcnt(0)
    s_barrier
    ds_read_b128 v[16:19], v5 offset:14336
    s_waitcnt lgkmcnt(0)
    v_mfma_f32_16x16x32_bf16 v[24:27], v[12:15], v[16:19], 0
    s_nop 2
    v_mfma_f32_16x16x32_bf16 v[40:43], v[64:67], v[16:19], 0
    s_nop 1
    s_nop 0
    v_mfma_f32_16x16x32_bf16 v[44:47], v[68:71], v[16:19], 0
    s_nop 1
    s_nop 0
    v_mfma_f32_16x16x16_bf16 v[24:27], v[12:13], v[20:21], v[24:27]
    s_nop 1
    s_nop 0
    v_mfma_f32_16x16x16_bf16 v[40:43], v[10:11], v[20:21], v[40:43]
    s_nop 2
    v_mfma_f32_16x16x16_bf16 v[44:47], v[10:11], v[22:23], v[44:47]
    s_nop 0
    v_rcp_f32 v25, v24
    s_nop 1
    v_mul_f32 v40, v25, v40
    v_mul_f32 v41, v25, v41
    v_mul_f32 v42, v25, v42
    v_mul_f32 v43, v25, v43
    v_cvt_pk_bf16_f32 v52, v40, v41
    v_cvt_pk_bf16_f32 v53, v42, v43
    v_mul_f32 v44, v25, v44
    v_mul_f32 v45, v25, v45
    v_mul_f32 v46, v25, v46
    v_mul_f32 v47, v25, v47
    v_cvt_pk_bf16_f32 v54, v44, v45
    v_cvt_pk_bf16_f32 v55, v46, v47
    ds_write_b128 v0, v[52:55] offset:13312
    s_waitcnt lgkmcnt(0)
    s_nop 11
    s_branch Lc3_fbd
L_code_end:
Ls0_top:
    v_mov_b64 v[56:57], v[72:73]
    v_mov_b64 v[58:59], v[74:75]
    v_mov_b64 v[60:61], v[76:77]
    v_mov_b64 v[62:63], v[78:79]
    v_mov_b64 v[64:65], v[80:81]
    v_mov_b64 v[66:67], v[82:83]
    v_mov_b64 v[68:69], v[84:85]
    v_mov_b64 v[70:71], v[86:87]
    buffer_load_dwordx4 v[48:51], v0, s[4:7], s19 offen offset:0 sc1
    buffer_load_dword v9, v8, s[4:7], s19 offen offset:3072 sc1
    ds_read_b128 v[40:43], v1 offset:0
    ds_read_b128 v[44:47], v1 offset:1024
    ds_read_b128 v[80:83], v1 offset:2048
    ds_read_b128 v[84:87], v1 offset:3072
    ds_read_b128 v[88:91], v1 offset:4096
    ds_read_b128 v[92:95], v1 offset:5120
    ds_read_b128 v[72:75], v1 offset:6144
    ds_read_b128 v[76:79], v1 offset:7168
    v_mov_b64 v[32:33], 0
    v_mov_b64 v[34:35], 0
    v_mov_b64 v[36:37], 0
    v_mov_b64 v[38:39], 0
    v_mov_b64 v[16:17], 0
    v_mov_b64 v[18:19], 0
    v_mov_b64 v[20:21], 0
    v_mov_b64 v[22:23], 0
    v_mov_b64 v[24:25], 0
    v_mov_b64 v[26:27], 0
    v_mov_b64 v[28:29], 0
    v_mov_b64 v[30:31], 0
    buffer_load_dwordx4 v[48:51], v0, s[4:7], s19 offen offset:0 sc1
    buffer_load_dword v9, v8, s[4:7], s19 offen offset:3072 sc1
    s_waitcnt lgkmcnt(0)
Ls0_pb:
    s_waitcnt vmcnt(3)
    v_max3_u32 v11, v48, v49, v50
    s_waitcnt vmcnt(2)
    v_max3_u32 v11, v11, v51, v9
    v_cmp_eq_u32 vcc, -1, v11
    ds_write_b128 v0, v[48:51] offset:0
    ds_write_b32 v8, v9 offset:3072
    s_cbranch_vccnz Ls0_pc
Ls0_pcd:
    v_smfmac_f32_16x16x64_bf16 v[16:19], v[48:51], v[40:47], v2
    buffer_load_dwordx4 v[12:15], v0, s[4:7], s21 offen offset:0 sc1
    v_smfmac_f32_16x16x64_bf16 v[20:23], v[48:51], v[80:87], v2
    buffer_load_dword v11, v8, s[4:7], s21 offen offset:3072 sc1
    v_smfmac_f32_16x16x64_bf16 v[24:27], v[48:51], v[88:95], v2
    s_waitcnt lgkmcnt(0)
    s_barrier
    ds_read_b128 v[40:43], v0 offset:1024
    v_smfmac_f32_16x16x64_bf16 v[28:31], v[48:51], v[72:79], v2
    ds_read_b128 v[44:47], v0 offset:2048
    ds_read_b128 v[80:83], v1 offset:8192
    v_smfmac_f32_16x16x64_bf16 v[32:35], v[48:51], v[96:103], v2
    ds_read_b128 v[84:87], v1 offset:9216
    ds_read_b128 v[88:91], v1 offset:10240
    v_smfmac_f32_16x16x64_bf16 v[36:39], v[48:51], v[104:111], v2
    ds_read_b128 v[92:95], v1 offset:11264
Ls0_pad:
    s_waitcnt lgkmcnt(5)
    v_smfmac_f32_16x16x64_bf16 v[16:19], v[40:43], v[112:119], v2
    ds_read_b128 v[72:75], v1 offset:12288
    v_smfmac_f32_16x16x64_bf16 v[20:23], v[40:43], v[120:127], v2
    s_waitcnt lgkmcnt(3)
    s_add_u32 s19, s19, 16384
    ds_read_b128 v[76:79], v1 offset:13312
    v_smfmac_f32_16x16x64_bf16 v[24:27], v[40:43], v[80:87], v2
    ds_read_b128 v[80:83], v1 offset:14336
    v_smfmac_f32_16x16x64_bf16 v[28:31], v[40:43], v[128:135], v2
    s_waitcnt lgkmcnt(3)
    s_bitset0_b32 s19, 16
    ds_read_b128 v[84:87], v1 offset:15360
    v_smfmac_f32_16x16x64_bf16 v[32:35], v[40:43], v[88:95], v2
    ds_read_b128 v[88:91], v1 offset:16384
    v_smfmac_f32_16x16x64_bf16 v[36:39], v[40:43], v[136:143], v2
    s_waitcnt lgkmcnt(3)
    s_add_u32 s20, s20, 16384
    ds_read_b128 v[92:95], v1 offset:17408
    v_smfmac_f32_16x16x64_bf16 v[16:19], v[44:47], v[72:79], v2
    ds_read_b128 v[40:43], v0 offset:3072
    v_smfmac_f32_16x16x64_bf16 v[20:23], v[44:47], v[144:151], v2
    s_waitcnt lgkmcnt(3)
    s_bitset0_b32 s20, 16
    ds_read_b128 v[72:75], v1 offset:18432
    v_smfmac_f32_16x16x64_bf16 v[24:27], v[44:47], v[80:87], v2
    ds_read_b128 v[76:79], v1 offset:19456
    v_smfmac_f32_16x16x64_bf16 v[28:31], v[44:47], v[152:159], v2
    s_waitcnt lgkmcnt(3)
    s_add_u32 s24, s24, 16384
    ds_read_b128 v[80:83], v1 offset:20480
    v_smfmac_f32_16x16x64_bf16 v[32:35], v[44:47], v[88:95], v2
    ds_read_b128 v[84:87], v1 offset:21504
    v_smfmac_f32_16x16x64_bf16 v[36:39], v[44:47], v[160:167], v2
    s_waitcnt lgkmcnt(4)
    s_bitset0_b32 s24, 16
    ds_read_b128 v[44:47], v0 offset:4096
    v_smfmac_f32_16x16x64_bf16 v[16:19], v[40:43], v[168:175], v2
    s_waitcnt vmcnt(2)
    ds_read_b128 v[48:51], v1 offset:22528
    s_waitcnt lgkmcnt(4)
    v_smfmac_f32_16x16x64_bf16 v[20:23], v[40:43], v[72:79], v2
    ds_read_b128 v[52:55], v1 offset:23552
    v_smfmac_f32_16x16x64_bf16 v[24:27], v[40:43], v[176:183], v2
    s_waitcnt lgkmcnt(3)
    s_xor_b32 s25, s24, 32768
    ds_read_b128 v[88:91], v1 offset:24576
    v_smfmac_f32_16x16x64_bf16 v[28:31], v[40:43], v[80:87], v2
    ds_read_b128 v[92:95], v1 offset:25600
    v_smfmac_f32_16x16x64_bf16 v[32:35], v[40:43], v[184:191], v2
    s_xor_b32 s26, s20, 32768
    ds_read_b128 v[72:75], v1 offset:26624
    v_smfmac_f32_16x16x64_bf16 v[36:39], v[40:43], v[192:199], v2
    ds_read_b128 v[76:79], v1 offset:27648
    s_waitcnt lgkmcnt(4)
    v_smfmac_f32_16x16x64_bf16 v[16:19], v[44:47], v[48:55], v2
    ds_read_b128 v[48:51], v1 offset:28672
    v_smfmac_f32_16x16x64_bf16 v[20:23], v[44:47], v[200:207], v2
    ds_read_b128 v[52:55], v1 offset:29696
    s_waitcnt lgkmcnt(4)
    v_smfmac_f32_16x16x64_bf16 v[24:27], v[44:47], v[88:95], v2
    v_smfmac_f32_16x16x64_bf16 v[28:31], v[44:47], v[208:215], v2
    s_waitcnt vmcnt(1)
    ds_write_b128 v0, v[12:15] offset:5120
    v_max3_u32 v9, v12, v13, v14
    s_waitcnt vmcnt(0)
    v_max3_u32 v9, v9, v15, v11
    v_cmp_eq_u32 vcc, -1, v9
    s_waitcnt lgkmcnt(3)
    v_smfmac_f32_16x16x64_bf16 v[32:35], v[44:47], v[72:79], v2
    ds_write_b32 v8, v11 offset:8192
    v_smfmac_f32_16x16x64_bf16 v[36:39], v[44:47], v[216:223], v2
    s_cbranch_vccnz Ls0_rr
Ls0_rrd:
    v_smfmac_f32_16x16x64_bf16 v[16:19], v[12:15], v[224:231], v2
    s_waitcnt lgkmcnt(2)
    s_add_u32 s21, s21, 16384
    s_bitset0_b32 s21, 16
    v_smfmac_f32_16x16x64_bf16 v[20:23], v[12:15], v[48:55], v2
    v_mov_b32 v10, -1
    v_smfmac_f32_16x16x64_bf16 v[24:27], v[12:15], v[232:239], v2
    s_waitcnt lgkmcnt(0)
    s_barrier
    ds_read_b128 v[40:43], v0 offset:6144
    v_smfmac_f32_16x16x64_bf16 v[28:31], v[12:15], v[240:247], v2
    ds_read_b128 v[44:47], v0 offset:7168
    v_smfmac_f32_16x16x64_bf16 v[32:35], v[12:15], v[248:255], v2
    ds_read_b128 v[88:91], v0 offset:8192
    v_smfmac_f32_16x16x64_bf16 v[36:39], v[12:15], a[0:7], v2
    s_waitcnt lgkmcnt(2)
    ds_read_b128 v[92:95], v0 offset:9216
    ds_read_b128 v[48:51], v1 offset:30720
    v_smfmac_f32_16x16x64_bf16 v[16:19], v[40:43], a[8:15], v2
    ds_read_b128 v[52:55], v1 offset:31744
    v_mov_b32 v12, 0x3f803f80
    v_smfmac_f32_16x16x64_bf16 v[20:23], v[40:43], a[16:23], v2
    s_waitcnt lgkmcnt(4)
    v_mov_b32 v13, 0x3f803f80
    v_smfmac_f32_16x16x64_bf16 v[16:19], v[44:47], a[24:31], v2
    buffer_load_dwordx4 v[72:75], v0, s[4:7], s22 offen offset:0 sc1
    v_mov_b32 v14, 0x3f803f80
    v_smfmac_f32_16x16x64_bf16 v[20:23], v[44:47], a[32:39], v2
    s_waitcnt lgkmcnt(3)
    buffer_store_dword v10, v7, s[4:7], s26 offen sc1
    v_mov_b32 v15, 0x3f803f80
    v_smfmac_f32_16x16x64_bf16 v[16:19], v[88:91], a[40:47], v2
    buffer_store_dword v10, v7, s[4:7], s25 offen sc1
    s_waitcnt lgkmcnt(0)
    v_smfmac_f32_16x16x64_bf16 v[20:23], v[88:91], v[48:55], v2
    buffer_load_dwordx4 v[76:79], v0, s[4:7], s22 offen offset:1024 sc1
    v_smfmac_f32_16x16x64_bf16 v[16:19], v[92:95], a[48:55], v2
    s_nop 2
    v_smfmac_f32_16x16x64_bf16 v[20:23], v[92:95], a[56:63], v2
    s_nop 0
    ds_read_b128 v[48:51], v1 offset:32768
    v_smfmac_f32_16x16x64_bf16 v[24:27], v[40:43], a[64:71], v2
    ds_read_b128 v[52:55], v1 offset:33792
    v_add_f32 v16, v16, v17
    v_add_f32 v18, v18, v19
    v_smfmac_f32_16x16x64_bf16 v[28:31], v[40:43], a[72:79], v2
    v_cvt_pk_bf16_f32 v16, v16, v18
    v_add_f32 v20, v20, v21
    v_smfmac_f32_16x16x64_bf16 v[24:27], v[44:47], a[80:87], v2
    buffer_load_dwordx4 v[80:83], v0, s[4:7], s32 offen offset:0 sc1
    v_add_f32 v22, v22, v23
    v_cvt_pk_bf16_f32 v17, v20, v22
    v_smfmac_f32_16x16x64_bf16 v[28:31], v[44:47], a[88:95], v2
    ds_write_b64 v3, v[16:17] offset:10240
    v_smfmac_f32_16x16x64_bf16 v[24:27], v[88:91], a[96:103], v2
    buffer_load_dwordx4 v[84:87], v0, s[4:7], s32 offen offset:1024 sc1
    v_smfmac_f32_16x16x64_bf16 v[28:31], v[88:91], a[104:111], v2
    v_smfmac_f32_16x16x64_bf16 v[24:27], v[92:95], a[112:119], v2
    v_smfmac_f32_16x16x64_bf16 v[28:31], v[92:95], a[120:127], v2
    s_waitcnt lgkmcnt(0)
    s_barrier
    ds_read_b64_tr_b16 v[16:17], v4 offset:10240
    v_smfmac_f32_16x16x64_bf16 v[32:35], v[40:43], v[48:55], v2
    ds_read_b64_tr_b16 v[18:19], v4 offset:10752
    ds_read_b64_tr_b16 v[20:21], v4 offset:11264
    ds_read_b64_tr_b16 v[22:23], v4 offset:11776
    v_add_f32 v24, v24, v25
    v_add_f32 v26, v26, v27
    v_cvt_pk_bf16_f32 v24, v24, v26
    v_add_f32 v28, v28, v29
    v_add_f32 v30, v30, v31
    v_cvt_pk_bf16_f32 v25, v28, v30
    v_smfmac_f32_16x16x64_bf16 v[36:39], v[40:43], a[128:135], v2
    ds_write_b64 v3, v[24:25] offset:12288
    s_waitcnt lgkmcnt(3)
    v_mfma_f32_16x16x32_bf16 v[48:51], v[56:59], v[16:19], 0
    s_waitcnt lgkmcnt(1)
    v_mfma_f32_16x16x32_bf16 v[48:51], v[60:63], v[20:23], v[48:51]
    v_smfmac_f32_16x16x64_bf16 v[32:35], v[44:47], a[136:143], v2
    s_waitcnt lgkmcnt(0)
    s_barrier
    ds_read_b64_tr_b16 v[24:25], v4 offset:12288
    v_smfmac_f32_16x16x64_bf16 v[36:39], v[44:47], a[144:151], v2
    ds_read_b64_tr_b16 v[26:27], v4 offset:12800
    ds_read_b64_tr_b16 v[28:29], v4 offset:13312
    ds_read_b64_tr_b16 v[30:31], v4 offset:13824
    v_add_f32_dpp v48, v50, v48 quad_perm:[2,3,0,1] row_mask:0xf bank_mask:0xf
    v_add_f32_dpp v49, v51, v49 quad_perm:[2,3,0,1] row_mask:0xf bank_mask:0xf
    v_exp_f32 v50, v48
    v_exp_f32 v51, v49
    s_nop 0
    v_cvt_pk_bf16_f32 v50, v50, v51
    ds_write_b32 v0, v50 offset:14336
    s_waitcnt lgkmcnt(3)
    v_mfma_f32_16x16x32_bf16 v[52:55], v[24:27], v[16:19], 0
    ds_read_b128 v[56:59], v1 offset:34816
    s_waitcnt lgkmcnt(2)
    v_mfma_f32_16x16x32_bf16 v[52:55], v[28:31], v[20:23], v[52:55]
    ds_read_b128 v[60:63], v1 offset:35840
    v_mov_b64 v[28:29], 0
    v_smfmac_f32_16x16x64_bf16 v[32:35], v[88:91], a[152:159], v2
    v_mov_b64 v[30:31], 0
    s_waitcnt lgkmcnt(2)
    s_barrier
    ds_read_b128 v[16:19], v5 offset:14336
    v_smfmac_f32_16x16x64_bf16 v[36:39], v[88:91], a[160:167], v2
    v_add_f32_dpp v52, v54, v52 quad_perm:[2,3,0,1] row_mask:0xf bank_mask:0xf
    v_add_f32_dpp v53, v55, v53 quad_perm:[2,3,0,1] row_mask:0xf bank_mask:0xf
    v_smfmac_f32_16x16x64_bf16 v[32:35], v[92:95], a[168:175], v2
    v_mul_f32 v50, s28, v52
    v_mul_f32 v51, s28, v53
    v_smfmac_f32_16x16x64_bf16 v[36:39], v[92:95], a[176:183], v2
    v_exp_f32_dpp v52, v50 quad_perm:[0,1,0,1] row_mask:0xf bank_mask:0xf
    v_exp_f32_dpp v53, v51 quad_perm:[0,1,0,1] row_mask:0xf bank_mask:0xf
    s_waitcnt lgkmcnt(0)
    v_mfma_f32_16x16x32_bf16 v[24:27], v[12:15], v[16:19], 0
    v_mov_b32 v21, 0
    v_cvt_pk_bf16_f32 v20, v52, v53
    v_mfma_f32_16x16x32_bf16 v[40:43], v[64:67], v[16:19], 0
    v_add_f32 v32, v32, v33
    v_add_f32 v34, v34, v35
    v_cvt_pk_bf16_f32 v10, v32, v34
    v_mfma_f32_16x16x32_bf16 v[44:47], v[68:71], v[16:19], 0
    v_add_f32 v36, v36, v37
    v_add_f32 v38, v38, v39
    v_cvt_pk_bf16_f32 v11, v36, v38
    v_mfma_f32_16x16x16_bf16 v[24:27], v[12:13], v[20:21], v[24:27]
    v_mov_b32 v22, 0
    v_cvt_pk_bf16_f32 v23, v52, v53
    v_mfma_f32_16x16x16_bf16 v[40:43], v[10:11], v[20:21], v[40:43]
    v_mov_b64 v[32:33], 0
    v_mov_b64 v[34:35], 0
    v_mfma_f32_16x16x16_bf16 v[44:47], v[10:11], v[22:23], v[44:47]
    v_mov_b64 v[36:37], 0
    v_mov_b64 v[38:39], 0
    v_rcp_f32 v25, v24
    v_subrev_u32 v26, s29, v24
    v_cmp_le_u32 vcc, s30, v26
    v_mul_f32 v40, v25, v40
    v_mul_f32 v41, v25, v41
    v_mul_f32 v42, v25, v42
    v_mul_f32 v43, v25, v43
    v_cvt_pk_bf16_f32 v52, v40, v41
    v_cvt_pk_bf16_f32 v53, v42, v43
    v_mul_f32 v44, v25, v44
    v_mul_f32 v45, v25, v45
    v_mul_f32 v46, v25, v46
    v_mul_f32 v47, v25, v47
    v_cvt_pk_bf16_f32 v54, v44, v45
    v_cvt_pk_bf16_f32 v55, v46, v47
    ds_write_b128 v0, v[52:55] offset:10240
    s_cbranch_vccnz Ls0_fb
Ls0_fbd:
    v_smfmac_f32_16x16x64_bf16 v[32:35], v[52:55], v[56:63], v2 abid:1
    s_cmp_eq_u32 s14, s31
    s_mov_b64 exec, s[36:37]
    buffer_store_dwordx2 v[10:11], v3, s[4:7], s23 offen offset:2048 sc1
    s_mov_b64 exec, -1
    v_smfmac_f32_16x16x64_bf16 v[36:39], v[52:55], a[184:191], v2 abid:1
    ds_read_b128 v[88:91], v1 offset:36864
    ds_read_b128 v[92:95], v1 offset:37888
    s_waitcnt lgkmcnt(2)
    s_barrier
    ds_read_b128 v[16:19], v0 offset:11264
    v_smfmac_f32_16x16x64_bf16 v[28:31], v[52:55], a[192:199], v2 abid:1
    ds_read_b128 v[20:23], v0 offset:12288
    ds_read_b128 v[24:27], v0 offset:13312
    v_mov_b32 v1, v1
    s_cbranch_scc1 Ls0_exit
    v_mov_b32 v1, v1
    s_add_u32 s25, s16, 65536
    s_add_u32 s26, s16, 131072
    v_mov_b32 v1, v1
    s_waitcnt lgkmcnt(2)
    v_smfmac_f32_16x16x64_bf16 v[32:35], v[16:19], v[88:95], v2 abid:1
    ds_read_b128 v[64:67], v1 offset:38912
    s_waitcnt lgkmcnt(2)
    v_smfmac_f32_16x16x64_bf16 v[32:35], v[20:23], a[200:207], v2 abid:1
    ds_read_b128 v[68:71], v1 offset:39936
    s_waitcnt lgkmcnt(2)
    v_smfmac_f32_16x16x64_bf16 v[32:35], v[24:27], a[208:215], v2 abid:1
    s_nop 2
    v_smfmac_f32_16x16x64_bf16 v[36:39], v[16:19], a[216:223], v2 abid:1
    s_nop 2
    v_smfmac_f32_16x16x64_bf16 v[36:39], v[20:23], a[224:231], v2 abid:1
    s_waitcnt lgkmcnt(0)
    v_cvt_pk_bf16_f32 v32, v32, v33
    v_smfmac_f32_16x16x64_bf16 v[36:39], v[24:27], v[64:71], v2 abid:1
    s_nop 1
    v_and_or_b32 v32, v32, -2, s18
    v_smfmac_f32_16x16x64_bf16 v[28:31], v[16:19], a[232:239], v2 abid:1
    s_nop 0
    v_cvt_pk_bf16_f32 v33, v34, v35
    v_smfmac_f32_16x16x64_bf16 v[28:31], v[20:23], a[240:247], v2 abid:1
    buffer_store_dwordx2 v[32:33], v6, s[4:7], s16 offen sc1
    v_cvt_pk_bf16_f32 v36, v36, v37
    v_smfmac_f32_16x16x64_bf16 v[28:31], v[24:27], a[248:255], v2 abid:1
    s_nop 1
    v_and_or_b32 v36, v36, -2, s18
    v_cvt_pk_bf16_f32 v37, v38, v39
    buffer_store_dwordx2 v[36:37], v6, s[4:7], s25 offen sc1
    s_nop 2
    v_cvt_pk_bf16_f32 v28, v28, v29
    v_and_or_b32 v28, v28, -2, s18
    v_cvt_pk_bf16_f32 v29, v30, v31
    buffer_store_dwordx2 v[28:29], v6, s[4:7], s26 offen sc1
    s_add_u32 s99, s99, 262144
    s_lshr_b32 s23, s99, 8
    s_and_b32 s23, s23, 0x2000
    s_xor_b32 s23, s99, s23
    s_add_u32 s14, s14, 1
    s_add_u32 s98, s98, 1048576
    s_lshr_b32 s22, s98, 8
    s_and_b32 s22, s22, 0x2000
    s_xor_b32 s22, s98, s22
    s_add_u32 s32, s22, 16384
    s_cmp_ge_u32 s12, 8
    s_cbranch_scc1 Ls0_nored
    v_mov_b32 v52, 0x3f80
    v_cndmask_b32 v52, v52, 1.0, s[46:47]
    v_cndmask_b32 v48, 0, v52, s[38:39]
    v_cndmask_b32 v49, 0, v52, s[40:41]
    v_cndmask_b32 v50, 0, v52, s[42:43]
    v_cndmask_b32 v51, 0, v52, s[44:45]
    s_waitcnt vmcnt(0)
    buffer_load_dwordx4 v[16:19], v0, s[4:7], s17 offen offset:0 sc1
    buffer_load_dwordx4 v[20:23], v0, s[4:7], s17 offen offset:1024 sc1
    buffer_load_dwordx4 v[24:27], v0, s[4:7], s17 offen offset:2048 sc1
    buffer_load_dwordx4 v[28:31], v0, s[4:7], s17 offen offset:3072 sc1
    ds_read_b128 v[12:15], v0
    s_waitcnt lgkmcnt(0)
    buffer_load_dwordx4 v[56:59], v0, s[4:7], s17 offen offset:0 sc1
    buffer_load_dwordx4 v[60:63], v0, s[4:7], s17 offen offset:1024 sc1
    buffer_load_dwordx4 v[64:67], v0, s[4:7], s17 offen offset:2048 sc1
    buffer_load_dwordx4 v[68:71], v0, s[4:7], s17 offen offset:3072 sc1
    s_waitcnt vmcnt(7)
    v_mfma_f32_16x16x32_bf16 v[52:55], v[48:51], v[16:19], 0
    v_bitop3_b32 v17, v16, v18, s18 bitop3:0x7e
    s_waitcnt vmcnt(6)
    v_mfma_f32_16x16x32_bf16 v[52:55], v[48:51], v[20:23], v[52:55]
    v_bitop3_b32 v21, v20, v22, s18 bitop3:0x7e
    s_waitcnt vmcnt(5)
    v_mfma_f32_16x16x32_bf16 v[52:55], v[48:51], v[24:27], v[52:55]
    v_bitop3_b32 v25, v24, v26, s18 bitop3:0x7e
    v_or3_b32 v17, v17, v21, v25
    v_and_b32 v17, 1, v17
    s_waitcnt vmcnt(4)
    v_mfma_f32_16x16x32_bf16 v[52:55], v[48:51], v[28:31], v[52:55]
    s_nop 0
    v_bitop3_b32 v29, v28, v30, s18 bitop3:0x7e
    v_and_or_b32 v17, v29, 1, v17
    v_cmp_ne_u32 vcc, 0, v17
    s_nop 1
    v_mov_b32 v1, v1
    s_nop 0
    v_add_f32_dpp v54, v52, v52 row_ror:8 row_mask:0xf bank_mask:0xf
    v_add_f32_dpp v55, v53, v53 row_ror:8 row_mask:0xf bank_mask:0xf
    v_cvt_pk_bf16_f32 v11, v54, v55
    s_cbranch_vccnz Ls0_r1
Ls0_r1d:
    buffer_store_dword v11, v7, s[4:7], s20 offen sc1
    buffer_store_dword v11, v7, s[4:7], s24 offen sc1
Ls0_redd:
    v_mov_b64 v[48:49], -1
    v_mov_b64 v[50:51], -1
    v_mov_b32 v9, -1
    s_xor_b32 s18, s18, 1
    s_waitcnt vmcnt(2)
    s_barrier
    s_branch Ls0_top
Ls0_exit:
    s_waitcnt vmcnt(0) lgkmcnt(0)
    s_barrier
    s_waitcnt vmcnt(0) lgkmcnt(0)
    s_nop 11
    s_endpgm
Ls0_pc:
    buffer_load_dwordx4 v[48:51], v0, s[4:7], s19 offen offset:0 sc1
    buffer_load_dword v9, v8, s[4:7], s19 offen offset:3072 sc1
    s_sub_u32 s15, s15, 1
    s_cbranch_scc0 Ls0_pb
    s_mov_b32 s15, 0
    s_branch Ls0_pcd
Ls0_rr:
    buffer_load_dwordx4 v[12:15], v0, s[4:7], s21 offen offset:0 sc1
    buffer_load_dword v11, v8, s[4:7], s21 offen offset:3072 sc1
    s_waitcnt vmcnt(1)
    ds_write_b128 v0, v[12:15] offset:5120
    s_waitcnt vmcnt(0)
    ds_write_b32 v8, v11 offset:8192
    v_max3_u32 v9, v12, v13, v14
    v_max3_u32 v9, v9, v15, v11
    v_cmp_eq_u32 vcc, -1, v9
    s_waitcnt lgkmcnt(0)
    s_cbranch_vccz Ls0_rrd
    s_sub_u32 s15, s15, 1
    s_cbranch_scc0 Ls0_rr
    s_mov_b32 s15, 0
    s_branch Ls0_rrd
Ls0_fb:
    s_waitcnt lgkmcnt(0)
    s_nop 11
    s_barrier
    v_max_f32 v16, v48, v49
    v_max3_f32 v16, v16, v50, v51
    ds_write_b32 v0, v16 offset:0
    s_waitcnt lgkmcnt(0)
    s_barrier
    v_and_b32 v40, 0xff, v0
    ds_read_b128 v[16:19], v40 offset:0
    ds_read_b128 v[20:23], v40 offset:256
    ds_read_b128 v[88:91], v40 offset:512
    ds_read_b128 v[92:95], v40 offset:768
    s_waitcnt lgkmcnt(3)
    v_max_f32 v40, v16, v17
    v_max3_f32 v40, v40, v18, v19
    s_waitcnt lgkmcnt(2)
    v_max3_f32 v40, v40, v20, v21
    v_max3_f32 v40, v40, v22, v23
    s_waitcnt lgkmcnt(1)
    v_max3_f32 v40, v40, v88, v89
    v_max3_f32 v40, v40, v90, v91
    s_waitcnt lgkmcnt(0)
    v_max3_f32 v40, v40, v92, v93
    v_max3_f32 v40, v40, v94, v95
    v_sub_f32 v48, v48, v40
    v_sub_f32 v49, v49, v40
    v_sub_f32 v50, v50, v40
    v_sub_f32 v51, v51, v40
    v_exp_f32 v40, v48
    v_exp_f32 v41, v49
    s_nop 0
    v_cvt_pk_bf16_f32 v40, v40, v41
    ds_write_b32 v0, v40 offset:14336
    v_mov_b32 v21, 0
    v_exp_f32_dpp v52, v50 quad_perm:[0,1,0,1] row_mask:0xf bank_mask:0xf
    v_exp_f32_dpp v53, v51 quad_perm:[0,1,0,1] row_mask:0xf bank_mask:0xf
    v_mov_b32 v22, 0
    v_cvt_pk_bf16_f32 v20, v52, v53
    v_cvt_pk_bf16_f32 v23, v52, v53
    s_waitcnt lgkmcnt(0)
    s_barrier
    ds_read_b128 v[16:19], v5 offset:14336
    s_waitcnt lgkmcnt(0)
    v_mfma_f32_16x16x32_bf16 v[24:27], v[12:15], v[16:19], 0
    s_nop 2
    v_mfma_f32_16x16x32_bf16 v[40:43], v[64:67], v[16:19], 0
    s_nop 1
    s_nop 0
    v_mfma_f32_16x16x32_bf16 v[44:47], v[68:71], v[16:19], 0
    s_nop 1
    s_nop 0
    v_mfma_f32_16x16x16_bf16 v[24:27], v[12:13], v[20:21], v[24:27]
    s_nop 1
    s_nop 0
    v_mfma_f32_16x16x16_bf16 v[40:43], v[10:11], v[20:21], v[40:43]
    s_nop 2
    v_mfma_f32_16x16x16_bf16 v[44:47], v[10:11], v[22:23], v[44:47]
    s_nop 0
    v_rcp_f32 v25, v24
    s_nop 1
    v_mul_f32 v40, v25, v40
    v_mul_f32 v41, v25, v41
    v_mul_f32 v42, v25, v42
    v_mul_f32 v43, v25, v43
    v_cvt_pk_bf16_f32 v52, v40, v41
    v_cvt_pk_bf16_f32 v53, v42, v43
    v_mul_f32 v44, v25, v44
    v_mul_f32 v45, v25, v45
    v_mul_f32 v46, v25, v46
    v_mul_f32 v47, v25, v47
    v_cvt_pk_bf16_f32 v54, v44, v45
    v_cvt_pk_bf16_f32 v55, v46, v47
    ds_write_b128 v0, v[52:55] offset:10240
    s_waitcnt lgkmcnt(0)
    s_nop 11
    s_branch Ls0_fbd
Ls0_nored:
    s_waitcnt vmcnt(0)
    s_branch Ls0_redd
Ls0_r1:
    buffer_load_dwordx4 v[16:19], v0, s[4:7], s17 offen offset:0 sc1
    buffer_load_dwordx4 v[20:23], v0, s[4:7], s17 offen offset:1024 sc1
    buffer_load_dwordx4 v[24:27], v0, s[4:7], s17 offen offset:2048 sc1
    buffer_load_dwordx4 v[28:31], v0, s[4:7], s17 offen offset:3072 sc1
    s_waitcnt vmcnt(7)
    v_mfma_f32_16x16x32_bf16 v[52:55], v[48:51], v[56:59], 0
    v_bitop3_b32 v57, v56, v58, s18 bitop3:0x7e
    s_waitcnt vmcnt(6)
    v_mfma_f32_16x16x32_bf16 v[52:55], v[48:51], v[60:63], v[52:55]
    v_bitop3_b32 v61, v60, v62, s18 bitop3:0x7e
    s_waitcnt vmcnt(5)
    v_mfma_f32_16x16x32_bf16 v[52:55], v[48:51], v[64:67], v[52:55]
    v_bitop3_b32 v65, v64, v66, s18 bitop3:0x7e
    v_or3_b32 v57, v57, v61, v65
    v_and_b32 v57, 1, v57
    s_waitcnt vmcnt(4)
    v_mfma_f32_16x16x32_bf16 v[52:55], v[48:51], v[68:71], v[52:55]
    s_nop 0
    v_bitop3_b32 v69, v68, v70, s18 bitop3:0x7e
    v_and_or_b32 v57, v69, 1, v57
    v_cmp_ne_u32 vcc, 0, v57
    s_nop 3
    v_add_f32_dpp v54, v52, v52 row_ror:8 row_mask:0xf bank_mask:0xf
    v_add_f32_dpp v55, v53, v53 row_ror:8 row_mask:0xf bank_mask:0xf
    v_cvt_pk_bf16_f32 v11, v54, v55
    s_cbranch_vccz Ls0_r1d
    buffer_load_dwordx4 v[56:59], v0, s[4:7], s17 offen offset:0 sc1
    buffer_load_dwordx4 v[60:63], v0, s[4:7], s17 offen offset:1024 sc1
    buffer_load_dwordx4 v[64:67], v0, s[4:7], s17 offen offset:2048 sc1
    buffer_load_dwordx4 v[68:71], v0, s[4:7], s17 offen offset:3072 sc1
    s_waitcnt vmcnt(7)
    v_mfma_f32_16x16x32_bf16 v[52:55], v[48:51], v[16:19], 0
    v_bitop3_b32 v17, v16, v18, s18 bitop3:0x7e
    s_waitcnt vmcnt(6)
    v_mfma_f32_16x16x32_bf16 v[52:55], v[48:51], v[20:23], v[52:55]
    v_bitop3_b32 v21, v20, v22, s18 bitop3:0x7e
    s_waitcnt vmcnt(5)
    v_mfma_f32_16x16x32_bf16 v[52:55], v[48:51], v[24:27], v[52:55]
    v_bitop3_b32 v25, v24, v26, s18 bitop3:0x7e
    v_or3_b32 v17, v17, v21, v25
    v_and_b32 v17, 1, v17
    s_waitcnt vmcnt(4)
    v_mfma_f32_16x16x32_bf16 v[52:55], v[48:51], v[28:31], v[52:55]
    s_nop 0
    v_bitop3_b32 v29, v28, v30, s18 bitop3:0x7e
    v_and_or_b32 v17, v29, 1, v17
    v_cmp_ne_u32 vcc, 0, v17
    s_nop 3
    v_add_f32_dpp v54, v52, v52 row_ror:8 row_mask:0xf bank_mask:0xf
    v_add_f32_dpp v55, v53, v53 row_ror:8 row_mask:0xf bank_mask:0xf
    v_cvt_pk_bf16_f32 v11, v54, v55
    s_cbranch_vccz Ls0_r1d
    s_sub_u32 s15, s15, 1
    s_cbranch_scc0 Ls0_r1
    s_mov_b32 s15, 0
    s_branch Ls0_r1d
Ls1_top:
    v_mov_b64 v[56:57], v[72:73]
    v_mov_b64 v[58:59], v[74:75]
    v_mov_b64 v[60:61], v[76:77]
    v_mov_b64 v[62:63], v[78:79]
    v_mov_b64 v[64:65], v[80:81]
    v_mov_b64 v[66:67], v[82:83]
    v_mov_b64 v[68:69], v[84:85]
    v_mov_b64 v[70:71], v[86:87]
    buffer_load_dwordx4 v[48:51], v0, s[4:7], s19 offen offset:0 sc1
    buffer_load_dword v9, v8, s[4:7], s19 offen offset:3328 sc1
    ds_read_b128 v[40:43], v1 offset:0
    ds_read_b128 v[44:47], v1 offset:1024
    ds_read_b128 v[80:83], v1 offset:2048
    ds_read_b128 v[84:87], v1 offset:3072
    ds_read_b128 v[88:91], v1 offset:4096
    ds_read_b128 v[92:95], v1 offset:5120
    ds_read_b128 v[72:75], v1 offset:6144
    ds_read_b128 v[76:79], v1 offset:7168
    v_mov_b64 v[32:33], 0
    v_mov_b64 v[34:35], 0
    v_mov_b64 v[36:37], 0
    v_mov_b64 v[38:39], 0
    v_mov_b64 v[16:17], 0
    v_mov_b64 v[18:19], 0
    v_mov_b64 v[20:21], 0
    v_mov_b64 v[22:23], 0
    v_mov_b64 v[24:25], 0
    v_mov_b64 v[26:27], 0
    v_mov_b64 v[28:29], 0
    v_mov_b64 v[30:31], 0
    buffer_load_dwordx4 v[48:51], v0, s[4:7], s19 offen offset:0 sc1
    buffer_load_dword v9, v8, s[4:7], s19 offen offset:3328 sc1
    s_waitcnt lgkmcnt(0)
Ls1_pb:
    s_waitcnt vmcnt(3)
    v_max3_u32 v11, v48, v49, v50
    s_waitcnt vmcnt(2)
    v_max3_u32 v11, v11, v51, v9
    v_cmp_eq_u32 vcc, -1, v11
    ds_write_b128 v0, v[48:51] offset:1024
    ds_write_b32 v8, v9 offset:4352
    s_cbranch_vccnz Ls1_pc
Ls1_pcd:
    v_smfmac_f32_16x16x64_bf16 v[16:19], v[48:51], v[40:47], v2
    buffer_load_dwordx4 v[12:15], v0, s[4:7], s21 offen offset:0 sc1
    v_smfmac_f32_16x16x64_bf16 v[20:23], v[48:51], v[80:87], v2
    buffer_load_dword v11, v8, s[4:7], s21 offen offset:3328 sc1
    v_smfmac_f32_16x16x64_bf16 v[24:27], v[48:51], v[88:95], v2
    s_waitcnt lgkmcnt(0)
    s_barrier
    ds_read_b128 v[40:43], v0 offset:0
    v_smfmac_f32_16x16x64_bf16 v[28:31], v[48:51], v[72:79], v2
    ds_read_b128 v[44:47], v0 offset:3072
    ds_read_b128 v[80:83], v1 offset:8192
    v_smfmac_f32_16x16x64_bf16 v[32:35], v[48:51], v[96:103], v2
    ds_read_b128 v[84:87], v1 offset:9216
    ds_read_b128 v[88:91], v1 offset:10240
    v_smfmac_f32_16x16x64_bf16 v[36:39], v[48:51], v[104:111], v2
    ds_read_b128 v[92:95], v1 offset:11264
Ls1_pad:
    s_waitcnt lgkmcnt(5)
    v_smfmac_f32_16x16x64_bf16 v[16:19], v[40:43], v[112:119], v2
    ds_read_b128 v[72:75], v1 offset:12288
    v_smfmac_f32_16x16x64_bf16 v[20:23], v[40:43], v[120:127], v2
    s_waitcnt lgkmcnt(3)
    s_add_u32 s19, s19, 16384
    ds_read_b128 v[76:79], v1 offset:13312
    v_smfmac_f32_16x16x64_bf16 v[24:27], v[40:43], v[80:87], v2
    ds_read_b128 v[80:83], v1 offset:14336
    v_smfmac_f32_16x16x64_bf16 v[28:31], v[40:43], v[128:135], v2
    s_waitcnt lgkmcnt(3)
    s_bitset0_b32 s19, 16
    ds_read_b128 v[84:87], v1 offset:15360
    v_smfmac_f32_16x16x64_bf16 v[32:35], v[40:43], v[88:95], v2
    ds_read_b128 v[88:91], v1 offset:16384
    v_smfmac_f32_16x16x64_bf16 v[36:39], v[40:43], v[136:143], v2
    s_waitcnt lgkmcnt(3)
    s_add_u32 s20, s20, 16384
    ds_read_b128 v[92:95], v1 offset:17408
    v_smfmac_f32_16x16x64_bf16 v[16:19], v[44:47], v[72:79], v2
    ds_read_b128 v[40:43], v0 offset:2048
    v_smfmac_f32_16x16x64_bf16 v[20:23], v[44:47], v[144:151], v2
    s_waitcnt lgkmcnt(3)
    s_bitset0_b32 s20, 16
    ds_read_b128 v[72:75], v1 offset:18432
    v_smfmac_f32_16x16x64_bf16 v[24:27], v[44:47], v[80:87], v2
    ds_read_b128 v[76:79], v1 offset:19456
    v_smfmac_f32_16x16x64_bf16 v[28:31], v[44:47], v[152:159], v2
    s_waitcnt lgkmcnt(3)
    s_add_u32 s24, s24, 16384
    ds_read_b128 v[80:83], v1 offset:20480
    v_smfmac_f32_16x16x64_bf16 v[32:35], v[44:47], v[88:95], v2
    ds_read_b128 v[84:87], v1 offset:21504
    v_smfmac_f32_16x16x64_bf16 v[36:39], v[44:47], v[160:167], v2
    s_waitcnt lgkmcnt(4)
    s_bitset0_b32 s24, 16
    ds_read_b128 v[44:47], v0 offset:4096
    v_smfmac_f32_16x16x64_bf16 v[16:19], v[40:43], v[168:175], v2
    s_waitcnt vmcnt(2)
    ds_read_b128 v[48:51], v1 offset:22528
    s_waitcnt lgkmcnt(4)
    v_smfmac_f32_16x16x64_bf16 v[20:23], v[40:43], v[72:79], v2
    ds_read_b128 v[52:55], v1 offset:23552
    v_smfmac_f32_16x16x64_bf16 v[24:27], v[40:43], v[176:183], v2
    ds_read_b128 v[88:91], v1 offset:24576
    s_waitcnt lgkmcnt(4)
    v_smfmac_f32_16x16x64_bf16 v[28:31], v[40:43], v[80:87], v2
    ds_read_b128 v[92:95], v1 offset:25600
    v_smfmac_f32_16x16x64_bf16 v[32:35], v[40:43], v[184:191], v2
    ds_read_b128 v[72:75], v1 offset:26624
    v_smfmac_f32_16x16x64_bf16 v[36:39], v[40:43], v[192:199], v2
    ds_read_b128 v[76:79], v1 offset:27648
    s_waitcnt lgkmcnt(4)
    v_smfmac_f32_16x16x64_bf16 v[16:19], v[44:47], v[48:55], v2
    ds_read_b128 v[48:51], v1 offset:28672
    v_smfmac_f32_16x16x64_bf16 v[20:23], v[44:47], v[200:207], v2
    ds_read_b128 v[52:55], v1 offset:29696
    s_waitcnt lgkmcnt(4)
    v_smfmac_f32_16x16x64_bf16 v[24:27], v[44:47], v[88:95], v2
    v_smfmac_f32_16x16x64_bf16 v[28:31], v[44:47], v[208:215], v2
    s_waitcnt vmcnt(1)
    ds_write_b128 v0, v[12:15] offset:6144
    v_max3_u32 v9, v12, v13, v14
    s_waitcnt vmcnt(0)
    v_max3_u32 v9, v9, v15, v11
    v_cmp_eq_u32 vcc, -1, v9
    s_waitcnt lgkmcnt(3)
    v_smfmac_f32_16x16x64_bf16 v[32:35], v[44:47], v[72:79], v2
    ds_write_b32 v8, v11 offset:9472
    v_smfmac_f32_16x16x64_bf16 v[36:39], v[44:47], v[216:223], v2
    s_cbranch_vccnz Ls1_rr
Ls1_rrd:
    v_smfmac_f32_16x16x64_bf16 v[16:19], v[12:15], v[224:231], v2
    s_waitcnt lgkmcnt(2)
    s_add_u32 s21, s21, 16384
    s_bitset0_b32 s21, 16
    v_smfmac_f32_16x16x64_bf16 v[20:23], v[12:15], v[48:55], v2
    v_and_b32 v9, 0x30, v0
    v_smfmac_f32_16x16x64_bf16 v[24:27], v[12:15], v[232:239], v2
    s_waitcnt lgkmcnt(0)
    s_barrier
    ds_read_b128 v[40:43], v0 offset:5120
    v_smfmac_f32_16x16x64_bf16 v[28:31], v[12:15], v[240:247], v2
    ds_read_b128 v[44:47], v0 offset:8192
    v_smfmac_f32_16x16x64_bf16 v[32:35], v[12:15], v[248:255], v2
    ds_read_b128 v[88:91], v0 offset:7168
    v_smfmac_f32_16x16x64_bf16 v[36:39], v[12:15], a[0:7], v2
    s_waitcnt lgkmcnt(2)
    ds_read_b128 v[92:95], v0 offset:9216
    ds_read_b128 v[48:51], v1 offset:30720
    v_smfmac_f32_16x16x64_bf16 v[16:19], v[40:43], a[8:15], v2
    ds_read_b128 v[52:55], v1 offset:31744
    v_mov_b32 v12, 0x3f803f80
    v_smfmac_f32_16x16x64_bf16 v[20:23], v[40:43], a[16:23], v2
    s_waitcnt lgkmcnt(4)
    buffer_load_dwordx4 v[72:75], v0, s[4:7], s22 offen offset:0 sc1
    v_mov_b32 v13, 0x3f803f80
    v_smfmac_f32_16x16x64_bf16 v[16:19], v[44:47], a[24:31], v2
    v_mov_b32 v14, 0x3f803f80
    v_smfmac_f32_16x16x64_bf16 v[20:23], v[44:47], a[32:39], v2
    s_waitcnt lgkmcnt(3)
    v_mov_b32 v15, 0x3f803f80
    v_smfmac_f32_16x16x64_bf16 v[16:19], v[88:91], a[40:47], v2
    buffer_load_dword v7, v9, s[4:7], s27 offen sc1
    s_waitcnt lgkmcnt(0)
    v_smfmac_f32_16x16x64_bf16 v[20:23], v[88:91], v[48:55], v2
    v_smfmac_f32_16x16x64_bf16 v[16:19], v[92:95], a[48:55], v2
    s_nop 1
    buffer_load_dwordx4 v[76:79], v0, s[4:7], s22 offen offset:1024 sc1
    v_smfmac_f32_16x16x64_bf16 v[20:23], v[92:95], a[56:63], v2
    s_nop 0
    ds_read_b128 v[48:51], v1 offset:32768
    v_smfmac_f32_16x16x64_bf16 v[24:27], v[40:43], a[64:71], v2
    ds_read_b128 v[52:55], v1 offset:33792
    v_add_f32 v16, v16, v17
    v_add_f32 v18, v18, v19
    v_smfmac_f32_16x16x64_bf16 v[28:31], v[40:43], a[72:79], v2
    v_cvt_pk_bf16_f32 v16, v16, v18
    v_add_f32 v20, v20, v21
    v_smfmac_f32_16x16x64_bf16 v[24:27], v[44:47], a[80:87], v2
    buffer_load_dwordx4 v[80:83], v0, s[4:7], s32 offen offset:0 sc1
    v_add_f32 v22, v22, v23
    v_cvt_pk_bf16_f32 v17, v20, v22
    v_smfmac_f32_16x16x64_bf16 v[28:31], v[44:47], a[88:95], v2
    ds_write_b64 v3, v[16:17] offset:10752
    v_smfmac_f32_16x16x64_bf16 v[24:27], v[88:91], a[96:103], v2
    buffer_load_dwordx4 v[84:87], v0, s[4:7], s32 offen offset:1024 sc1
    v_smfmac_f32_16x16x64_bf16 v[28:31], v[88:91], a[104:111], v2
    v_smfmac_f32_16x16x64_bf16 v[24:27], v[92:95], a[112:119], v2
    v_smfmac_f32_16x16x64_bf16 v[28:31], v[92:95], a[120:127], v2
    s_waitcnt lgkmcnt(0)
    s_barrier
    ds_read_b64_tr_b16 v[16:17], v4 offset:10240
    v_smfmac_f32_16x16x64_bf16 v[32:35], v[40:43], v[48:55], v2
    ds_read_b64_tr_b16 v[18:19], v4 offset:10752
    ds_read_b64_tr_b16 v[20:21], v4 offset:11264
    ds_read_b64_tr_b16 v[22:23], v4 offset:11776
    v_add_f32 v24, v24, v25
    v_add_f32 v26, v26, v27
    v_cvt_pk_bf16_f32 v24, v24, v26
    v_add_f32 v28, v28, v29
    v_add_f32 v30, v30, v31
    v_cvt_pk_bf16_f32 v25, v28, v30
    v_smfmac_f32_16x16x64_bf16 v[36:39], v[40:43], a[128:135], v2
    ds_write_b64 v3, v[24:25] offset:12800
    s_waitcnt lgkmcnt(3)
    v_mfma_f32_16x16x32_bf16 v[48:51], v[56:59], v[16:19], 0
    s_waitcnt lgkmcnt(1)
    v_mfma_f32_16x16x32_bf16 v[48:51], v[60:63], v[20:23], v[48:51]
    v_smfmac_f32_16x16x64_bf16 v[32:35], v[44:47], a[136:143], v2
    s_waitcnt lgkmcnt(0)
    s_barrier
    ds_read_b64_tr_b16 v[24:25], v4 offset:12288
    v_smfmac_f32_16x16x64_bf16 v[36:39], v[44:47], a[144:151], v2
    ds_read_b64_tr_b16 v[26:27], v4 offset:12800
    ds_read_b64_tr_b16 v[28:29], v4 offset:13312
    ds_read_b64_tr_b16 v[30:31], v4 offset:13824
    v_add_f32_dpp v48, v50, v48 quad_perm:[2,3,0,1] row_mask:0xf bank_mask:0xf
    v_add_f32_dpp v49, v51, v49 quad_perm:[2,3,0,1] row_mask:0xf bank_mask:0xf
    v_exp_f32 v50, v48
    v_exp_f32 v51, v49
    s_nop 0
    v_cvt_pk_bf16_f32 v50, v50, v51
    ds_write_b32 v0, v50 offset:14340
    s_waitcnt lgkmcnt(3)
    v_mfma_f32_16x16x32_bf16 v[52:55], v[24:27], v[16:19], 0
    ds_read_b128 v[56:59], v1 offset:34816
    s_waitcnt lgkmcnt(2)
    v_mfma_f32_16x16x32_bf16 v[52:55], v[28:31], v[20:23], v[52:55]
    ds_read_b128 v[60:63], v1 offset:35840
    v_mov_b64 v[28:29], 0
    v_smfmac_f32_16x16x64_bf16 v[32:35], v[88:91], a[152:159], v2
    v_mov_b64 v[30:31], 0
    s_waitcnt lgkmcnt(2)
    s_barrier
    ds_read_b128 v[16:19], v5 offset:14336
    v_smfmac_f32_16x16x64_bf16 v[36:39], v[88:91], a[160:167], v2
    v_add_f32_dpp v52, v54, v52 quad_perm:[2,3,0,1] row_mask:0xf bank_mask:0xf
    v_add_f32_dpp v53, v55, v53 quad_perm:[2,3,0,1] row_mask:0xf bank_mask:0xf
    v_smfmac_f32_16x16x64_bf16 v[32:35], v[92:95], a[168:175], v2
    v_mul_f32 v50, s28, v52
    v_mul_f32 v51, s28, v53
    v_smfmac_f32_16x16x64_bf16 v[36:39], v[92:95], a[176:183], v2
    v_exp_f32_dpp v52, v50 quad_perm:[0,1,0,1] row_mask:0xf bank_mask:0xf
    v_exp_f32_dpp v53, v51 quad_perm:[0,1,0,1] row_mask:0xf bank_mask:0xf
    s_waitcnt lgkmcnt(0)
    v_mfma_f32_16x16x32_bf16 v[24:27], v[12:15], v[16:19], 0
    v_mov_b32 v21, 0
    v_cvt_pk_bf16_f32 v20, v52, v53
    v_mfma_f32_16x16x32_bf16 v[40:43], v[64:67], v[16:19], 0
    v_add_f32 v32, v32, v33
    v_add_f32 v34, v34, v35
    v_cvt_pk_bf16_f32 v10, v32, v34
    v_mfma_f32_16x16x32_bf16 v[44:47], v[68:71], v[16:19], 0
    v_add_f32 v36, v36, v37
    v_add_f32 v38, v38, v39
    v_cvt_pk_bf16_f32 v11, v36, v38
    v_mfma_f32_16x16x16_bf16 v[24:27], v[12:13], v[20:21], v[24:27]
    v_mov_b32 v22, 0
    v_cvt_pk_bf16_f32 v23, v52, v53
    v_mfma_f32_16x16x16_bf16 v[40:43], v[10:11], v[20:21], v[40:43]
    v_mov_b64 v[32:33], 0
    v_mov_b64 v[34:35], 0
    v_mfma_f32_16x16x16_bf16 v[44:47], v[10:11], v[22:23], v[44:47]
    v_mov_b64 v[36:37], 0
    v_mov_b64 v[38:39], 0
    v_rcp_f32 v25, v24
    v_subrev_u32 v26, s29, v24
    v_cmp_le_u32 vcc, s30, v26
    v_mul_f32 v40, v25, v40
    v_mul_f32 v41, v25, v41
    v_mul_f32 v42, v25, v42
    v_mul_f32 v43, v25, v43
    v_cvt_pk_bf16_f32 v52, v40, v41
    v_cvt_pk_bf16_f32 v53, v42, v43
    v_mul_f32 v44, v25, v44
    v_mul_f32 v45, v25, v45
    v_mul_f32 v46, v25, v46
    v_mul_f32 v47, v25, v47
    v_cvt_pk_bf16_f32 v54, v44, v45
    v_cvt_pk_bf16_f32 v55, v46, v47
    ds_write_b128 v0, v[52:55] offset:11264
    s_cbranch_vccnz Ls1_fb
Ls1_fbd:
    v_smfmac_f32_16x16x64_bf16 v[32:35], v[52:55], v[56:63], v2 abid:1
    s_cmp_eq_u32 s14, s31
    s_mov_b64 exec, s[36:37]
    buffer_store_dwordx2 v[10:11], v3, s[4:7], s23 offen offset:2560 sc1
    s_mov_b64 exec, -1
    v_smfmac_f32_16x16x64_bf16 v[36:39], v[52:55], a[184:191], v2 abid:1
    ds_read_b128 v[88:91], v1 offset:36864
    ds_read_b128 v[92:95], v1 offset:37888
    s_waitcnt lgkmcnt(2)
    s_barrier
    ds_read_b128 v[16:19], v0 offset:10240
    v_smfmac_f32_16x16x64_bf16 v[28:31], v[52:55], a[192:199], v2 abid:1
    ds_read_b128 v[20:23], v0 offset:13312
    ds_read_b128 v[24:27], v0 offset:12288
    v_mov_b32 v1, v1
    s_cbranch_scc1 Ls1_exit
    v_mov_b32 v1, v1
    s_add_u32 s25, s16, 65536
    s_add_u32 s26, s16, 131072
    v_mov_b32 v1, v1
    s_waitcnt lgkmcnt(2)
    v_smfmac_f32_16x16x64_bf16 v[32:35], v[16:19], v[88:95], v2 abid:1
    ds_read_b128 v[64:67], v1 offset:38912
    s_waitcnt lgkmcnt(2)
    v_smfmac_f32_16x16x64_bf16 v[32:35], v[20:23], a[200:207], v2 abid:1
    ds_read_b128 v[68:71], v1 offset:39936
    s_waitcnt lgkmcnt(2)
    v_smfmac_f32_16x16x64_bf16 v[32:35], v[24:27], a[208:215], v2 abid:1
    s_nop 2
    v_smfmac_f32_16x16x64_bf16 v[36:39], v[16:19], a[216:223], v2 abid:1
    s_nop 2
    v_smfmac_f32_16x16x64_bf16 v[36:39], v[20:23], a[224:231], v2 abid:1
    s_waitcnt lgkmcnt(0)
    v_cvt_pk_bf16_f32 v32, v32, v33
    v_smfmac_f32_16x16x64_bf16 v[36:39], v[24:27], v[64:71], v2 abid:1
    s_nop 1
    v_and_or_b32 v32, v32, -2, s18
    v_smfmac_f32_16x16x64_bf16 v[28:31], v[16:19], a[232:239], v2 abid:1
    s_nop 0
    v_cvt_pk_bf16_f32 v33, v34, v35
    v_smfmac_f32_16x16x64_bf16 v[28:31], v[20:23], a[240:247], v2 abid:1
    buffer_store_dwordx2 v[32:33], v6, s[4:7], s16 offen sc1
    v_cvt_pk_bf16_f32 v36, v36, v37
    v_smfmac_f32_16x16x64_bf16 v[28:31], v[24:27], a[248:255], v2 abid:1
    s_nop 1
    v_and_or_b32 v36, v36, -2, s18
    v_cvt_pk_bf16_f32 v37, v38, v39
    buffer_store_dwordx2 v[36:37], v6, s[4:7], s25 offen sc1
    s_nop 2
    v_cvt_pk_bf16_f32 v28, v28, v29
    v_and_or_b32 v28, v28, -2, s18
    v_cvt_pk_bf16_f32 v29, v30, v31
    buffer_store_dwordx2 v[28:29], v6, s[4:7], s26 offen sc1
    s_add_u32 s99, s99, 262144
    s_lshr_b32 s23, s99, 8
    s_and_b32 s23, s23, 0x2000
    s_xor_b32 s23, s99, s23
    s_add_u32 s14, s14, 1
    s_add_u32 s98, s98, 1048576
    s_lshr_b32 s22, s98, 8
    s_and_b32 s22, s22, 0x2000
    s_xor_b32 s22, s98, s22
    s_add_u32 s32, s22, 16384
    s_waitcnt vmcnt(0)
    s_add_u32 s25, s14, 2
    s_min_u32 s25, s25, 64
    v_cmp_gt_u32 vcc, s25, v7
    s_cbranch_vccnz Ls1_kv
Ls1_kvd:
    s_xor_b32 s18, s18, 1
    s_barrier
    s_branch Ls1_top
Ls1_exit:
    s_waitcnt vmcnt(0) lgkmcnt(0)
    s_barrier
    s_waitcnt vmcnt(0) lgkmcnt(0)
    s_nop 11
    s_endpgm
Ls1_pc:
    buffer_load_dwordx4 v[48:51], v0, s[4:7], s19 offen offset:0 sc1
    buffer_load_dword v9, v8, s[4:7], s19 offen offset:3328 sc1
    s_sub_u32 s15, s15, 1
    s_cbranch_scc0 Ls1_pb
    s_mov_b32 s15, 0
    s_branch Ls1_pcd
Ls1_rr:
    buffer_load_dwordx4 v[12:15], v0, s[4:7], s21 offen offset:0 sc1
    buffer_load_dword v11, v8, s[4:7], s21 offen offset:3328 sc1
    s_waitcnt vmcnt(1)
    ds_write_b128 v0, v[12:15] offset:6144
    s_waitcnt vmcnt(0)
    ds_write_b32 v8, v11 offset:9472
    v_max3_u32 v9, v12, v13, v14
    v_max3_u32 v9, v9, v15, v11
    v_cmp_eq_u32 vcc, -1, v9
    s_waitcnt lgkmcnt(0)
    s_cbranch_vccz Ls1_rrd
    s_sub_u32 s15, s15, 1
    s_cbranch_scc0 Ls1_rr
    s_mov_b32 s15, 0
    s_branch Ls1_rrd
Ls1_fb:
    s_waitcnt lgkmcnt(0)
    s_nop 11
    s_barrier
    v_max_f32 v16, v48, v49
    v_max3_f32 v16, v16, v50, v51
    ds_write_b32 v0, v16 offset:4
    s_waitcnt lgkmcnt(0)
    s_barrier
    v_and_b32 v40, 0xff, v0
    ds_read_b128 v[16:19], v40 offset:0
    ds_read_b128 v[20:23], v40 offset:256
    ds_read_b128 v[88:91], v40 offset:512
    ds_read_b128 v[92:95], v40 offset:768
    s_waitcnt lgkmcnt(3)
    v_max_f32 v40, v16, v17
    v_max3_f32 v40, v40, v18, v19
    s_waitcnt lgkmcnt(2)
    v_max3_f32 v40, v40, v20, v21
    v_max3_f32 v40, v40, v22, v23
    s_waitcnt lgkmcnt(1)
    v_max3_f32 v40, v40, v88, v89
    v_max3_f32 v40, v40, v90, v91
    s_waitcnt lgkmcnt(0)
    v_max3_f32 v40, v40, v92, v93
    v_max3_f32 v40, v40, v94, v95
    v_sub_f32 v48, v48, v40
    v_sub_f32 v49, v49, v40
    v_sub_f32 v50, v50, v40
    v_sub_f32 v51, v51, v40
    v_exp_f32 v40, v48
    v_exp_f32 v41, v49
    s_nop 0
    v_cvt_pk_bf16_f32 v40, v40, v41
    ds_write_b32 v0, v40 offset:14340
    v_mov_b32 v21, 0
    v_exp_f32_dpp v52, v50 quad_perm:[0,1,0,1] row_mask:0xf bank_mask:0xf
    v_exp_f32_dpp v53, v51 quad_perm:[0,1,0,1] row_mask:0xf bank_mask:0xf
    v_mov_b32 v22, 0
    v_cvt_pk_bf16_f32 v20, v52, v53
    v_cvt_pk_bf16_f32 v23, v52, v53
    s_waitcnt lgkmcnt(0)
    s_barrier
    ds_read_b128 v[16:19], v5 offset:14336
    s_waitcnt lgkmcnt(0)
    v_mfma_f32_16x16x32_bf16 v[24:27], v[12:15], v[16:19], 0
    s_nop 2
    v_mfma_f32_16x16x32_bf16 v[40:43], v[64:67], v[16:19], 0
    s_nop 1
    s_nop 0
    v_mfma_f32_16x16x32_bf16 v[44:47], v[68:71], v[16:19], 0
    s_nop 1
    s_nop 0
    v_mfma_f32_16x16x16_bf16 v[24:27], v[12:13], v[20:21], v[24:27]
    s_nop 1
    s_nop 0
    v_mfma_f32_16x16x16_bf16 v[40:43], v[10:11], v[20:21], v[40:43]
    s_nop 2
    v_mfma_f32_16x16x16_bf16 v[44:47], v[10:11], v[22:23], v[44:47]
    s_nop 0
    v_rcp_f32 v25, v24
    s_nop 1
    v_mul_f32 v40, v25, v40
    v_mul_f32 v41, v25, v41
    v_mul_f32 v42, v25, v42
    v_mul_f32 v43, v25, v43
    v_cvt_pk_bf16_f32 v52, v40, v41
    v_cvt_pk_bf16_f32 v53, v42, v43
    v_mul_f32 v44, v25, v44
    v_mul_f32 v45, v25, v45
    v_mul_f32 v46, v25, v46
    v_mul_f32 v47, v25, v47
    v_cvt_pk_bf16_f32 v54, v44, v45
    v_cvt_pk_bf16_f32 v55, v46, v47
    ds_write_b128 v0, v[52:55] offset:11264
    s_waitcnt lgkmcnt(0)
    s_nop 11
    s_branch Ls1_fbd
Ls1_kv:
    v_and_b32 v9, 0x30, v0
    buffer_load_dword v7, v9, s[4:7], s27 offen sc1
    s_waitcnt vmcnt(0)
    v_cmp_gt_u32 vcc, s25, v7
    s_cbranch_vccz Ls1_kvd
    s_sub_u32 s15, s15, 1
    s_cbranch_scc0 Ls1_kv
    s_mov_b32 s15, 0
    s_branch Ls1_kvd
Ls2_top:
    v_mov_b64 v[56:57], v[72:73]
    v_mov_b64 v[58:59], v[74:75]
    v_mov_b64 v[60:61], v[76:77]
    v_mov_b64 v[62:63], v[78:79]
    v_mov_b64 v[64:65], v[80:81]
    v_mov_b64 v[66:67], v[82:83]
    v_mov_b64 v[68:69], v[84:85]
    v_mov_b64 v[70:71], v[86:87]
    buffer_load_dwordx4 v[48:51], v0, s[4:7], s19 offen offset:1024 sc1
    buffer_load_dword v9, v8, s[4:7], s19 offen offset:3584 sc1
    ds_read_b128 v[40:43], v1 offset:0
    ds_read_b128 v[44:47], v1 offset:1024
    ds_read_b128 v[80:83], v1 offset:2048
    ds_read_b128 v[84:87], v1 offset:3072
    ds_read_b128 v[88:91], v1 offset:4096
    ds_read_b128 v[92:95], v1 offset:5120
    ds_read_b128 v[72:75], v1 offset:6144
    ds_read_b128 v[76:79], v1 offset:7168
    v_mov_b64 v[32:33], 0
    v_mov_b64 v[34:35], 0
    v_mov_b64 v[36:37], 0
    v_mov_b64 v[38:39], 0
    v_mov_b64 v[16:17], 0
    v_mov_b64 v[18:19], 0
    v_mov_b64 v[20:21], 0
    v_mov_b64 v[22:23], 0
    v_mov_b64 v[24:25], 0
    v_mov_b64 v[26:27], 0
    v_mov_b64 v[28:29], 0
    v_mov_b64 v[30:31], 0
    buffer_load_dwordx4 v[48:51], v0, s[4:7], s19 offen offset:1024 sc1
    buffer_load_dword v9, v8, s[4:7], s19 offen offset:3584 sc1
    s_waitcnt lgkmcnt(0)
Ls2_pb:
    s_waitcnt vmcnt(3)
    v_max3_u32 v11, v48, v49, v50
    s_waitcnt vmcnt(2)
    v_max3_u32 v11, v11, v51, v9
    v_cmp_eq_u32 vcc, -1, v11
    ds_write_b128 v0, v[48:51] offset:2048
    ds_write_b32 v8, v9 offset:4608
    s_cbranch_vccnz Ls2_pc
Ls2_pcd:
    v_smfmac_f32_16x16x64_bf16 v[16:19], v[48:51], v[40:47], v2
    buffer_load_dwordx4 v[12:15], v0, s[4:7], s21 offen offset:1024 sc1
    v_smfmac_f32_16x16x64_bf16 v[20:23], v[48:51], v[80:87], v2
    buffer_load_dword v11, v8, s[4:7], s21 offen offset:3584 sc1
    v_smfmac_f32_16x16x64_bf16 v[24:27], v[48:51], v[88:95], v2
    s_waitcnt lgkmcnt(0)
    s_barrier
    ds_read_b128 v[40:43], v0 offset:3072
    v_smfmac_f32_16x16x64_bf16 v[28:31], v[48:51], v[72:79], v2
    ds_read_b128 v[44:47], v0 offset:0
    ds_read_b128 v[80:83], v1 offset:8192
    v_smfmac_f32_16x16x64_bf16 v[32:35], v[48:51], v[96:103], v2
    ds_read_b128 v[84:87], v1 offset:9216
    ds_read_b128 v[88:91], v1 offset:10240
    v_smfmac_f32_16x16x64_bf16 v[36:39], v[48:51], v[104:111], v2
    ds_read_b128 v[92:95], v1 offset:11264
Ls2_pad:
    s_waitcnt lgkmcnt(5)
    v_smfmac_f32_16x16x64_bf16 v[16:19], v[40:43], v[112:119], v2
    ds_read_b128 v[72:75], v1 offset:12288
    v_smfmac_f32_16x16x64_bf16 v[20:23], v[40:43], v[120:127], v2
    s_waitcnt lgkmcnt(3)
    s_add_u32 s19, s19, 16384
    ds_read_b128 v[76:79], v1 offset:13312
    v_smfmac_f32_16x16x64_bf16 v[24:27], v[40:43], v[80:87], v2
    ds_read_b128 v[80:83], v1 offset:14336
    v_smfmac_f32_16x16x64_bf16 v[28:31], v[40:43], v[128:135], v2
    s_waitcnt lgkmcnt(3)
    s_bitset0_b32 s19, 16
    ds_read_b128 v[84:87], v1 offset:15360
    v_smfmac_f32_16x16x64_bf16 v[32:35], v[40:43], v[88:95], v2
    ds_read_b128 v[88:91], v1 offset:16384
    v_smfmac_f32_16x16x64_bf16 v[36:39], v[40:43], v[136:143], v2
    s_waitcnt lgkmcnt(3)
    s_add_u32 s20, s20, 16384
    ds_read_b128 v[92:95], v1 offset:17408
    v_smfmac_f32_16x16x64_bf16 v[16:19], v[44:47], v[72:79], v2
    ds_read_b128 v[40:43], v0 offset:1024
    v_smfmac_f32_16x16x64_bf16 v[20:23], v[44:47], v[144:151], v2
    s_waitcnt lgkmcnt(3)
    s_bitset0_b32 s20, 16
    ds_read_b128 v[72:75], v1 offset:18432
    v_smfmac_f32_16x16x64_bf16 v[24:27], v[44:47], v[80:87], v2
    ds_read_b128 v[76:79], v1 offset:19456
    v_smfmac_f32_16x16x64_bf16 v[28:31], v[44:47], v[152:159], v2
    s_waitcnt lgkmcnt(3)
    s_add_u32 s24, s24, 16384
    ds_read_b128 v[80:83], v1 offset:20480
    v_smfmac_f32_16x16x64_bf16 v[32:35], v[44:47], v[88:95], v2
    ds_read_b128 v[84:87], v1 offset:21504
    v_smfmac_f32_16x16x64_bf16 v[36:39], v[44:47], v[160:167], v2
    s_waitcnt lgkmcnt(4)
    s_bitset0_b32 s24, 16
    ds_read_b128 v[44:47], v0 offset:4096
    v_smfmac_f32_16x16x64_bf16 v[16:19], v[40:43], v[168:175], v2
    s_waitcnt vmcnt(2)
    ds_read_b128 v[48:51], v1 offset:22528
    s_waitcnt lgkmcnt(4)
    v_smfmac_f32_16x16x64_bf16 v[20:23], v[40:43], v[72:79], v2
    ds_read_b128 v[52:55], v1 offset:23552
    v_smfmac_f32_16x16x64_bf16 v[24:27], v[40:43], v[176:183], v2
    s_xor_b32 s25, s24, 32768
    s_waitcnt lgkmcnt(3)
    v_smfmac_f32_16x16x64_bf16 v[28:31], v[40:43], v[80:87], v2
    v_smfmac_f32_16x16x64_bf16 v[32:35], v[40:43], v[184:191], v2
    s_xor_b32 s26, s20, 32768
    v_smfmac_f32_16x16x64_bf16 v[36:39], v[40:43], v[192:199], v2
    s_waitcnt lgkmcnt(0)
    v_smfmac_f32_16x16x64_bf16 v[16:19], v[44:47], v[48:55], v2
    v_smfmac_f32_16x16x64_bf16 v[20:23], v[44:47], v[200:207], v2
    v_smfmac_f32_16x16x64_bf16 v[24:27], v[44:47], v[208:215], v2
    v_smfmac_f32_16x16x64_bf16 v[28:31], v[44:47], v[216:223], v2
    s_waitcnt vmcnt(1)
    ds_write_b128 v0, v[12:15] offset:7168
    v_max3_u32 v9, v12, v13, v14
    s_waitcnt vmcnt(0)
    v_max3_u32 v9, v9, v15, v11
    v_cmp_eq_u32 vcc, -1, v9
    v_smfmac_f32_16x16x64_bf16 v[32:35], v[44:47], v[224:231], v2
    ds_write_b32 v8, v11 offset:9728
    v_smfmac_f32_16x16x64_bf16 v[36:39], v[44:47], v[232:239], v2
    s_cbranch_vccnz Ls2_rr
Ls2_rrd:
    v_smfmac_f32_16x16x64_bf16 v[16:19], v[12:15], v[240:247], v2
    s_add_u32 s21, s21, 16384
    s_bitset0_b32 s21, 16
    v_smfmac_f32_16x16x64_bf16 v[20:23], v[12:15], v[248:255], v2
    v_mov_b32 v10, -1
    v_smfmac_f32_16x16x64_bf16 v[24:27], v[12:15], a[0:7], v2
    s_waitcnt lgkmcnt(0)
    s_barrier
    ds_read_b128 v[40:43], v0 offset:8192
    v_smfmac_f32_16x16x64_bf16 v[28:31], v[12:15], a[8:15], v2
    ds_read_b128 v[44:47], v0 offset:5120
    v_smfmac_f32_16x16x64_bf16 v[32:35], v[12:15], a[16:23], v2
    ds_read_b128 v[88:91], v0 offset:6144
    v_smfmac_f32_16x16x64_bf16 v[36:39], v[12:15], a[24:31], v2
    ds_read_b128 v[92:95], v0 offset:9216
    s_waitcnt lgkmcnt(3)
    v_smfmac_f32_16x16x64_bf16 v[16:19], v[40:43], a[32:39], v2
    buffer_load_dwordx4 v[72:75], v0, s[4:7], s22 offen offset:0 sc1
    v_mov_b32 v12, 0x3f803f80
    v_smfmac_f32_16x16x64_bf16 v[20:23], v[40:43], a[40:47], v2
    s_waitcnt lgkmcnt(2)
    v_mov_b32 v13, 0x3f803f80
    v_smfmac_f32_16x16x64_bf16 v[16:19], v[44:47], a[48:55], v2
    buffer_store_dword v10, v7, s[4:7], s26 offen sc1
    v_mov_b32 v14, 0x3f803f80
    v_smfmac_f32_16x16x64_bf16 v[20:23], v[44:47], a[56:63], v2
    s_waitcnt lgkmcnt(1)
    v_mov_b32 v15, 0x3f803f80
    v_smfmac_f32_16x16x64_bf16 v[16:19], v[88:91], a[64:71], v2
    buffer_load_dwordx4 v[76:79], v0, s[4:7], s22 offen offset:1024 sc1
    v_smfmac_f32_16x16x64_bf16 v[20:23], v[88:91], a[72:79], v2
    s_waitcnt lgkmcnt(0)
    v_smfmac_f32_16x16x64_bf16 v[16:19], v[92:95], a[80:87], v2
    s_nop 1
    buffer_store_dword v10, v7, s[4:7], s25 offen sc1
    v_smfmac_f32_16x16x64_bf16 v[20:23], v[92:95], a[88:95], v2
    s_nop 0
    ds_read_b128 v[48:51], v1 offset:24576
    v_smfmac_f32_16x16x64_bf16 v[24:27], v[40:43], a[96:103], v2
    ds_read_b128 v[52:55], v1 offset:25600
    v_add_f32 v16, v16, v17
    v_add_f32 v18, v18, v19
    v_smfmac_f32_16x16x64_bf16 v[28:31], v[40:43], a[104:111], v2
    buffer_load_dwordx4 v[80:83], v0, s[4:7], s32 offen offset:0 sc1
    v_cvt_pk_bf16_f32 v16, v16, v18
    v_add_f32 v20, v20, v21
    v_smfmac_f32_16x16x64_bf16 v[24:27], v[44:47], a[112:119], v2
    v_add_f32 v22, v22, v23
    v_cvt_pk_bf16_f32 v17, v20, v22
    v_smfmac_f32_16x16x64_bf16 v[28:31], v[44:47], a[120:127], v2
    ds_write_b64 v3, v[16:17] offset:11264
    v_smfmac_f32_16x16x64_bf16 v[24:27], v[88:91], a[128:135], v2
    buffer_load_dwordx4 v[84:87], v0, s[4:7], s32 offen offset:1024 sc1
    v_smfmac_f32_16x16x64_bf16 v[28:31], v[88:91], a[136:143], v2
    v_smfmac_f32_16x16x64_bf16 v[24:27], v[92:95], a[144:151], v2
    v_smfmac_f32_16x16x64_bf16 v[28:31], v[92:95], a[152:159], v2
    s_waitcnt lgkmcnt(0)
    s_barrier
    ds_read_b64_tr_b16 v[16:17], v4 offset:10240
    v_smfmac_f32_16x16x64_bf16 v[32:35], v[40:43], v[48:55], v2
    ds_read_b64_tr_b16 v[18:19], v4 offset:10752
    ds_read_b64_tr_b16 v[20:21], v4 offset:11264
    ds_read_b64_tr_b16 v[22:23], v4 offset:11776
    v_add_f32 v24, v24, v25
    v_add_f32 v26, v26, v27
    v_cvt_pk_bf16_f32 v24, v24, v26
    v_add_f32 v28, v28, v29
    v_add_f32 v30, v30, v31
    v_cvt_pk_bf16_f32 v25, v28, v30
    v_smfmac_f32_16x16x64_bf16 v[36:39], v[40:43], a[160:167], v2
    ds_write_b64 v3, v[24:25] offset:13312
    s_waitcnt lgkmcnt(3)
    v_mfma_f32_16x16x32_bf16 v[48:51], v[56:59], v[16:19], 0
    s_waitcnt lgkmcnt(1)
    v_mfma_f32_16x16x32_bf16 v[48:51], v[60:63], v[20:23], v[48:51]
    v_smfmac_f32_16x16x64_bf16 v[32:35], v[44:47], a[168:175], v2
    s_waitcnt lgkmcnt(0)
    s_barrier
    ds_read_b64_tr_b16 v[24:25], v4 offset:12288
    v_smfmac_f32_16x16x64_bf16 v[36:39], v[44:47], a[176:183], v2
    ds_read_b64_tr_b16 v[26:27], v4 offset:12800
    ds_read_b64_tr_b16 v[28:29], v4 offset:13312
    ds_read_b64_tr_b16 v[30:31], v4 offset:13824
    v_add_f32_dpp v48, v50, v48 quad_perm:[2,3,0,1] row_mask:0xf bank_mask:0xf
    v_add_f32_dpp v49, v51, v49 quad_perm:[2,3,0,1] row_mask:0xf bank_mask:0xf
    v_exp_f32 v50, v48
    v_exp_f32 v51, v49
    s_nop 0
    v_cvt_pk_bf16_f32 v50, v50, v51
    ds_write_b32 v0, v50 offset:14344
    s_waitcnt lgkmcnt(3)
    v_mfma_f32_16x16x32_bf16 v[52:55], v[24:27], v[16:19], 0
    ds_read_b128 v[56:59], v1 offset:26624
    s_waitcnt lgkmcnt(2)
    v_mfma_f32_16x16x32_bf16 v[52:55], v[28:31], v[20:23], v[52:55]
    s_nop 1
    ds_read_b128 v[60:63], v1 offset:27648
    v_smfmac_f32_16x16x64_bf16 v[32:35], v[88:91], a[184:191], v2
    s_waitcnt lgkmcnt(2)
    s_barrier
    ds_read_b128 v[16:19], v5 offset:14336
    v_smfmac_f32_16x16x64_bf16 v[36:39], v[88:91], a[192:199], v2
    v_add_f32_dpp v52, v54, v52 quad_perm:[2,3,0,1] row_mask:0xf bank_mask:0xf
    v_add_f32_dpp v53, v55, v53 quad_perm:[2,3,0,1] row_mask:0xf bank_mask:0xf
    v_smfmac_f32_16x16x64_bf16 v[32:35], v[92:95], a[200:207], v2
    v_mul_f32 v50, s28, v52
    v_mul_f32 v51, s28, v53
    v_smfmac_f32_16x16x64_bf16 v[36:39], v[92:95], a[208:215], v2
    v_exp_f32_dpp v52, v50 quad_perm:[0,1,0,1] row_mask:0xf bank_mask:0xf
    v_exp_f32_dpp v53, v51 quad_perm:[0,1,0,1] row_mask:0xf bank_mask:0xf
    s_waitcnt lgkmcnt(0)
    v_mfma_f32_16x16x32_bf16 v[28:31], v[12:15], v[16:19], 0
    v_mov_b32 v21, 0
    v_cvt_pk_bf16_f32 v20, v52, v53
    v_mfma_f32_16x16x32_bf16 v[40:43], v[64:67], v[16:19], 0
    v_add_f32 v32, v32, v33
    v_add_f32 v34, v34, v35
    v_cvt_pk_bf16_f32 v10, v32, v34
    v_mfma_f32_16x16x32_bf16 v[44:47], v[68:71], v[16:19], 0
    v_add_f32 v36, v36, v37
    v_add_f32 v38, v38, v39
    v_cvt_pk_bf16_f32 v11, v36, v38
    v_mfma_f32_16x16x16_bf16 v[28:31], v[12:13], v[20:21], v[28:31]
    v_mov_b32 v22, 0
    v_cvt_pk_bf16_f32 v23, v52, v53
    v_mfma_f32_16x16x16_bf16 v[40:43], v[10:11], v[20:21], v[40:43]
    v_mov_b64 v[32:33], 0
    v_mov_b64 v[34:35], 0
    v_mfma_f32_16x16x16_bf16 v[44:47], v[10:11], v[22:23], v[44:47]
    v_mov_b64 v[36:37], 0
    v_mov_b64 v[38:39], 0
    v_rcp_f32 v29, v28
    v_subrev_u32 v30, s29, v28
    v_cmp_le_u32 vcc, s30, v30
    v_mul_f32 v40, v29, v40
    v_mul_f32 v41, v29, v41
    v_mul_f32 v42, v29, v42
    v_mul_f32 v43, v29, v43
    v_cvt_pk_bf16_f32 v52, v40, v41
    v_cvt_pk_bf16_f32 v53, v42, v43
    v_mul_f32 v44, v29, v44
    v_mul_f32 v45, v29, v45
    v_mul_f32 v46, v29, v46
    v_mul_f32 v47, v29, v47
    v_cvt_pk_bf16_f32 v54, v44, v45
    v_cvt_pk_bf16_f32 v55, v46, v47
    ds_write_b128 v0, v[52:55] offset:12288
    s_cbranch_vccnz Ls2_fb
Ls2_fbd:
    v_smfmac_f32_16x16x64_bf16 v[32:35], v[52:55], v[56:63], v2 abid:1
    s_cmp_eq_u32 s14, s31
    s_mov_b64 exec, s[36:37]
    buffer_store_dwordx2 v[10:11], v3, s[4:7], s23 offen offset:3072 sc1
    s_mov_b64 exec, -1
    s_mov_b64 exec, s[36:37]
    buffer_store_dwordx4 v[24:27], v0, s[4:7], s23 offen offset:0 sc1
    s_mov_b64 exec, -1
    ds_read_b128 v[88:91], v1 offset:28672
    ds_read_b128 v[92:95], v1 offset:29696
    s_waitcnt lgkmcnt(2)
    s_barrier
    ds_read_b128 v[16:19], v0 offset:13312
    v_smfmac_f32_16x16x64_bf16 v[36:39], v[52:55], a[216:223], v2 abid:1
    ds_read_b128 v[20:23], v0 offset:10240
    ds_read_b128 v[24:27], v0 offset:11264
    v_mov_b32 v1, v1
    s_cbranch_scc1 Ls2_exit
    v_mov_b32 v1, v1
    s_add_u32 s25, s16, 65536
    s_add_u32 s26, s16, 131072
    v_mov_b32 v1, v1
    s_waitcnt lgkmcnt(2)
    v_smfmac_f32_16x16x64_bf16 v[32:35], v[16:19], v[88:95], v2 abid:1
    ds_read_b128 v[64:67], v1 offset:30720
    s_waitcnt lgkmcnt(2)
    v_smfmac_f32_16x16x64_bf16 v[32:35], v[20:23], a[224:231], v2 abid:1
    ds_read_b128 v[68:71], v1 offset:31744
    s_waitcnt lgkmcnt(2)
    v_smfmac_f32_16x16x64_bf16 v[32:35], v[24:27], a[232:239], v2 abid:1
    s_nop 2
    v_smfmac_f32_16x16x64_bf16 v[36:39], v[16:19], a[240:247], v2 abid:1
    s_nop 2
    v_smfmac_f32_16x16x64_bf16 v[36:39], v[20:23], a[248:255], v2 abid:1
    s_waitcnt lgkmcnt(0)
    v_cvt_pk_bf16_f32 v32, v32, v33
    v_smfmac_f32_16x16x64_bf16 v[36:39], v[24:27], v[64:71], v2 abid:1
    s_nop 1
    v_and_or_b32 v32, v32, -2, s18
    v_cvt_pk_bf16_f32 v33, v34, v35
    buffer_store_dwordx2 v[32:33], v6, s[4:7], s16 offen sc1
    s_nop 2
    v_cvt_pk_bf16_f32 v36, v36, v37
    v_and_or_b32 v36, v36, -2, s18
    v_cvt_pk_bf16_f32 v37, v38, v39
    buffer_store_dwordx2 v[36:37], v6, s[4:7], s25 offen sc1
    s_add_u32 s99, s99, 262144
    s_lshr_b32 s23, s99, 8
    s_and_b32 s23, s23, 0x2000
    s_xor_b32 s23, s99, s23
    s_add_u32 s14, s14, 1
    s_add_u32 s98, s98, 1048576
    s_lshr_b32 s22, s98, 8
    s_and_b32 s22, s22, 0x2000
    s_xor_b32 s22, s98, s22
    s_add_u32 s32, s22, 16384
    v_mov_b32 v52, 0x3f80
    v_cndmask_b32 v52, v52, 1.0, s[46:47]
    v_cndmask_b32 v48, 0, v52, s[38:39]
    v_cndmask_b32 v49, 0, v52, s[40:41]
    v_cndmask_b32 v50, 0, v52, s[42:43]
    v_cndmask_b32 v51, 0, v52, s[44:45]
    s_waitcnt vmcnt(0)
    buffer_load_dwordx4 v[16:19], v0, s[4:7], s17 offen offset:0 sc1
    buffer_load_dwordx4 v[20:23], v0, s[4:7], s17 offen offset:1024 sc1
    buffer_load_dwordx4 v[24:27], v0, s[4:7], s17 offen offset:2048 sc1
    buffer_load_dwordx4 v[28:31], v0, s[4:7], s17 offen offset:3072 sc1
    ds_read_b128 v[12:15], v0
    s_waitcnt lgkmcnt(0)
    buffer_load_dwordx4 v[56:59], v0, s[4:7], s17 offen offset:0 sc1
    buffer_load_dwordx4 v[60:63], v0, s[4:7], s17 offen offset:1024 sc1
    buffer_load_dwordx4 v[64:67], v0, s[4:7], s17 offen offset:2048 sc1
    buffer_load_dwordx4 v[68:71], v0, s[4:7], s17 offen offset:3072 sc1
    s_waitcnt vmcnt(7)
    v_mfma_f32_16x16x32_bf16 v[52:55], v[48:51], v[16:19], 0
    v_bitop3_b32 v17, v16, v18, s18 bitop3:0x7e
    s_waitcnt vmcnt(6)
    v_mfma_f32_16x16x32_bf16 v[52:55], v[48:51], v[20:23], v[52:55]
    v_bitop3_b32 v21, v20, v22, s18 bitop3:0x7e
    s_waitcnt vmcnt(5)
    v_mfma_f32_16x16x32_bf16 v[52:55], v[48:51], v[24:27], v[52:55]
    v_bitop3_b32 v25, v24, v26, s18 bitop3:0x7e
    v_or3_b32 v17, v17, v21, v25
    v_and_b32 v17, 1, v17
    s_waitcnt vmcnt(4)
    v_mfma_f32_16x16x32_bf16 v[52:55], v[48:51], v[28:31], v[52:55]
    s_nop 0
    v_bitop3_b32 v29, v28, v30, s18 bitop3:0x7e
    v_and_or_b32 v17, v29, 1, v17
    v_cmp_ne_u32 vcc, 0, v17
    s_nop 1
    v_mov_b32 v1, v1
    s_nop 0
    v_add_f32_dpp v54, v52, v52 row_ror:8 row_mask:0xf bank_mask:0xf
    v_add_f32_dpp v55, v53, v53 row_ror:8 row_mask:0xf bank_mask:0xf
    v_cvt_pk_bf16_f32 v11, v54, v55
    s_cbranch_vccnz Ls2_r1
Ls2_r1d:
    buffer_store_dword v11, v7, s[4:7], s20 offen sc1
    buffer_store_dword v11, v7, s[4:7], s24 offen sc1
    v_mov_b64 v[48:49], -1
    v_mov_b64 v[50:51], -1
    v_mov_b32 v9, -1
    s_xor_b32 s18, s18, 1
    s_waitcnt vmcnt(2)
    s_barrier
    s_branch Ls2_top
Ls2_exit:
    s_waitcnt vmcnt(0) lgkmcnt(0)
    s_barrier
    s_waitcnt vmcnt(0) lgkmcnt(0)
    s_nop 11
    s_endpgm
Ls2_pc:
    buffer_load_dwordx4 v[48:51], v0, s[4:7], s19 offen offset:1024 sc1
    buffer_load_dword v9, v8, s[4:7], s19 offen offset:3584 sc1
    s_sub_u32 s15, s15, 1
    s_cbranch_scc0 Ls2_pb
    s_mov_b32 s15, 0
    s_branch Ls2_pcd
Ls2_rr:
    buffer_load_dwordx4 v[12:15], v0, s[4:7], s21 offen offset:1024 sc1
    buffer_load_dword v11, v8, s[4:7], s21 offen offset:3584 sc1
    s_waitcnt vmcnt(1)
    ds_write_b128 v0, v[12:15] offset:7168
    s_waitcnt vmcnt(0)
    ds_write_b32 v8, v11 offset:9728
    v_max3_u32 v9, v12, v13, v14
    v_max3_u32 v9, v9, v15, v11
    v_cmp_eq_u32 vcc, -1, v9
    s_waitcnt lgkmcnt(0)
    s_cbranch_vccz Ls2_rrd
    s_sub_u32 s15, s15, 1
    s_cbranch_scc0 Ls2_rr
    s_mov_b32 s15, 0
    s_branch Ls2_rrd
Ls2_fb:
    s_waitcnt lgkmcnt(0)
    s_nop 11
    s_barrier
    v_max_f32 v16, v48, v49
    v_max3_f32 v16, v16, v50, v51
    ds_write_b32 v0, v16 offset:8
    s_waitcnt lgkmcnt(0)
    s_barrier
    v_and_b32 v40, 0xff, v0
    ds_read_b128 v[16:19], v40 offset:0
    ds_read_b128 v[20:23], v40 offset:256
    ds_read_b128 v[88:91], v40 offset:512
    ds_read_b128 v[92:95], v40 offset:768
    s_waitcnt lgkmcnt(3)
    v_max_f32 v40, v16, v17
    v_max3_f32 v40, v40, v18, v19
    s_waitcnt lgkmcnt(2)
    v_max3_f32 v40, v40, v20, v21
    v_max3_f32 v40, v40, v22, v23
    s_waitcnt lgkmcnt(1)
    v_max3_f32 v40, v40, v88, v89
    v_max3_f32 v40, v40, v90, v91
    s_waitcnt lgkmcnt(0)
    v_max3_f32 v40, v40, v92, v93
    v_max3_f32 v40, v40, v94, v95
    v_sub_f32 v48, v48, v40
    v_sub_f32 v49, v49, v40
    v_sub_f32 v50, v50, v40
    v_sub_f32 v51, v51, v40
    v_exp_f32 v40, v48
    v_exp_f32 v41, v49
    s_nop 0
    v_cvt_pk_bf16_f32 v40, v40, v41
    ds_write_b32 v0, v40 offset:14344
    v_mov_b32 v21, 0
    v_exp_f32_dpp v52, v50 quad_perm:[0,1,0,1] row_mask:0xf bank_mask:0xf
    v_exp_f32_dpp v53, v51 quad_perm:[0,1,0,1] row_mask:0xf bank_mask:0xf
    v_mov_b32 v22, 0
    v_cvt_pk_bf16_f32 v20, v52, v53
    v_cvt_pk_bf16_f32 v23, v52, v53
    s_waitcnt lgkmcnt(0)
    s_barrier
    ds_read_b128 v[16:19], v5 offset:14336
    s_waitcnt lgkmcnt(0)
    v_mfma_f32_16x16x32_bf16 v[28:31], v[12:15], v[16:19], 0
    s_nop 2
    v_mfma_f32_16x16x32_bf16 v[40:43], v[64:67], v[16:19], 0
    s_nop 1
    s_nop 0
    v_mfma_f32_16x16x32_bf16 v[44:47], v[68:71], v[16:19], 0
    s_nop 1
    s_nop 0
    v_mfma_f32_16x16x16_bf16 v[28:31], v[12:13], v[20:21], v[28:31]
    s_nop 1
    s_nop 0
    v_mfma_f32_16x16x16_bf16 v[40:43], v[10:11], v[20:21], v[40:43]
    s_nop 2
    v_mfma_f32_16x16x16_bf16 v[44:47], v[10:11], v[22:23], v[44:47]
    s_nop 0
    v_rcp_f32 v29, v28
    s_nop 1
    v_mul_f32 v40, v29, v40
    v_mul_f32 v41, v29, v41
    v_mul_f32 v42, v29, v42
    v_mul_f32 v43, v29, v43
    v_cvt_pk_bf16_f32 v52, v40, v41
    v_cvt_pk_bf16_f32 v53, v42, v43
    v_mul_f32 v44, v29, v44
    v_mul_f32 v45, v29, v45
    v_mul_f32 v46, v29, v46
    v_mul_f32 v47, v29, v47
    v_cvt_pk_bf16_f32 v54, v44, v45
    v_cvt_pk_bf16_f32 v55, v46, v47
    ds_write_b128 v0, v[52:55] offset:12288
    s_waitcnt lgkmcnt(0)
    s_nop 11
    s_branch Ls2_fbd
Ls2_r1:
    buffer_load_dwordx4 v[16:19], v0, s[4:7], s17 offen offset:0 sc1
    buffer_load_dwordx4 v[20:23], v0, s[4:7], s17 offen offset:1024 sc1
    buffer_load_dwordx4 v[24:27], v0, s[4:7], s17 offen offset:2048 sc1
    buffer_load_dwordx4 v[28:31], v0, s[4:7], s17 offen offset:3072 sc1
    s_waitcnt vmcnt(7)
    v_mfma_f32_16x16x32_bf16 v[52:55], v[48:51], v[56:59], 0
    v_bitop3_b32 v57, v56, v58, s18 bitop3:0x7e
    s_waitcnt vmcnt(6)
    v_mfma_f32_16x16x32_bf16 v[52:55], v[48:51], v[60:63], v[52:55]
    v_bitop3_b32 v61, v60, v62, s18 bitop3:0x7e
    s_waitcnt vmcnt(5)
    v_mfma_f32_16x16x32_bf16 v[52:55], v[48:51], v[64:67], v[52:55]
    v_bitop3_b32 v65, v64, v66, s18 bitop3:0x7e
    v_or3_b32 v57, v57, v61, v65
    v_and_b32 v57, 1, v57
    s_waitcnt vmcnt(4)
    v_mfma_f32_16x16x32_bf16 v[52:55], v[48:51], v[68:71], v[52:55]
    s_nop 0
    v_bitop3_b32 v69, v68, v70, s18 bitop3:0x7e
    v_and_or_b32 v57, v69, 1, v57
    v_cmp_ne_u32 vcc, 0, v57
    s_nop 3
    v_add_f32_dpp v54, v52, v52 row_ror:8 row_mask:0xf bank_mask:0xf
    v_add_f32_dpp v55, v53, v53 row_ror:8 row_mask:0xf bank_mask:0xf
    v_cvt_pk_bf16_f32 v11, v54, v55
    s_cbranch_vccz Ls2_r1d
    buffer_load_dwordx4 v[56:59], v0, s[4:7], s17 offen offset:0 sc1
    buffer_load_dwordx4 v[60:63], v0, s[4:7], s17 offen offset:1024 sc1
    buffer_load_dwordx4 v[64:67], v0, s[4:7], s17 offen offset:2048 sc1
    buffer_load_dwordx4 v[68:71], v0, s[4:7], s17 offen offset:3072 sc1
    s_waitcnt vmcnt(7)
    v_mfma_f32_16x16x32_bf16 v[52:55], v[48:51], v[16:19], 0
    v_bitop3_b32 v17, v16, v18, s18 bitop3:0x7e
    s_waitcnt vmcnt(6)
    v_mfma_f32_16x16x32_bf16 v[52:55], v[48:51], v[20:23], v[52:55]
    v_bitop3_b32 v21, v20, v22, s18 bitop3:0x7e
    s_waitcnt vmcnt(5)
    v_mfma_f32_16x16x32_bf16 v[52:55], v[48:51], v[24:27], v[52:55]
    v_bitop3_b32 v25, v24, v26, s18 bitop3:0x7e
    v_or3_b32 v17, v17, v21, v25
    v_and_b32 v17, 1, v17
    s_waitcnt vmcnt(4)
    v_mfma_f32_16x16x32_bf16 v[52:55], v[48:51], v[28:31], v[52:55]
    s_nop 0
    v_bitop3_b32 v29, v28, v30, s18 bitop3:0x7e
    v_and_or_b32 v17, v29, 1, v17
    v_cmp_ne_u32 vcc, 0, v17
    s_nop 3
    v_add_f32_dpp v54, v52, v52 row_ror:8 row_mask:0xf bank_mask:0xf
    v_add_f32_dpp v55, v53, v53 row_ror:8 row_mask:0xf bank_mask:0xf
    v_cvt_pk_bf16_f32 v11, v54, v55
    s_cbranch_vccz Ls2_r1d
    s_sub_u32 s15, s15, 1
    s_cbranch_scc0 Ls2_r1
    s_mov_b32 s15, 0
    s_branch Ls2_r1d
Ls3_top:
    v_mov_b64 v[56:57], v[72:73]
    v_mov_b64 v[58:59], v[74:75]
    v_mov_b64 v[60:61], v[76:77]
    v_mov_b64 v[62:63], v[78:79]
    v_mov_b64 v[64:65], v[80:81]
    v_mov_b64 v[66:67], v[82:83]
    v_mov_b64 v[68:69], v[84:85]
    v_mov_b64 v[70:71], v[86:87]
    buffer_load_dwordx4 v[48:51], v0, s[4:7], s19 offen offset:2048 sc1
    buffer_load_dword v9, v8, s[4:7], s19 offen offset:3840 sc1
    ds_read_b128 v[40:43], v1 offset:0
    ds_read_b128 v[44:47], v1 offset:1024
    ds_read_b128 v[80:83], v1 offset:2048
    ds_read_b128 v[84:87], v1 offset:3072
    ds_read_b128 v[88:91], v1 offset:4096
    ds_read_b128 v[92:95], v1 offset:5120
    ds_read_b128 v[72:75], v1 offset:6144
    ds_read_b128 v[76:79], v1 offset:7168
    v_mov_b64 v[32:33], 0
    v_mov_b64 v[34:35], 0
    v_mov_b64 v[36:37], 0
    v_mov_b64 v[38:39], 0
    v_mov_b64 v[16:17], 0
    v_mov_b64 v[18:19], 0
    v_mov_b64 v[20:21], 0
    v_mov_b64 v[22:23], 0
    v_mov_b64 v[24:25], 0
    v_mov_b64 v[26:27], 0
    v_mov_b64 v[28:29], 0
    v_mov_b64 v[30:31], 0
    buffer_load_dwordx4 v[48:51], v0, s[4:7], s19 offen offset:2048 sc1
    buffer_load_dword v9, v8, s[4:7], s19 offen offset:3840 sc1
    s_waitcnt lgkmcnt(0)
Ls3_pb:
    s_waitcnt vmcnt(3)
    v_max3_u32 v11, v48, v49, v50
    s_waitcnt vmcnt(2)
    v_max3_u32 v11, v11, v51, v9
    v_cmp_eq_u32 vcc, -1, v11
    ds_write_b128 v0, v[48:51] offset:3072
    ds_write_b32 v8, v9 offset:4864
    s_cbranch_vccnz Ls3_pc
Ls3_pcd:
    v_smfmac_f32_16x16x64_bf16 v[16:19], v[48:51], v[40:47], v2
    buffer_load_dwordx4 v[12:15], v0, s[4:7], s21 offen offset:2048 sc1
    v_smfmac_f32_16x16x64_bf16 v[20:23], v[48:51], v[80:87], v2
    buffer_load_dword v11, v8, s[4:7], s21 offen offset:3840 sc1
    v_smfmac_f32_16x16x64_bf16 v[24:27], v[48:51], v[88:95], v2
    s_waitcnt lgkmcnt(0)
    s_barrier
    ds_read_b128 v[40:43], v0 offset:2048
    v_smfmac_f32_16x16x64_bf16 v[28:31], v[48:51], v[72:79], v2
    ds_read_b128 v[44:47], v0 offset:1024
    ds_read_b128 v[80:83], v1 offset:8192
    v_smfmac_f32_16x16x64_bf16 v[32:35], v[48:51], v[96:103], v2
    ds_read_b128 v[84:87], v1 offset:9216
    ds_read_b128 v[88:91], v1 offset:10240
    v_smfmac_f32_16x16x64_bf16 v[36:39], v[48:51], v[104:111], v2
    ds_read_b128 v[92:95], v1 offset:11264
Ls3_pad:
    s_waitcnt lgkmcnt(5)
    v_smfmac_f32_16x16x64_bf16 v[16:19], v[40:43], v[112:119], v2
    ds_read_b128 v[72:75], v1 offset:12288
    v_mov_b32 v10, s14
    v_smfmac_f32_16x16x64_bf16 v[20:23], v[40:43], v[120:127], v2
    s_waitcnt lgkmcnt(3)
    s_add_u32 s19, s19, 16384
    ds_read_b128 v[76:79], v1 offset:13312
    v_smfmac_f32_16x16x64_bf16 v[24:27], v[40:43], v[80:87], v2
    ds_read_b128 v[80:83], v1 offset:14336
    buffer_store_dword v10, off, s[4:7], s100 sc1
    v_smfmac_f32_16x16x64_bf16 v[28:31], v[40:43], v[128:135], v2
    s_waitcnt lgkmcnt(3)
    s_bitset0_b32 s19, 16
    ds_read_b128 v[84:87], v1 offset:15360
    v_smfmac_f32_16x16x64_bf16 v[32:35], v[40:43], v[88:95], v2
    ds_read_b128 v[88:91], v1 offset:16384
    v_smfmac_f32_16x16x64_bf16 v[36:39], v[40:43], v[136:143], v2
    s_waitcnt lgkmcnt(3)
    s_add_u32 s20, s20, 16384
    ds_read_b128 v[92:95], v1 offset:17408
    v_smfmac_f32_16x16x64_bf16 v[16:19], v[44:47], v[72:79], v2
    ds_read_b128 v[40:43], v0 offset:0
    v_smfmac_f32_16x16x64_bf16 v[20:23], v[44:47], v[144:151], v2
    s_waitcnt lgkmcnt(3)
    s_bitset0_b32 s20, 16
    ds_read_b128 v[72:75], v1 offset:18432
    v_smfmac_f32_16x16x64_bf16 v[24:27], v[44:47], v[80:87], v2
    ds_read_b128 v[76:79], v1 offset:19456
    v_smfmac_f32_16x16x64_bf16 v[28:31], v[44:47], v[152:159], v2
    s_waitcnt lgkmcnt(3)
    s_add_u32 s24, s24, 16384
    ds_read_b128 v[80:83], v1 offset:20480
    v_smfmac_f32_16x16x64_bf16 v[32:35], v[44:47], v[88:95], v2
    ds_read_b128 v[84:87], v1 offset:21504
    v_smfmac_f32_16x16x64_bf16 v[36:39], v[44:47], v[160:167], v2
    s_waitcnt lgkmcnt(4)
    s_bitset0_b32 s24, 16
    ds_read_b128 v[44:47], v0 offset:4096
    v_smfmac_f32_16x16x64_bf16 v[16:19], v[40:43], v[168:175], v2
    s_waitcnt vmcnt(3)
    ds_read_b128 v[48:51], v1 offset:22528
    s_waitcnt lgkmcnt(4)
    v_smfmac_f32_16x16x64_bf16 v[20:23], v[40:43], v[72:79], v2
    ds_read_b128 v[52:55], v1 offset:23552
    v_smfmac_f32_16x16x64_bf16 v[24:27], v[40:43], v[176:183], v2
    s_waitcnt lgkmcnt(3)
    v_smfmac_f32_16x16x64_bf16 v[28:31], v[40:43], v[80:87], v2
    v_smfmac_f32_16x16x64_bf16 v[32:35], v[40:43], v[184:191], v2
    v_smfmac_f32_16x16x64_bf16 v[36:39], v[40:43], v[192:199], v2
    s_waitcnt lgkmcnt(0)
    v_smfmac_f32_16x16x64_bf16 v[16:19], v[44:47], v[48:55], v2
    v_smfmac_f32_16x16x64_bf16 v[20:23], v[44:47], v[200:207], v2
    v_smfmac_f32_16x16x64_bf16 v[24:27], v[44:47], v[208:215], v2
    v_smfmac_f32_16x16x64_bf16 v[28:31], v[44:47], v[216:223], v2
    s_waitcnt vmcnt(2)
    ds_write_b128 v0, v[12:15] offset:8192
    v_max3_u32 v9, v12, v13, v14
    s_waitcnt vmcnt(1)
    v_max3_u32 v9, v9, v15, v11
    v_cmp_eq_u32 vcc, -1, v9
    v_smfmac_f32_16x16x64_bf16 v[32:35], v[44:47], v[224:231], v2
    ds_write_b32 v8, v11 offset:9984
    v_smfmac_f32_16x16x64_bf16 v[36:39], v[44:47], v[232:239], v2
    s_cbranch_vccnz Ls3_rr
Ls3_rrd:
    v_smfmac_f32_16x16x64_bf16 v[16:19], v[12:15], v[240:247], v2
    s_add_u32 s21, s21, 16384
    s_bitset0_b32 s21, 16
    v_smfmac_f32_16x16x64_bf16 v[20:23], v[12:15], v[248:255], v2
    v_smfmac_f32_16x16x64_bf16 v[24:27], v[12:15], a[0:7], v2
    s_waitcnt lgkmcnt(0)
    s_barrier
    ds_read_b128 v[40:43], v0 offset:7168
    v_smfmac_f32_16x16x64_bf16 v[28:31], v[12:15], a[8:15], v2
    ds_read_b128 v[44:47], v0 offset:6144
    v_smfmac_f32_16x16x64_bf16 v[32:35], v[12:15], a[16:23], v2
    ds_read_b128 v[88:91], v0 offset:5120
    v_smfmac_f32_16x16x64_bf16 v[36:39], v[12:15], a[24:31], v2
    ds_read_b128 v[92:95], v0 offset:9216
    s_waitcnt lgkmcnt(3)
    v_smfmac_f32_16x16x64_bf16 v[16:19], v[40:43], a[32:39], v2
    v_mov_b32 v12, 0x3f803f80
    v_smfmac_f32_16x16x64_bf16 v[20:23], v[40:43], a[40:47], v2
    s_waitcnt lgkmcnt(2)
    buffer_load_dwordx4 v[72:75], v0, s[4:7], s22 offen offset:0 sc1
    v_mov_b32 v13, 0x3f803f80
    v_smfmac_f32_16x16x64_bf16 v[16:19], v[44:47], a[48:55], v2
    v_mov_b32 v14, 0x3f803f80
    v_smfmac_f32_16x16x64_bf16 v[20:23], v[44:47], a[56:63], v2
    s_waitcnt lgkmcnt(1)
    v_mov_b32 v15, 0x3f803f80
    v_smfmac_f32_16x16x64_bf16 v[16:19], v[88:91], a[64:71], v2
    v_smfmac_f32_16x16x64_bf16 v[20:23], v[88:91], a[72:79], v2
    buffer_load_dwordx4 v[76:79], v0, s[4:7], s22 offen offset:1024 sc1
    s_waitcnt lgkmcnt(0)
    v_smfmac_f32_16x16x64_bf16 v[16:19], v[92:95], a[80:87], v2
    s_nop 2
    v_smfmac_f32_16x16x64_bf16 v[20:23], v[92:95], a[88:95], v2
    s_nop 0
    ds_read_b128 v[48:51], v1 offset:24576
    v_smfmac_f32_16x16x64_bf16 v[24:27], v[40:43], a[96:103], v2
    ds_read_b128 v[52:55], v1 offset:25600
    v_add_f32 v16, v16, v17
    v_add_f32 v18, v18, v19
    v_smfmac_f32_16x16x64_bf16 v[28:31], v[40:43], a[104:111], v2
    v_cvt_pk_bf16_f32 v16, v16, v18
    v_add_f32 v20, v20, v21
    v_smfmac_f32_16x16x64_bf16 v[24:27], v[44:47], a[112:119], v2
    buffer_load_dwordx4 v[80:83], v0, s[4:7], s32 offen offset:0 sc1
    v_add_f32 v22, v22, v23
    v_cvt_pk_bf16_f32 v17, v20, v22
    v_smfmac_f32_16x16x64_bf16 v[28:31], v[44:47], a[120:127], v2
    ds_write_b64 v3, v[16:17] offset:11776
    v_smfmac_f32_16x16x64_bf16 v[24:27], v[88:91], a[128:135], v2
    buffer_load_dwordx4 v[84:87], v0, s[4:7], s32 offen offset:1024 sc1
    v_smfmac_f32_16x16x64_bf16 v[28:31], v[88:91], a[136:143], v2
    v_smfmac_f32_16x16x64_bf16 v[24:27], v[92:95], a[144:151], v2
    v_smfmac_f32_16x16x64_bf16 v[28:31], v[92:95], a[152:159], v2
    s_waitcnt lgkmcnt(0)
    s_barrier
    ds_read_b64_tr_b16 v[16:17], v4 offset:10240
    v_smfmac_f32_16x16x64_bf16 v[32:35], v[40:43], v[48:55], v2
    ds_read_b64_tr_b16 v[18:19], v4 offset:10752
    ds_read_b64_tr_b16 v[20:21], v4 offset:11264
    ds_read_b64_tr_b16 v[22:23], v4 offset:11776
    v_add_f32 v24, v24, v25
    v_add_f32 v26, v26, v27
    v_cvt_pk_bf16_f32 v24, v24, v26
    v_add_f32 v28, v28, v29
    v_add_f32 v30, v30, v31
    v_cvt_pk_bf16_f32 v25, v28, v30
    v_smfmac_f32_16x16x64_bf16 v[36:39], v[40:43], a[160:167], v2
    ds_write_b64 v3, v[24:25] offset:13824
    s_waitcnt lgkmcnt(3)
    v_mfma_f32_16x16x32_bf16 v[48:51], v[56:59], v[16:19], 0
    s_waitcnt lgkmcnt(1)
    v_mfma_f32_16x16x32_bf16 v[48:51], v[60:63], v[20:23], v[48:51]
    v_smfmac_f32_16x16x64_bf16 v[32:35], v[44:47], a[168:175], v2
    s_waitcnt lgkmcnt(0)
    s_barrier
    ds_read_b64_tr_b16 v[24:25], v4 offset:12288
    v_smfmac_f32_16x16x64_bf16 v[36:39], v[44:47], a[176:183], v2
    ds_read_b64_tr_b16 v[26:27], v4 offset:12800
    ds_read_b64_tr_b16 v[28:29], v4 offset:13312
    ds_read_b64_tr_b16 v[30:31], v4 offset:13824
    v_add_f32_dpp v48, v50, v48 quad_perm:[2,3,0,1] row_mask:0xf bank_mask:0xf
    v_add_f32_dpp v49, v51, v49 quad_perm:[2,3,0,1] row_mask:0xf bank_mask:0xf
    v_exp_f32 v50, v48
    v_exp_f32 v51, v49
    s_nop 0
    v_cvt_pk_bf16_f32 v50, v50, v51
    ds_write_b32 v0, v50 offset:14348
    s_waitcnt lgkmcnt(3)
    v_mfma_f32_16x16x32_bf16 v[52:55], v[24:27], v[16:19], 0
    ds_read_b128 v[56:59], v1 offset:26624
    s_waitcnt lgkmcnt(2)
    v_mfma_f32_16x16x32_bf16 v[52:55], v[28:31], v[20:23], v[52:55]
    s_nop 1
    ds_read_b128 v[60:63], v1 offset:27648
    v_smfmac_f32_16x16x64_bf16 v[32:35], v[88:91], a[184:191], v2
    s_waitcnt lgkmcnt(2)
    s_barrier
    ds_read_b128 v[16:19], v5 offset:14336
    v_smfmac_f32_16x16x64_bf16 v[36:39], v[88:91], a[192:199], v2
    v_add_f32_dpp v52, v54, v52 quad_perm:[2,3,0,1] row_mask:0xf bank_mask:0xf
    v_add_f32_dpp v53, v55, v53 quad_perm:[2,3,0,1] row_mask:0xf bank_mask:0xf
    v_smfmac_f32_16x16x64_bf16 v[32:35], v[92:95], a[200:207], v2
    v_mul_f32 v50, s28, v52
    v_mul_f32 v51, s28, v53
    v_smfmac_f32_16x16x64_bf16 v[36:39], v[92:95], a[208:215], v2
    v_exp_f32_dpp v52, v50 quad_perm:[0,1,0,1] row_mask:0xf bank_mask:0xf
    v_exp_f32_dpp v53, v51 quad_perm:[0,1,0,1] row_mask:0xf bank_mask:0xf
    s_waitcnt lgkmcnt(0)
    v_mfma_f32_16x16x32_bf16 v[24:27], v[12:15], v[16:19], 0
    v_mov_b32 v21, 0
    v_cvt_pk_bf16_f32 v20, v52, v53
    v_mfma_f32_16x16x32_bf16 v[40:43], v[64:67], v[16:19], 0
    v_add_f32 v32, v32, v33
    v_add_f32 v34, v34, v35
    v_cvt_pk_bf16_f32 v10, v32, v34
    v_mfma_f32_16x16x32_bf16 v[44:47], v[68:71], v[16:19], 0
    v_add_f32 v36, v36, v37
    v_add_f32 v38, v38, v39
    v_cvt_pk_bf16_f32 v11, v36, v38
    v_mfma_f32_16x16x16_bf16 v[24:27], v[12:13], v[20:21], v[24:27]
    v_mov_b32 v22, 0
    v_cvt_pk_bf16_f32 v23, v52, v53
    v_mfma_f32_16x16x16_bf16 v[40:43], v[10:11], v[20:21], v[40:43]
    v_mov_b64 v[32:33], 0
    v_mov_b64 v[34:35], 0
    v_mfma_f32_16x16x16_bf16 v[44:47], v[10:11], v[22:23], v[44:47]
    v_mov_b64 v[36:37], 0
    v_mov_b64 v[38:39], 0
    v_rcp_f32 v25, v24
    v_subrev_u32 v26, s29, v24
    v_cmp_le_u32 vcc, s30, v26
    v_mul_f32 v40, v25, v40
    v_mul_f32 v41, v25, v41
    v_mul_f32 v42, v25, v42
    v_mul_f32 v43, v25, v43
    v_cvt_pk_bf16_f32 v52, v40, v41
    v_cvt_pk_bf16_f32 v53, v42, v43
    v_mul_f32 v44, v25, v44
    v_mul_f32 v45, v25, v45
    v_mul_f32 v46, v25, v46
    v_mul_f32 v47, v25, v47
    v_cvt_pk_bf16_f32 v54, v44, v45
    v_cvt_pk_bf16_f32 v55, v46, v47
    ds_write_b128 v0, v[52:55] offset:13312
    s_cbranch_vccnz Ls3_fb
Ls3_fbd:
    v_smfmac_f32_16x16x64_bf16 v[32:35], v[52:55], v[56:63], v2 abid:1
    s_cmp_eq_u32 s14, s31
    s_mov_b64 exec, s[36:37]
    buffer_store_dwordx2 v[10:11], v3, s[4:7], s23 offen offset:3584 sc1
    s_mov_b64 exec, -1
    s_mov_b64 exec, s[36:37]
    buffer_store_dwordx4 v[28:31], v0, s[4:7], s23 offen offset:1024 sc1
    s_mov_b64 exec, -1
    ds_read_b128 v[88:91], v1 offset:28672
    ds_read_b128 v[92:95], v1 offset:29696
    s_waitcnt lgkmcnt(2)
    s_barrier
    ds_read_b128 v[16:19], v0 offset:12288
    v_smfmac_f32_16x16x64_bf16 v[36:39], v[52:55], a[216:223], v2 abid:1
    ds_read_b128 v[20:23], v0 offset:11264
    ds_read_b128 v[24:27], v0 offset:10240
    v_mov_b32 v1, v1
    s_cbranch_scc1 Ls3_exit
    v_mov_b32 v1, v1
    s_add_u32 s25, s16, 65536
    s_add_u32 s26, s16, 131072
    v_mov_b32 v1, v1
    s_waitcnt lgkmcnt(2)
    v_smfmac_f32_16x16x64_bf16 v[32:35], v[16:19], v[88:95], v2 abid:1
    ds_read_b128 v[64:67], v1 offset:30720
    s_waitcnt lgkmcnt(2)
    v_smfmac_f32_16x16x64_bf16 v[32:35], v[20:23], a[224:231], v2 abid:1
    ds_read_b128 v[68:71], v1 offset:31744
    s_waitcnt lgkmcnt(2)
    v_smfmac_f32_16x16x64_bf16 v[32:35], v[24:27], a[232:239], v2 abid:1
    s_nop 2
    v_smfmac_f32_16x16x64_bf16 v[36:39], v[16:19], a[240:247], v2 abid:1
    s_nop 2
    v_smfmac_f32_16x16x64_bf16 v[36:39], v[20:23], a[248:255], v2 abid:1
    s_waitcnt lgkmcnt(0)
    v_cvt_pk_bf16_f32 v32, v32, v33
    v_smfmac_f32_16x16x64_bf16 v[36:39], v[24:27], v[64:71], v2 abid:1
    s_nop 1
    v_and_or_b32 v32, v32, -2, s18
    v_cvt_pk_bf16_f32 v33, v34, v35
    buffer_store_dwordx2 v[32:33], v6, s[4:7], s16 offen sc1
    s_nop 2
    v_cvt_pk_bf16_f32 v36, v36, v37
    v_and_or_b32 v36, v36, -2, s18
    v_cvt_pk_bf16_f32 v37, v38, v39
    buffer_store_dwordx2 v[36:37], v6, s[4:7], s25 offen sc1
    s_add_u32 s99, s99, 262144
    s_lshr_b32 s23, s99, 8
    s_and_b32 s23, s23, 0x2000
    s_xor_b32 s23, s99, s23
    s_add_u32 s14, s14, 1
    s_add_u32 s98, s98, 1048576
    s_lshr_b32 s22, s98, 8
    s_and_b32 s22, s22, 0x2000
    s_xor_b32 s22, s98, s22
    s_add_u32 s32, s22, 16384
    s_waitcnt vmcnt(0)
    s_xor_b32 s18, s18, 1
    s_barrier
    s_branch Ls3_top
Ls3_exit:
    s_waitcnt vmcnt(0) lgkmcnt(0)
    s_barrier
    s_add_u32 s14, s14, 1
    v_mov_b32 v10, s14
    buffer_store_dword v10, off, s[4:7], s100 sc1
    s_waitcnt vmcnt(0) lgkmcnt(0)
    s_nop 11
    s_endpgm
Ls3_pc:
    buffer_load_dwordx4 v[48:51], v0, s[4:7], s19 offen offset:2048 sc1
    buffer_load_dword v9, v8, s[4:7], s19 offen offset:3840 sc1
    s_sub_u32 s15, s15, 1
    s_cbranch_scc0 Ls3_pb
    s_mov_b32 s15, 0
    s_branch Ls3_pcd
Ls3_rr:
    buffer_load_dwordx4 v[12:15], v0, s[4:7], s21 offen offset:2048 sc1
    buffer_load_dword v11, v8, s[4:7], s21 offen offset:3840 sc1
    s_waitcnt vmcnt(1)
    ds_write_b128 v0, v[12:15] offset:8192
    s_waitcnt vmcnt(0)
    ds_write_b32 v8, v11 offset:9984
    v_max3_u32 v9, v12, v13, v14
    v_max3_u32 v9, v9, v15, v11
    v_cmp_eq_u32 vcc, -1, v9
    s_waitcnt lgkmcnt(0)
    s_cbranch_vccz Ls3_rrd
    s_sub_u32 s15, s15, 1
    s_cbranch_scc0 Ls3_rr
    s_mov_b32 s15, 0
    s_branch Ls3_rrd
Ls3_fb:
    s_waitcnt lgkmcnt(0)
    s_nop 11
    s_barrier
    v_max_f32 v16, v48, v49
    v_max3_f32 v16, v16, v50, v51
    ds_write_b32 v0, v16 offset:12
    s_waitcnt lgkmcnt(0)
    s_barrier
    v_and_b32 v40, 0xff, v0
    ds_read_b128 v[16:19], v40 offset:0
    ds_read_b128 v[20:23], v40 offset:256
    ds_read_b128 v[88:91], v40 offset:512
    ds_read_b128 v[92:95], v40 offset:768
    s_waitcnt lgkmcnt(3)
    v_max_f32 v40, v16, v17
    v_max3_f32 v40, v40, v18, v19
    s_waitcnt lgkmcnt(2)
    v_max3_f32 v40, v40, v20, v21
    v_max3_f32 v40, v40, v22, v23
    s_waitcnt lgkmcnt(1)
    v_max3_f32 v40, v40, v88, v89
    v_max3_f32 v40, v40, v90, v91
    s_waitcnt lgkmcnt(0)
    v_max3_f32 v40, v40, v92, v93
    v_max3_f32 v40, v40, v94, v95
    v_sub_f32 v48, v48, v40
    v_sub_f32 v49, v49, v40
    v_sub_f32 v50, v50, v40
    v_sub_f32 v51, v51, v40
    v_exp_f32 v40, v48
    v_exp_f32 v41, v49
    s_nop 0
    v_cvt_pk_bf16_f32 v40, v40, v41
    ds_write_b32 v0, v40 offset:14348
    v_mov_b32 v21, 0
    v_exp_f32_dpp v52, v50 quad_perm:[0,1,0,1] row_mask:0xf bank_mask:0xf
    v_exp_f32_dpp v53, v51 quad_perm:[0,1,0,1] row_mask:0xf bank_mask:0xf
    v_mov_b32 v22, 0
    v_cvt_pk_bf16_f32 v20, v52, v53
    v_cvt_pk_bf16_f32 v23, v52, v53
    s_waitcnt lgkmcnt(0)
    s_barrier
    ds_read_b128 v[16:19], v5 offset:14336
    s_waitcnt lgkmcnt(0)
    v_mfma_f32_16x16x32_bf16 v[24:27], v[12:15], v[16:19], 0
    s_nop 2
    v_mfma_f32_16x16x32_bf16 v[40:43], v[64:67], v[16:19], 0
    s_nop 1
    s_nop 0
    v_mfma_f32_16x16x32_bf16 v[44:47], v[68:71], v[16:19], 0
    s_nop 1
    s_nop 0
    v_mfma_f32_16x16x16_bf16 v[24:27], v[12:13], v[20:21], v[24:27]
    s_nop 1
    s_nop 0
    v_mfma_f32_16x16x16_bf16 v[40:43], v[10:11], v[20:21], v[40:43]
    s_nop 2
    v_mfma_f32_16x16x16_bf16 v[44:47], v[10:11], v[22:23], v[44:47]
    s_nop 0
    v_rcp_f32 v25, v24
    s_nop 1
    v_mul_f32 v40, v25, v40
    v_mul_f32 v41, v25, v41
    v_mul_f32 v42, v25, v42
    v_mul_f32 v43, v25, v43
    v_cvt_pk_bf16_f32 v52, v40, v41
    v_cvt_pk_bf16_f32 v53, v42, v43
    v_mul_f32 v44, v25, v44
    v_mul_f32 v45, v25, v45
    v_mul_f32 v46, v25, v46
    v_mul_f32 v47, v25, v47
    v_cvt_pk_bf16_f32 v54, v44, v45
    v_cvt_pk_bf16_f32 v55, v46, v47
    ds_write_b128 v0, v[52:55] offset:13312
    s_waitcnt lgkmcnt(0)
    s_nop 11
    s_branch Ls3_fbd

.section .rodata,"a"
.p2align 6
.amdhsa_kernel adaLN_cond__memory_aug_recurrent_mem_tr__mixer_channel_mlp__prompt_kernel
  .amdhsa_next_free_vgpr 512
  .amdhsa_next_free_sgpr 102
  .amdhsa_accum_offset 256
  .amdhsa_group_segment_fixed_size 0
  .amdhsa_kernarg_size 136
  .amdhsa_user_sgpr_count 2
  .amdhsa_user_sgpr_kernarg_segment_ptr 1
  .amdhsa_system_sgpr_workgroup_id_x 1
.end_amdhsa_kernel
```
